```python
import torch

def _softmax(x, axis=-1):
    return torch.softmax(x, dim=axis)
def _gelu(x):
    return torch.nn.functional.gelu(x, approximate="tanh")
def _silu(x):
    return torch.nn.functional.silu(x)
def _sigmoid(x):
    return torch.sigmoid(x)
def _layernorm(x, axis=-1, eps=1e-5):
    m = x.mean(dim=axis, keepdim=True)
    v = x.var(dim=axis, keepdim=True, unbiased=False)
    return (x - m) / torch.sqrt(v + eps)
def _scatter_add(tgt, idx, src, axis=0):
    return tgt.clone().index_add_(axis, idx, src)
def _segment_sum(src, seg, n):
    out = torch.zeros((n,) + src.shape[1:], dtype=src.dtype)
    return out.index_add_(0, seg, src)
def _pad(x, pw):
    flat = tuple(v for pair in reversed(pw) for v in pair)
    return torch.nn.functional.pad(x, flat)

kernel_name = 'recurrent_scan__ssm_conv_s4d__mixer_channel_mlp__prompt'

def setup_inputs():

    _w = (lambda a: (lambda t: t.to(torch.bfloat16) if t.is_floating_point() else t)(torch.as_tensor(a)))
    def _A_setup():
        Bsz, L, D, N = 1, 2048, 576, 128
        return {
            "u": _w((lambda *s: torch.randn(*s, dtype=torch.bfloat16) * 0.05)(Bsz, L, D)),
            "log_A_real": _w((lambda *s: torch.randn(*s, dtype=torch.bfloat16) * 3.2)(D, N) * 0.5),
            "A_imag": _w((lambda *s: torch.randn(*s, dtype=torch.bfloat16) * 0.2)(D, N) * 3.14),
            "C_real": _w((lambda *s: torch.randn(*s, dtype=torch.bfloat16) * 0.4)(D, N) / N ** 0.5),
            "C_imag": _w((lambda *s: torch.randn(*s, dtype=torch.bfloat16) * 0.4)(D, N) / N ** 0.5),
            "log_dt": _w((lambda *s: torch.randn(*s, dtype=torch.bfloat16) * 0.2)(D) * 0.5 - 4.0),
            "D_skip": _w((lambda *s: torch.randn(*s, dtype=torch.bfloat16) * 0.2)(D)),
        }
    _A_in = _A_setup()

    def _B_setup():
        B, S, D, F = 1, 2048, 576, 4608
        return {
            "x": _w((lambda *s: torch.randn(*s, dtype=torch.bfloat16) * 0.05)(B, S, D)),
            "w1": _w((lambda *s: torch.randn(*s, dtype=torch.bfloat16) * 0.8)(D, F) * (D ** -0.5)),
            "b1": _w((lambda *s: torch.randn(*s, dtype=torch.bfloat16) * 0.4)(F)),
            "w2": _w((lambda *s: torch.randn(*s, dtype=torch.bfloat16) * 0.1)(F, D) * (F ** -0.5)),
            "b2": _w((lambda *s: torch.randn(*s, dtype=torch.bfloat16) * 0.1)(D)),
        }
    _B_in = _B_setup()

    return {
        "A_u": _A_in["u"],
        "A_log_A_real": _A_in["log_A_real"],
        "A_A_imag": _A_in["A_imag"],
        "A_C_real": _A_in["C_real"],
        "A_C_imag": _A_in["C_imag"],
        "A_log_dt": _A_in["log_dt"],
        "A_D_skip": _A_in["D_skip"],
        "B_x": _B_in["x"],
        "B_w1": _B_in["w1"],
        "B_b1": _B_in["b1"],
        "B_w2": _B_in["w2"],
        "B_b2": _B_in["b2"],
    }

def reference(A_u, A_log_A_real, A_A_imag, A_C_real, A_C_imag, A_log_dt, A_D_skip, B_x, B_w1, B_b1, B_w2, B_b2):
    def _A_ref(u, log_A_real, A_imag, C_real, C_imag, log_dt, D_skip):
        L = u.shape[1]
        dt = torch.exp(log_dt)
        A = -torch.exp(log_A_real) + 1j * A_imag
        C = (C_real + 1j * C_imag) * dt[:, None]
        pos = (lambda x, dt: x.to(dt))(torch.arange(L), log_dt.dtype)
        P = torch.exp((A * dt[:, None])[:, :, None] * pos[None, None, :])
        K = 2.0 * torch.einsum("dn,dnl->dl", C, P).real
        L2 = 2 * L
        u_t = (lambda x, *d: x.permute(*d))(u, 0, 2, 1)
        Kf = (lambda x, *a, **k: torch.fft.rfft(x.float(), *a, **k))(K, L2)
        Uf = (lambda x, *a, **k: torch.fft.rfft(x.float(), *a, **k))(u_t, L2)
        y = (lambda x, *a, **k: torch.fft.irfft(x, *a, **k).to(torch.bfloat16))(Uf * Kf[None, :, :], L2)[:, :, :L]
        y = (lambda x, *d: x.permute(*d))(y, 0, 2, 1)
        return y + u * D_skip[None, None, :]

    def _B_ref(x, w1, b1, w2, b2):
        y = _layernorm(x, axis=-1)
        h = _gelu(torch.einsum("bsd,df->bsf", y, w1) + b1)
        return torch.einsum("bsf,fd->bsd", h, w2) + b2

    x = A_u
    xn = _layernorm(x, axis=-1)
    s = _A_ref(xn, A_log_A_real, A_A_imag, A_C_real, A_C_imag, A_log_dt, A_D_skip)
    g = _silu(_B_ref(xn, B_w1, B_b1, B_w2, B_b2))
    return x + s * g
```

```asm
; @launch grid=(256,1,1) block=(256,1,1) lds=163840
.amdgcn_target "amdgcn-amd-amdhsa--gfx950"
.text
.globl recurrent_scan__ssm_conv_s4d__mixer_channel_mlp__prompt_kernel
.p2align 8
.type recurrent_scan__ssm_conv_s4d__mixer_channel_mlp__prompt_kernel,@function
recurrent_scan__ssm_conv_s4d__mixer_channel_mlp__prompt_kernel:
    s_getpc_b64 s[6:7]
    L_pc_here:
    s_sub_u32 s6, s6, (L_pc_here - recurrent_scan__ssm_conv_s4d__mixer_channel_mlp__prompt_kernel)
    s_subb_u32 s7, s7, 0
    s_lshr_b32 s3, s2, 3
    s_and_b32 s3, s3, 31
    s_mul_i32 s3, s3, 0xa00
    v_lshlrev_b32 v2, 4, v0
    v_add_u32 v2, s3, v2
    v_min_u32 v2, 0x13f40, v2
    v_mov_b32 v3, s7
    v_add_co_u32 v2, vcc, s6, v2
    s_nop 1
    v_addc_co_u32 v3, vcc, 0, v3, vcc
    global_load_dwordx4 v[252:255], v[2:3], off

    s_cmp_ge_u32 s2, 256
    s_cbranch_scc1 L_main_done
    s_load_dwordx2 s[4:5], s[0:1], 64
    s_load_dwordx2 s[6:7], s[0:1], 80
    s_load_dwordx2 s[52:53], s[0:1], 112
    s_load_dwordx2 s[54:55], s[0:1], 72
    s_load_dwordx2 s[56:57], s[0:1], 0
    s_load_dwordx2 s[58:59], s[0:1], 96
    s_load_dwordx2 s[60:61], s[0:1], 88
    v_lshrrev_b32 v61, 6, v0
    v_and_b32 v60, 63, v0
    s_nop 0
    v_readfirstlane_b32 s36, v61
    s_waitcnt lgkmcnt(0)

    s_mov_b32 s8, s4
    s_mov_b32 s9, s5
    s_mov_b32 s10, 5308416
    s_mov_b32 s11, 0x20000

    s_mov_b32 s12, s6
    s_mov_b32 s13, s7
    s_mov_b32 s14, 5308416
    s_mov_b32 s15, 0x20000

    s_mov_b32 s16, s52
    s_mov_b32 s17, s53
    s_mov_b32 s18, 268435456
    s_mov_b32 s19, 0x20000

    s_mov_b32 s20, s54
    s_mov_b32 s21, s55
    s_mov_b32 s22, 9216
    s_mov_b32 s23, 0x20000

    s_mov_b32 s24, s56
    s_mov_b32 s25, s57
    s_mov_b32 s26, 2359296
    s_mov_b32 s27, 0x20000

    s_mov_b32 s28, s58
    s_mov_b32 s29, s59
    s_mov_b32 s30, 2359296
    s_mov_b32 s31, 0x20000

    s_mov_b32 s32, s60
    s_mov_b32 s33, s61
    s_mov_b32 s34, 1152
    s_mov_b32 s35, 0x20000

    s_cmp_ge_u32 s2, 192
    s_cbranch_scc1 L_conv_role
    v_and_b32 v65, 31, v0
    v_lshrrev_b32 v66, 5, v0
    s_lshl_b32 s91, s2, 3
    v_add_u32 v67, s91, v66
    v_mul_u32_u24 v67, 1152, v67
    v_lshl_add_u32 v67, v65, 2, v67

    buffer_load_dword v92, v67, s[24:27], 0 offen offset:0
    buffer_load_dword v93, v67, s[24:27], 0 offen offset:128
    buffer_load_dword v94, v67, s[24:27], 0 offen offset:256
    buffer_load_dword v95, v67, s[24:27], 0 offen offset:384
    buffer_load_dword v96, v67, s[24:27], 0 offen offset:512
    buffer_load_dword v97, v67, s[24:27], 0 offen offset:640
    buffer_load_dword v98, v67, s[24:27], 0 offen offset:768
    buffer_load_dword v99, v67, s[24:27], 0 offen offset:896
    buffer_load_dword v100, v67, s[24:27], 0 offen offset:1024
    v_mov_b32 v120, 42070016

    buffer_load_dword v121, v120, s[16:19], 0 offen sc1

    s_and_b32 s3, s2, 7
    s_lshr_b32 s4, s2, 3
    s_mul_i32 s5, s4, 171
    s_lshr_b32 s5, s5, 9
    s_mul_i32 s6, s5, 3
    s_sub_u32 s6, s4, s6
    s_lshr_b32 s7, s3, 1
    s_mul_i32 s7, s7, 3
    s_add_u32 s40, s7, s6
    s_and_b32 s7, s3, 1
    s_lshl_b32 s7, s7, 3
    s_add_u32 s39, s7, s5
    s_mul_i32 s45, s36, 6144
    s_mul_i32 s3, s39, 147456
    s_add_u32 s3, s3, s45
    s_add_u32 s44, s3, 0
    v_lshlrev_b32 v38, 4, v60
    s_mul_i32 s3, s36, 221184
    s_mul_i32 s4, s40, 768
    s_add_u32 s41, s3, s4
    s_mul_i32 s47, s36, 3072
    v_lshrrev_b32 v2, 3, v60
    v_and_b32 v3, 7, v60
    v_lshrrev_b32 v4, 1, v3
    v_and_b32 v5, 2, v2
    v_xor_b32 v4, v4, v5
    v_lshlrev_b32 v4, 1, v4
    v_and_b32 v3, 1, v3
    v_or_b32 v4, v4, v3
    v_lshlrev_b32 v7, 4, v4
    v_mul_u32_u24 v5, 9216, v2
    v_mov_b32 v6, v2
    v_add_u32 v32, v5, v7
    v_add_u32 v33, 72704, v32
    v_add_u32 v34, 145408, v32
    s_mul_i32 s3, s40, 768
    v_min_u32 v2, 95, v0
    v_lshlrev_b32 v2, 3, v2
    v_add_u32 v8, s3, v2

    buffer_load_dwordx2 v[160:161], v8, s[20:23], 0 offen
    s_add_u32 m0, s47, 98304
    s_add_u32 s62, s41, 0
    buffer_load_dwordx4 v32, s[8:11], s62 offen lds
    buffer_load_dwordx4 v33, s[8:11], s62 offen offset:1024 lds
    buffer_load_dwordx4 v34, s[8:11], s62 offen offset:2048 lds
    s_add_u32 m0, s47, 110592
    s_add_u32 s62, s41, 884736
    buffer_load_dwordx4 v32, s[8:11], s62 offen lds
    buffer_load_dwordx4 v33, s[8:11], s62 offen offset:1024 lds
    buffer_load_dwordx4 v34, s[8:11], s62 offen offset:2048 lds
    s_add_u32 m0, s47, 122880
    s_add_u32 s62, s41, 1769472
    buffer_load_dwordx4 v32, s[8:11], s62 offen lds
    buffer_load_dwordx4 v33, s[8:11], s62 offen offset:1024 lds
    buffer_load_dwordx4 v34, s[8:11], s62 offen offset:2048 lds
    s_load_dwordx4 s[4:7], s[0:1], 8
    s_load_dwordx2 s[62:63], s[0:1], 24
    s_load_dwordx2 s[64:65], s[0:1], 32
    s_load_dwordx2 s[60:61], s[0:1], 40
    s_waitcnt lgkmcnt(0)

    s_mov_b32 s20, s4
    s_mov_b32 s21, s5
    s_mov_b32 s22, 147456
    s_mov_b32 s23, 0x20000
    s_mov_b32 s24, s6
    s_mov_b32 s25, s7
    s_mov_b32 s26, 147456
    s_mov_b32 s27, 0x20000
    s_mov_b32 s28, s62
    s_mov_b32 s29, s63
    s_mov_b32 s30, 147456
    s_mov_b32 s31, 0x20000
    s_mov_b32 s32, s64
    s_mov_b32 s33, s65
    s_mov_b32 s34, 147456
    s_mov_b32 s35, 0x20000
    s_mov_b32 s4, s60
    s_mov_b32 s5, s61
    s_mov_b32 s6, 1152
    s_mov_b32 s7, 0x20000
    s_lshl_b32 s54, s2, 1
    s_lshr_b32 s56, s36, 1
    s_add_u32 s54, s54, s56
    s_min_u32 s54, s54, 575
    s_and_b32 s57, s36, 1
    s_lshl_b32 s59, s57, 4
    s_mul_i32 s55, s36, 17664
    s_add_u32 s55, s55, 24576
    v_and_b32 v1, 63, v0
    v_lshlrev_b32 v3, 2, v1

    s_lshl_b32 s60, s54, 8
    buffer_load_dword v32, v3, s[20:23], s60 offen
    buffer_load_dword v33, v3, s[24:27], s60 offen
    buffer_load_dword v34, v3, s[28:31], s60 offen
    buffer_load_dword v35, v3, s[32:35], s60 offen
    s_lshl_b32 s61, s54, 1
    v_mov_b32 v6, s61
    buffer_load_ushort v36, v6, s[4:7], 0 offen
    v_add_u32 v4, s55, v3
    v_and_b32 v30, 15, v1
    v_lshrrev_b32 v31, 4, v1
    v_mul_u32_u24 v5, 272, v30
    v_lshl_add_u32 v5, v31, 4, v5
    v_add_u32 v5, s55, v5
    v_lshlrev_b32 v7, 4, v1
    s_or_b32 s62, s57, 0
    s_sub_u32 s63, 1, s57
    s_mul_i32 s63, s63, 17664
    s_add_u32 s63, s63, s55
    v_add_u32 v7, s63, v7
    v_lshlrev_b32 v24, 6, v31
    v_lshl_add_u32 v25, v30, 2, v24
    v_lshl_add_u32 v26, v30, 1, v24
    v_cmp_gt_u32 vcc, 2, v31

    v_add_u32 v27, 0, v25
    v_add_u32 v28, 0, v26
    v_cndmask_b32 v27, v28, v27, vcc
    v_lshlrev_b32 v27, 2, v27
    v_add_u32 v8, s55, v27
    v_add_u32 v27, 1, v25
    v_add_u32 v28, 1, v26
    v_cndmask_b32 v27, v28, v27, vcc
    v_lshlrev_b32 v27, 2, v27
    v_add_u32 v9, s55, v27
    v_add_u32 v27, 2, v25
    v_add_u32 v28, 32, v26
    v_cndmask_b32 v27, v28, v27, vcc
    v_lshlrev_b32 v27, 2, v27
    v_add_u32 v10, s55, v27
    v_add_u32 v27, 3, v25
    v_add_u32 v28, 33, v26
    v_cndmask_b32 v27, v28, v27, vcc
    v_lshlrev_b32 v27, 2, v27
    v_add_u32 v11, s55, v27
    v_add_u32 v25, v24, v30
    v_cmp_eq_u32 s[64:65], 47, v1
    v_add_u32 v27, 256, v25
    v_mov_b32 v28, 400
    v_cndmask_b32 v27, v28, v27, vcc
    v_mov_b32 v28, 384
    s_nop 0
    v_cndmask_b32 v27, v27, v28, s[64:65]
    v_lshlrev_b32 v27, 2, v27
    v_add_u32 v12, s55, v27
    v_add_u32 v27, 272, v25
    v_mov_b32 v28, 400
    v_cndmask_b32 v27, v28, v27, vcc
    v_lshlrev_b32 v27, 2, v27
    v_add_u32 v13, s55, v27
    v_add_u32 v27, 288, v25
    v_mov_b32 v28, 400
    v_cndmask_b32 v27, v28, v27, vcc
    v_lshlrev_b32 v27, 2, v27
    v_add_u32 v14, s55, v27
    v_add_u32 v27, 304, v25
    v_mov_b32 v28, 400
    v_cndmask_b32 v27, v28, v27, vcc
    v_lshlrev_b32 v27, 2, v27
    v_add_u32 v15, s55, v27
    v_lshrrev_b32 v24, 1, v31
    v_lshl_add_u32 v24, v24, 4, v30
    v_and_b32 v25, 1, v31
    v_lshlrev_b32 v25, 3, v25
    v_and_b32 v27, 3, v24
    v_lshrrev_b32 v28, 2, v24
    v_lshlrev_b32 v27, 10, v27
    v_lshl_add_u32 v16, v28, 4, v27

    v_add_u32 v16, v16, v25
    v_lshrrev_b32 v24, 1, v1
    v_add_u32 v24, 32, v24
    v_and_b32 v25, 1, v1
    v_lshlrev_b32 v25, 3, v25
    v_and_b32 v27, 3, v24
    v_lshrrev_b32 v28, 2, v24
    v_lshlrev_b32 v27, 10, v27
    v_lshl_add_u32 v20, v28, 4, v27

    v_add_u32 v20, v20, v25
    v_add_u32 v24, 64, v1
    v_and_b32 v27, 3, v24
    v_lshrrev_b32 v28, 2, v24
    v_lshlrev_b32 v27, 10, v27
    v_lshl_add_u32 v21, v28, 4, v27

    v_lshlrev_b32 v24, 1, v1
    v_add_u32 v24, 128, v24
    v_and_b32 v27, 3, v24
    v_lshrrev_b32 v28, 2, v24
    v_lshlrev_b32 v27, 10, v27
    v_lshl_add_u32 v22, v28, 4, v27

    v_lshlrev_b32 v24, 3, v1
    v_add_u32 v17, s55, v24
    v_add_u32 v18, 512, v17
    v_add_u32 v19, 1024, v17
    v_mul_u32_u24 v68, 1184, v66
    v_lshl_add_u32 v68, v65, 2, v68
    v_add_u32 v68, 0, v68
    v_lshrrev_b32 v69, 6, v0
    v_mul_u32_u24 v69, 2304, v69
    v_bfe_u32 v70, v0, 5, 1
    v_lshlrev_b32 v71, 3, v65
    v_lshl_add_u32 v71, v70, 2, v71
    v_add_u32 v69, v69, v71
    v_add_u32 v69, 9472, v69
    v_mov_b32 v72, 0x05040100
    v_mov_b32 v73, 0x07060302
    v_cmp_eq_u32 vcc, 1, v70
    s_nop 1
    v_cndmask_b32 v72, v72, v73, vcc
    s_waitcnt vmcnt(15)
    v_add_u32 v121, 16, v121
    v_and_b32 v121, 0xfffffff0, v121
    v_or_b32 v121, 0x80000000, v121
    s_nop 0
    v_readfirstlane_b32 s90, v121

    v_lshlrev_b32 v74, 16, v92
    v_and_b32 v75, 0xffff0000, v92
    v_lshlrev_b32 v76, 16, v93
    v_and_b32 v77, 0xffff0000, v93
    v_lshlrev_b32 v78, 16, v94
    v_and_b32 v79, 0xffff0000, v94
    v_lshlrev_b32 v80, 16, v95
    v_and_b32 v81, 0xffff0000, v95
    v_lshlrev_b32 v82, 16, v96
    v_and_b32 v83, 0xffff0000, v96
    v_lshlrev_b32 v84, 16, v97
    v_and_b32 v85, 0xffff0000, v97
    v_lshlrev_b32 v86, 16, v98
    v_and_b32 v87, 0xffff0000, v98
    v_lshlrev_b32 v88, 16, v99
    v_and_b32 v89, 0xffff0000, v99
    v_lshlrev_b32 v90, 16, v100
    v_and_b32 v91, 0xffff0000, v100
    v_pk_add_f32 v[106:107], v[74:75], v[76:77]
    v_pk_add_f32 v[106:107], v[106:107], v[78:79]
    v_pk_add_f32 v[106:107], v[106:107], v[80:81]
    v_pk_add_f32 v[106:107], v[106:107], v[82:83]
    v_pk_add_f32 v[106:107], v[106:107], v[84:85]
    v_pk_add_f32 v[106:107], v[106:107], v[86:87]
    v_pk_add_f32 v[106:107], v[106:107], v[88:89]
    v_pk_add_f32 v[106:107], v[106:107], v[90:91]
    v_add_f32 v102, v106, v107
    s_nop 1
    v_add_f32_dpp v102, v102, v102 quad_perm:[1,0,3,2] row_mask:0xf bank_mask:0xf
    s_nop 1
    v_add_f32_dpp v102, v102, v102 quad_perm:[2,3,0,1] row_mask:0xf bank_mask:0xf
    s_nop 1
    v_add_f32_dpp v102, v102, v102 row_half_mirror row_mask:0xf bank_mask:0xf
    s_nop 1
    v_add_f32_dpp v102, v102, v102 row_mirror row_mask:0xf bank_mask:0xf
    s_nop 0
    v_mov_b32 v103, v102
    s_nop 1
    v_permlane16_swap_b32 v102, v103
    s_nop 1
    v_add_f32 v102, v102, v103

    v_mul_f32 v102, 0x3ae38e39, v102
    v_sub_f32 v104, 0, v102
    v_mov_b32 v105, v104
    v_pk_add_f32 v[108:109], v[74:75], v[104:105]
    v_pk_mul_f32 v[106:107], v[108:109], v[108:109]
    v_pk_add_f32 v[108:109], v[76:77], v[104:105]
    v_pk_fma_f32 v[106:107], v[108:109], v[108:109], v[106:107]
    v_pk_add_f32 v[108:109], v[78:79], v[104:105]
    v_pk_fma_f32 v[106:107], v[108:109], v[108:109], v[106:107]
    v_pk_add_f32 v[108:109], v[80:81], v[104:105]
    v_pk_fma_f32 v[106:107], v[108:109], v[108:109], v[106:107]
    v_pk_add_f32 v[108:109], v[82:83], v[104:105]
    v_pk_fma_f32 v[106:107], v[108:109], v[108:109], v[106:107]
    v_pk_add_f32 v[108:109], v[84:85], v[104:105]
    v_pk_fma_f32 v[106:107], v[108:109], v[108:109], v[106:107]
    v_pk_add_f32 v[108:109], v[86:87], v[104:105]
    v_pk_fma_f32 v[106:107], v[108:109], v[108:109], v[106:107]
    v_pk_add_f32 v[108:109], v[88:89], v[104:105]
    v_pk_fma_f32 v[106:107], v[108:109], v[108:109], v[106:107]
    v_pk_add_f32 v[108:109], v[90:91], v[104:105]
    v_pk_fma_f32 v[106:107], v[108:109], v[108:109], v[106:107]
    v_add_f32 v106, v106, v107
    s_nop 1
    v_add_f32_dpp v106, v106, v106 quad_perm:[1,0,3,2] row_mask:0xf bank_mask:0xf
    s_nop 1
    v_add_f32_dpp v106, v106, v106 quad_perm:[2,3,0,1] row_mask:0xf bank_mask:0xf
    s_nop 1
    v_add_f32_dpp v106, v106, v106 row_half_mirror row_mask:0xf bank_mask:0xf
    s_nop 1
    v_add_f32_dpp v106, v106, v106 row_mirror row_mask:0xf bank_mask:0xf
    s_nop 0
    v_mov_b32 v103, v106
    s_nop 1
    v_permlane16_swap_b32 v106, v103
    s_nop 1
    v_add_f32 v106, v106, v103

    v_mul_f32 v106, 0x3ae38e39, v106
    v_cvt_pk_bf16_f32 v106, v106, v106
    v_and_b32 v106, 0xffff0000, v106
    v_add_f32 v106, 0x3727c5ac, v106
    v_cvt_pk_bf16_f32 v106, v106, v106
    v_and_b32 v106, 0xffff0000, v106
    v_sqrt_f32 v106, v106
    s_nop 0
    v_cvt_pk_bf16_f32 v106, v106, v106
    v_and_b32 v106, 0xffff0000, v106
    v_rcp_f32 v108, v106
    v_cvt_pk_bf16_f32 v102, v102, v102
    v_and_b32 v102, 0xffff0000, v102
    v_sub_f32 v104, 0, v102
    v_mov_b32 v105, v104
    v_mov_b32 v109, v108
    v_pk_add_f32 v[74:75], v[74:75], v[104:105]
    v_cvt_pk_bf16_f32 v92, v74, v75
    v_pk_add_f32 v[76:77], v[76:77], v[104:105]
    v_cvt_pk_bf16_f32 v93, v76, v77
    v_pk_add_f32 v[78:79], v[78:79], v[104:105]
    v_cvt_pk_bf16_f32 v94, v78, v79
    v_pk_add_f32 v[80:81], v[80:81], v[104:105]
    v_cvt_pk_bf16_f32 v95, v80, v81
    v_pk_add_f32 v[82:83], v[82:83], v[104:105]
    v_cvt_pk_bf16_f32 v96, v82, v83
    v_pk_add_f32 v[84:85], v[84:85], v[104:105]
    v_cvt_pk_bf16_f32 v97, v84, v85
    v_pk_add_f32 v[86:87], v[86:87], v[104:105]
    v_cvt_pk_bf16_f32 v98, v86, v87
    v_pk_add_f32 v[88:89], v[88:89], v[104:105]
    v_cvt_pk_bf16_f32 v99, v88, v89
    v_pk_add_f32 v[90:91], v[90:91], v[104:105]
    v_cvt_pk_bf16_f32 v100, v90, v91
    v_lshlrev_b32 v74, 16, v92
    v_and_b32 v75, 0xffff0000, v92
    v_pk_mul_f32 v[74:75], v[74:75], v[108:109]
    v_cvt_pk_bf16_f32 v92, v74, v75
    v_lshlrev_b32 v76, 16, v93
    v_and_b32 v77, 0xffff0000, v93
    v_pk_mul_f32 v[76:77], v[76:77], v[108:109]
    v_cvt_pk_bf16_f32 v93, v76, v77
    v_lshlrev_b32 v78, 16, v94
    v_and_b32 v79, 0xffff0000, v94
    v_pk_mul_f32 v[78:79], v[78:79], v[108:109]
    v_cvt_pk_bf16_f32 v94, v78, v79
    v_lshlrev_b32 v80, 16, v95
    v_and_b32 v81, 0xffff0000, v95
    v_pk_mul_f32 v[80:81], v[80:81], v[108:109]
    v_cvt_pk_bf16_f32 v95, v80, v81
    v_lshlrev_b32 v82, 16, v96
    v_and_b32 v83, 0xffff0000, v96
    v_pk_mul_f32 v[82:83], v[82:83], v[108:109]
    v_cvt_pk_bf16_f32 v96, v82, v83
    v_lshlrev_b32 v84, 16, v97
    v_and_b32 v85, 0xffff0000, v97
    v_pk_mul_f32 v[84:85], v[84:85], v[108:109]
    v_cvt_pk_bf16_f32 v97, v84, v85
    v_lshlrev_b32 v86, 16, v98
    v_and_b32 v87, 0xffff0000, v98
    v_pk_mul_f32 v[86:87], v[86:87], v[108:109]
    v_cvt_pk_bf16_f32 v98, v86, v87
    v_lshlrev_b32 v88, 16, v99
    v_and_b32 v89, 0xffff0000, v99
    v_pk_mul_f32 v[88:89], v[88:89], v[108:109]
    v_cvt_pk_bf16_f32 v99, v88, v89
    v_lshlrev_b32 v90, 16, v100
    v_and_b32 v91, 0xffff0000, v100
    v_pk_mul_f32 v[90:91], v[90:91], v[108:109]
    v_cvt_pk_bf16_f32 v100, v90, v91
    v_lshlrev_b32 v74, 16, v92
    v_and_b32 v75, 0xffff0000, v92
    v_lshlrev_b32 v76, 16, v93
    v_and_b32 v77, 0xffff0000, v93
    v_lshlrev_b32 v78, 16, v94
    v_and_b32 v79, 0xffff0000, v94
    v_lshlrev_b32 v80, 16, v95
    v_and_b32 v81, 0xffff0000, v95
    v_lshlrev_b32 v82, 16, v96
    v_and_b32 v83, 0xffff0000, v96
    v_lshlrev_b32 v84, 16, v97
    v_and_b32 v85, 0xffff0000, v97
    v_lshlrev_b32 v86, 16, v98
    v_and_b32 v87, 0xffff0000, v98
    v_lshlrev_b32 v88, 16, v99
    v_and_b32 v89, 0xffff0000, v99
    v_lshlrev_b32 v90, 16, v100
    v_and_b32 v91, 0xffff0000, v100
    v_cvt_pk_f16_f32 v110, v74, v75
    v_cvt_pk_f16_f32 v111, v76, v77
    v_cvt_pk_f16_f32 v112, v78, v79
    v_cvt_pk_f16_f32 v113, v80, v81
    v_cvt_pk_f16_f32 v114, v82, v83
    v_cvt_pk_f16_f32 v115, v84, v85
    v_cvt_pk_f16_f32 v116, v86, v87
    v_cvt_pk_f16_f32 v117, v88, v89
    v_cvt_pk_f16_f32 v118, v90, v91
    v_mov_b32 v124, v110
    v_mov_b32 v125, v111
    v_mov_b32 v126, v112
    v_mov_b32 v127, v113
    v_mov_b32 v128, v114
    v_mov_b32 v129, v115
    v_mov_b32 v130, v116
    v_mov_b32 v131, v117
    v_mov_b32 v132, v118
    v_permlane32_swap_b32 v110, v124
    v_permlane32_swap_b32 v111, v125
    v_permlane32_swap_b32 v112, v126
    v_permlane32_swap_b32 v113, v127
    v_permlane32_swap_b32 v114, v128
    v_permlane32_swap_b32 v115, v129
    v_permlane32_swap_b32 v116, v130
    v_permlane32_swap_b32 v117, v131
    v_permlane32_swap_b32 v118, v132
    s_nop 0
    v_perm_b32 v110, v124, v110, v72
    v_perm_b32 v111, v125, v111, v72
    v_perm_b32 v112, v126, v112, v72
    v_perm_b32 v113, v127, v113, v72
    v_perm_b32 v114, v128, v114, v72
    v_perm_b32 v115, v129, v115, v72
    v_perm_b32 v116, v130, v116, v72
    v_perm_b32 v117, v131, v117, v72
    v_perm_b32 v118, v132, v118, v72
    ds_write_b32 v69, v110 offset:0
    ds_write_b32 v69, v111 offset:256
    ds_write_b32 v69, v112 offset:512
    ds_write_b32 v69, v113 offset:768
    ds_write_b32 v69, v114 offset:1024
    ds_write_b32 v69, v115 offset:1280
    ds_write_b32 v69, v116 offset:1536
    ds_write_b32 v69, v117 offset:1792
    ds_write_b32 v69, v118 offset:2048
    v_pk_add_f32 v[106:107], v[74:75], v[76:77]
    v_pk_add_f32 v[106:107], v[106:107], v[78:79]
    v_pk_add_f32 v[106:107], v[106:107], v[80:81]
    v_pk_add_f32 v[106:107], v[106:107], v[82:83]
    v_pk_add_f32 v[106:107], v[106:107], v[84:85]
    v_pk_add_f32 v[106:107], v[106:107], v[86:87]
    v_pk_add_f32 v[106:107], v[106:107], v[88:89]
    v_pk_add_f32 v[106:107], v[106:107], v[90:91]
    v_add_f32 v102, v106, v107
    s_nop 1
    v_add_f32_dpp v102, v102, v102 quad_perm:[1,0,3,2] row_mask:0xf bank_mask:0xf
    s_nop 1
    v_add_f32_dpp v102, v102, v102 quad_perm:[2,3,0,1] row_mask:0xf bank_mask:0xf
    s_nop 1
    v_add_f32_dpp v102, v102, v102 row_half_mirror row_mask:0xf bank_mask:0xf
    s_nop 1
    v_add_f32_dpp v102, v102, v102 row_mirror row_mask:0xf bank_mask:0xf
    s_nop 0
    v_mov_b32 v103, v102
    s_nop 1
    v_permlane16_swap_b32 v102, v103
    s_nop 1
    v_add_f32 v102, v102, v103

    v_mul_f32 v102, 0x3ae38e39, v102
    v_sub_f32 v104, 0, v102
    v_mov_b32 v105, v104
    v_pk_add_f32 v[108:109], v[74:75], v[104:105]
    v_pk_mul_f32 v[106:107], v[108:109], v[108:109]
    v_pk_add_f32 v[108:109], v[76:77], v[104:105]
    v_pk_fma_f32 v[106:107], v[108:109], v[108:109], v[106:107]
    v_pk_add_f32 v[108:109], v[78:79], v[104:105]
    v_pk_fma_f32 v[106:107], v[108:109], v[108:109], v[106:107]
    v_pk_add_f32 v[108:109], v[80:81], v[104:105]
    v_pk_fma_f32 v[106:107], v[108:109], v[108:109], v[106:107]
    v_pk_add_f32 v[108:109], v[82:83], v[104:105]
    v_pk_fma_f32 v[106:107], v[108:109], v[108:109], v[106:107]
    v_pk_add_f32 v[108:109], v[84:85], v[104:105]
    v_pk_fma_f32 v[106:107], v[108:109], v[108:109], v[106:107]
    v_pk_add_f32 v[108:109], v[86:87], v[104:105]
    v_pk_fma_f32 v[106:107], v[108:109], v[108:109], v[106:107]
    v_pk_add_f32 v[108:109], v[88:89], v[104:105]
    v_pk_fma_f32 v[106:107], v[108:109], v[108:109], v[106:107]
    v_pk_add_f32 v[108:109], v[90:91], v[104:105]
    v_pk_fma_f32 v[106:107], v[108:109], v[108:109], v[106:107]
    v_add_f32 v106, v106, v107
    s_nop 1
    v_add_f32_dpp v106, v106, v106 quad_perm:[1,0,3,2] row_mask:0xf bank_mask:0xf
    s_nop 1
    v_add_f32_dpp v106, v106, v106 quad_perm:[2,3,0,1] row_mask:0xf bank_mask:0xf
    s_nop 1
    v_add_f32_dpp v106, v106, v106 row_half_mirror row_mask:0xf bank_mask:0xf
    s_nop 1
    v_add_f32_dpp v106, v106, v106 row_mirror row_mask:0xf bank_mask:0xf
    s_nop 0
    v_mov_b32 v103, v106
    s_nop 1
    v_permlane16_swap_b32 v106, v103
    s_nop 1
    v_add_f32 v106, v106, v103

    v_mul_f32 v106, 0x3ae38e39, v106
    v_cvt_pk_bf16_f32 v106, v106, v106
    v_and_b32 v106, 0xffff0000, v106
    v_add_f32 v106, 0x3727c5ac, v106
    v_cvt_pk_bf16_f32 v106, v106, v106
    v_and_b32 v106, 0xffff0000, v106
    v_sqrt_f32 v106, v106
    s_nop 0
    v_cvt_pk_bf16_f32 v106, v106, v106
    v_and_b32 v106, 0xffff0000, v106
    v_rcp_f32 v108, v106
    v_cvt_pk_bf16_f32 v102, v102, v102
    v_and_b32 v102, 0xffff0000, v102
    v_sub_f32 v104, 0, v102
    v_mov_b32 v105, v104
    v_mov_b32 v109, v108
    v_pk_add_f32 v[74:75], v[74:75], v[104:105]
    v_cvt_pk_bf16_f32 v92, v74, v75
    v_pk_add_f32 v[76:77], v[76:77], v[104:105]
    v_cvt_pk_bf16_f32 v93, v76, v77
    v_pk_add_f32 v[78:79], v[78:79], v[104:105]
    v_cvt_pk_bf16_f32 v94, v78, v79
    v_pk_add_f32 v[80:81], v[80:81], v[104:105]
    v_cvt_pk_bf16_f32 v95, v80, v81
    v_pk_add_f32 v[82:83], v[82:83], v[104:105]
    v_cvt_pk_bf16_f32 v96, v82, v83
    v_pk_add_f32 v[84:85], v[84:85], v[104:105]
    v_cvt_pk_bf16_f32 v97, v84, v85
    v_pk_add_f32 v[86:87], v[86:87], v[104:105]
    v_cvt_pk_bf16_f32 v98, v86, v87
    v_pk_add_f32 v[88:89], v[88:89], v[104:105]
    v_cvt_pk_bf16_f32 v99, v88, v89
    v_pk_add_f32 v[90:91], v[90:91], v[104:105]
    v_cvt_pk_bf16_f32 v100, v90, v91
    v_lshlrev_b32 v74, 16, v92
    v_and_b32 v75, 0xffff0000, v92
    v_pk_mul_f32 v[74:75], v[74:75], v[108:109]
    v_cvt_pk_bf16_f32 v92, v74, v75
    v_lshlrev_b32 v76, 16, v93
    v_and_b32 v77, 0xffff0000, v93
    v_pk_mul_f32 v[76:77], v[76:77], v[108:109]
    v_cvt_pk_bf16_f32 v93, v76, v77
    v_lshlrev_b32 v78, 16, v94
    v_and_b32 v79, 0xffff0000, v94
    v_pk_mul_f32 v[78:79], v[78:79], v[108:109]
    v_cvt_pk_bf16_f32 v94, v78, v79
    v_lshlrev_b32 v80, 16, v95
    v_and_b32 v81, 0xffff0000, v95
    v_pk_mul_f32 v[80:81], v[80:81], v[108:109]
    v_cvt_pk_bf16_f32 v95, v80, v81
    v_lshlrev_b32 v82, 16, v96
    v_and_b32 v83, 0xffff0000, v96
    v_pk_mul_f32 v[82:83], v[82:83], v[108:109]
    v_cvt_pk_bf16_f32 v96, v82, v83
    v_lshlrev_b32 v84, 16, v97
    v_and_b32 v85, 0xffff0000, v97
    v_pk_mul_f32 v[84:85], v[84:85], v[108:109]
    v_cvt_pk_bf16_f32 v97, v84, v85
    v_lshlrev_b32 v86, 16, v98
    v_and_b32 v87, 0xffff0000, v98
    v_pk_mul_f32 v[86:87], v[86:87], v[108:109]
    v_cvt_pk_bf16_f32 v98, v86, v87
    v_lshlrev_b32 v88, 16, v99
    v_and_b32 v89, 0xffff0000, v99
    v_pk_mul_f32 v[88:89], v[88:89], v[108:109]
    v_cvt_pk_bf16_f32 v99, v88, v89
    v_lshlrev_b32 v90, 16, v100
    v_and_b32 v91, 0xffff0000, v100
    v_pk_mul_f32 v[90:91], v[90:91], v[108:109]
    v_cvt_pk_bf16_f32 v100, v90, v91
    v_lshlrev_b32 v74, 16, v92
    v_and_b32 v75, 0xffff0000, v92
    v_lshlrev_b32 v76, 16, v93
    v_and_b32 v77, 0xffff0000, v93
    v_lshlrev_b32 v78, 16, v94
    v_and_b32 v79, 0xffff0000, v94
    v_lshlrev_b32 v80, 16, v95
    v_and_b32 v81, 0xffff0000, v95
    v_lshlrev_b32 v82, 16, v96
    v_and_b32 v83, 0xffff0000, v96
    v_lshlrev_b32 v84, 16, v97
    v_and_b32 v85, 0xffff0000, v97
    v_lshlrev_b32 v86, 16, v98
    v_and_b32 v87, 0xffff0000, v98
    v_lshlrev_b32 v88, 16, v99
    v_and_b32 v89, 0xffff0000, v99
    v_lshlrev_b32 v90, 16, v100
    v_and_b32 v91, 0xffff0000, v100
    ds_write_b32 v68, v92 offset:0
    ds_write_b32 v68, v93 offset:128
    ds_write_b32 v68, v94 offset:256
    ds_write_b32 v68, v95 offset:384
    ds_write_b32 v68, v96 offset:512
    ds_write_b32 v68, v97 offset:640
    ds_write_b32 v68, v98 offset:768
    ds_write_b32 v68, v99 offset:896
    ds_write_b32 v68, v100 offset:1024
    v_and_b32 v65, 7, v0
    v_bfe_u32 v66, v0, 3, 1
    v_lshrrev_b32 v67, 4, v0
    v_mul_u32_u24 v68, 1184, v65
    v_lshl_add_u32 v68, v66, 4, v68
    v_lshl_add_u32 v68, v67, 5, v68
    v_add_u32 v68, 0, v68
    s_lshr_b32 s94, s2, 4
    s_mul_i32 s94, s94, 147456
    s_bfe_u32 s95, s2, 0x20002
    s_lshl_b32 s95, s95, 10
    s_add_u32 s94, s94, s95
    s_and_b32 s95, s2, 3
    s_lshl_b32 s95, s95, 7
    s_add_u32 s94, s94, s95
    s_add_u32 s94, s94, 0
    v_lshlrev_b32 v69, 12, v67
    v_lshl_add_u32 v69, v66, 9, v69
    v_lshl_add_u32 v69, v65, 4, v69
    v_lshlrev_b32 v70, 2, v0
    v_add_u32 v70, 9472, v70
    v_lshlrev_b32 v71, 4, v0
    s_mul_i32 s96, s2, 9216
    s_add_u32 s96, s96, 2359296
    s_waitcnt lgkmcnt(0)
    s_barrier
    s_waitcnt vmcnt(0)

    ds_read_b128 v[76:79], v68 offset:0
    ds_read_b32 v80, v70 offset:0
    ds_read_b32 v81, v70 offset:2304
    ds_read_b32 v82, v70 offset:4608
    ds_read_b32 v83, v70 offset:6912
    ds_read_b128 v[84:87], v68 offset:512
    ds_read_b32 v88, v70 offset:1024
    ds_read_b32 v89, v70 offset:3328
    ds_read_b32 v90, v70 offset:5632
    ds_read_b32 v91, v70 offset:7936
    s_cmp_lg_u32 s36, 0
    s_cbranch_scc1 L_ln_skip_m
    ds_read_b128 v[92:95], v68 offset:1024
    ds_read_b32 v96, v70 offset:2048
    ds_read_b32 v97, v70 offset:4352
    ds_read_b32 v98, v70 offset:6656
    ds_read_b32 v99, v70 offset:8960
    s_waitcnt lgkmcnt(0)
    s_add_u32 s97, s94, 131072
    buffer_store_dwordx4 v[92:95], v69, s[16:19], s97 offen sc1
    s_add_u32 s97, s96, 8192
    buffer_store_dwordx4 v[96:99], v71, s[16:19], s97 offen sc1
    L_ln_skip_m:
    s_waitcnt lgkmcnt(0)
    s_add_u32 s97, s94, 0
    buffer_store_dwordx4 v[76:79], v69, s[16:19], s97 offen sc1
    s_add_u32 s97, s96, 0
    buffer_store_dwordx4 v[80:83], v71, s[16:19], s97 offen sc1
    s_add_u32 s97, s94, 65536
    buffer_store_dwordx4 v[84:87], v69, s[16:19], s97 offen sc1
    s_add_u32 s97, s96, 4096
    buffer_store_dwordx4 v[88:91], v71, s[16:19], s97 offen sc1
    s_cmp_ge_u32 s2, 192
    s_cbranch_scc1 L_m_nokg
    v_lshlrev_b32 v36, 16, v36
    v_mul_f32 v36, 0x3fb8aa3b, v36
    v_exp_f32 v36, v36
    v_lshrrev_b32 v38, s59, v32
    v_lshrrev_b32 v39, s59, v33
    v_lshrrev_b32 v40, s59, v34
    v_lshrrev_b32 v41, s59, v35
    v_cvt_pk_bf16_f32 v36, v36, v36
    v_lshlrev_b32 v38, 16, v38
    v_lshlrev_b32 v39, 16, v39
    v_lshlrev_b32 v40, 16, v40
    v_lshlrev_b32 v41, 16, v41
    v_and_b32 v36, 0xffff0000, v36
    v_lshlrev_b32 v42, 16, v34
    v_and_b32 v43, 0xffff0000, v34
    v_lshlrev_b32 v44, 16, v35
    v_and_b32 v45, 0xffff0000, v35
    v_mul_f32 v38, 0x3fb8aa3b, v38
    v_max3_f32 v42, abs(v42), abs(v43), abs(v44)
    v_exp_f32 v38, v38
    v_max_f32 v42, v42, abs(v45)
    v_mul_f32 v39, v39, v36
    v_mul_f32 v42, v42, v36
    v_cvt_pk_bf16_f32 v38, v38, v38
    v_mul_f32 v40, v40, v36
    v_mul_f32 v41, v41, v36
    v_max_f32_dpp v42, v42, v42 quad_perm:[1,0,3,2] row_mask:0xf bank_mask:0xf
    v_and_b32 v38, 0xffff0000, v38
    v_mul_f32 v39, 0x3e22f983, v39
    v_max_f32_dpp v42, v42, v42 quad_perm:[2,3,0,1] row_mask:0xf bank_mask:0xf
    v_mul_f32 v38, v38, v36
    v_mul_f32 v38, 0xbfb8aa3b, v38
    v_max_f32_dpp v42, v42, v42 row_half_mirror row_mask:0xf bank_mask:0xf
    s_nop 1
    v_max_f32_dpp v42, v42, v42 row_mirror row_mask:0xf bank_mask:0xf
    s_nop 0
    v_mov_b32 v43, v42
    s_nop 1
    v_permlane16_swap_b32 v42, v43
    s_nop 1
    v_max_f32 v42, v42, v43
    v_mov_b32 v43, v42
    s_nop 1
    v_permlane32_swap_b32 v42, v43
    s_nop 1
    v_max_f32 v42, v42, v43
    v_max_f32 v42, 0x0d800000, v42
    v_min_f32 v42, 0x71800000, v42
    v_add_u32 v42, 0x7fffff, v42
    v_and_b32 v42, 0x7f800000, v42
    v_sub_u32 v43, 0x7f000000, v42
    v_add_f32 v37, v42, v42
    v_mul_f32 v40, v40, v43
    v_mul_f32 v41, v41, v43

    v_mul_f32 v122, 0x3f800000, v38
    v_mul_f32 v124, 0x41000000, v38
    v_mul_f32 v126, 0x43000000, v38
    s_waitcnt vmcnt(0)
    s_barrier
    s_lshl_b32 s4, s2, 6
    s_add_u32 s4, s4, 41943040
    v_mov_b32 v162, s4
    v_mov_b32 v163, 0x7ffffff0
    v_cmp_eq_u32 vcc, 0, v0
    s_add_u32 s4, s90, 1
    v_mov_b32 v164, s4
    v_cndmask_b32 v163, v163, v162, vcc
    buffer_store_dword v164, v163, s[16:19], 0 offen sc1

    v_mul_f32 v123, 0x3f800000, v39
    v_mul_f32 v125, 0x41000000, v39
    v_mul_f32 v127, 0x43000000, v39
    v_exp_f32 v122, v122
    v_exp_f32 v124, v124
    v_exp_f32 v126, v126
    v_fract_f32 v123, v123
    v_fract_f32 v125, v125
    v_fract_f32 v127, v127
    s_nop 0
    s_nop 0
    s_nop 0
    v_cos_f32 v46, v123
    v_cos_f32 v60, v125
    v_cos_f32 v62, v127
    v_sin_f32 v47, v123
    v_sin_f32 v61, v125
    v_sin_f32 v63, v127
    s_nop 0
    s_nop 0
    s_nop 0
    v_mul_f32 v46, v46, v122
    v_mul_f32 v60, v60, v124
    v_mul_f32 v62, v62, v126
    v_mul_f32 v47, v47, v122
    v_mul_f32 v61, v61, v124
    v_mul_f32 v63, v63, v126
    v_pk_mul_f32 v[64:65], v[40:41], v[62:63] op_sel_hi:[1,0]
    v_pk_mul_f32 v[94:95], v[60:61], v[60:61] op_sel_hi:[1,0]
    v_pk_mul_f32 v[48:49], v[46:47], v[46:47] op_sel_hi:[1,0]
    v_pk_fma_f32 v[64:65], v[40:41], v[62:63], v[64:65] op_sel:[1,1,0] op_sel_hi:[0,1,1] neg_lo:[1,0,0]
    v_pk_fma_f32 v[94:95], v[60:61], v[60:61], v[94:95] op_sel:[1,1,0] op_sel_hi:[0,1,1] neg_lo:[1,0,0]
    s_and_b32 s66, s39, 15
    s_lshl_b32 s66, s66, 2
    s_add_u32 s66, s66, s36
    s_mul_i32 s67, s40, 768
    v_and_b32 v176, 63, v0
    v_lshrrev_b32 v177, 3, v176
    v_mul_u32_u24 v177, 9216, v177
    v_and_b32 v176, 7, v176
    v_lshl_add_u32 v176, v176, 4, v177

    v_pk_fma_f32 v[48:49], v[46:47], v[46:47], v[48:49] op_sel:[1,1,0] op_sel_hi:[0,1,1] neg_lo:[1,0,0]
    v_pk_mul_f32 v[66:67], v[64:65], v[62:63] op_sel_hi:[1,0]
    s_add_u32 s4, s66, 0
    s_min_u32 s4, s4, 431
    s_mul_i32 s5, s4, 911
    s_lshr_b32 s5, s5, 16
    s_mul_i32 s6, s5, 72
    s_sub_u32 s4, s4, s6
    s_mul_i32 s4, s4, 73728
    s_lshl_b32 s5, s5, 7
    s_add_u32 s4, s4, s5
    s_add_u32 s4, s4, s67
    buffer_load_dwordx4 v[180:183], v176, s[8:11], s4 offen

    v_pk_mul_f32 v[96:97], v[94:95], v[60:61] op_sel_hi:[1,0]
    v_pk_mul_f32 v[50:51], v[48:49], v[46:47] op_sel_hi:[1,0]
    v_pk_fma_f32 v[66:67], v[64:65], v[62:63], v[66:67] op_sel:[1,1,0] op_sel_hi:[0,1,1] neg_lo:[1,0,0]
    v_pk_fma_f32 v[96:97], v[94:95], v[60:61], v[96:97] op_sel:[1,1,0] op_sel_hi:[0,1,1] neg_lo:[1,0,0]
    v_pk_fma_f32 v[50:51], v[48:49], v[46:47], v[50:51] op_sel:[1,1,0] op_sel_hi:[0,1,1] neg_lo:[1,0,0]
    v_pk_mul_f32 v[68:69], v[66:67], v[62:63] op_sel_hi:[1,0]
    v_pk_mul_f32 v[98:99], v[96:97], v[60:61] op_sel_hi:[1,0]
    v_pk_mul_f32 v[52:53], v[48:49], v[48:49] op_sel_hi:[1,0]
    v_pk_fma_f32 v[68:69], v[66:67], v[62:63], v[68:69] op_sel:[1,1,0] op_sel_hi:[0,1,1] neg_lo:[1,0,0]
    v_pk_fma_f32 v[98:99], v[96:97], v[60:61], v[98:99] op_sel:[1,1,0] op_sel_hi:[0,1,1] neg_lo:[1,0,0]
    v_pk_fma_f32 v[52:53], v[48:49], v[48:49], v[52:53] op_sel:[1,1,0] op_sel_hi:[0,1,1] neg_lo:[1,0,0]
    v_pk_mul_f32 v[70:71], v[68:69], v[62:63] op_sel_hi:[1,0]
    v_pk_mul_f32 v[100:101], v[98:99], v[60:61] op_sel_hi:[1,0]
    v_pk_mul_f32 v[54:55], v[52:53], v[46:47] op_sel_hi:[1,0]
    v_pk_fma_f32 v[70:71], v[68:69], v[62:63], v[70:71] op_sel:[1,1,0] op_sel_hi:[0,1,1] neg_lo:[1,0,0]
    v_pk_fma_f32 v[100:101], v[98:99], v[60:61], v[100:101] op_sel:[1,1,0] op_sel_hi:[0,1,1] neg_lo:[1,0,0]
    v_pk_fma_f32 v[54:55], v[52:53], v[46:47], v[54:55] op_sel:[1,1,0] op_sel_hi:[0,1,1] neg_lo:[1,0,0]
    v_pk_mul_f32 v[72:73], v[70:71], v[62:63] op_sel_hi:[1,0]
    s_add_u32 s4, s66, 64
    s_min_u32 s4, s4, 431
    s_mul_i32 s5, s4, 911
    s_lshr_b32 s5, s5, 16
    s_mul_i32 s6, s5, 72
    s_sub_u32 s4, s4, s6
    s_mul_i32 s4, s4, 73728
    s_lshl_b32 s5, s5, 7
    s_add_u32 s4, s4, s5
    s_add_u32 s4, s4, s67
    buffer_load_dwordx4 v[180:183], v176, s[8:11], s4 offen

    v_pk_mul_f32 v[102:103], v[100:101], v[60:61] op_sel_hi:[1,0]
    v_pk_mul_f32 v[56:57], v[52:53], v[48:49] op_sel_hi:[1,0]
    v_pk_fma_f32 v[72:73], v[70:71], v[62:63], v[72:73] op_sel:[1,1,0] op_sel_hi:[0,1,1] neg_lo:[1,0,0]
    v_pk_fma_f32 v[102:103], v[100:101], v[60:61], v[102:103] op_sel:[1,1,0] op_sel_hi:[0,1,1] neg_lo:[1,0,0]
    v_pk_fma_f32 v[56:57], v[52:53], v[48:49], v[56:57] op_sel:[1,1,0] op_sel_hi:[0,1,1] neg_lo:[1,0,0]
    v_pk_mul_f32 v[74:75], v[72:73], v[62:63] op_sel_hi:[1,0]
    v_pk_mul_f32 v[104:105], v[102:103], v[60:61] op_sel_hi:[1,0]
    v_pk_mul_f32 v[58:59], v[52:53], v[50:51] op_sel_hi:[1,0]
    v_pk_fma_f32 v[74:75], v[72:73], v[62:63], v[74:75] op_sel:[1,1,0] op_sel_hi:[0,1,1] neg_lo:[1,0,0]
    v_pk_fma_f32 v[104:105], v[102:103], v[60:61], v[104:105] op_sel:[1,1,0] op_sel_hi:[0,1,1] neg_lo:[1,0,0]
    v_pk_fma_f32 v[58:59], v[52:53], v[50:51], v[58:59] op_sel:[1,1,0] op_sel_hi:[0,1,1] neg_lo:[1,0,0]
    v_pk_mul_f32 v[76:77], v[74:75], v[62:63] op_sel_hi:[1,0]
    v_pk_mul_f32 v[106:107], v[104:105], v[60:61] op_sel_hi:[1,0]
    v_pk_fma_f32 v[76:77], v[74:75], v[62:63], v[76:77] op_sel:[1,1,0] op_sel_hi:[0,1,1] neg_lo:[1,0,0]
    v_pk_fma_f32 v[106:107], v[104:105], v[60:61], v[106:107] op_sel:[1,1,0] op_sel_hi:[0,1,1] neg_lo:[1,0,0]
    s_nop 0
    v_pk_mul_f32 v[78:79], v[76:77], v[62:63] op_sel_hi:[1,0]
    v_pk_mul_f32 v[108:109], v[106:107], v[60:61] op_sel_hi:[1,0]
    v_pk_fma_f32 v[78:79], v[76:77], v[62:63], v[78:79] op_sel:[1,1,0] op_sel_hi:[0,1,1] neg_lo:[1,0,0]
    s_add_u32 s4, s66, 128
    s_min_u32 s4, s4, 431
    s_mul_i32 s5, s4, 911
    s_lshr_b32 s5, s5, 16
    s_mul_i32 s6, s5, 72
    s_sub_u32 s4, s4, s6
    s_mul_i32 s4, s4, 73728
    s_lshl_b32 s5, s5, 7
    s_add_u32 s4, s4, s5
    s_add_u32 s4, s4, s67
    buffer_load_dwordx4 v[180:183], v176, s[8:11], s4 offen

    v_pk_fma_f32 v[108:109], v[106:107], v[60:61], v[108:109] op_sel:[1,1,0] op_sel_hi:[0,1,1] neg_lo:[1,0,0]
    s_nop 0
    v_pk_mul_f32 v[80:81], v[78:79], v[62:63] op_sel_hi:[1,0]
    v_pk_mul_f32 v[110:111], v[108:109], v[60:61] op_sel_hi:[1,0]
    v_pk_fma_f32 v[80:81], v[78:79], v[62:63], v[80:81] op_sel:[1,1,0] op_sel_hi:[0,1,1] neg_lo:[1,0,0]
    v_pk_fma_f32 v[110:111], v[108:109], v[60:61], v[110:111] op_sel:[1,1,0] op_sel_hi:[0,1,1] neg_lo:[1,0,0]
    s_nop 0
    v_pk_mul_f32 v[82:83], v[80:81], v[62:63] op_sel_hi:[1,0]
    v_pk_mul_f32 v[112:113], v[110:111], v[60:61] op_sel_hi:[1,0]
    v_pk_fma_f32 v[82:83], v[80:81], v[62:63], v[82:83] op_sel:[1,1,0] op_sel_hi:[0,1,1] neg_lo:[1,0,0]
    v_pk_fma_f32 v[112:113], v[110:111], v[60:61], v[112:113] op_sel:[1,1,0] op_sel_hi:[0,1,1] neg_lo:[1,0,0]
    s_nop 0
    v_pk_mul_f32 v[84:85], v[82:83], v[62:63] op_sel_hi:[1,0]
    v_pk_mul_f32 v[114:115], v[112:113], v[60:61] op_sel_hi:[1,0]
    v_pk_fma_f32 v[84:85], v[82:83], v[62:63], v[84:85] op_sel:[1,1,0] op_sel_hi:[0,1,1] neg_lo:[1,0,0]
    v_pk_fma_f32 v[114:115], v[112:113], v[60:61], v[114:115] op_sel:[1,1,0] op_sel_hi:[0,1,1] neg_lo:[1,0,0]
    s_nop 0
    v_pk_mul_f32 v[86:87], v[84:85], v[62:63] op_sel_hi:[1,0]
    s_add_u32 s4, s66, 192
    s_min_u32 s4, s4, 431
    s_mul_i32 s5, s4, 911
    s_lshr_b32 s5, s5, 16
    s_mul_i32 s6, s5, 72
    s_sub_u32 s4, s4, s6
    s_mul_i32 s4, s4, 73728
    s_lshl_b32 s5, s5, 7
    s_add_u32 s4, s4, s5
    s_add_u32 s4, s4, s67
    buffer_load_dwordx4 v[180:183], v176, s[8:11], s4 offen

    v_pk_mul_f32 v[116:117], v[114:115], v[60:61] op_sel_hi:[1,0]
    v_pk_fma_f32 v[86:87], v[84:85], v[62:63], v[86:87] op_sel:[1,1,0] op_sel_hi:[0,1,1] neg_lo:[1,0,0]
    v_pk_fma_f32 v[116:117], v[114:115], v[60:61], v[116:117] op_sel:[1,1,0] op_sel_hi:[0,1,1] neg_lo:[1,0,0]
    s_nop 0
    v_pk_mul_f32 v[88:89], v[86:87], v[62:63] op_sel_hi:[1,0]
    v_pk_mul_f32 v[118:119], v[116:117], v[60:61] op_sel_hi:[1,0]
    v_pk_fma_f32 v[88:89], v[86:87], v[62:63], v[88:89] op_sel:[1,1,0] op_sel_hi:[0,1,1] neg_lo:[1,0,0]
    v_pk_fma_f32 v[118:119], v[116:117], v[60:61], v[118:119] op_sel:[1,1,0] op_sel_hi:[0,1,1] neg_lo:[1,0,0]
    s_nop 0
    v_pk_mul_f32 v[90:91], v[88:89], v[62:63] op_sel_hi:[1,0]
    v_pk_mul_f32 v[120:121], v[118:119], v[60:61] op_sel_hi:[1,0]
    v_pk_fma_f32 v[90:91], v[88:89], v[62:63], v[90:91] op_sel:[1,1,0] op_sel_hi:[0,1,1] neg_lo:[1,0,0]
    v_pk_fma_f32 v[120:121], v[118:119], v[60:61], v[120:121] op_sel:[1,1,0] op_sel_hi:[0,1,1] neg_lo:[1,0,0]
    s_nop 0
    v_pk_mul_f32 v[92:93], v[90:91], v[62:63] op_sel_hi:[1,0]
    v_pk_fma_f32 v[92:93], v[90:91], v[62:63], v[92:93] op_sel:[1,1,0] op_sel_hi:[0,1,1] neg_lo:[1,0,0]
    s_nop 0
    v_mov_b32 v158, 1.0
    v_mov_b32 v159, 0
    s_add_u32 s4, s66, 256
    s_min_u32 s4, s4, 431
    s_mul_i32 s5, s4, 911
    s_lshr_b32 s5, s5, 16
    s_mul_i32 s6, s5, 72
    s_sub_u32 s4, s4, s6
    s_mul_i32 s4, s4, 73728
    s_lshl_b32 s5, s5, 7
    s_add_u32 s4, s4, s5
    s_add_u32 s4, s4, s67
    buffer_load_dwordx4 v[180:183], v176, s[8:11], s4 offen

    v_pk_mul_f32 v[122:123], v[40:41], v[46:47] op_sel_hi:[1,0]
    v_pk_mul_f32 v[124:125], v[40:41], v[48:49] op_sel_hi:[1,0]
    v_pk_mul_f32 v[126:127], v[40:41], v[50:51] op_sel_hi:[1,0]
    v_pk_mul_f32 v[128:129], v[40:41], v[52:53] op_sel_hi:[1,0]
    v_cvt_pk_f16_f32 v138, v40, -v41
    v_cvt_pk_f16_f32 v139, v64, -v65
    v_cvt_pk_f16_f32 v140, v66, -v67
    v_cvt_pk_f16_f32 v141, v68, -v69
    v_cvt_pk_f16_f32 v142, v70, -v71
    v_pk_fma_f32 v[122:123], v[40:41], v[46:47], v[122:123] op_sel:[1,1,0] op_sel_hi:[0,1,1] neg_lo:[1,0,0]
    v_pk_fma_f32 v[124:125], v[40:41], v[48:49], v[124:125] op_sel:[1,1,0] op_sel_hi:[0,1,1] neg_lo:[1,0,0]
    v_pk_fma_f32 v[126:127], v[40:41], v[50:51], v[126:127] op_sel:[1,1,0] op_sel_hi:[0,1,1] neg_lo:[1,0,0]
    v_pk_fma_f32 v[128:129], v[40:41], v[52:53], v[128:129] op_sel:[1,1,0] op_sel_hi:[0,1,1] neg_lo:[1,0,0]
    ds_write_b32 v4, v138 offset:0
    ds_write_b32 v4, v139 offset:2176
    ds_write_b32 v4, v140 offset:4352
    ds_write_b32 v4, v141 offset:5440
    ds_write_b32 v4, v142 offset:6528
    v_cvt_pk_f16_f32 v130, v122, -v123
    s_add_u32 s4, s66, 320
    s_min_u32 s4, s4, 431
    s_mul_i32 s5, s4, 911
    s_lshr_b32 s5, s5, 16
    s_mul_i32 s6, s5, 72
    s_sub_u32 s4, s4, s6
    s_mul_i32 s4, s4, 73728
    s_lshl_b32 s5, s5, 7
    s_add_u32 s4, s4, s5
    s_add_u32 s4, s4, s67
    buffer_load_dwordx4 v[180:183], v176, s[8:11], s4 offen

    v_cvt_pk_f16_f32 v131, v124, -v125
    v_cvt_pk_f16_f32 v132, v126, -v127
    v_cvt_pk_f16_f32 v133, v128, -v129
    s_nop 0
    ds_write_b32 v4, v130 offset:272
    ds_write_b32 v4, v131 offset:544
    ds_write_b32 v4, v132 offset:816
    ds_write_b32 v4, v133 offset:1088
    v_pk_mul_f32 v[122:123], v[40:41], v[54:55] op_sel_hi:[1,0]
    v_pk_mul_f32 v[124:125], v[40:41], v[56:57] op_sel_hi:[1,0]
    v_pk_mul_f32 v[126:127], v[40:41], v[58:59] op_sel_hi:[1,0]
    v_pk_mul_f32 v[128:129], v[64:65], v[46:47] op_sel_hi:[1,0]
    v_cvt_pk_f16_f32 v138, v72, -v73
    v_cvt_pk_f16_f32 v139, v74, -v75
    v_cvt_pk_f16_f32 v140, v76, -v77
    v_cvt_pk_f16_f32 v141, v78, -v79
    v_cvt_pk_f16_f32 v142, v80, -v81
    v_pk_fma_f32 v[122:123], v[40:41], v[54:55], v[122:123] op_sel:[1,1,0] op_sel_hi:[0,1,1] neg_lo:[1,0,0]
    s_add_u32 s4, s66, 384
    s_min_u32 s4, s4, 431
    s_mul_i32 s5, s4, 911
    s_lshr_b32 s5, s5, 16
    s_mul_i32 s6, s5, 72
    s_sub_u32 s4, s4, s6
    s_mul_i32 s4, s4, 73728
    s_lshl_b32 s5, s5, 7
    s_add_u32 s4, s4, s5
    s_add_u32 s4, s4, s67
    buffer_load_dwordx4 v[180:183], v176, s[8:11], s4 offen

    v_pk_fma_f32 v[124:125], v[40:41], v[56:57], v[124:125] op_sel:[1,1,0] op_sel_hi:[0,1,1] neg_lo:[1,0,0]
    v_pk_fma_f32 v[126:127], v[40:41], v[58:59], v[126:127] op_sel:[1,1,0] op_sel_hi:[0,1,1] neg_lo:[1,0,0]
    v_pk_fma_f32 v[128:129], v[64:65], v[46:47], v[128:129] op_sel:[1,1,0] op_sel_hi:[0,1,1] neg_lo:[1,0,0]
    ds_write_b32 v4, v138 offset:7072
    ds_write_b32 v4, v139 offset:7616
    ds_write_b32 v4, v140 offset:8160
    ds_write_b32 v4, v141 offset:8704
    ds_write_b32 v4, v142 offset:8976
    v_cvt_pk_f16_f32 v130, v122, -v123
    v_cvt_pk_f16_f32 v131, v124, -v125
    v_cvt_pk_f16_f32 v132, v126, -v127
    v_cvt_pk_f16_f32 v133, v128, -v129
    s_nop 0
    ds_write_b32 v4, v130 offset:1360
    ds_write_b32 v4, v131 offset:1632
    ds_write_b32 v4, v132 offset:1904
    ds_write_b32 v4, v133 offset:2448
    v_pk_mul_f32 v[122:123], v[64:65], v[48:49] op_sel_hi:[1,0]
    v_pk_mul_f32 v[124:125], v[64:65], v[50:51] op_sel_hi:[1,0]
    v_pk_mul_f32 v[126:127], v[64:65], v[52:53] op_sel_hi:[1,0]
    v_pk_mul_f32 v[128:129], v[64:65], v[54:55] op_sel_hi:[1,0]
    v_cvt_pk_f16_f32 v138, v82, -v83
    v_cvt_pk_f16_f32 v139, v84, -v85
    v_cvt_pk_f16_f32 v140, v86, -v87
    v_cvt_pk_f16_f32 v141, v88, -v89
    v_cvt_pk_f16_f32 v142, v90, -v91
    v_pk_fma_f32 v[122:123], v[64:65], v[48:49], v[122:123] op_sel:[1,1,0] op_sel_hi:[0,1,1] neg_lo:[1,0,0]
    v_pk_fma_f32 v[124:125], v[64:65], v[50:51], v[124:125] op_sel:[1,1,0] op_sel_hi:[0,1,1] neg_lo:[1,0,0]
    v_pk_fma_f32 v[126:127], v[64:65], v[52:53], v[126:127] op_sel:[1,1,0] op_sel_hi:[0,1,1] neg_lo:[1,0,0]
    v_pk_fma_f32 v[128:129], v[64:65], v[54:55], v[128:129] op_sel:[1,1,0] op_sel_hi:[0,1,1] neg_lo:[1,0,0]
    ds_write_b32 v4, v138 offset:9248
    ds_write_b32 v4, v139 offset:9520
    ds_write_b32 v4, v140 offset:9792
    ds_write_b32 v4, v141 offset:10064
    ds_write_b32 v4, v142 offset:10336
    v_cvt_pk_f16_f32 v130, v122, -v123
    v_cvt_pk_f16_f32 v131, v124, -v125
    v_cvt_pk_f16_f32 v132, v126, -v127
    v_cvt_pk_f16_f32 v133, v128, -v129
    s_nop 0
    ds_write_b32 v4, v130 offset:2720
    ds_write_b32 v4, v131 offset:2992
    ds_write_b32 v4, v132 offset:3264
    ds_write_b32 v4, v133 offset:3536
    v_pk_mul_f32 v[122:123], v[64:65], v[56:57] op_sel_hi:[1,0]
    v_pk_mul_f32 v[124:125], v[64:65], v[58:59] op_sel_hi:[1,0]
    v_pk_mul_f32 v[126:127], v[66:67], v[48:49] op_sel_hi:[1,0]
    v_pk_mul_f32 v[128:129], v[66:67], v[52:53] op_sel_hi:[1,0]
    v_cvt_pk_f16_f32 v138, v92, -v93
    v_cvt_pk_f16_f32 v139, v158, v159
    v_cvt_pk_f16_f32 v140, v60, v61
    v_cvt_pk_f16_f32 v141, v94, v95
    v_cvt_pk_f16_f32 v142, v96, v97
    v_pk_fma_f32 v[122:123], v[64:65], v[56:57], v[122:123] op_sel:[1,1,0] op_sel_hi:[0,1,1] neg_lo:[1,0,0]
    v_pk_fma_f32 v[124:125], v[64:65], v[58:59], v[124:125] op_sel:[1,1,0] op_sel_hi:[0,1,1] neg_lo:[1,0,0]
    v_pk_fma_f32 v[126:127], v[66:67], v[48:49], v[126:127] op_sel:[1,1,0] op_sel_hi:[0,1,1] neg_lo:[1,0,0]
    v_min_u32 v165, 15, v1
    s_lshl_b32 s4, s39, 4
    v_add_u32 v165, s4, v165
    v_lshlrev_b32 v165, 6, v165
    v_add_u32 v165, 41943040, v165
    buffer_load_dword v166, v165, s[16:19], 0 offen sc1

    v_pk_fma_f32 v[128:129], v[66:67], v[52:53], v[128:129] op_sel:[1,1,0] op_sel_hi:[0,1,1] neg_lo:[1,0,0]
    ds_write_b32 v4, v138 offset:10608
    ds_write_b32 v4, v139 offset:11264
    ds_write_b32 v4, v140 offset:11536
    ds_write_b32 v4, v141 offset:11808
    ds_write_b32 v4, v142 offset:12080
    v_cvt_pk_f16_f32 v130, v122, -v123
    v_cvt_pk_f16_f32 v131, v124, -v125
    v_cvt_pk_f16_f32 v132, v126, -v127
    v_cvt_pk_f16_f32 v133, v128, -v129
    s_nop 0
    ds_write_b32 v4, v130 offset:3808
    ds_write_b32 v4, v131 offset:4080
    ds_write_b32 v4, v132 offset:4624
    ds_write_b32 v4, v133 offset:4896
    v_pk_mul_f32 v[122:123], v[66:67], v[56:57] op_sel_hi:[1,0]
    v_pk_mul_f32 v[124:125], v[68:69], v[48:49] op_sel_hi:[1,0]
    v_pk_mul_f32 v[126:127], v[68:69], v[52:53] op_sel_hi:[1,0]
    v_pk_mul_f32 v[128:129], v[68:69], v[56:57] op_sel_hi:[1,0]
    v_cvt_pk_f16_f32 v138, v98, v99
    v_cvt_pk_f16_f32 v139, v100, v101
    v_cvt_pk_f16_f32 v140, v102, v103
    v_cvt_pk_f16_f32 v141, v104, v105
    v_cvt_pk_f16_f32 v142, v106, v107
    v_pk_fma_f32 v[122:123], v[66:67], v[56:57], v[122:123] op_sel:[1,1,0] op_sel_hi:[0,1,1] neg_lo:[1,0,0]
    v_pk_fma_f32 v[124:125], v[68:69], v[48:49], v[124:125] op_sel:[1,1,0] op_sel_hi:[0,1,1] neg_lo:[1,0,0]
    v_pk_fma_f32 v[126:127], v[68:69], v[52:53], v[126:127] op_sel:[1,1,0] op_sel_hi:[0,1,1] neg_lo:[1,0,0]
    v_pk_fma_f32 v[128:129], v[68:69], v[56:57], v[128:129] op_sel:[1,1,0] op_sel_hi:[0,1,1] neg_lo:[1,0,0]
    ds_write_b32 v4, v138 offset:12352
    ds_write_b32 v4, v139 offset:12624
    ds_write_b32 v4, v140 offset:12896
    ds_write_b32 v4, v141 offset:13168
    ds_write_b32 v4, v142 offset:13440
    v_cvt_pk_f16_f32 v130, v122, -v123
    v_cvt_pk_f16_f32 v131, v124, -v125
    v_cvt_pk_f16_f32 v132, v126, -v127
    v_cvt_pk_f16_f32 v133, v128, -v129
    s_nop 0
    ds_write_b32 v4, v130 offset:5168
    ds_write_b32 v4, v131 offset:5712
    ds_write_b32 v4, v132 offset:5984
    ds_write_b32 v4, v133 offset:6256
    v_pk_mul_f32 v[122:123], v[70:71], v[52:53] op_sel_hi:[1,0]
    v_pk_mul_f32 v[124:125], v[72:73], v[52:53] op_sel_hi:[1,0]
    v_pk_mul_f32 v[126:127], v[74:75], v[52:53] op_sel_hi:[1,0]
    v_pk_mul_f32 v[128:129], v[76:77], v[52:53] op_sel_hi:[1,0]
    v_cvt_pk_f16_f32 v138, v108, v109
    v_cvt_pk_f16_f32 v139, v110, v111
    v_cvt_pk_f16_f32 v140, v112, v113
    v_cvt_pk_f16_f32 v141, v114, v115
    v_cvt_pk_f16_f32 v142, v116, v117
    v_pk_fma_f32 v[122:123], v[70:71], v[52:53], v[122:123] op_sel:[1,1,0] op_sel_hi:[0,1,1] neg_lo:[1,0,0]
    v_pk_fma_f32 v[124:125], v[72:73], v[52:53], v[124:125] op_sel:[1,1,0] op_sel_hi:[0,1,1] neg_lo:[1,0,0]
    v_pk_fma_f32 v[126:127], v[74:75], v[52:53], v[126:127] op_sel:[1,1,0] op_sel_hi:[0,1,1] neg_lo:[1,0,0]
    v_pk_fma_f32 v[128:129], v[76:77], v[52:53], v[128:129] op_sel:[1,1,0] op_sel_hi:[0,1,1] neg_lo:[1,0,0]
    ds_write_b32 v4, v138 offset:13712
    ds_write_b32 v4, v139 offset:13984
    ds_write_b32 v4, v140 offset:14256
    ds_write_b32 v4, v141 offset:14528
    ds_write_b32 v4, v142 offset:14800
    v_cvt_pk_f16_f32 v130, v122, -v123
    v_cvt_pk_f16_f32 v131, v124, -v125
    v_cvt_pk_f16_f32 v132, v126, -v127
    v_cvt_pk_f16_f32 v133, v128, -v129
    s_nop 0
    ds_write_b32 v4, v130 offset:6800
    ds_write_b32 v4, v131 offset:7344
    ds_write_b32 v4, v132 offset:7888
    ds_write_b32 v4, v133 offset:8432
    v_pk_mul_f32 v[122:123], v[92:93], v[60:61] op_sel_hi:[1,0]
    v_cvt_pk_f16_f32 v138, v118, v119
    v_cvt_pk_f16_f32 v139, v120, v121
    v_pk_fma_f32 v[122:123], v[92:93], v[60:61], v[122:123] op_sel:[1,1,0] op_sel_hi:[0,1,1] neg_lo:[1,0,0]
    ds_write_b32 v4, v138 offset:15072
    ds_write_b32 v4, v139 offset:15344
    v_cvt_pk_f16_f32 v130, v122, -v123
    s_nop 0
    ds_write_b32 v4, v130 offset:10880
    s_waitcnt lgkmcnt(0)
    ds_read_b128 v[64:67], v5 offset:11264
    ds_read_b128 v[68:71], v5 offset:0
    ds_read_b128 v[72:75], v5 offset:4352
    s_waitcnt vmcnt(0)
    s_add_u32 s4, s90, 1
    v_subrev_u32 v167, s4, v166
    v_cmp_le_u32 vcc, 15, v167
    s_nop 3
    s_cmp_eq_u64 vcc, 0
    s_cbranch_scc1 L_ok_2
    s_mov_b32 s69, 20000
    L_poll_1:
    buffer_load_dword v166, v165, s[16:19], 0 offen sc1
    s_waitcnt vmcnt(0)
    s_add_u32 s4, s90, 1
    v_subrev_u32 v167, s4, v166
    v_cmp_le_u32 vcc, 15, v167
    s_sub_u32 s69, s69, 1
    s_cbranch_scc1 L_ok_2
    s_nop 1
    s_cmp_eq_u64 vcc, 0
    s_cbranch_scc1 L_ok_2
    s_sleep 1
    s_branch L_poll_1
    L_ok_2:
    v_lshlrev_b32 v168, 4, v1
    s_add_u32 m0, s45, 0
    s_add_u32 s63, s44, 0
    buffer_load_dwordx4 v168, s[16:19], s63 offen sc1 lds
    buffer_load_dwordx4 v168, s[16:19], s63 offen offset:1024 sc1 lds
    buffer_load_dwordx4 v168, s[16:19], s63 offen offset:2048 sc1 lds
    buffer_load_dwordx4 v168, s[16:19], s63 offen offset:3072 sc1 lds
    s_add_u32 m0, s45, 4096
    s_add_u32 s63, s44, 4096
    buffer_load_dwordx4 v168, s[16:19], s63 offen sc1 lds
    buffer_load_dwordx4 v168, s[16:19], s63 offen offset:1024 sc1 lds
    ds_read_b128 v[76:79], v5 offset:8704
    ds_read_b128 v[80:83], v5 offset:11328
    ds_read_b128 v[84:87], v5 offset:64
    ds_read_b128 v[88:91], v5 offset:4416
    ds_read_b128 v[92:95], v5 offset:8768
    s_waitcnt lgkmcnt(4)
    v_mfma_f32_16x16x32_f16 v[146:149], v[68:71], v[64:67], 0
    v_mfma_f32_16x16x32_f16 v[150:153], v[72:75], v[64:67], 0
    v_mfma_f32_16x16x32_f16 v[154:157], v[76:79], v[64:67], 0
    s_waitcnt lgkmcnt(0)
    v_mfma_f32_16x16x32_f16 v[146:149], v[84:87], v[80:83], v[146:149]
    v_mfma_f32_16x16x32_f16 v[150:153], v[88:91], v[80:83], v[150:153]
    v_mfma_f32_16x16x32_f16 v[154:157], v[92:95], v[80:83], v[154:157]
    ds_read_b128 v[64:67], v5 offset:11392
    ds_read_b128 v[68:71], v5 offset:128
    ds_read_b128 v[72:75], v5 offset:4480
    ds_read_b128 v[76:79], v5 offset:8832
    ds_read_b128 v[80:83], v5 offset:11456
    ds_read_b128 v[84:87], v5 offset:192
    ds_read_b128 v[88:91], v5 offset:4544
    ds_read_b128 v[92:95], v5 offset:8896
    s_waitcnt lgkmcnt(4)
    v_mfma_f32_16x16x32_f16 v[146:149], v[68:71], v[64:67], v[146:149]
    v_mfma_f32_16x16x32_f16 v[150:153], v[72:75], v[64:67], v[150:153]
    v_mfma_f32_16x16x32_f16 v[154:157], v[76:79], v[64:67], v[154:157]
    s_waitcnt lgkmcnt(0)
    v_mfma_f32_16x16x32_f16 v[146:149], v[84:87], v[80:83], v[146:149]
    v_mfma_f32_16x16x32_f16 v[150:153], v[88:91], v[80:83], v[150:153]
    v_mfma_f32_16x16x32_f16 v[154:157], v[92:95], v[80:83], v[154:157]
    s_nop 7
    s_cmp_eq_u32 s57, 0
    s_cbranch_scc1 L_kh_first_m
    ds_write_b128 v7, v[146:149]
    ds_write_b128 v7, v[150:153] offset:1024
    ds_write_b128 v7, v[154:157] offset:2048
    s_waitcnt lgkmcnt(0)
    s_barrier

    s_branch L_kh_done_m
    L_kh_first_m:
    s_barrier
    ds_read_b128 v[100:103], v7
    ds_read_b128 v[104:107], v7 offset:1024
    ds_read_b128 v[108:111], v7 offset:2048
    s_add_u32 s60, s55, 4096
    v_add_u32 v16, s60, v16
    v_add_u32 v20, s60, v20
    v_add_u32 v21, s60, v21
    v_add_u32 v22, s60, v22
    s_waitcnt lgkmcnt(0)

    v_add_f32 v146, v146, v100
    v_add_f32 v147, v147, v101
    v_add_f32 v148, v148, v102
    v_add_f32 v149, v149, v103
    v_add_f32 v150, v150, v104
    v_add_f32 v151, v151, v105
    v_add_f32 v152, v152, v106
    v_add_f32 v153, v153, v107
    v_add_f32 v154, v154, v108
    v_add_f32 v155, v155, v109
    v_add_f32 v156, v156, v110
    v_add_f32 v157, v157, v111
    v_cvt_pk_f16_f32 v100, v146, v147
    v_cvt_pk_f16_f32 v101, v148, v149
    ds_write_b64 v16, v[100:101]

    ds_write_b32 v8, v150
    ds_write_b32 v9, v151
    ds_write_b32 v10, v152
    ds_write_b32 v11, v153
    ds_write_b32 v12, v154
    ds_write_b32 v13, v155
    ds_write_b32 v14, v156
    ds_write_b32 v15, v157
    s_waitcnt lgkmcnt(0)
    ds_read_b64 v[104:105], v17
    ds_read_b32 v106, v17 offset:8
    ds_read_b64 v[108:109], v18
    ds_read_b32 v110, v18 offset:8
    ds_read_b64 v[112:113], v19
    ds_read_b32 v114, v19 offset:8
    s_lshl_b32 s61, s54, 2
    s_add_u32 s61, s61, 7143424
    v_mov_b32 v126, 0x7ffffff0
    v_cmp_eq_u32 vcc, 0, v1
    v_mov_b32 v127, s61
    s_nop 0
    v_cndmask_b32 v126, v126, v127, vcc
    buffer_store_dword v37, v126, s[16:19], 0 offen sc1
    s_waitcnt lgkmcnt(0)
    v_cvt_pk_f16_f32 v120, v104, v104
    v_cvt_pk_f16_f32 v121, v105, v106
    ds_write_b64 v20, v[120:121]
    v_cvt_pk_f16_f32 v124, v108, v108
    v_cvt_pk_f16_f32 v125, v108, v109
    v_cvt_pk_f16_f32 v126, v109, v109
    v_cvt_pk_f16_f32 v127, v110, v110
    ds_write_b128 v21, v[124:127]
    v_cvt_pk_f16_f32 v128, v112, v112
    v_mov_b32 v129, v128
    v_cvt_pk_f16_f32 v130, v112, v113
    v_cvt_pk_f16_f32 v131, v113, v113
    ds_write_b128 v22, v[128:131]
    v_mov_b32 v132, v131
    v_mov_b32 v133, v131
    v_cvt_pk_f16_f32 v134, v114, v114
    v_mov_b32 v135, v134
    ds_write_b128 v22, v[132:135] offset:1024
    v_lshlrev_b32 v2, 4, v1
    v_add_u32 v3, s60, v2
    s_waitcnt lgkmcnt(0)
    ds_read_b128 v[136:139], v3
    ds_read_b128 v[140:143], v3 offset:1024
    ds_read_b128 v[144:147], v3 offset:2048
    ds_read_b128 v[148:151], v3 offset:3072
    s_lshl_b32 s61, s54, 12
    s_add_u32 s61, s61, 38797312
    s_waitcnt lgkmcnt(0)
    buffer_store_dwordx4 v[136:139], v2, s[16:19], s61 offen sc1
    buffer_store_dwordx4 v[140:143], v2, s[16:19], s61 offen offset:1024 sc1
    buffer_store_dwordx4 v[144:147], v2, s[16:19], s61 offen offset:2048 sc1
    buffer_store_dwordx4 v[148:151], v2, s[16:19], s61 offen offset:3072 sc1
    L_kh_done_m:
    s_nop 1

    s_branch L_m_kgdone
    L_m_nokg:
    s_waitcnt vmcnt(0)
    s_barrier
    s_lshl_b32 s4, s2, 6
    s_add_u32 s4, s4, 41943040
    v_mov_b32 v162, s4
    v_mov_b32 v163, 0x7ffffff0
    v_cmp_eq_u32 vcc, 0, v0
    s_add_u32 s4, s90, 1
    v_mov_b32 v164, s4
    v_cndmask_b32 v163, v163, v162, vcc
    buffer_store_dword v164, v163, s[16:19], 0 offen sc1

    s_and_b32 s66, s39, 15
    s_lshl_b32 s66, s66, 2
    s_add_u32 s66, s66, s36
    s_mul_i32 s67, s40, 768
    v_and_b32 v176, 63, v0
    v_lshrrev_b32 v177, 3, v176
    v_mul_u32_u24 v177, 9216, v177
    v_and_b32 v176, 7, v176
    v_lshl_add_u32 v176, v176, 4, v177

    s_add_u32 s4, s66, 0
    s_min_u32 s4, s4, 431
    s_mul_i32 s5, s4, 911
    s_lshr_b32 s5, s5, 16
    s_mul_i32 s6, s5, 72
    s_sub_u32 s4, s4, s6
    s_mul_i32 s4, s4, 73728
    s_lshl_b32 s5, s5, 7
    s_add_u32 s4, s4, s5
    s_add_u32 s4, s4, s67
    buffer_load_dwordx4 v[180:183], v176, s[8:11], s4 offen

    s_add_u32 s4, s66, 64
    s_min_u32 s4, s4, 431
    s_mul_i32 s5, s4, 911
    s_lshr_b32 s5, s5, 16
    s_mul_i32 s6, s5, 72
    s_sub_u32 s4, s4, s6
    s_mul_i32 s4, s4, 73728
    s_lshl_b32 s5, s5, 7
    s_add_u32 s4, s4, s5
    s_add_u32 s4, s4, s67
    buffer_load_dwordx4 v[180:183], v176, s[8:11], s4 offen

    s_add_u32 s4, s66, 128
    s_min_u32 s4, s4, 431
    s_mul_i32 s5, s4, 911
    s_lshr_b32 s5, s5, 16
    s_mul_i32 s6, s5, 72
    s_sub_u32 s4, s4, s6
    s_mul_i32 s4, s4, 73728
    s_lshl_b32 s5, s5, 7
    s_add_u32 s4, s4, s5
    s_add_u32 s4, s4, s67
    buffer_load_dwordx4 v[180:183], v176, s[8:11], s4 offen

    s_add_u32 s4, s66, 192
    s_min_u32 s4, s4, 431
    s_mul_i32 s5, s4, 911
    s_lshr_b32 s5, s5, 16
    s_mul_i32 s6, s5, 72
    s_sub_u32 s4, s4, s6
    s_mul_i32 s4, s4, 73728
    s_lshl_b32 s5, s5, 7
    s_add_u32 s4, s4, s5
    s_add_u32 s4, s4, s67
    buffer_load_dwordx4 v[180:183], v176, s[8:11], s4 offen

    s_add_u32 s4, s66, 256
    s_min_u32 s4, s4, 431
    s_mul_i32 s5, s4, 911
    s_lshr_b32 s5, s5, 16
    s_mul_i32 s6, s5, 72
    s_sub_u32 s4, s4, s6
    s_mul_i32 s4, s4, 73728
    s_lshl_b32 s5, s5, 7
    s_add_u32 s4, s4, s5
    s_add_u32 s4, s4, s67
    buffer_load_dwordx4 v[180:183], v176, s[8:11], s4 offen

    s_add_u32 s4, s66, 320
    s_min_u32 s4, s4, 431
    s_mul_i32 s5, s4, 911
    s_lshr_b32 s5, s5, 16
    s_mul_i32 s6, s5, 72
    s_sub_u32 s4, s4, s6
    s_mul_i32 s4, s4, 73728
    s_lshl_b32 s5, s5, 7
    s_add_u32 s4, s4, s5
    s_add_u32 s4, s4, s67
    buffer_load_dwordx4 v[180:183], v176, s[8:11], s4 offen

    s_add_u32 s4, s66, 384
    s_min_u32 s4, s4, 431
    s_mul_i32 s5, s4, 911
    s_lshr_b32 s5, s5, 16
    s_mul_i32 s6, s5, 72
    s_sub_u32 s4, s4, s6
    s_mul_i32 s4, s4, 73728
    s_lshl_b32 s5, s5, 7
    s_add_u32 s4, s4, s5
    s_add_u32 s4, s4, s67
    buffer_load_dwordx4 v[180:183], v176, s[8:11], s4 offen

    v_min_u32 v165, 15, v1
    s_lshl_b32 s4, s39, 4
    v_add_u32 v165, s4, v165
    v_lshlrev_b32 v165, 6, v165
    v_add_u32 v165, 41943040, v165
    buffer_load_dword v166, v165, s[16:19], 0 offen sc1

    s_waitcnt vmcnt(0)
    s_add_u32 s4, s90, 1
    v_subrev_u32 v167, s4, v166
    v_cmp_le_u32 vcc, 15, v167
    s_nop 3
    s_cmp_eq_u64 vcc, 0
    s_cbranch_scc1 L_ok_4
    s_mov_b32 s69, 20000
    L_poll_3:
    buffer_load_dword v166, v165, s[16:19], 0 offen sc1
    s_waitcnt vmcnt(0)
    s_add_u32 s4, s90, 1
    v_subrev_u32 v167, s4, v166
    v_cmp_le_u32 vcc, 15, v167
    s_sub_u32 s69, s69, 1
    s_cbranch_scc1 L_ok_4
    s_nop 1
    s_cmp_eq_u64 vcc, 0
    s_cbranch_scc1 L_ok_4
    s_sleep 1
    s_branch L_poll_3
    L_ok_4:
    v_lshlrev_b32 v168, 4, v1
    s_add_u32 m0, s45, 0
    s_add_u32 s63, s44, 0
    buffer_load_dwordx4 v168, s[16:19], s63 offen sc1 lds
    buffer_load_dwordx4 v168, s[16:19], s63 offen offset:1024 sc1 lds
    buffer_load_dwordx4 v168, s[16:19], s63 offen offset:2048 sc1 lds
    buffer_load_dwordx4 v168, s[16:19], s63 offen offset:3072 sc1 lds
    s_add_u32 m0, s45, 4096
    s_add_u32 s63, s44, 4096
    buffer_load_dwordx4 v168, s[16:19], s63 offen sc1 lds
    buffer_load_dwordx4 v168, s[16:19], s63 offen offset:1024 sc1 lds
    s_mov_b32 s57, 1
    L_m_kgdone:
    v_lshlrev_b32 v12, 16, v160
    v_and_b32 v13, 0xffff0000, v160
    v_lshlrev_b32 v14, 16, v161
    v_and_b32 v15, 0xffff0000, v161
    v_min_u32 v5, 95, v0
    v_lshlrev_b32 v5, 4, v5
    v_add_u32 v5, 147456, v5
    ds_write_b128 v5, v[12:15]

    v_and_b32 v60, 63, v0
    s_waitcnt vmcnt(0) lgkmcnt(0)
    s_lshl_b32 s60, s54, 6
    s_add_u32 s60, s60, 41959424
    v_mov_b32 v162, s60
    v_mov_b32 v163, 0x7ffffff0
    v_cmp_eq_u32 vcc, 0, v1
    s_cmp_eq_u32 s57, 0
    s_cselect_b64 s[62:63], -1, 0
    s_and_b64 vcc, vcc, s[62:63]
    s_add_u32 s60, s90, 1
    v_mov_b32 v164, s60
    v_cndmask_b32 v163, v163, v162, vcc
    buffer_store_dword v164, v163, s[16:19], 0 offen sc1

    s_barrier
    s_and_b32 s3, s2, 7
    s_lshr_b32 s4, s2, 3
    s_mul_i32 s5, s4, 171
    s_lshr_b32 s5, s5, 9
    s_mul_i32 s6, s5, 3
    s_sub_u32 s6, s4, s6
    s_lshr_b32 s7, s3, 1
    s_mul_i32 s7, s7, 3
    s_add_u32 s40, s7, s6
    s_and_b32 s7, s3, 1
    s_lshl_b32 s7, s7, 3
    s_add_u32 s39, s7, s5
    s_mul_i32 s45, s36, 6144
    s_mul_i32 s3, s39, 147456
    s_add_u32 s3, s3, s45
    s_add_u32 s44, s3, 0
    v_lshlrev_b32 v38, 4, v60
    s_mul_i32 s3, s36, 221184
    s_mul_i32 s4, s40, 768
    s_add_u32 s41, s3, s4
    s_mul_i32 s47, s36, 3072
    v_lshrrev_b32 v2, 3, v60
    v_and_b32 v3, 7, v60
    v_lshrrev_b32 v4, 1, v3
    v_and_b32 v5, 2, v2
    v_xor_b32 v4, v4, v5
    v_lshlrev_b32 v4, 1, v4
    v_and_b32 v3, 1, v3
    v_or_b32 v4, v4, v3
    v_lshlrev_b32 v7, 4, v4
    v_mul_u32_u24 v5, 9216, v2
    v_mov_b32 v6, v2
    v_add_u32 v32, v5, v7
    v_add_u32 v33, 72704, v32
    v_add_u32 v34, 145408, v32
    s_mul_i32 s3, s40, 768
    v_min_u32 v2, 95, v0
    v_lshlrev_b32 v2, 3, v2
    v_add_u32 v8, s3, v2

    s_add_u32 m0, s45, 24576
    s_add_u32 s63, s44, 24576
    buffer_load_dwordx4 v38, s[16:19], s63 offen sc1 lds
    buffer_load_dwordx4 v38, s[16:19], s63 offen offset:1024 sc1 lds
    buffer_load_dwordx4 v38, s[16:19], s63 offen offset:2048 sc1 lds
    buffer_load_dwordx4 v38, s[16:19], s63 offen offset:3072 sc1 lds
    s_add_u32 m0, s45, 28672
    s_add_u32 s63, s44, 28672
    buffer_load_dwordx4 v38, s[16:19], s63 offen sc1 lds
    buffer_load_dwordx4 v38, s[16:19], s63 offen offset:1024 sc1 lds
    s_add_u32 m0, s45, 49152
    s_add_u32 s63, s44, 49152
    buffer_load_dwordx4 v38, s[16:19], s63 offen sc1 lds
    buffer_load_dwordx4 v38, s[16:19], s63 offen offset:1024 sc1 lds
    buffer_load_dwordx4 v38, s[16:19], s63 offen offset:2048 sc1 lds
    buffer_load_dwordx4 v38, s[16:19], s63 offen offset:3072 sc1 lds
    s_add_u32 m0, s45, 53248
    s_add_u32 s63, s44, 53248
    buffer_load_dwordx4 v38, s[16:19], s63 offen sc1 lds
    buffer_load_dwordx4 v38, s[16:19], s63 offen offset:1024 sc1 lds
    s_lshr_b32 s37, s36, 1
    s_and_b32 s38, s36, 1
    s_mul_i32 s3, s40, 384
    s_mul_i32 s4, s36, 24
    s_add_u32 s3, s3, s4
    s_mul_i32 s42, s3, 1152
    s_add_u32 s43, s47, 98304
    s_mul_i32 s3, s39, 108
    s_add_u32 s3, s3, s40
    s_lshl_b32 s3, s3, 14
    s_lshl_b32 s4, s36, 12
    s_add_u32 s3, s3, s4
    s_add_u32 s49, s3, 7340032
    s_mov_b32 s66, 0xbdd2d0c8
    s_mov_b32 s67, 0xbdd2d0c8
    v_mov_b32 v56, 0xc0135761
    v_mov_b32 v57, 0xc0135761
    v_mul_u32_u24 v5, 1152, v6
    v_add_u32 v35, v5, v7
    v_add_u32 v36, 8192, v35
    v_add_u32 v37, 16384, v35
    v_mov_b32 v46, v38
    s_lshl_b32 s3, s37, 11
    v_add_u32 v39, s3, v38
    v_add_u32 v40, 49152, v39
    s_mul_i32 s3, s37, 49152
    v_add_u32 v41, s3, v38
    s_lshl_b32 s3, s38, 12
    v_add_u32 v42, s3, v41
    v_and_b32 v2, 3, v60
    v_bfe_u32 v3, v60, 2, 2
    v_bfe_u32 v4, v60, 4, 1
    v_lshrrev_b32 v5, 5, v60
    s_lshl_b32 s3, s38, 1
    v_add_u32 v4, s3, v4
    v_and_b32 v6, 2, v3
    v_xor_b32 v4, v4, v6
    v_lshlrev_b32 v4, 5, v4
    v_lshl_add_u32 v4, v2, 3, v4
    v_lshl_add_u32 v4, v3, 7, v4
    v_add_u32 v4, 98304, v4
    v_lshl_add_u32 v43, v5, 10, v4
    v_lshl_add_u32 v44, v5, 9, v4
    v_subrev_u32 v49, 98304, v44
    v_add_u32 v50, 61440, v49
    v_add_u32 v51, 122880, v49
    s_lshl_b32 s3, s38, 7
    s_add_u32 s3, s3, 147456
    v_lshlrev_b32 v45, 4, v5
    v_add_u32 v45, s3, v45
    s_mul_i32 s3, s39, 12
    s_add_u32 s3, s3, s40
    s_lshl_b32 s3, s3, 2
    s_add_u32 s3, s3, s36
    s_lshl_b32 s3, s3, 6
    s_add_u32 s3, s3, 42008576
    v_mov_b32 v2, s3
    v_mov_b32 v47, 0x7ffffff0
    v_cmp_eq_u32 vcc, 0, v60
    s_nop 1
    v_cndmask_b32 v47, v47, v2, vcc

    s_barrier
    ds_read_b128 v[152:155], v45 offset:0
    ds_read_b128 v[156:159], v45 offset:32
    ds_read_b128 v[160:163], v45 offset:64
    ds_read_b128 v[164:167], v45 offset:96
    ds_read_b128 a[0:3], v39 offset:0
    ds_read_b128 a[4:7], v39 offset:1024
    ds_read_b64_tr_b16 v[128:129], v43 offset:0
    ds_read_b64_tr_b16 v[130:131], v43 offset:512
    ds_read_b128 a[8:11], v39 offset:4096
    ds_read_b128 a[12:15], v39 offset:5120
    ds_read_b64_tr_b16 v[132:133], v43 offset:2048
    ds_read_b64_tr_b16 v[134:135], v43 offset:2560
    s_waitcnt lgkmcnt(4)
    v_mfma_f32_32x32x16_bf16 v[64:79], v[128:131], a[0:3], v[152:167]
    ds_read_b64_tr_b16 v[136:137], v43 offset:4096
    ds_read_b64_tr_b16 v[138:139], v43 offset:4608
    ds_read_b128 a[16:19], v39 offset:8192
    ds_read_b128 a[20:23], v39 offset:9216
    v_mfma_f32_32x32x16_bf16 v[80:95], v[128:131], a[4:7], v[152:167]
    s_add_u32 m0, s45, 73728
    s_add_u32 s63, s44, 73728
    buffer_load_dwordx4 v38, s[16:19], s63 offen sc1 lds
    buffer_load_dwordx4 v38, s[16:19], s63 offen offset:1024 sc1 lds
    buffer_load_dwordx4 v38, s[16:19], s63 offen offset:2048 sc1 lds
    s_waitcnt lgkmcnt(4)
    v_mfma_f32_32x32x16_bf16 v[64:79], v[132:135], a[8:11], v[64:79]
    ds_read_b64_tr_b16 v[140:141], v43 offset:6144
    ds_read_b64_tr_b16 v[142:143], v43 offset:6656
    ds_read_b128 a[24:27], v39 offset:12288
    ds_read_b128 a[28:31], v39 offset:13312
    v_mfma_f32_32x32x16_bf16 v[80:95], v[132:135], a[12:15], v[80:95]
    buffer_load_dwordx4 v38, s[16:19], s63 offen offset:3072 sc1 lds
    s_add_u32 m0, s45, 77824
    s_add_u32 s63, s44, 77824
    buffer_load_dwordx4 v38, s[16:19], s63 offen sc1 lds
    s_waitcnt lgkmcnt(4)
    v_mfma_f32_32x32x16_bf16 v[64:79], v[136:139], a[16:19], v[64:79]
    ds_read_b64_tr_b16 v[128:129], v43 offset:8192
    ds_read_b64_tr_b16 v[130:131], v43 offset:8704
    ds_read_b128 a[32:35], v39 offset:16384
    ds_read_b128 a[36:39], v39 offset:17408
    ds_read_b64_tr_b16 v[132:133], v43 offset:10240
    ds_read_b64_tr_b16 v[134:135], v43 offset:10752
    ds_read_b128 a[40:43], v39 offset:20480
    ds_read_b128 a[44:47], v39 offset:21504
    v_mfma_f32_32x32x16_bf16 v[80:95], v[136:139], a[20:23], v[80:95]
    buffer_load_dwordx4 v38, s[16:19], s63 offen offset:1024 sc1 lds
    s_add_u32 m0, s47, 135168
    s_add_u32 s62, s41, 2654208
    buffer_load_dwordx4 v32, s[8:11], s62 offen lds
    s_waitcnt lgkmcnt(8)
    v_mfma_f32_32x32x16_bf16 v[64:79], v[140:143], a[24:27], v[64:79]
    v_mfma_f32_32x32x16_bf16 v[80:95], v[140:143], a[28:31], v[80:95]
    buffer_load_dwordx4 v33, s[8:11], s62 offen offset:1024 lds
    buffer_load_dwordx4 v34, s[8:11], s62 offen offset:2048 lds
    s_waitcnt lgkmcnt(0)
    s_waitcnt vmcnt(15)
    s_barrier
    v_mfma_f32_32x32x16_bf16 v[64:79], v[128:131], a[32:35], v[64:79]
    ds_read_b64_tr_b16 v[136:137], v43 offset:12288
    ds_read_b64_tr_b16 v[138:139], v43 offset:12800
    ds_read_b128 a[48:51], v39 offset:24576
    ds_read_b128 a[52:55], v39 offset:25600
    v_mfma_f32_32x32x16_bf16 v[80:95], v[128:131], a[36:39], v[80:95]
    s_add_u32 m0, s45, 0
    s_add_u32 s63, s44, 98304
    buffer_load_dwordx4 v38, s[16:19], s63 offen sc1 lds
    buffer_load_dwordx4 v38, s[16:19], s63 offen offset:1024 sc1 lds
    v_mfma_f32_32x32x16_bf16 v[64:79], v[132:135], a[40:43], v[64:79]
    ds_read_b64_tr_b16 v[140:141], v43 offset:14336
    ds_read_b64_tr_b16 v[142:143], v43 offset:14848
    ds_read_b128 a[56:59], v39 offset:28672
    ds_read_b128 a[60:63], v39 offset:29696
    v_mfma_f32_32x32x16_bf16 v[80:95], v[132:135], a[44:47], v[80:95]
    buffer_load_dwordx4 v38, s[16:19], s63 offen offset:2048 sc1 lds
    buffer_load_dwordx4 v38, s[16:19], s63 offen offset:3072 sc1 lds
    s_waitcnt lgkmcnt(4)
    v_mfma_f32_32x32x16_bf16 v[64:79], v[136:139], a[48:51], v[64:79]
    ds_read_b64_tr_b16 v[128:129], v43 offset:16384
    ds_read_b64_tr_b16 v[130:131], v43 offset:16896
    ds_read_b128 a[64:67], v39 offset:32768
    ds_read_b128 a[68:71], v39 offset:33792
    v_mfma_f32_32x32x16_bf16 v[80:95], v[136:139], a[52:55], v[80:95]
    s_add_u32 m0, s45, 4096
    s_add_u32 s63, s44, 102400
    buffer_load_dwordx4 v38, s[16:19], s63 offen sc1 lds
    buffer_load_dwordx4 v38, s[16:19], s63 offen offset:1024 sc1 lds
    s_waitcnt lgkmcnt(4)
    v_mfma_f32_32x32x16_bf16 v[64:79], v[140:143], a[56:59], v[64:79]
    ds_read_b64_tr_b16 v[132:133], v43 offset:18432
    ds_read_b64_tr_b16 v[134:135], v43 offset:18944
    ds_read_b128 a[72:75], v39 offset:36864
    ds_read_b128 a[76:79], v39 offset:37888
    v_mfma_f32_32x32x16_bf16 v[80:95], v[140:143], a[60:63], v[80:95]
    s_add_u32 m0, s47, 98304
    s_add_u32 s62, s41, 3538944
    buffer_load_dwordx4 v32, s[8:11], s62 offen lds
    s_waitcnt lgkmcnt(4)
    v_mfma_f32_32x32x16_bf16 v[64:79], v[128:131], a[64:67], v[64:79]
    ds_read_b64_tr_b16 v[136:137], v43 offset:20480
    ds_read_b64_tr_b16 v[138:139], v43 offset:20992
    ds_read_b128 a[80:83], v39 offset:40960
    ds_read_b128 a[84:87], v39 offset:41984
    ds_read_b64_tr_b16 v[140:141], v43 offset:22528
    ds_read_b64_tr_b16 v[142:143], v43 offset:23040
    ds_read_b128 a[88:91], v39 offset:45056
    ds_read_b128 a[92:95], v39 offset:46080
    v_mfma_f32_32x32x16_bf16 v[80:95], v[128:131], a[68:71], v[80:95]
    s_waitcnt lgkmcnt(8)
    v_mfma_f32_32x32x16_bf16 v[64:79], v[132:135], a[72:75], v[64:79]
    v_mfma_f32_32x32x16_bf16 v[80:95], v[132:135], a[76:79], v[80:95]
    buffer_load_dwordx4 v33, s[8:11], s62 offen offset:1024 lds
    buffer_load_dwordx4 v34, s[8:11], s62 offen offset:2048 lds
    s_waitcnt lgkmcnt(0)
    s_waitcnt vmcnt(18)
    s_barrier
    v_mfma_f32_32x32x16_bf16 v[64:79], v[136:139], a[80:83], v[64:79]
    ds_read_b64_tr_b16 v[128:129], v43 offset:24576
    ds_read_b64_tr_b16 v[130:131], v43 offset:25088
    ds_read_b128 a[96:99], v40 offset:0
    ds_read_b128 a[100:103], v40 offset:1024
    v_mfma_f32_32x32x16_bf16 v[80:95], v[136:139], a[84:87], v[80:95]
    s_add_u32 m0, s45, 24576
    s_add_u32 s63, s44, 122880
    buffer_load_dwordx4 v38, s[16:19], s63 offen sc1 lds
    buffer_load_dwordx4 v38, s[16:19], s63 offen offset:1024 sc1 lds
    v_mfma_f32_32x32x16_bf16 v[64:79], v[140:143], a[88:91], v[64:79]
    ds_read_b64_tr_b16 v[132:133], v43 offset:26624
    ds_read_b64_tr_b16 v[134:135], v43 offset:27136
    ds_read_b128 a[104:107], v40 offset:4096
    ds_read_b128 a[108:111], v40 offset:5120
    v_mfma_f32_32x32x16_bf16 v[80:95], v[140:143], a[92:95], v[80:95]
    buffer_load_dwordx4 v38, s[16:19], s63 offen offset:2048 sc1 lds
    buffer_load_dwordx4 v38, s[16:19], s63 offen offset:3072 sc1 lds
    s_waitcnt lgkmcnt(4)
    v_mfma_f32_32x32x16_bf16 v[64:79], v[128:131], a[96:99], v[64:79]
    ds_read_b64_tr_b16 v[136:137], v43 offset:28672
    ds_read_b64_tr_b16 v[138:139], v43 offset:29184
    ds_read_b128 a[112:115], v40 offset:8192
    ds_read_b128 a[116:119], v40 offset:9216
    v_mfma_f32_32x32x16_bf16 v[80:95], v[128:131], a[100:103], v[80:95]
    s_add_u32 m0, s45, 28672
    s_add_u32 s63, s44, 126976
    buffer_load_dwordx4 v38, s[16:19], s63 offen sc1 lds
    buffer_load_dwordx4 v38, s[16:19], s63 offen offset:1024 sc1 lds
    s_waitcnt lgkmcnt(4)
    v_mfma_f32_32x32x16_bf16 v[64:79], v[132:135], a[104:107], v[64:79]
    ds_read_b64_tr_b16 v[140:141], v43 offset:30720
    ds_read_b64_tr_b16 v[142:143], v43 offset:31232
    ds_read_b128 a[120:123], v40 offset:12288
    ds_read_b128 a[124:127], v40 offset:13312
    v_mfma_f32_32x32x16_bf16 v[80:95], v[132:135], a[108:111], v[80:95]
    s_add_u32 m0, s47, 110592
    s_add_u32 s62, s41, 4423680
    buffer_load_dwordx4 v32, s[8:11], s62 offen lds
    s_waitcnt lgkmcnt(4)
    v_mfma_f32_32x32x16_bf16 v[64:79], v[136:139], a[112:115], v[64:79]
    ds_read_b64_tr_b16 v[128:129], v43 offset:32768
    ds_read_b64_tr_b16 v[130:131], v43 offset:33280
    ds_read_b128 a[128:131], v40 offset:16384
    ds_read_b128 a[132:135], v40 offset:17408
    ds_read_b64_tr_b16 v[132:133], v43 offset:34816
    ds_read_b64_tr_b16 v[134:135], v43 offset:35328
    ds_read_b128 a[136:139], v40 offset:20480
    ds_read_b128 a[140:143], v40 offset:21504
    v_mfma_f32_32x32x16_bf16 v[80:95], v[136:139], a[116:119], v[80:95]
    s_waitcnt lgkmcnt(8)
    v_mfma_f32_32x32x16_bf16 v[64:79], v[140:143], a[120:123], v[64:79]
    v_mfma_f32_32x32x16_bf16 v[80:95], v[140:143], a[124:127], v[80:95]
    buffer_load_dwordx4 v33, s[8:11], s62 offen offset:1024 lds
    buffer_load_dwordx4 v34, s[8:11], s62 offen offset:2048 lds
    s_waitcnt lgkmcnt(0)
    s_waitcnt vmcnt(18)
    s_barrier
    v_mfma_f32_32x32x16_bf16 v[64:79], v[128:131], a[128:131], v[64:79]
    ds_read_b64_tr_b16 v[136:137], v43 offset:36864
    ds_read_b64_tr_b16 v[138:139], v43 offset:37376
    ds_read_b128 a[144:147], v40 offset:24576
    ds_read_b128 a[148:151], v40 offset:25600
    v_mfma_f32_32x32x16_bf16 v[80:95], v[128:131], a[132:135], v[80:95]
    v_mfma_f32_32x32x16_bf16 v[64:79], v[132:135], a[136:139], v[64:79]
    ds_read_b64_tr_b16 v[140:141], v43 offset:38912
    ds_read_b64_tr_b16 v[142:143], v43 offset:39424
    ds_read_b128 a[152:155], v40 offset:28672
    ds_read_b128 a[156:159], v40 offset:29696
    v_mfma_f32_32x32x16_bf16 v[80:95], v[132:135], a[140:143], v[80:95]
    s_add_u32 m0, s47, 122880
    s_add_u32 s62, s41, 128
    buffer_load_dwordx4 v32, s[8:11], s62 offen lds
    s_waitcnt lgkmcnt(4)
    v_mfma_f32_32x32x16_bf16 v[64:79], v[136:139], a[144:147], v[64:79]
    ds_read_b64_tr_b16 v[128:129], v43 offset:40960
    ds_read_b64_tr_b16 v[130:131], v43 offset:41472
    ds_read_b128 a[160:163], v40 offset:32768
    ds_read_b128 a[164:167], v40 offset:33792
    v_mfma_f32_32x32x16_bf16 v[80:95], v[136:139], a[148:151], v[80:95]
    s_waitcnt lgkmcnt(4)
    v_mfma_f32_32x32x16_bf16 v[64:79], v[140:143], a[152:155], v[64:79]
    ds_read_b64_tr_b16 v[132:133], v43 offset:43008
    ds_read_b64_tr_b16 v[134:135], v43 offset:43520
    ds_read_b128 a[168:171], v40 offset:36864
    ds_read_b128 a[172:175], v40 offset:37888
    v_mfma_f32_32x32x16_bf16 v[80:95], v[140:143], a[156:159], v[80:95]
    buffer_load_dwordx4 v33, s[8:11], s62 offen offset:1024 lds
    s_waitcnt lgkmcnt(4)
    v_mfma_f32_32x32x16_bf16 v[64:79], v[128:131], a[160:163], v[64:79]
    ds_read_b64_tr_b16 v[136:137], v43 offset:45056
    ds_read_b64_tr_b16 v[138:139], v43 offset:45568
    ds_read_b128 a[176:179], v40 offset:40960
    ds_read_b128 a[180:183], v40 offset:41984
    ds_read_b64_tr_b16 v[140:141], v43 offset:47104
    ds_read_b64_tr_b16 v[142:143], v43 offset:47616
    ds_read_b128 a[184:187], v40 offset:45056
    ds_read_b128 a[188:191], v40 offset:46080
    ds_read_b128 v[152:155], v45 offset:256
    v_mfma_f32_32x32x16_bf16 v[80:95], v[128:131], a[164:167], v[80:95]
    s_waitcnt lgkmcnt(9)
    v_mfma_f32_32x32x16_bf16 v[64:79], v[132:135], a[168:171], v[64:79]
    ds_read_b128 v[156:159], v45 offset:288
    v_mfma_f32_32x32x16_bf16 v[80:95], v[132:135], a[172:175], v[80:95]
    buffer_load_dwordx4 v34, s[8:11], s62 offen offset:2048 lds
    s_waitcnt lgkmcnt(2)
    s_waitcnt vmcnt(12)
    s_barrier
    v_mfma_f32_32x32x16_bf16 v[64:79], v[136:139], a[176:179], v[64:79]
    ds_read_b64_tr_b16 v[128:129], v43 offset:0
    ds_read_b64_tr_b16 v[130:131], v43 offset:512
    ds_read_b128 a[192:195], v39 offset:0
    ds_read_b128 a[196:199], v39 offset:1024
    ds_read_b128 v[160:163], v45 offset:320
    v_mfma_f32_32x32x16_bf16 v[80:95], v[136:139], a[180:183], v[80:95]
    v_mfma_f32_32x32x16_bf16 v[64:79], v[140:143], a[184:187], v[64:79]
    ds_read_b64_tr_b16 v[132:133], v43 offset:2048
    ds_read_b64_tr_b16 v[134:135], v43 offset:2560
    ds_read_b128 a[200:203], v39 offset:4096
    ds_read_b128 a[204:207], v39 offset:5120
    ds_read_b128 v[164:167], v45 offset:352
    v_mfma_f32_32x32x16_bf16 v[80:95], v[140:143], a[188:191], v[80:95]
    s_add_u32 m0, s47, 135168
    s_add_u32 s62, s41, 884864
    buffer_load_dwordx4 v32, s[8:11], s62 offen lds
    s_waitcnt lgkmcnt(6)
    v_mfma_f32_32x32x16_bf16 v[64:79], v[128:131], a[192:195], v[64:79]
    ds_read_b64_tr_b16 v[136:137], v43 offset:4096
    ds_read_b64_tr_b16 v[138:139], v43 offset:4608
    ds_read_b128 a[208:211], v39 offset:8192
    ds_read_b128 a[212:215], v39 offset:9216
    v_mfma_f32_32x32x16_bf16 v[80:95], v[128:131], a[196:199], v[80:95]
    s_waitcnt lgkmcnt(5)
    v_mfma_f32_32x32x16_bf16 v[64:79], v[132:135], a[200:203], v[64:79]
    ds_read_b64_tr_b16 v[140:141], v43 offset:6144
    ds_read_b64_tr_b16 v[142:143], v43 offset:6656
    ds_read_b128 a[216:219], v39 offset:12288
    ds_read_b128 a[220:223], v39 offset:13312
    v_mfma_f32_32x32x16_bf16 v[80:95], v[132:135], a[204:207], v[80:95]
    buffer_load_dwordx4 v33, s[8:11], s62 offen offset:1024 lds
    s_waitcnt lgkmcnt(4)
    v_mfma_f32_32x32x16_bf16 v[64:79], v[136:139], a[208:211], v[64:79]
    ds_read_b64_tr_b16 v[128:129], v43 offset:8192
    ds_read_b64_tr_b16 v[130:131], v43 offset:8704
    ds_read_b128 a[224:227], v39 offset:16384
    ds_read_b128 a[228:231], v39 offset:17408
    ds_read_b64_tr_b16 v[132:133], v43 offset:10240
    ds_read_b64_tr_b16 v[134:135], v43 offset:10752
    ds_read_b128 a[232:235], v39 offset:20480
    ds_read_b128 a[236:239], v39 offset:21504
    v_mfma_f32_32x32x16_bf16 v[80:95], v[136:139], a[212:215], v[80:95]
    s_waitcnt lgkmcnt(8)
    v_mfma_f32_32x32x16_bf16 v[64:79], v[140:143], a[216:219], v[64:79]
    v_mfma_f32_32x32x16_bf16 v[80:95], v[140:143], a[220:223], v[80:95]
    buffer_load_dwordx4 v34, s[8:11], s62 offen offset:2048 lds
    s_waitcnt lgkmcnt(0)
    s_waitcnt vmcnt(6)
    s_barrier
    v_mfma_f32_32x32x16_bf16 v[64:79], v[128:131], a[224:227], v[64:79]
    ds_read_b64_tr_b16 v[136:137], v43 offset:12288
    ds_read_b64_tr_b16 v[138:139], v43 offset:12800
    ds_read_b128 a[240:243], v39 offset:24576
    ds_read_b128 a[244:247], v39 offset:25600
    v_mfma_f32_32x32x16_bf16 v[80:95], v[128:131], a[228:231], v[80:95]
    v_mfma_f32_32x32x16_bf16 v[64:79], v[132:135], a[232:235], v[64:79]
    ds_read_b64_tr_b16 v[140:141], v43 offset:14336
    ds_read_b64_tr_b16 v[142:143], v43 offset:14848
    ds_read_b128 a[248:251], v39 offset:28672
    ds_read_b128 a[252:255], v39 offset:29696
    v_mfma_f32_32x32x16_bf16 v[80:95], v[132:135], a[236:239], v[80:95]
    s_add_u32 m0, s47, 98304
    s_add_u32 s62, s41, 1769600
    buffer_load_dwordx4 v32, s[8:11], s62 offen lds
    s_waitcnt lgkmcnt(4)
    v_mfma_f32_32x32x16_bf16 v[64:79], v[136:139], a[240:243], v[64:79]
    ds_read_b64_tr_b16 v[128:129], v43 offset:16384
    ds_read_b64_tr_b16 v[130:131], v43 offset:16896
    ds_read_b128 v[224:227], v39 offset:32768
    ds_read_b128 v[228:231], v39 offset:33792
    v_mfma_f32_32x32x16_bf16 v[80:95], v[136:139], a[244:247], v[80:95]
    s_waitcnt lgkmcnt(4)
    v_mfma_f32_32x32x16_bf16 v[64:79], v[140:143], a[248:251], v[64:79]
    ds_read_b64_tr_b16 v[132:133], v43 offset:18432
    ds_read_b64_tr_b16 v[134:135], v43 offset:18944
    ds_read_b128 v[232:235], v39 offset:36864
    ds_read_b128 v[236:239], v39 offset:37888
    v_mfma_f32_32x32x16_bf16 v[80:95], v[140:143], a[252:255], v[80:95]
    buffer_load_dwordx4 v33, s[8:11], s62 offen offset:1024 lds
    s_waitcnt lgkmcnt(4)
    v_mfma_f32_32x32x16_bf16 v[64:79], v[128:131], v[224:227], v[64:79]
    ds_read_b64_tr_b16 v[136:137], v43 offset:20480
    ds_read_b64_tr_b16 v[138:139], v43 offset:20992
    ds_read_b128 v[240:243], v39 offset:40960
    ds_read_b128 v[244:247], v39 offset:41984
    ds_read_b64_tr_b16 v[140:141], v43 offset:22528
    ds_read_b64_tr_b16 v[142:143], v43 offset:23040
    ds_read_b128 v[248:251], v39 offset:45056
    ds_read_b128 v[252:255], v39 offset:46080
    v_mfma_f32_32x32x16_bf16 v[80:95], v[128:131], v[228:231], v[80:95]
    s_waitcnt lgkmcnt(8)
    v_mfma_f32_32x32x16_bf16 v[64:79], v[132:135], v[232:235], v[64:79]
    v_mfma_f32_32x32x16_bf16 v[80:95], v[132:135], v[236:239], v[80:95]
    buffer_load_dwordx4 v34, s[8:11], s62 offen offset:2048 lds
    s_waitcnt lgkmcnt(0)
    s_waitcnt vmcnt(6)
    s_barrier
    v_mfma_f32_32x32x16_bf16 v[64:79], v[136:139], v[240:243], v[64:79]
    ds_read_b64_tr_b16 v[128:129], v43 offset:24576
    ds_read_b64_tr_b16 v[130:131], v43 offset:25088
    v_mfma_f32_32x32x16_bf16 v[80:95], v[136:139], v[244:247], v[80:95]
    v_mfma_f32_32x32x16_bf16 v[64:79], v[140:143], v[248:251], v[64:79]
    ds_read_b64_tr_b16 v[132:133], v43 offset:26624
    ds_read_b64_tr_b16 v[134:135], v43 offset:27136
    v_mfma_f32_32x32x16_bf16 v[80:95], v[140:143], v[252:255], v[80:95]
    s_add_u32 m0, s47, 110592
    s_add_u32 s62, s41, 2654336
    buffer_load_dwordx4 v32, s[8:11], s62 offen lds
    s_waitcnt lgkmcnt(2)
    v_mfma_f32_32x32x16_bf16 v[96:111], v[128:131], a[0:3], v[152:167]
    ds_read_b64_tr_b16 v[136:137], v43 offset:28672
    ds_read_b64_tr_b16 v[138:139], v43 offset:29184
    v_mfma_f32_32x32x16_bf16 v[112:127], v[128:131], a[4:7], v[152:167]
    s_waitcnt lgkmcnt(2)
    v_mfma_f32_32x32x16_bf16 v[96:111], v[132:135], a[8:11], v[96:111]
    ds_read_b64_tr_b16 v[140:141], v43 offset:30720
    ds_read_b64_tr_b16 v[142:143], v43 offset:31232
    v_mul_f32 v168, v64, v64
    v_mul_f32 v169, v65, v65
    v_mul_f32 v170, v66, v66
    v_mul_f32 v171, v67, v67
    v_mfma_f32_32x32x16_bf16 v[112:127], v[132:135], a[12:15], v[112:127]
    buffer_load_dwordx4 v33, s[8:11], s62 offen offset:1024 lds
    v_mul_f32 v172, v68, v68
    v_mul_f32 v173, v69, v69
    v_mul_f32 v174, v70, v70
    s_waitcnt lgkmcnt(2)
    v_mfma_f32_32x32x16_bf16 v[96:111], v[136:139], a[16:19], v[96:111]
    ds_read_b64_tr_b16 v[128:129], v43 offset:32768
    ds_read_b64_tr_b16 v[130:131], v43 offset:33280
    ds_read_b64_tr_b16 v[132:133], v43 offset:34816
    ds_read_b64_tr_b16 v[134:135], v43 offset:35328
    v_mul_f32 v175, v71, v71
    v_mul_f32 v176, v72, v72
    v_mul_f32 v177, v73, v73
    v_mfma_f32_32x32x16_bf16 v[112:127], v[136:139], a[20:23], v[112:127]
    v_mul_f32 v178, v74, v74
    v_mul_f32 v179, v75, v75
    v_mul_f32 v180, v76, v76
    v_mul_f32 v181, v77, v77
    v_mul_f32 v182, v78, v78
    v_mul_f32 v183, v79, v79
    s_waitcnt lgkmcnt(4)
    v_mfma_f32_32x32x16_bf16 v[96:111], v[140:143], a[24:27], v[96:111]
    v_mul_f32 v184, v80, v80
    v_mul_f32 v185, v81, v81
    v_mul_f32 v186, v82, v82
    v_mul_f32 v187, v83, v83
    v_mfma_f32_32x32x16_bf16 v[112:127], v[140:143], a[28:31], v[112:127]
    buffer_load_dwordx4 v34, s[8:11], s62 offen offset:2048 lds
    s_waitcnt lgkmcnt(0)
    s_waitcnt vmcnt(6)
    s_barrier
    v_mfma_f32_32x32x16_bf16 v[96:111], v[128:131], a[32:35], v[96:111]
    ds_read_b64_tr_b16 v[136:137], v43 offset:36864
    ds_read_b64_tr_b16 v[138:139], v43 offset:37376
    v_mul_f32 v188, v84, v84
    v_mul_f32 v189, v85, v85
    v_mul_f32 v190, v86, v86
    v_mul_f32 v191, v87, v87
    v_mul_f32 v192, v88, v88
    v_mfma_f32_32x32x16_bf16 v[112:127], v[128:131], a[36:39], v[112:127]
    v_mul_f32 v193, v89, v89
    v_mul_f32 v194, v90, v90
    v_mul_f32 v195, v91, v91
    v_mul_f32 v196, v92, v92
    v_mul_f32 v197, v93, v93
    v_mul_f32 v198, v94, v94
    v_mul_f32 v199, v95, v95
    v_mfma_f32_32x32x16_bf16 v[96:111], v[132:135], a[40:43], v[96:111]
    ds_read_b64_tr_b16 v[140:141], v43 offset:38912
    ds_read_b64_tr_b16 v[142:143], v43 offset:39424
    v_mfma_f32_32x32x16_bf16 v[112:127], v[132:135], a[44:47], v[112:127]
    s_add_u32 m0, s47, 122880
    s_add_u32 s62, s41, 3539072
    buffer_load_dwordx4 v32, s[8:11], s62 offen lds
    v_pk_fma_f32 v[168:169], v[168:169], s[66:67], v[56:57]
    v_pk_fma_f32 v[170:171], v[170:171], s[66:67], v[56:57]
    v_pk_fma_f32 v[172:173], v[172:173], s[66:67], v[56:57]
    v_pk_fma_f32 v[174:175], v[174:175], s[66:67], v[56:57]
    v_pk_fma_f32 v[176:177], v[176:177], s[66:67], v[56:57]
    v_pk_fma_f32 v[178:179], v[178:179], s[66:67], v[56:57]
    v_pk_fma_f32 v[180:181], v[180:181], s[66:67], v[56:57]
    v_pk_fma_f32 v[182:183], v[182:183], s[66:67], v[56:57]
    v_pk_fma_f32 v[184:185], v[184:185], s[66:67], v[56:57]
    v_pk_fma_f32 v[186:187], v[186:187], s[66:67], v[56:57]
    v_pk_fma_f32 v[188:189], v[188:189], s[66:67], v[56:57]
    v_pk_fma_f32 v[190:191], v[190:191], s[66:67], v[56:57]
    v_pk_fma_f32 v[192:193], v[192:193], s[66:67], v[56:57]
    v_pk_fma_f32 v[194:195], v[194:195], s[66:67], v[56:57]
    v_pk_fma_f32 v[196:197], v[196:197], s[66:67], v[56:57]
    v_pk_fma_f32 v[198:199], v[198:199], s[66:67], v[56:57]
    v_pk_mul_f32 v[168:169], v[168:169], v[64:65]
    v_pk_mul_f32 v[170:171], v[170:171], v[66:67]
    v_pk_mul_f32 v[172:173], v[172:173], v[68:69]
    v_pk_mul_f32 v[174:175], v[174:175], v[70:71]
    v_pk_mul_f32 v[176:177], v[176:177], v[72:73]
    v_pk_mul_f32 v[178:179], v[178:179], v[74:75]
    v_pk_mul_f32 v[180:181], v[180:181], v[76:77]
    v_pk_mul_f32 v[182:183], v[182:183], v[78:79]
    v_pk_mul_f32 v[184:185], v[184:185], v[80:81]
    v_pk_mul_f32 v[186:187], v[186:187], v[82:83]
    v_pk_mul_f32 v[188:189], v[188:189], v[84:85]
    v_pk_mul_f32 v[190:191], v[190:191], v[86:87]
    v_pk_mul_f32 v[192:193], v[192:193], v[88:89]
    v_pk_mul_f32 v[194:195], v[194:195], v[90:91]
    v_pk_mul_f32 v[196:197], v[196:197], v[92:93]
    v_pk_mul_f32 v[198:199], v[198:199], v[94:95]
    s_waitcnt lgkmcnt(2)
    v_mfma_f32_32x32x16_bf16 v[96:111], v[136:139], a[48:51], v[96:111]
    ds_read_b64_tr_b16 v[128:129], v43 offset:40960
    ds_read_b64_tr_b16 v[130:131], v43 offset:41472
    v_exp_f32 v168, v168
    v_exp_f32 v169, v169
    v_mfma_f32_32x32x16_bf16 v[112:127], v[136:139], a[52:55], v[112:127]
    v_exp_f32 v170, v170
    v_exp_f32 v171, v171
    s_waitcnt lgkmcnt(2)
    v_mfma_f32_32x32x16_bf16 v[96:111], v[140:143], a[56:59], v[96:111]
    ds_read_b64_tr_b16 v[132:133], v43 offset:43008
    ds_read_b64_tr_b16 v[134:135], v43 offset:43520
    v_exp_f32 v172, v172
    v_exp_f32 v173, v173
    v_mfma_f32_32x32x16_bf16 v[112:127], v[140:143], a[60:63], v[112:127]
    buffer_load_dwordx4 v33, s[8:11], s62 offen offset:1024 lds
    v_exp_f32 v174, v174
    s_waitcnt lgkmcnt(2)
    v_mfma_f32_32x32x16_bf16 v[96:111], v[128:131], a[64:67], v[96:111]
    ds_read_b64_tr_b16 v[136:137], v43 offset:45056
    ds_read_b64_tr_b16 v[138:139], v43 offset:45568
    ds_read_b64_tr_b16 v[140:141], v43 offset:47104
    ds_read_b64_tr_b16 v[142:143], v43 offset:47616
    v_exp_f32 v175, v175
    v_add_f32 v168, 1.0, v168
    v_mfma_f32_32x32x16_bf16 v[112:127], v[128:131], a[68:71], v[112:127]
    v_add_f32 v169, 1.0, v169
    v_add_f32 v170, 1.0, v170
    v_add_f32 v171, 1.0, v171
    v_exp_f32 v176, v176
    v_exp_f32 v177, v177
    s_waitcnt lgkmcnt(4)
    v_mfma_f32_32x32x16_bf16 v[96:111], v[132:135], a[72:75], v[96:111]
    v_exp_f32 v178, v178
    v_exp_f32 v179, v179
    v_mfma_f32_32x32x16_bf16 v[112:127], v[132:135], a[76:79], v[112:127]
    buffer_load_dwordx4 v34, s[8:11], s62 offen offset:2048 lds
    s_waitcnt lgkmcnt(0)
    s_waitcnt vmcnt(6)
    s_barrier
    v_mfma_f32_32x32x16_bf16 v[96:111], v[136:139], a[80:83], v[96:111]
    ds_read_b64_tr_b16 v[128:129], v43 offset:0
    ds_read_b64_tr_b16 v[130:131], v43 offset:512
    v_add_f32 v172, 1.0, v172
    v_add_f32 v173, 1.0, v173
    v_add_f32 v174, 1.0, v174
    v_add_f32 v175, 1.0, v175
    v_mfma_f32_32x32x16_bf16 v[112:127], v[136:139], a[84:87], v[112:127]
    v_rcp_f32 v168, v168
    v_rcp_f32 v169, v169
    v_rcp_f32 v170, v170
    v_mfma_f32_32x32x16_bf16 v[96:111], v[140:143], a[88:91], v[96:111]
    ds_read_b64_tr_b16 v[132:133], v43 offset:2048
    ds_read_b64_tr_b16 v[134:135], v43 offset:2560
    v_rcp_f32 v171, v171
    v_exp_f32 v180, v180
    v_mfma_f32_32x32x16_bf16 v[112:127], v[140:143], a[92:95], v[112:127]
    s_add_u32 m0, s47, 135168
    s_add_u32 s62, s41, 4423808
    buffer_load_dwordx4 v32, s[8:11], s62 offen lds
    v_exp_f32 v181, v181
    s_waitcnt lgkmcnt(2)
    v_mfma_f32_32x32x16_bf16 v[96:111], v[128:131], a[96:99], v[96:111]
    ds_read_b64_tr_b16 v[136:137], v43 offset:4096
    ds_read_b64_tr_b16 v[138:139], v43 offset:4608
    v_exp_f32 v182, v182
    v_exp_f32 v183, v183
    v_add_f32 v176, 1.0, v176
    v_mfma_f32_32x32x16_bf16 v[112:127], v[128:131], a[100:103], v[112:127]
    v_add_f32 v177, 1.0, v177
    v_add_f32 v178, 1.0, v178
    v_add_f32 v179, 1.0, v179
    v_rcp_f32 v172, v172
    v_rcp_f32 v173, v173
    s_waitcnt lgkmcnt(2)
    v_mfma_f32_32x32x16_bf16 v[96:111], v[132:135], a[104:107], v[96:111]
    ds_read_b64_tr_b16 v[140:141], v43 offset:6144
    ds_read_b64_tr_b16 v[142:143], v43 offset:6656
    v_rcp_f32 v174, v174
    v_rcp_f32 v175, v175
    v_mfma_f32_32x32x16_bf16 v[112:127], v[132:135], a[108:111], v[112:127]
    buffer_load_dwordx4 v33, s[8:11], s62 offen offset:1024 lds
    v_exp_f32 v184, v184
    s_waitcnt lgkmcnt(2)
    v_mfma_f32_32x32x16_bf16 v[96:111], v[136:139], a[112:115], v[96:111]
    ds_read_b64_tr_b16 v[128:129], v43 offset:8192
    ds_read_b64_tr_b16 v[130:131], v43 offset:8704
    ds_read_b64_tr_b16 v[132:133], v43 offset:10240
    ds_read_b64_tr_b16 v[134:135], v43 offset:10752
    v_exp_f32 v185, v185
    v_mfma_f32_32x32x16_bf16 v[112:127], v[136:139], a[116:119], v[112:127]
    v_exp_f32 v186, v186
    v_exp_f32 v187, v187
    v_add_f32 v180, 1.0, v180
    v_add_f32 v181, 1.0, v181
    v_add_f32 v182, 1.0, v182
    s_waitcnt lgkmcnt(4)
    v_mfma_f32_32x32x16_bf16 v[96:111], v[140:143], a[120:123], v[96:111]
    v_add_f32 v183, 1.0, v183
    v_rcp_f32 v176, v176
    v_rcp_f32 v177, v177
    v_mfma_f32_32x32x16_bf16 v[112:127], v[140:143], a[124:127], v[112:127]
    buffer_load_dwordx4 v34, s[8:11], s62 offen offset:2048 lds
    s_waitcnt lgkmcnt(0)
    s_waitcnt vmcnt(6)
    s_barrier
    v_mfma_f32_32x32x16_bf16 v[96:111], v[128:131], a[128:131], v[96:111]
    ds_read_b64_tr_b16 v[136:137], v43 offset:12288
    ds_read_b64_tr_b16 v[138:139], v43 offset:12800
    v_rcp_f32 v178, v178
    v_rcp_f32 v179, v179
    v_mfma_f32_32x32x16_bf16 v[112:127], v[128:131], a[132:135], v[112:127]
    v_exp_f32 v188, v188
    v_exp_f32 v189, v189
    v_exp_f32 v190, v190
    v_mfma_f32_32x32x16_bf16 v[96:111], v[132:135], a[136:139], v[96:111]
    ds_read_b64_tr_b16 v[140:141], v43 offset:14336
    ds_read_b64_tr_b16 v[142:143], v43 offset:14848
    v_exp_f32 v191, v191
    v_add_f32 v184, 1.0, v184
    v_add_f32 v185, 1.0, v185
    v_add_f32 v186, 1.0, v186
    v_mfma_f32_32x32x16_bf16 v[112:127], v[132:135], a[140:143], v[112:127]
    s_add_u32 m0, s47, 98304
    s_add_u32 s62, s41, 256
    buffer_load_dwordx4 v32, s[8:11], s62 offen lds
    v_add_f32 v187, 1.0, v187
    v_rcp_f32 v180, v180
    s_waitcnt lgkmcnt(2)
    v_mfma_f32_32x32x16_bf16 v[96:111], v[136:139], a[144:147], v[96:111]
    ds_read_b64_tr_b16 v[128:129], v43 offset:16384
    ds_read_b64_tr_b16 v[130:131], v43 offset:16896
    v_rcp_f32 v181, v181
    v_rcp_f32 v182, v182
    v_mfma_f32_32x32x16_bf16 v[112:127], v[136:139], a[148:151], v[112:127]
    v_rcp_f32 v183, v183
    v_exp_f32 v192, v192
    v_exp_f32 v193, v193
    s_waitcnt lgkmcnt(2)
    v_mfma_f32_32x32x16_bf16 v[96:111], v[140:143], a[152:155], v[96:111]
    ds_read_b64_tr_b16 v[132:133], v43 offset:18432
    ds_read_b64_tr_b16 v[134:135], v43 offset:18944
    v_exp_f32 v194, v194
    v_exp_f32 v195, v195
    v_mfma_f32_32x32x16_bf16 v[112:127], v[140:143], a[156:159], v[112:127]
    buffer_load_dwordx4 v33, s[8:11], s62 offen offset:1024 lds
    v_add_f32 v188, 1.0, v188
    v_add_f32 v189, 1.0, v189
    v_add_f32 v190, 1.0, v190
    s_waitcnt lgkmcnt(2)
    v_mfma_f32_32x32x16_bf16 v[96:111], v[128:131], a[160:163], v[96:111]
    ds_read_b64_tr_b16 v[136:137], v43 offset:20480
    ds_read_b64_tr_b16 v[138:139], v43 offset:20992
    ds_read_b64_tr_b16 v[140:141], v43 offset:22528
    ds_read_b64_tr_b16 v[142:143], v43 offset:23040
    ds_read_b128 v[152:155], v45 offset:512
    v_add_f32 v191, 1.0, v191
    v_mfma_f32_32x32x16_bf16 v[112:127], v[128:131], a[164:167], v[112:127]
    v_rcp_f32 v184, v184
    v_rcp_f32 v185, v185
    v_rcp_f32 v186, v186
    s_waitcnt lgkmcnt(5)
    v_mfma_f32_32x32x16_bf16 v[96:111], v[132:135], a[168:171], v[96:111]
    ds_read_b128 v[156:159], v45 offset:544
    v_rcp_f32 v187, v187
    v_exp_f32 v196, v196
    v_exp_f32 v197, v197
    v_mfma_f32_32x32x16_bf16 v[112:127], v[132:135], a[172:175], v[112:127]
    buffer_load_dwordx4 v34, s[8:11], s62 offen offset:2048 lds
    s_waitcnt lgkmcnt(2)
    s_waitcnt vmcnt(6)
    s_barrier
    v_mfma_f32_32x32x16_bf16 v[96:111], v[136:139], a[176:179], v[96:111]
    ds_read_b64_tr_b16 v[128:129], v43 offset:24576
    ds_read_b64_tr_b16 v[130:131], v43 offset:25088
    ds_read_b128 v[160:163], v45 offset:576
    v_exp_f32 v198, v198
    v_exp_f32 v199, v199
    v_mfma_f32_32x32x16_bf16 v[112:127], v[136:139], a[180:183], v[112:127]
    v_add_f32 v192, 1.0, v192
    v_add_f32 v193, 1.0, v193
    v_add_f32 v194, 1.0, v194
    v_add_f32 v195, 1.0, v195
    v_rcp_f32 v188, v188
    v_mfma_f32_32x32x16_bf16 v[96:111], v[140:143], a[184:187], v[96:111]
    ds_read_b64_tr_b16 v[132:133], v43 offset:26624
    ds_read_b64_tr_b16 v[134:135], v43 offset:27136
    ds_read_b128 v[164:167], v45 offset:608
    v_rcp_f32 v189, v189
    v_rcp_f32 v190, v190
    v_mfma_f32_32x32x16_bf16 v[112:127], v[140:143], a[188:191], v[112:127]
    s_add_u32 m0, s47, 110592
    s_add_u32 s62, s41, 884992
    buffer_load_dwordx4 v32, s[8:11], s62 offen lds
    v_rcp_f32 v191, v191
    v_add_f32 v196, 1.0, v196
    s_waitcnt lgkmcnt(4)
    v_mfma_f32_32x32x16_bf16 v[96:111], v[128:131], a[192:195], v[96:111]
    ds_read_b64_tr_b16 v[136:137], v43 offset:28672
    ds_read_b64_tr_b16 v[138:139], v43 offset:29184
    v_add_f32 v197, 1.0, v197
    v_add_f32 v198, 1.0, v198
    v_add_f32 v199, 1.0, v199
    v_rcp_f32 v192, v192
    v_mfma_f32_32x32x16_bf16 v[112:127], v[128:131], a[196:199], v[112:127]
    v_rcp_f32 v193, v193
    v_rcp_f32 v194, v194
    v_rcp_f32 v195, v195
    s_waitcnt lgkmcnt(3)
    v_mfma_f32_32x32x16_bf16 v[96:111], v[132:135], a[200:203], v[96:111]
    ds_read_b64_tr_b16 v[140:141], v43 offset:30720
    ds_read_b64_tr_b16 v[142:143], v43 offset:31232
    v_rcp_f32 v196, v196
    v_rcp_f32 v197, v197
    v_mfma_f32_32x32x16_bf16 v[112:127], v[132:135], a[204:207], v[112:127]
    buffer_load_dwordx4 v33, s[8:11], s62 offen offset:1024 lds
    v_rcp_f32 v198, v198
    s_waitcnt lgkmcnt(2)
    v_mfma_f32_32x32x16_bf16 v[96:111], v[136:139], a[208:211], v[96:111]
    ds_read_b64_tr_b16 v[128:129], v43 offset:32768
    ds_read_b64_tr_b16 v[130:131], v43 offset:33280
    ds_read_b64_tr_b16 v[132:133], v43 offset:34816
    ds_read_b64_tr_b16 v[134:135], v43 offset:35328
    v_rcp_f32 v199, v199
    v_mul_f32 v168, v168, v64
    v_mfma_f32_32x32x16_bf16 v[112:127], v[136:139], a[212:215], v[112:127]
    v_mul_f32 v169, v169, v65
    v_mul_f32 v170, v170, v66
    v_mul_f32 v171, v171, v67
    v_mul_f32 v172, v172, v68
    v_mul_f32 v173, v173, v69
    v_mul_f32 v174, v174, v70
    v_mul_f32 v175, v175, v71
    s_waitcnt lgkmcnt(4)
    v_mfma_f32_32x32x16_bf16 v[96:111], v[140:143], a[216:219], v[96:111]
    v_cvt_pk_bf16_f32 v200, v168, v169
    v_cvt_pk_bf16_f32 v201, v170, v171
    v_cvt_pk_bf16_f32 v202, v172, v173
    v_cvt_pk_bf16_f32 v203, v174, v175
    v_mfma_f32_32x32x16_bf16 v[112:127], v[140:143], a[220:223], v[112:127]
    buffer_load_dwordx4 v34, s[8:11], s62 offen offset:2048 lds
    s_waitcnt lgkmcnt(0)
    s_waitcnt vmcnt(6)
    s_barrier
    v_mfma_f32_32x32x16_bf16 v[96:111], v[128:131], a[224:227], v[96:111]
    ds_read_b64_tr_b16 v[136:137], v43 offset:36864
    ds_read_b64_tr_b16 v[138:139], v43 offset:37376
    ds_write_b128 v42, v[200:203] offset:0
    v_mul_f32 v176, v176, v72
    v_mfma_f32_32x32x16_bf16 v[112:127], v[128:131], a[228:231], v[112:127]
    v_mul_f32 v177, v177, v73
    v_mul_f32 v178, v178, v74
    v_mul_f32 v179, v179, v75
    v_mul_f32 v180, v180, v76
    v_mul_f32 v181, v181, v77
    v_mul_f32 v182, v182, v78
    v_mul_f32 v183, v183, v79
    v_mfma_f32_32x32x16_bf16 v[96:111], v[132:135], a[232:235], v[96:111]
    ds_read_b64_tr_b16 v[140:141], v43 offset:38912
    ds_read_b64_tr_b16 v[142:143], v43 offset:39424
    v_cvt_pk_bf16_f32 v204, v176, v177
    v_cvt_pk_bf16_f32 v205, v178, v179
    v_cvt_pk_bf16_f32 v206, v180, v181
    v_cvt_pk_bf16_f32 v207, v182, v183
    v_mfma_f32_32x32x16_bf16 v[112:127], v[132:135], a[236:239], v[112:127]
    s_add_u32 m0, s47, 122880
    s_add_u32 s62, s41, 1769728
    buffer_load_dwordx4 v32, s[8:11], s62 offen lds
    ds_write_b128 v42, v[204:207] offset:2048
    s_waitcnt lgkmcnt(4)
    v_mfma_f32_32x32x16_bf16 v[96:111], v[136:139], a[240:243], v[96:111]
    ds_read_b64_tr_b16 v[128:129], v43 offset:40960
    ds_read_b64_tr_b16 v[130:131], v43 offset:41472
    v_mul_f32 v184, v184, v80
    v_mul_f32 v185, v185, v81
    v_mul_f32 v186, v186, v82
    v_mul_f32 v187, v187, v83
    v_mfma_f32_32x32x16_bf16 v[112:127], v[136:139], a[244:247], v[112:127]
    v_mul_f32 v188, v188, v84
    v_mul_f32 v189, v189, v85
    v_mul_f32 v190, v190, v86
    v_mul_f32 v191, v191, v87
    s_waitcnt lgkmcnt(3)
    v_mfma_f32_32x32x16_bf16 v[96:111], v[140:143], a[248:251], v[96:111]
    ds_read_b64_tr_b16 v[132:133], v43 offset:43008
    ds_read_b64_tr_b16 v[134:135], v43 offset:43520
    v_cvt_pk_bf16_f32 v208, v184, v185
    v_cvt_pk_bf16_f32 v209, v186, v187
    v_cvt_pk_bf16_f32 v210, v188, v189
    v_cvt_pk_bf16_f32 v211, v190, v191
    v_mfma_f32_32x32x16_bf16 v[112:127], v[140:143], a[252:255], v[112:127]
    buffer_load_dwordx4 v33, s[8:11], s62 offen offset:1024 lds
    ds_write_b128 v42, v[208:211] offset:1024
    s_waitcnt lgkmcnt(3)
    v_mfma_f32_32x32x16_bf16 v[96:111], v[128:131], v[224:227], v[96:111]
    ds_read_b64_tr_b16 v[136:137], v43 offset:45056
    ds_read_b64_tr_b16 v[138:139], v43 offset:45568
    ds_read_b64_tr_b16 v[140:141], v43 offset:47104
    ds_read_b64_tr_b16 v[142:143], v43 offset:47616
    v_mul_f32 v192, v192, v88
    v_mul_f32 v193, v193, v89
    v_mul_f32 v194, v194, v90
    v_mfma_f32_32x32x16_bf16 v[112:127], v[128:131], v[228:231], v[112:127]
    v_mul_f32 v195, v195, v91
    v_mul_f32 v196, v196, v92
    v_mul_f32 v197, v197, v93
    v_mul_f32 v198, v198, v94
    v_mul_f32 v199, v199, v95
    s_waitcnt lgkmcnt(5)
    v_mfma_f32_32x32x16_bf16 v[96:111], v[132:135], v[232:235], v[96:111]
    v_cvt_pk_bf16_f32 v212, v192, v193
    v_cvt_pk_bf16_f32 v213, v194, v195
    v_cvt_pk_bf16_f32 v214, v196, v197
    v_cvt_pk_bf16_f32 v215, v198, v199
    v_mfma_f32_32x32x16_bf16 v[112:127], v[132:135], v[236:239], v[112:127]
    buffer_load_dwordx4 v34, s[8:11], s62 offen offset:2048 lds
    s_waitcnt lgkmcnt(0)
    s_waitcnt vmcnt(6)
    s_barrier
    v_mfma_f32_32x32x16_bf16 v[96:111], v[136:139], v[240:243], v[96:111]
    ds_read_b64_tr_b16 v[128:129], v43 offset:0
    ds_read_b64_tr_b16 v[130:131], v43 offset:512
    ds_write_b128 v42, v[212:215] offset:3072
    v_mfma_f32_32x32x16_bf16 v[112:127], v[136:139], v[244:247], v[112:127]
    v_mfma_f32_32x32x16_bf16 v[96:111], v[140:143], v[248:251], v[96:111]
    ds_read_b64_tr_b16 v[132:133], v43 offset:2048
    ds_read_b64_tr_b16 v[134:135], v43 offset:2560
    v_mfma_f32_32x32x16_bf16 v[112:127], v[140:143], v[252:255], v[112:127]
    s_add_u32 m0, s47, 135168
    s_add_u32 s62, s41, 2654464
    buffer_load_dwordx4 v32, s[8:11], s62 offen lds
    s_waitcnt lgkmcnt(3)
    v_mfma_f32_32x32x16_bf16 v[64:79], v[128:131], a[0:3], v[152:167]
    ds_read_b64_tr_b16 v[136:137], v43 offset:4096
    ds_read_b64_tr_b16 v[138:139], v43 offset:4608
    v_mfma_f32_32x32x16_bf16 v[80:95], v[128:131], a[4:7], v[152:167]
    s_waitcnt lgkmcnt(2)
    v_mfma_f32_32x32x16_bf16 v[64:79], v[132:135], a[8:11], v[64:79]
    ds_read_b64_tr_b16 v[140:141], v43 offset:6144
    ds_read_b64_tr_b16 v[142:143], v43 offset:6656
    v_mul_f32 v168, v96, v96
    v_mul_f32 v169, v97, v97
    v_mul_f32 v170, v98, v98
    v_mul_f32 v171, v99, v99
    v_mfma_f32_32x32x16_bf16 v[80:95], v[132:135], a[12:15], v[80:95]
    buffer_load_dwordx4 v33, s[8:11], s62 offen offset:1024 lds
    v_mul_f32 v172, v100, v100
    v_mul_f32 v173, v101, v101
    v_mul_f32 v174, v102, v102
    s_waitcnt lgkmcnt(2)
    v_mfma_f32_32x32x16_bf16 v[64:79], v[136:139], a[16:19], v[64:79]
    ds_read_b64_tr_b16 v[128:129], v43 offset:8192
    ds_read_b64_tr_b16 v[130:131], v43 offset:8704
    ds_read_b64_tr_b16 v[132:133], v43 offset:10240
    ds_read_b64_tr_b16 v[134:135], v43 offset:10752
    v_mul_f32 v175, v103, v103
    v_mul_f32 v176, v104, v104
    v_mul_f32 v177, v105, v105
    v_mfma_f32_32x32x16_bf16 v[80:95], v[136:139], a[20:23], v[80:95]
    v_mul_f32 v178, v106, v106
    v_mul_f32 v179, v107, v107
    v_mul_f32 v180, v108, v108
    v_mul_f32 v181, v109, v109
    v_mul_f32 v182, v110, v110
    v_mul_f32 v183, v111, v111
    s_waitcnt lgkmcnt(4)
    v_mfma_f32_32x32x16_bf16 v[64:79], v[140:143], a[24:27], v[64:79]
    v_mul_f32 v184, v112, v112
    v_mul_f32 v185, v113, v113
    v_mul_f32 v186, v114, v114
    v_mul_f32 v187, v115, v115
    v_mfma_f32_32x32x16_bf16 v[80:95], v[140:143], a[28:31], v[80:95]
    buffer_load_dwordx4 v34, s[8:11], s62 offen offset:2048 lds
    s_waitcnt lgkmcnt(0)
    s_waitcnt vmcnt(6)
    s_barrier
    v_mfma_f32_32x32x16_bf16 v[64:79], v[128:131], a[32:35], v[64:79]
    ds_read_b64_tr_b16 v[136:137], v43 offset:12288
    ds_read_b64_tr_b16 v[138:139], v43 offset:12800
    v_mul_f32 v188, v116, v116
    v_mul_f32 v189, v117, v117
    v_mul_f32 v190, v118, v118
    v_mul_f32 v191, v119, v119
    v_mul_f32 v192, v120, v120
    v_mfma_f32_32x32x16_bf16 v[80:95], v[128:131], a[36:39], v[80:95]
    v_mul_f32 v193, v121, v121
    v_mul_f32 v194, v122, v122
    v_mul_f32 v195, v123, v123
    v_mul_f32 v196, v124, v124
    v_mul_f32 v197, v125, v125
    v_mul_f32 v198, v126, v126
    v_mul_f32 v199, v127, v127
    v_mfma_f32_32x32x16_bf16 v[64:79], v[132:135], a[40:43], v[64:79]
    ds_read_b64_tr_b16 v[140:141], v43 offset:14336
    ds_read_b64_tr_b16 v[142:143], v43 offset:14848
    v_mfma_f32_32x32x16_bf16 v[80:95], v[132:135], a[44:47], v[80:95]
    s_add_u32 m0, s47, 98304
    s_add_u32 s62, s41, 3539200
    buffer_load_dwordx4 v32, s[8:11], s62 offen lds
    v_pk_fma_f32 v[168:169], v[168:169], s[66:67], v[56:57]
    v_pk_fma_f32 v[170:171], v[170:171], s[66:67], v[56:57]
    v_pk_fma_f32 v[172:173], v[172:173], s[66:67], v[56:57]
    v_pk_fma_f32 v[174:175], v[174:175], s[66:67], v[56:57]
    v_pk_fma_f32 v[176:177], v[176:177], s[66:67], v[56:57]
    v_pk_fma_f32 v[178:179], v[178:179], s[66:67], v[56:57]
    v_pk_fma_f32 v[180:181], v[180:181], s[66:67], v[56:57]
    v_pk_fma_f32 v[182:183], v[182:183], s[66:67], v[56:57]
    v_pk_fma_f32 v[184:185], v[184:185], s[66:67], v[56:57]
    v_pk_fma_f32 v[186:187], v[186:187], s[66:67], v[56:57]
    v_pk_fma_f32 v[188:189], v[188:189], s[66:67], v[56:57]
    v_pk_fma_f32 v[190:191], v[190:191], s[66:67], v[56:57]
    v_pk_fma_f32 v[192:193], v[192:193], s[66:67], v[56:57]
    v_pk_fma_f32 v[194:195], v[194:195], s[66:67], v[56:57]
    v_pk_fma_f32 v[196:197], v[196:197], s[66:67], v[56:57]
    v_pk_fma_f32 v[198:199], v[198:199], s[66:67], v[56:57]
    v_pk_mul_f32 v[168:169], v[168:169], v[96:97]
    v_pk_mul_f32 v[170:171], v[170:171], v[98:99]
    v_pk_mul_f32 v[172:173], v[172:173], v[100:101]
    v_pk_mul_f32 v[174:175], v[174:175], v[102:103]
    v_pk_mul_f32 v[176:177], v[176:177], v[104:105]
    v_pk_mul_f32 v[178:179], v[178:179], v[106:107]
    v_pk_mul_f32 v[180:181], v[180:181], v[108:109]
    v_pk_mul_f32 v[182:183], v[182:183], v[110:111]
    v_pk_mul_f32 v[184:185], v[184:185], v[112:113]
    v_pk_mul_f32 v[186:187], v[186:187], v[114:115]
    v_pk_mul_f32 v[188:189], v[188:189], v[116:117]
    v_pk_mul_f32 v[190:191], v[190:191], v[118:119]
    v_pk_mul_f32 v[192:193], v[192:193], v[120:121]
    v_pk_mul_f32 v[194:195], v[194:195], v[122:123]
    v_pk_mul_f32 v[196:197], v[196:197], v[124:125]
    v_pk_mul_f32 v[198:199], v[198:199], v[126:127]
    s_waitcnt lgkmcnt(2)
    v_mfma_f32_32x32x16_bf16 v[64:79], v[136:139], a[48:51], v[64:79]
    ds_read_b64_tr_b16 v[128:129], v43 offset:16384
    ds_read_b64_tr_b16 v[130:131], v43 offset:16896
    v_exp_f32 v168, v168
    v_exp_f32 v169, v169
    v_mfma_f32_32x32x16_bf16 v[80:95], v[136:139], a[52:55], v[80:95]
    v_exp_f32 v170, v170
    v_exp_f32 v171, v171
    s_waitcnt lgkmcnt(2)
    v_mfma_f32_32x32x16_bf16 v[64:79], v[140:143], a[56:59], v[64:79]
    ds_read_b64_tr_b16 v[132:133], v43 offset:18432
    ds_read_b64_tr_b16 v[134:135], v43 offset:18944
    v_exp_f32 v172, v172
    v_exp_f32 v173, v173
    v_mfma_f32_32x32x16_bf16 v[80:95], v[140:143], a[60:63], v[80:95]
    buffer_load_dwordx4 v33, s[8:11], s62 offen offset:1024 lds
    v_exp_f32 v174, v174
    s_waitcnt lgkmcnt(2)
    v_mfma_f32_32x32x16_bf16 v[64:79], v[128:131], a[64:67], v[64:79]
    ds_read_b64_tr_b16 v[136:137], v43 offset:20480
    ds_read_b64_tr_b16 v[138:139], v43 offset:20992
    ds_read_b64_tr_b16 v[140:141], v43 offset:22528
    ds_read_b64_tr_b16 v[142:143], v43 offset:23040
    v_exp_f32 v175, v175
    v_add_f32 v168, 1.0, v168
    v_mfma_f32_32x32x16_bf16 v[80:95], v[128:131], a[68:71], v[80:95]
    v_add_f32 v169, 1.0, v169
    v_add_f32 v170, 1.0, v170
    v_add_f32 v171, 1.0, v171
    v_exp_f32 v176, v176
    v_exp_f32 v177, v177
    s_waitcnt lgkmcnt(4)
    v_mfma_f32_32x32x16_bf16 v[64:79], v[132:135], a[72:75], v[64:79]
    v_exp_f32 v178, v178
    v_exp_f32 v179, v179
    v_mfma_f32_32x32x16_bf16 v[80:95], v[132:135], a[76:79], v[80:95]
    buffer_load_dwordx4 v34, s[8:11], s62 offen offset:2048 lds
    s_waitcnt lgkmcnt(0)
    s_waitcnt vmcnt(6)
    s_barrier
    v_mfma_f32_32x32x16_bf16 v[64:79], v[136:139], a[80:83], v[64:79]
    ds_read_b64_tr_b16 v[128:129], v43 offset:24576
    ds_read_b64_tr_b16 v[130:131], v43 offset:25088
    v_add_f32 v172, 1.0, v172
    v_add_f32 v173, 1.0, v173
    v_add_f32 v174, 1.0, v174
    v_add_f32 v175, 1.0, v175
    v_mfma_f32_32x32x16_bf16 v[80:95], v[136:139], a[84:87], v[80:95]
    v_rcp_f32 v168, v168
    v_rcp_f32 v169, v169
    v_rcp_f32 v170, v170
    v_mfma_f32_32x32x16_bf16 v[64:79], v[140:143], a[88:91], v[64:79]
    ds_read_b64_tr_b16 v[132:133], v43 offset:26624
    ds_read_b64_tr_b16 v[134:135], v43 offset:27136
    v_rcp_f32 v171, v171
    v_exp_f32 v180, v180
    v_mfma_f32_32x32x16_bf16 v[80:95], v[140:143], a[92:95], v[80:95]
    s_add_u32 m0, s47, 110592
    s_add_u32 s62, s41, 4423936
    buffer_load_dwordx4 v32, s[8:11], s62 offen lds
    v_exp_f32 v181, v181
    s_waitcnt lgkmcnt(2)
    v_mfma_f32_32x32x16_bf16 v[64:79], v[128:131], a[96:99], v[64:79]
    ds_read_b64_tr_b16 v[136:137], v43 offset:28672
    ds_read_b64_tr_b16 v[138:139], v43 offset:29184
    v_exp_f32 v182, v182
    v_exp_f32 v183, v183
    v_add_f32 v176, 1.0, v176
    v_mfma_f32_32x32x16_bf16 v[80:95], v[128:131], a[100:103], v[80:95]
    v_add_f32 v177, 1.0, v177
    v_add_f32 v178, 1.0, v178
    v_add_f32 v179, 1.0, v179
    v_rcp_f32 v172, v172
    v_rcp_f32 v173, v173
    s_waitcnt lgkmcnt(2)
    v_mfma_f32_32x32x16_bf16 v[64:79], v[132:135], a[104:107], v[64:79]
    ds_read_b64_tr_b16 v[140:141], v43 offset:30720
    ds_read_b64_tr_b16 v[142:143], v43 offset:31232
    v_rcp_f32 v174, v174
    v_rcp_f32 v175, v175
    v_mfma_f32_32x32x16_bf16 v[80:95], v[132:135], a[108:111], v[80:95]
    buffer_load_dwordx4 v33, s[8:11], s62 offen offset:1024 lds
    v_exp_f32 v184, v184
    s_waitcnt lgkmcnt(2)
    v_mfma_f32_32x32x16_bf16 v[64:79], v[136:139], a[112:115], v[64:79]
    ds_read_b64_tr_b16 v[128:129], v43 offset:32768
    ds_read_b64_tr_b16 v[130:131], v43 offset:33280
    ds_read_b64_tr_b16 v[132:133], v43 offset:34816
    ds_read_b64_tr_b16 v[134:135], v43 offset:35328
    v_exp_f32 v185, v185
    v_mfma_f32_32x32x16_bf16 v[80:95], v[136:139], a[116:119], v[80:95]
    v_exp_f32 v186, v186
    v_exp_f32 v187, v187
    v_add_f32 v180, 1.0, v180
    v_add_f32 v181, 1.0, v181
    v_add_f32 v182, 1.0, v182
    s_waitcnt lgkmcnt(4)
    v_mfma_f32_32x32x16_bf16 v[64:79], v[140:143], a[120:123], v[64:79]
    v_add_f32 v183, 1.0, v183
    v_rcp_f32 v176, v176
    v_rcp_f32 v177, v177
    v_mfma_f32_32x32x16_bf16 v[80:95], v[140:143], a[124:127], v[80:95]
    buffer_load_dwordx4 v34, s[8:11], s62 offen offset:2048 lds
    s_waitcnt lgkmcnt(0)
    s_waitcnt vmcnt(6)
    s_barrier
    v_mfma_f32_32x32x16_bf16 v[64:79], v[128:131], a[128:131], v[64:79]
    ds_read_b64_tr_b16 v[136:137], v43 offset:36864
    ds_read_b64_tr_b16 v[138:139], v43 offset:37376
    v_rcp_f32 v178, v178
    v_rcp_f32 v179, v179
    v_mfma_f32_32x32x16_bf16 v[80:95], v[128:131], a[132:135], v[80:95]
    v_exp_f32 v188, v188
    v_exp_f32 v189, v189
    v_exp_f32 v190, v190
    v_mfma_f32_32x32x16_bf16 v[64:79], v[132:135], a[136:139], v[64:79]
    ds_read_b64_tr_b16 v[140:141], v43 offset:38912
    ds_read_b64_tr_b16 v[142:143], v43 offset:39424
    v_exp_f32 v191, v191
    v_add_f32 v184, 1.0, v184
    v_add_f32 v185, 1.0, v185
    v_add_f32 v186, 1.0, v186
    v_mfma_f32_32x32x16_bf16 v[80:95], v[132:135], a[140:143], v[80:95]
    s_add_u32 m0, s47, 122880
    s_add_u32 s62, s41, 384
    buffer_load_dwordx4 v32, s[8:11], s62 offen lds
    v_add_f32 v187, 1.0, v187
    v_rcp_f32 v180, v180
    s_waitcnt lgkmcnt(2)
    v_mfma_f32_32x32x16_bf16 v[64:79], v[136:139], a[144:147], v[64:79]
    ds_read_b64_tr_b16 v[128:129], v43 offset:40960
    ds_read_b64_tr_b16 v[130:131], v43 offset:41472
    v_rcp_f32 v181, v181
    v_rcp_f32 v182, v182
    v_mfma_f32_32x32x16_bf16 v[80:95], v[136:139], a[148:151], v[80:95]
    v_rcp_f32 v183, v183
    v_exp_f32 v192, v192
    v_exp_f32 v193, v193
    s_waitcnt lgkmcnt(2)
    v_mfma_f32_32x32x16_bf16 v[64:79], v[140:143], a[152:155], v[64:79]
    ds_read_b64_tr_b16 v[132:133], v43 offset:43008
    ds_read_b64_tr_b16 v[134:135], v43 offset:43520
    v_exp_f32 v194, v194
    v_exp_f32 v195, v195
    v_mfma_f32_32x32x16_bf16 v[80:95], v[140:143], a[156:159], v[80:95]
    buffer_load_dwordx4 v33, s[8:11], s62 offen offset:1024 lds
    v_add_f32 v188, 1.0, v188
    v_add_f32 v189, 1.0, v189
    v_add_f32 v190, 1.0, v190
    s_waitcnt lgkmcnt(2)
    v_mfma_f32_32x32x16_bf16 v[64:79], v[128:131], a[160:163], v[64:79]
    ds_read_b64_tr_b16 v[136:137], v43 offset:45056
    ds_read_b64_tr_b16 v[138:139], v43 offset:45568
    ds_read_b64_tr_b16 v[140:141], v43 offset:47104
    ds_read_b64_tr_b16 v[142:143], v43 offset:47616
    ds_read_b128 v[152:155], v45 offset:768
    v_add_f32 v191, 1.0, v191
    v_mfma_f32_32x32x16_bf16 v[80:95], v[128:131], a[164:167], v[80:95]
    v_rcp_f32 v184, v184
    v_rcp_f32 v185, v185
    v_rcp_f32 v186, v186
    s_waitcnt lgkmcnt(5)
    v_mfma_f32_32x32x16_bf16 v[64:79], v[132:135], a[168:171], v[64:79]
    ds_read_b128 v[156:159], v45 offset:800
    v_rcp_f32 v187, v187
    v_exp_f32 v196, v196
    v_exp_f32 v197, v197
    v_mfma_f32_32x32x16_bf16 v[80:95], v[132:135], a[172:175], v[80:95]
    buffer_load_dwordx4 v34, s[8:11], s62 offen offset:2048 lds
    s_waitcnt lgkmcnt(2)
    s_waitcnt vmcnt(6)
    s_barrier
    v_mfma_f32_32x32x16_bf16 v[64:79], v[136:139], a[176:179], v[64:79]
    ds_read_b64_tr_b16 v[128:129], v43 offset:0
    ds_read_b64_tr_b16 v[130:131], v43 offset:512
    ds_read_b128 v[160:163], v45 offset:832
    v_exp_f32 v198, v198
    v_exp_f32 v199, v199
    v_mfma_f32_32x32x16_bf16 v[80:95], v[136:139], a[180:183], v[80:95]
    v_add_f32 v192, 1.0, v192
    v_add_f32 v193, 1.0, v193
    v_add_f32 v194, 1.0, v194
    v_add_f32 v195, 1.0, v195
    v_rcp_f32 v188, v188
    v_mfma_f32_32x32x16_bf16 v[64:79], v[140:143], a[184:187], v[64:79]
    ds_read_b64_tr_b16 v[132:133], v43 offset:2048
    ds_read_b64_tr_b16 v[134:135], v43 offset:2560
    ds_read_b128 v[164:167], v45 offset:864
    v_rcp_f32 v189, v189
    v_rcp_f32 v190, v190
    v_mfma_f32_32x32x16_bf16 v[80:95], v[140:143], a[188:191], v[80:95]
    s_add_u32 m0, s47, 135168
    s_add_u32 s62, s41, 885120
    buffer_load_dwordx4 v32, s[8:11], s62 offen lds
    v_rcp_f32 v191, v191
    v_add_f32 v196, 1.0, v196
    s_waitcnt lgkmcnt(4)
    v_mfma_f32_32x32x16_bf16 v[64:79], v[128:131], a[192:195], v[64:79]
    ds_read_b64_tr_b16 v[136:137], v43 offset:4096
    ds_read_b64_tr_b16 v[138:139], v43 offset:4608
    v_add_f32 v197, 1.0, v197
    v_add_f32 v198, 1.0, v198
    v_add_f32 v199, 1.0, v199
    v_rcp_f32 v192, v192
    v_mfma_f32_32x32x16_bf16 v[80:95], v[128:131], a[196:199], v[80:95]
    v_rcp_f32 v193, v193
    v_rcp_f32 v194, v194
    v_rcp_f32 v195, v195
    s_waitcnt lgkmcnt(3)
    v_mfma_f32_32x32x16_bf16 v[64:79], v[132:135], a[200:203], v[64:79]
    ds_read_b64_tr_b16 v[140:141], v43 offset:6144
    ds_read_b64_tr_b16 v[142:143], v43 offset:6656
    v_rcp_f32 v196, v196
    v_rcp_f32 v197, v197
    v_mfma_f32_32x32x16_bf16 v[80:95], v[132:135], a[204:207], v[80:95]
    buffer_load_dwordx4 v33, s[8:11], s62 offen offset:1024 lds
    v_rcp_f32 v198, v198
    s_waitcnt lgkmcnt(2)
    v_mfma_f32_32x32x16_bf16 v[64:79], v[136:139], a[208:211], v[64:79]
    ds_read_b64_tr_b16 v[128:129], v43 offset:8192
    ds_read_b64_tr_b16 v[130:131], v43 offset:8704
    ds_read_b64_tr_b16 v[132:133], v43 offset:10240
    ds_read_b64_tr_b16 v[134:135], v43 offset:10752
    v_rcp_f32 v199, v199
    v_mul_f32 v168, v168, v96
    v_mfma_f32_32x32x16_bf16 v[80:95], v[136:139], a[212:215], v[80:95]
    v_mul_f32 v169, v169, v97
    v_mul_f32 v170, v170, v98
    v_mul_f32 v171, v171, v99
    v_mul_f32 v172, v172, v100
    v_mul_f32 v173, v173, v101
    v_mul_f32 v174, v174, v102
    v_mul_f32 v175, v175, v103
    s_waitcnt lgkmcnt(4)
    v_mfma_f32_32x32x16_bf16 v[64:79], v[140:143], a[216:219], v[64:79]
    v_cvt_pk_bf16_f32 v200, v168, v169
    v_cvt_pk_bf16_f32 v201, v170, v171
    v_cvt_pk_bf16_f32 v202, v172, v173
    v_cvt_pk_bf16_f32 v203, v174, v175
    v_mfma_f32_32x32x16_bf16 v[80:95], v[140:143], a[220:223], v[80:95]
    buffer_load_dwordx4 v34, s[8:11], s62 offen offset:2048 lds
    s_waitcnt lgkmcnt(0)
    s_waitcnt vmcnt(6)
    s_barrier
    v_mfma_f32_32x32x16_bf16 v[64:79], v[128:131], a[224:227], v[64:79]
    ds_read_b64_tr_b16 v[136:137], v43 offset:12288
    ds_read_b64_tr_b16 v[138:139], v43 offset:12800
    ds_write_b128 v42, v[200:203] offset:8192
    v_mul_f32 v176, v176, v104
    v_mfma_f32_32x32x16_bf16 v[80:95], v[128:131], a[228:231], v[80:95]
    v_mul_f32 v177, v177, v105
    v_mul_f32 v178, v178, v106
    v_mul_f32 v179, v179, v107
    v_mul_f32 v180, v180, v108
    v_mul_f32 v181, v181, v109
    v_mul_f32 v182, v182, v110
    v_mul_f32 v183, v183, v111
    v_mfma_f32_32x32x16_bf16 v[64:79], v[132:135], a[232:235], v[64:79]
    ds_read_b64_tr_b16 v[140:141], v43 offset:14336
    ds_read_b64_tr_b16 v[142:143], v43 offset:14848
    v_cvt_pk_bf16_f32 v204, v176, v177
    v_cvt_pk_bf16_f32 v205, v178, v179
    v_cvt_pk_bf16_f32 v206, v180, v181
    v_cvt_pk_bf16_f32 v207, v182, v183
    v_mfma_f32_32x32x16_bf16 v[80:95], v[132:135], a[236:239], v[80:95]
    s_add_u32 m0, s47, 98304
    s_add_u32 s62, s41, 1769856
    buffer_load_dwordx4 v32, s[8:11], s62 offen lds
    ds_write_b128 v42, v[204:207] offset:10240
    s_waitcnt lgkmcnt(4)
    v_mfma_f32_32x32x16_bf16 v[64:79], v[136:139], a[240:243], v[64:79]
    ds_read_b64_tr_b16 v[128:129], v43 offset:16384
    ds_read_b64_tr_b16 v[130:131], v43 offset:16896
    v_mul_f32 v184, v184, v112
    v_mul_f32 v185, v185, v113
    v_mul_f32 v186, v186, v114
    v_mul_f32 v187, v187, v115
    v_mfma_f32_32x32x16_bf16 v[80:95], v[136:139], a[244:247], v[80:95]
    v_mul_f32 v188, v188, v116
    v_mul_f32 v189, v189, v117
    v_mul_f32 v190, v190, v118
    v_mul_f32 v191, v191, v119
    s_waitcnt lgkmcnt(3)
    v_mfma_f32_32x32x16_bf16 v[64:79], v[140:143], a[248:251], v[64:79]
    ds_read_b64_tr_b16 v[132:133], v43 offset:18432
    ds_read_b64_tr_b16 v[134:135], v43 offset:18944
    v_cvt_pk_bf16_f32 v208, v184, v185
    v_cvt_pk_bf16_f32 v209, v186, v187
    v_cvt_pk_bf16_f32 v210, v188, v189
    v_cvt_pk_bf16_f32 v211, v190, v191
    v_mfma_f32_32x32x16_bf16 v[80:95], v[140:143], a[252:255], v[80:95]
    buffer_load_dwordx4 v33, s[8:11], s62 offen offset:1024 lds
    ds_write_b128 v42, v[208:211] offset:9216
    s_waitcnt lgkmcnt(3)
    v_mfma_f32_32x32x16_bf16 v[64:79], v[128:131], v[224:227], v[64:79]
    ds_read_b64_tr_b16 v[136:137], v43 offset:20480
    ds_read_b64_tr_b16 v[138:139], v43 offset:20992
    ds_read_b64_tr_b16 v[140:141], v43 offset:22528
    ds_read_b64_tr_b16 v[142:143], v43 offset:23040
    v_mul_f32 v192, v192, v120
    v_mul_f32 v193, v193, v121
    v_mul_f32 v194, v194, v122
    v_mfma_f32_32x32x16_bf16 v[80:95], v[128:131], v[228:231], v[80:95]
    v_mul_f32 v195, v195, v123
    v_mul_f32 v196, v196, v124
    v_mul_f32 v197, v197, v125
    v_mul_f32 v198, v198, v126
    v_mul_f32 v199, v199, v127
    s_waitcnt lgkmcnt(5)
    v_mfma_f32_32x32x16_bf16 v[64:79], v[132:135], v[232:235], v[64:79]
    v_cvt_pk_bf16_f32 v212, v192, v193
    v_cvt_pk_bf16_f32 v213, v194, v195
    v_cvt_pk_bf16_f32 v214, v196, v197
    v_cvt_pk_bf16_f32 v215, v198, v199
    v_mfma_f32_32x32x16_bf16 v[80:95], v[132:135], v[236:239], v[80:95]
    buffer_load_dwordx4 v34, s[8:11], s62 offen offset:2048 lds
    s_waitcnt lgkmcnt(0)
    s_waitcnt vmcnt(6)
    s_barrier
    v_mfma_f32_32x32x16_bf16 v[64:79], v[136:139], v[240:243], v[64:79]
    ds_read_b64_tr_b16 v[128:129], v43 offset:24576
    ds_read_b64_tr_b16 v[130:131], v43 offset:25088
    ds_write_b128 v42, v[212:215] offset:11264
    v_mfma_f32_32x32x16_bf16 v[80:95], v[136:139], v[244:247], v[80:95]
    v_mfma_f32_32x32x16_bf16 v[64:79], v[140:143], v[248:251], v[64:79]
    ds_read_b64_tr_b16 v[132:133], v43 offset:26624
    ds_read_b64_tr_b16 v[134:135], v43 offset:27136
    v_mfma_f32_32x32x16_bf16 v[80:95], v[140:143], v[252:255], v[80:95]
    s_add_u32 m0, s47, 110592
    s_add_u32 s62, s41, 2654592
    buffer_load_dwordx4 v32, s[8:11], s62 offen lds
    s_waitcnt lgkmcnt(3)
    v_mfma_f32_32x32x16_bf16 v[96:111], v[128:131], a[0:3], v[152:167]
    ds_read_b64_tr_b16 v[136:137], v43 offset:28672
    ds_read_b64_tr_b16 v[138:139], v43 offset:29184
    v_mfma_f32_32x32x16_bf16 v[112:127], v[128:131], a[4:7], v[152:167]
    s_waitcnt lgkmcnt(2)
    v_mfma_f32_32x32x16_bf16 v[96:111], v[132:135], a[8:11], v[96:111]
    ds_read_b64_tr_b16 v[140:141], v43 offset:30720
    ds_read_b64_tr_b16 v[142:143], v43 offset:31232
    v_mul_f32 v168, v64, v64
    v_mul_f32 v169, v65, v65
    v_mul_f32 v170, v66, v66
    v_mul_f32 v171, v67, v67
    v_mfma_f32_32x32x16_bf16 v[112:127], v[132:135], a[12:15], v[112:127]
    buffer_load_dwordx4 v33, s[8:11], s62 offen offset:1024 lds
    v_mul_f32 v172, v68, v68
    v_mul_f32 v173, v69, v69
    v_mul_f32 v174, v70, v70
    s_waitcnt lgkmcnt(2)
    v_mfma_f32_32x32x16_bf16 v[96:111], v[136:139], a[16:19], v[96:111]
    ds_read_b64_tr_b16 v[128:129], v43 offset:32768
    ds_read_b64_tr_b16 v[130:131], v43 offset:33280
    ds_read_b64_tr_b16 v[132:133], v43 offset:34816
    ds_read_b64_tr_b16 v[134:135], v43 offset:35328
    v_mul_f32 v175, v71, v71
    v_mul_f32 v176, v72, v72
    v_mul_f32 v177, v73, v73
    v_mfma_f32_32x32x16_bf16 v[112:127], v[136:139], a[20:23], v[112:127]
    v_mul_f32 v178, v74, v74
    v_mul_f32 v179, v75, v75
    v_mul_f32 v180, v76, v76
    v_mul_f32 v181, v77, v77
    v_mul_f32 v182, v78, v78
    v_mul_f32 v183, v79, v79
    s_waitcnt lgkmcnt(4)
    v_mfma_f32_32x32x16_bf16 v[96:111], v[140:143], a[24:27], v[96:111]
    v_mul_f32 v184, v80, v80
    v_mul_f32 v185, v81, v81
    v_mul_f32 v186, v82, v82
    v_mul_f32 v187, v83, v83
    v_mfma_f32_32x32x16_bf16 v[112:127], v[140:143], a[28:31], v[112:127]
    buffer_load_dwordx4 v34, s[8:11], s62 offen offset:2048 lds
    s_waitcnt lgkmcnt(0)
    s_waitcnt vmcnt(6)
    s_barrier
    v_mfma_f32_32x32x16_bf16 v[96:111], v[128:131], a[32:35], v[96:111]
    ds_read_b64_tr_b16 v[136:137], v43 offset:36864
    ds_read_b64_tr_b16 v[138:139], v43 offset:37376
    v_mul_f32 v188, v84, v84
    v_mul_f32 v189, v85, v85
    v_mul_f32 v190, v86, v86
    v_mul_f32 v191, v87, v87
    v_mul_f32 v192, v88, v88
    v_mfma_f32_32x32x16_bf16 v[112:127], v[128:131], a[36:39], v[112:127]
    v_mul_f32 v193, v89, v89
    v_mul_f32 v194, v90, v90
    v_mul_f32 v195, v91, v91
    v_mul_f32 v196, v92, v92
    v_mul_f32 v197, v93, v93
    v_mul_f32 v198, v94, v94
    v_mul_f32 v199, v95, v95
    v_mfma_f32_32x32x16_bf16 v[96:111], v[132:135], a[40:43], v[96:111]
    ds_read_b64_tr_b16 v[140:141], v43 offset:38912
    ds_read_b64_tr_b16 v[142:143], v43 offset:39424
    v_mfma_f32_32x32x16_bf16 v[112:127], v[132:135], a[44:47], v[112:127]
    s_add_u32 m0, s47, 122880
    s_add_u32 s62, s41, 3539328
    buffer_load_dwordx4 v32, s[8:11], s62 offen lds
    v_pk_fma_f32 v[168:169], v[168:169], s[66:67], v[56:57]
    v_pk_fma_f32 v[170:171], v[170:171], s[66:67], v[56:57]
    v_pk_fma_f32 v[172:173], v[172:173], s[66:67], v[56:57]
    v_pk_fma_f32 v[174:175], v[174:175], s[66:67], v[56:57]
    v_pk_fma_f32 v[176:177], v[176:177], s[66:67], v[56:57]
    v_pk_fma_f32 v[178:179], v[178:179], s[66:67], v[56:57]
    v_pk_fma_f32 v[180:181], v[180:181], s[66:67], v[56:57]
    v_pk_fma_f32 v[182:183], v[182:183], s[66:67], v[56:57]
    v_pk_fma_f32 v[184:185], v[184:185], s[66:67], v[56:57]
    v_pk_fma_f32 v[186:187], v[186:187], s[66:67], v[56:57]
    v_pk_fma_f32 v[188:189], v[188:189], s[66:67], v[56:57]
    v_pk_fma_f32 v[190:191], v[190:191], s[66:67], v[56:57]
    v_pk_fma_f32 v[192:193], v[192:193], s[66:67], v[56:57]
    v_pk_fma_f32 v[194:195], v[194:195], s[66:67], v[56:57]
    v_pk_fma_f32 v[196:197], v[196:197], s[66:67], v[56:57]
    v_pk_fma_f32 v[198:199], v[198:199], s[66:67], v[56:57]
    v_pk_mul_f32 v[168:169], v[168:169], v[64:65]
    v_pk_mul_f32 v[170:171], v[170:171], v[66:67]
    v_pk_mul_f32 v[172:173], v[172:173], v[68:69]
    v_pk_mul_f32 v[174:175], v[174:175], v[70:71]
    v_pk_mul_f32 v[176:177], v[176:177], v[72:73]
    v_pk_mul_f32 v[178:179], v[178:179], v[74:75]
    v_pk_mul_f32 v[180:181], v[180:181], v[76:77]
    v_pk_mul_f32 v[182:183], v[182:183], v[78:79]
    v_pk_mul_f32 v[184:185], v[184:185], v[80:81]
    v_pk_mul_f32 v[186:187], v[186:187], v[82:83]
    v_pk_mul_f32 v[188:189], v[188:189], v[84:85]
    v_pk_mul_f32 v[190:191], v[190:191], v[86:87]
    v_pk_mul_f32 v[192:193], v[192:193], v[88:89]
    v_pk_mul_f32 v[194:195], v[194:195], v[90:91]
    v_pk_mul_f32 v[196:197], v[196:197], v[92:93]
    v_pk_mul_f32 v[198:199], v[198:199], v[94:95]
    s_waitcnt lgkmcnt(2)
    v_mfma_f32_32x32x16_bf16 v[96:111], v[136:139], a[48:51], v[96:111]
    ds_read_b64_tr_b16 v[128:129], v43 offset:40960
    ds_read_b64_tr_b16 v[130:131], v43 offset:41472
    v_exp_f32 v168, v168
    v_exp_f32 v169, v169
    v_mfma_f32_32x32x16_bf16 v[112:127], v[136:139], a[52:55], v[112:127]
    v_exp_f32 v170, v170
    v_exp_f32 v171, v171
    s_waitcnt lgkmcnt(2)
    v_mfma_f32_32x32x16_bf16 v[96:111], v[140:143], a[56:59], v[96:111]
    ds_read_b64_tr_b16 v[132:133], v43 offset:43008
    ds_read_b64_tr_b16 v[134:135], v43 offset:43520
    v_exp_f32 v172, v172
    v_exp_f32 v173, v173
    v_mfma_f32_32x32x16_bf16 v[112:127], v[140:143], a[60:63], v[112:127]
    buffer_load_dwordx4 v33, s[8:11], s62 offen offset:1024 lds
    v_exp_f32 v174, v174
    s_waitcnt lgkmcnt(2)
    v_mfma_f32_32x32x16_bf16 v[96:111], v[128:131], a[64:67], v[96:111]
    ds_read_b64_tr_b16 v[136:137], v43 offset:45056
    ds_read_b64_tr_b16 v[138:139], v43 offset:45568
    ds_read_b64_tr_b16 v[140:141], v43 offset:47104
    ds_read_b64_tr_b16 v[142:143], v43 offset:47616
    v_exp_f32 v175, v175
    v_add_f32 v168, 1.0, v168
    v_mfma_f32_32x32x16_bf16 v[112:127], v[128:131], a[68:71], v[112:127]
    v_add_f32 v169, 1.0, v169
    v_add_f32 v170, 1.0, v170
    v_add_f32 v171, 1.0, v171
    v_exp_f32 v176, v176
    v_exp_f32 v177, v177
    s_waitcnt lgkmcnt(4)
    v_mfma_f32_32x32x16_bf16 v[96:111], v[132:135], a[72:75], v[96:111]
    v_exp_f32 v178, v178
    v_exp_f32 v179, v179
    v_mfma_f32_32x32x16_bf16 v[112:127], v[132:135], a[76:79], v[112:127]
    buffer_load_dwordx4 v34, s[8:11], s62 offen offset:2048 lds
    s_waitcnt lgkmcnt(0)
    s_waitcnt vmcnt(6)
    s_barrier
    v_mfma_f32_32x32x16_bf16 v[96:111], v[136:139], a[80:83], v[96:111]
    ds_read_b64_tr_b16 v[128:129], v43 offset:0
    ds_read_b64_tr_b16 v[130:131], v43 offset:512
    v_add_f32 v172, 1.0, v172
    v_add_f32 v173, 1.0, v173
    v_add_f32 v174, 1.0, v174
    v_add_f32 v175, 1.0, v175
    v_mfma_f32_32x32x16_bf16 v[112:127], v[136:139], a[84:87], v[112:127]
    v_rcp_f32 v168, v168
    v_rcp_f32 v169, v169
    v_rcp_f32 v170, v170
    v_mfma_f32_32x32x16_bf16 v[96:111], v[140:143], a[88:91], v[96:111]
    ds_read_b64_tr_b16 v[132:133], v43 offset:2048
    ds_read_b64_tr_b16 v[134:135], v43 offset:2560
    v_rcp_f32 v171, v171
    v_exp_f32 v180, v180
    v_mfma_f32_32x32x16_bf16 v[112:127], v[140:143], a[92:95], v[112:127]
    s_add_u32 m0, s47, 135168
    s_add_u32 s62, s41, 4424064
    buffer_load_dwordx4 v32, s[8:11], s62 offen lds
    v_exp_f32 v181, v181
    s_waitcnt lgkmcnt(2)
    v_mfma_f32_32x32x16_bf16 v[96:111], v[128:131], a[96:99], v[96:111]
    ds_read_b64_tr_b16 v[136:137], v43 offset:4096
    ds_read_b64_tr_b16 v[138:139], v43 offset:4608
    v_exp_f32 v182, v182
    v_exp_f32 v183, v183
    v_add_f32 v176, 1.0, v176
    v_mfma_f32_32x32x16_bf16 v[112:127], v[128:131], a[100:103], v[112:127]
    v_add_f32 v177, 1.0, v177
    v_add_f32 v178, 1.0, v178
    v_add_f32 v179, 1.0, v179
    v_rcp_f32 v172, v172
    v_rcp_f32 v173, v173
    s_waitcnt lgkmcnt(2)
    v_mfma_f32_32x32x16_bf16 v[96:111], v[132:135], a[104:107], v[96:111]
    ds_read_b64_tr_b16 v[140:141], v43 offset:6144
    ds_read_b64_tr_b16 v[142:143], v43 offset:6656
    v_rcp_f32 v174, v174
    v_rcp_f32 v175, v175
    v_mfma_f32_32x32x16_bf16 v[112:127], v[132:135], a[108:111], v[112:127]
    buffer_load_dwordx4 v33, s[8:11], s62 offen offset:1024 lds
    v_exp_f32 v184, v184
    s_waitcnt lgkmcnt(2)
    v_mfma_f32_32x32x16_bf16 v[96:111], v[136:139], a[112:115], v[96:111]
    ds_read_b64_tr_b16 v[128:129], v43 offset:8192
    ds_read_b64_tr_b16 v[130:131], v43 offset:8704
    ds_read_b64_tr_b16 v[132:133], v43 offset:10240
    ds_read_b64_tr_b16 v[134:135], v43 offset:10752
    v_exp_f32 v185, v185
    v_mfma_f32_32x32x16_bf16 v[112:127], v[136:139], a[116:119], v[112:127]
    v_exp_f32 v186, v186
    v_exp_f32 v187, v187
    v_add_f32 v180, 1.0, v180
    v_add_f32 v181, 1.0, v181
    v_add_f32 v182, 1.0, v182
    s_waitcnt lgkmcnt(4)
    v_mfma_f32_32x32x16_bf16 v[96:111], v[140:143], a[120:123], v[96:111]
    v_add_f32 v183, 1.0, v183
    v_rcp_f32 v176, v176
    v_rcp_f32 v177, v177
    v_mfma_f32_32x32x16_bf16 v[112:127], v[140:143], a[124:127], v[112:127]
    buffer_load_dwordx4 v34, s[8:11], s62 offen offset:2048 lds
    s_waitcnt lgkmcnt(0)
    s_waitcnt vmcnt(6)
    s_barrier
    v_mfma_f32_32x32x16_bf16 v[96:111], v[128:131], a[128:131], v[96:111]
    ds_read_b64_tr_b16 v[136:137], v43 offset:12288
    ds_read_b64_tr_b16 v[138:139], v43 offset:12800
    v_rcp_f32 v178, v178
    v_rcp_f32 v179, v179
    v_mfma_f32_32x32x16_bf16 v[112:127], v[128:131], a[132:135], v[112:127]
    v_exp_f32 v188, v188
    v_exp_f32 v189, v189
    v_exp_f32 v190, v190
    v_mfma_f32_32x32x16_bf16 v[96:111], v[132:135], a[136:139], v[96:111]
    ds_read_b64_tr_b16 v[140:141], v43 offset:14336
    ds_read_b64_tr_b16 v[142:143], v43 offset:14848
    v_exp_f32 v191, v191
    v_add_f32 v184, 1.0, v184
    v_add_f32 v185, 1.0, v185
    v_add_f32 v186, 1.0, v186
    v_mfma_f32_32x32x16_bf16 v[112:127], v[132:135], a[140:143], v[112:127]
    s_add_u32 m0, s47, 98304
    s_add_u32 s62, s41, 512
    buffer_load_dwordx4 v32, s[8:11], s62 offen lds
    v_add_f32 v187, 1.0, v187
    v_rcp_f32 v180, v180
    s_waitcnt lgkmcnt(2)
    v_mfma_f32_32x32x16_bf16 v[96:111], v[136:139], a[144:147], v[96:111]
    ds_read_b64_tr_b16 v[128:129], v43 offset:16384
    ds_read_b64_tr_b16 v[130:131], v43 offset:16896
    v_rcp_f32 v181, v181
    v_rcp_f32 v182, v182
    v_mfma_f32_32x32x16_bf16 v[112:127], v[136:139], a[148:151], v[112:127]
    v_rcp_f32 v183, v183
    v_exp_f32 v192, v192
    v_exp_f32 v193, v193
    s_waitcnt lgkmcnt(2)
    v_mfma_f32_32x32x16_bf16 v[96:111], v[140:143], a[152:155], v[96:111]
    ds_read_b64_tr_b16 v[132:133], v43 offset:18432
    ds_read_b64_tr_b16 v[134:135], v43 offset:18944
    v_exp_f32 v194, v194
    v_exp_f32 v195, v195
    v_mfma_f32_32x32x16_bf16 v[112:127], v[140:143], a[156:159], v[112:127]
    buffer_load_dwordx4 v33, s[8:11], s62 offen offset:1024 lds
    v_add_f32 v188, 1.0, v188
    v_add_f32 v189, 1.0, v189
    v_add_f32 v190, 1.0, v190
    s_waitcnt lgkmcnt(2)
    v_mfma_f32_32x32x16_bf16 v[96:111], v[128:131], a[160:163], v[96:111]
    ds_read_b64_tr_b16 v[136:137], v43 offset:20480
    ds_read_b64_tr_b16 v[138:139], v43 offset:20992
    ds_read_b64_tr_b16 v[140:141], v43 offset:22528
    ds_read_b64_tr_b16 v[142:143], v43 offset:23040
    ds_read_b128 v[152:155], v45 offset:1024
    v_add_f32 v191, 1.0, v191
    v_mfma_f32_32x32x16_bf16 v[112:127], v[128:131], a[164:167], v[112:127]
    v_rcp_f32 v184, v184
    v_rcp_f32 v185, v185
    v_rcp_f32 v186, v186
    s_waitcnt lgkmcnt(5)
    v_mfma_f32_32x32x16_bf16 v[96:111], v[132:135], a[168:171], v[96:111]
    ds_read_b128 v[156:159], v45 offset:1056
    v_rcp_f32 v187, v187
    v_exp_f32 v196, v196
    v_exp_f32 v197, v197
    v_mfma_f32_32x32x16_bf16 v[112:127], v[132:135], a[172:175], v[112:127]
    buffer_load_dwordx4 v34, s[8:11], s62 offen offset:2048 lds
    s_waitcnt lgkmcnt(2)
    s_waitcnt vmcnt(6)
    s_barrier
    v_mfma_f32_32x32x16_bf16 v[96:111], v[136:139], a[176:179], v[96:111]
    ds_read_b64_tr_b16 v[128:129], v43 offset:24576
    ds_read_b64_tr_b16 v[130:131], v43 offset:25088
    ds_read_b128 v[160:163], v45 offset:1088
    v_exp_f32 v198, v198
    v_exp_f32 v199, v199
    v_mfma_f32_32x32x16_bf16 v[112:127], v[136:139], a[180:183], v[112:127]
    v_add_f32 v192, 1.0, v192
    v_add_f32 v193, 1.0, v193
    v_add_f32 v194, 1.0, v194
    v_add_f32 v195, 1.0, v195
    v_rcp_f32 v188, v188
    v_mfma_f32_32x32x16_bf16 v[96:111], v[140:143], a[184:187], v[96:111]
    ds_read_b64_tr_b16 v[132:133], v43 offset:26624
    ds_read_b64_tr_b16 v[134:135], v43 offset:27136
    ds_read_b128 v[164:167], v45 offset:1120
    v_rcp_f32 v189, v189
    v_rcp_f32 v190, v190
    v_mfma_f32_32x32x16_bf16 v[112:127], v[140:143], a[188:191], v[112:127]
    s_add_u32 m0, s47, 110592
    s_add_u32 s62, s41, 885248
    buffer_load_dwordx4 v32, s[8:11], s62 offen lds
    v_rcp_f32 v191, v191
    v_add_f32 v196, 1.0, v196
    s_waitcnt lgkmcnt(4)
    v_mfma_f32_32x32x16_bf16 v[96:111], v[128:131], a[192:195], v[96:111]
    ds_read_b64_tr_b16 v[136:137], v43 offset:28672
    ds_read_b64_tr_b16 v[138:139], v43 offset:29184
    v_add_f32 v197, 1.0, v197
    v_add_f32 v198, 1.0, v198
    v_add_f32 v199, 1.0, v199
    v_rcp_f32 v192, v192
    v_mfma_f32_32x32x16_bf16 v[112:127], v[128:131], a[196:199], v[112:127]
    v_rcp_f32 v193, v193
    v_rcp_f32 v194, v194
    v_rcp_f32 v195, v195
    s_waitcnt lgkmcnt(3)
    v_mfma_f32_32x32x16_bf16 v[96:111], v[132:135], a[200:203], v[96:111]
    ds_read_b64_tr_b16 v[140:141], v43 offset:30720
    ds_read_b64_tr_b16 v[142:143], v43 offset:31232
    v_rcp_f32 v196, v196
    v_rcp_f32 v197, v197
    v_mfma_f32_32x32x16_bf16 v[112:127], v[132:135], a[204:207], v[112:127]
    buffer_load_dwordx4 v33, s[8:11], s62 offen offset:1024 lds
    v_rcp_f32 v198, v198
    s_waitcnt lgkmcnt(2)
    v_mfma_f32_32x32x16_bf16 v[96:111], v[136:139], a[208:211], v[96:111]
    ds_read_b64_tr_b16 v[128:129], v43 offset:32768
    ds_read_b64_tr_b16 v[130:131], v43 offset:33280
    ds_read_b64_tr_b16 v[132:133], v43 offset:34816
    ds_read_b64_tr_b16 v[134:135], v43 offset:35328
    v_rcp_f32 v199, v199
    v_mul_f32 v168, v168, v64
    v_mfma_f32_32x32x16_bf16 v[112:127], v[136:139], a[212:215], v[112:127]
    v_mul_f32 v169, v169, v65
    v_mul_f32 v170, v170, v66
    v_mul_f32 v171, v171, v67
    v_mul_f32 v172, v172, v68
    v_mul_f32 v173, v173, v69
    v_mul_f32 v174, v174, v70
    v_mul_f32 v175, v175, v71
    s_waitcnt lgkmcnt(4)
    v_mfma_f32_32x32x16_bf16 v[96:111], v[140:143], a[216:219], v[96:111]
    v_cvt_pk_bf16_f32 v200, v168, v169
    v_cvt_pk_bf16_f32 v201, v170, v171
    v_cvt_pk_bf16_f32 v202, v172, v173
    v_cvt_pk_bf16_f32 v203, v174, v175
    v_mfma_f32_32x32x16_bf16 v[112:127], v[140:143], a[220:223], v[112:127]
    buffer_load_dwordx4 v34, s[8:11], s62 offen offset:2048 lds
    s_waitcnt lgkmcnt(0)
    s_waitcnt vmcnt(6)
    s_barrier
    v_mfma_f32_32x32x16_bf16 v[96:111], v[128:131], a[224:227], v[96:111]
    ds_read_b64_tr_b16 v[136:137], v43 offset:36864
    ds_read_b64_tr_b16 v[138:139], v43 offset:37376
    ds_write_b128 v42, v[200:203] offset:16384
    v_mul_f32 v176, v176, v72
    v_mfma_f32_32x32x16_bf16 v[112:127], v[128:131], a[228:231], v[112:127]
    v_mul_f32 v177, v177, v73
    v_mul_f32 v178, v178, v74
    v_mul_f32 v179, v179, v75
    v_mul_f32 v180, v180, v76
    v_mul_f32 v181, v181, v77
    v_mul_f32 v182, v182, v78
    v_mul_f32 v183, v183, v79
    v_mfma_f32_32x32x16_bf16 v[96:111], v[132:135], a[232:235], v[96:111]
    ds_read_b64_tr_b16 v[140:141], v43 offset:38912
    ds_read_b64_tr_b16 v[142:143], v43 offset:39424
    v_cvt_pk_bf16_f32 v204, v176, v177
    v_cvt_pk_bf16_f32 v205, v178, v179
    v_cvt_pk_bf16_f32 v206, v180, v181
    v_cvt_pk_bf16_f32 v207, v182, v183
    v_mfma_f32_32x32x16_bf16 v[112:127], v[132:135], a[236:239], v[112:127]
    s_add_u32 m0, s47, 122880
    s_add_u32 s62, s41, 1769984
    buffer_load_dwordx4 v32, s[8:11], s62 offen lds
    ds_write_b128 v42, v[204:207] offset:18432
    s_waitcnt lgkmcnt(4)
    v_mfma_f32_32x32x16_bf16 v[96:111], v[136:139], a[240:243], v[96:111]
    ds_read_b64_tr_b16 v[128:129], v43 offset:40960
    ds_read_b64_tr_b16 v[130:131], v43 offset:41472
    v_mul_f32 v184, v184, v80
    v_mul_f32 v185, v185, v81
    v_mul_f32 v186, v186, v82
    v_mul_f32 v187, v187, v83
    v_mfma_f32_32x32x16_bf16 v[112:127], v[136:139], a[244:247], v[112:127]
    v_mul_f32 v188, v188, v84
    v_mul_f32 v189, v189, v85
    v_mul_f32 v190, v190, v86
    v_mul_f32 v191, v191, v87
    s_waitcnt lgkmcnt(3)
    v_mfma_f32_32x32x16_bf16 v[96:111], v[140:143], a[248:251], v[96:111]
    ds_read_b64_tr_b16 v[132:133], v43 offset:43008
    ds_read_b64_tr_b16 v[134:135], v43 offset:43520
    v_cvt_pk_bf16_f32 v208, v184, v185
    v_cvt_pk_bf16_f32 v209, v186, v187
    v_cvt_pk_bf16_f32 v210, v188, v189
    v_cvt_pk_bf16_f32 v211, v190, v191
    v_mfma_f32_32x32x16_bf16 v[112:127], v[140:143], a[252:255], v[112:127]
    buffer_load_dwordx4 v33, s[8:11], s62 offen offset:1024 lds
    ds_write_b128 v42, v[208:211] offset:17408
    s_waitcnt lgkmcnt(3)
    v_mfma_f32_32x32x16_bf16 v[96:111], v[128:131], v[224:227], v[96:111]
    ds_read_b64_tr_b16 v[136:137], v43 offset:45056
    ds_read_b64_tr_b16 v[138:139], v43 offset:45568
    ds_read_b64_tr_b16 v[140:141], v43 offset:47104
    ds_read_b64_tr_b16 v[142:143], v43 offset:47616
    v_mul_f32 v192, v192, v88
    v_mul_f32 v193, v193, v89
    v_mul_f32 v194, v194, v90
    v_mfma_f32_32x32x16_bf16 v[112:127], v[128:131], v[228:231], v[112:127]
    v_mul_f32 v195, v195, v91
    v_mul_f32 v196, v196, v92
    v_mul_f32 v197, v197, v93
    v_mul_f32 v198, v198, v94
    v_mul_f32 v199, v199, v95
    s_waitcnt lgkmcnt(5)
    v_mfma_f32_32x32x16_bf16 v[96:111], v[132:135], v[232:235], v[96:111]
    v_cvt_pk_bf16_f32 v212, v192, v193
    v_cvt_pk_bf16_f32 v213, v194, v195
    v_cvt_pk_bf16_f32 v214, v196, v197
    v_cvt_pk_bf16_f32 v215, v198, v199
    v_mfma_f32_32x32x16_bf16 v[112:127], v[132:135], v[236:239], v[112:127]
    buffer_load_dwordx4 v34, s[8:11], s62 offen offset:2048 lds
    s_waitcnt lgkmcnt(0)
    s_waitcnt vmcnt(6)
    s_barrier
    v_mfma_f32_32x32x16_bf16 v[96:111], v[136:139], v[240:243], v[96:111]
    ds_read_b64_tr_b16 v[128:129], v43 offset:0
    ds_read_b64_tr_b16 v[130:131], v43 offset:512
    ds_write_b128 v42, v[212:215] offset:19456
    v_mfma_f32_32x32x16_bf16 v[112:127], v[136:139], v[244:247], v[112:127]
    v_mfma_f32_32x32x16_bf16 v[96:111], v[140:143], v[248:251], v[96:111]
    ds_read_b64_tr_b16 v[132:133], v43 offset:2048
    ds_read_b64_tr_b16 v[134:135], v43 offset:2560
    v_mfma_f32_32x32x16_bf16 v[112:127], v[140:143], v[252:255], v[112:127]
    s_add_u32 m0, s47, 135168
    s_add_u32 s62, s41, 2654720
    buffer_load_dwordx4 v32, s[8:11], s62 offen lds
    s_waitcnt lgkmcnt(3)
    v_mfma_f32_32x32x16_bf16 v[64:79], v[128:131], a[0:3], v[152:167]
    ds_read_b64_tr_b16 v[136:137], v43 offset:4096
    ds_read_b64_tr_b16 v[138:139], v43 offset:4608
    v_mfma_f32_32x32x16_bf16 v[80:95], v[128:131], a[4:7], v[152:167]
    s_waitcnt lgkmcnt(2)
    v_mfma_f32_32x32x16_bf16 v[64:79], v[132:135], a[8:11], v[64:79]
    ds_read_b64_tr_b16 v[140:141], v43 offset:6144
    ds_read_b64_tr_b16 v[142:143], v43 offset:6656
    v_mul_f32 v168, v96, v96
    v_mul_f32 v169, v97, v97
    v_mul_f32 v170, v98, v98
    v_mul_f32 v171, v99, v99
    v_mfma_f32_32x32x16_bf16 v[80:95], v[132:135], a[12:15], v[80:95]
    buffer_load_dwordx4 v33, s[8:11], s62 offen offset:1024 lds
    v_mul_f32 v172, v100, v100
    v_mul_f32 v173, v101, v101
    v_mul_f32 v174, v102, v102
    s_waitcnt lgkmcnt(2)
    v_mfma_f32_32x32x16_bf16 v[64:79], v[136:139], a[16:19], v[64:79]
    ds_read_b64_tr_b16 v[128:129], v43 offset:8192
    ds_read_b64_tr_b16 v[130:131], v43 offset:8704
    ds_read_b64_tr_b16 v[132:133], v43 offset:10240
    ds_read_b64_tr_b16 v[134:135], v43 offset:10752
    v_mul_f32 v175, v103, v103
    v_mul_f32 v176, v104, v104
    v_mul_f32 v177, v105, v105
    v_mfma_f32_32x32x16_bf16 v[80:95], v[136:139], a[20:23], v[80:95]
    v_mul_f32 v178, v106, v106
    v_mul_f32 v179, v107, v107
    v_mul_f32 v180, v108, v108
    v_mul_f32 v181, v109, v109
    v_mul_f32 v182, v110, v110
    v_mul_f32 v183, v111, v111
    s_waitcnt lgkmcnt(4)
    v_mfma_f32_32x32x16_bf16 v[64:79], v[140:143], a[24:27], v[64:79]
    v_mul_f32 v184, v112, v112
    v_mul_f32 v185, v113, v113
    v_mul_f32 v186, v114, v114
    v_mul_f32 v187, v115, v115
    v_mfma_f32_32x32x16_bf16 v[80:95], v[140:143], a[28:31], v[80:95]
    buffer_load_dwordx4 v34, s[8:11], s62 offen offset:2048 lds
    s_waitcnt lgkmcnt(0)
    s_waitcnt vmcnt(6)
    s_barrier
    v_mfma_f32_32x32x16_bf16 v[64:79], v[128:131], a[32:35], v[64:79]
    ds_read_b64_tr_b16 v[136:137], v43 offset:12288
    ds_read_b64_tr_b16 v[138:139], v43 offset:12800
    v_mul_f32 v188, v116, v116
    v_mul_f32 v189, v117, v117
    v_mul_f32 v190, v118, v118
    v_mul_f32 v191, v119, v119
    v_mul_f32 v192, v120, v120
    v_mfma_f32_32x32x16_bf16 v[80:95], v[128:131], a[36:39], v[80:95]
    v_mul_f32 v193, v121, v121
    v_mul_f32 v194, v122, v122
    v_mul_f32 v195, v123, v123
    v_mul_f32 v196, v124, v124
    v_mul_f32 v197, v125, v125
    v_mul_f32 v198, v126, v126
    v_mul_f32 v199, v127, v127
    v_mfma_f32_32x32x16_bf16 v[64:79], v[132:135], a[40:43], v[64:79]
    ds_read_b64_tr_b16 v[140:141], v43 offset:14336
    ds_read_b64_tr_b16 v[142:143], v43 offset:14848
    v_mfma_f32_32x32x16_bf16 v[80:95], v[132:135], a[44:47], v[80:95]
    s_add_u32 m0, s47, 98304
    s_add_u32 s62, s41, 3539456
    buffer_load_dwordx4 v32, s[8:11], s62 offen lds
    v_pk_fma_f32 v[168:169], v[168:169], s[66:67], v[56:57]
    v_pk_fma_f32 v[170:171], v[170:171], s[66:67], v[56:57]
    v_pk_fma_f32 v[172:173], v[172:173], s[66:67], v[56:57]
    v_pk_fma_f32 v[174:175], v[174:175], s[66:67], v[56:57]
    v_pk_fma_f32 v[176:177], v[176:177], s[66:67], v[56:57]
    v_pk_fma_f32 v[178:179], v[178:179], s[66:67], v[56:57]
    v_pk_fma_f32 v[180:181], v[180:181], s[66:67], v[56:57]
    v_pk_fma_f32 v[182:183], v[182:183], s[66:67], v[56:57]
    v_pk_fma_f32 v[184:185], v[184:185], s[66:67], v[56:57]
    v_pk_fma_f32 v[186:187], v[186:187], s[66:67], v[56:57]
    v_pk_fma_f32 v[188:189], v[188:189], s[66:67], v[56:57]
    v_pk_fma_f32 v[190:191], v[190:191], s[66:67], v[56:57]
    v_pk_fma_f32 v[192:193], v[192:193], s[66:67], v[56:57]
    v_pk_fma_f32 v[194:195], v[194:195], s[66:67], v[56:57]
    v_pk_fma_f32 v[196:197], v[196:197], s[66:67], v[56:57]
    v_pk_fma_f32 v[198:199], v[198:199], s[66:67], v[56:57]
    v_pk_mul_f32 v[168:169], v[168:169], v[96:97]
    v_pk_mul_f32 v[170:171], v[170:171], v[98:99]
    v_pk_mul_f32 v[172:173], v[172:173], v[100:101]
    v_pk_mul_f32 v[174:175], v[174:175], v[102:103]
    v_pk_mul_f32 v[176:177], v[176:177], v[104:105]
    v_pk_mul_f32 v[178:179], v[178:179], v[106:107]
    v_pk_mul_f32 v[180:181], v[180:181], v[108:109]
    v_pk_mul_f32 v[182:183], v[182:183], v[110:111]
    v_pk_mul_f32 v[184:185], v[184:185], v[112:113]
    v_pk_mul_f32 v[186:187], v[186:187], v[114:115]
    v_pk_mul_f32 v[188:189], v[188:189], v[116:117]
    v_pk_mul_f32 v[190:191], v[190:191], v[118:119]
    v_pk_mul_f32 v[192:193], v[192:193], v[120:121]
    v_pk_mul_f32 v[194:195], v[194:195], v[122:123]
    v_pk_mul_f32 v[196:197], v[196:197], v[124:125]
    v_pk_mul_f32 v[198:199], v[198:199], v[126:127]
    s_waitcnt lgkmcnt(2)
    v_mfma_f32_32x32x16_bf16 v[64:79], v[136:139], a[48:51], v[64:79]
    ds_read_b64_tr_b16 v[128:129], v43 offset:16384
    ds_read_b64_tr_b16 v[130:131], v43 offset:16896
    v_exp_f32 v168, v168
    v_exp_f32 v169, v169
    v_mfma_f32_32x32x16_bf16 v[80:95], v[136:139], a[52:55], v[80:95]
    v_exp_f32 v170, v170
    v_exp_f32 v171, v171
    s_waitcnt lgkmcnt(2)
    v_mfma_f32_32x32x16_bf16 v[64:79], v[140:143], a[56:59], v[64:79]
    ds_read_b64_tr_b16 v[132:133], v43 offset:18432
    ds_read_b64_tr_b16 v[134:135], v43 offset:18944
    v_exp_f32 v172, v172
    v_exp_f32 v173, v173
    v_mfma_f32_32x32x16_bf16 v[80:95], v[140:143], a[60:63], v[80:95]
    buffer_load_dwordx4 v33, s[8:11], s62 offen offset:1024 lds
    v_exp_f32 v174, v174
    s_waitcnt lgkmcnt(2)
    v_mfma_f32_32x32x16_bf16 v[64:79], v[128:131], a[64:67], v[64:79]
    ds_read_b64_tr_b16 v[136:137], v43 offset:20480
    ds_read_b64_tr_b16 v[138:139], v43 offset:20992
    ds_read_b64_tr_b16 v[140:141], v43 offset:22528
    ds_read_b64_tr_b16 v[142:143], v43 offset:23040
    v_exp_f32 v175, v175
    v_add_f32 v168, 1.0, v168
    v_mfma_f32_32x32x16_bf16 v[80:95], v[128:131], a[68:71], v[80:95]
    v_add_f32 v169, 1.0, v169
    v_add_f32 v170, 1.0, v170
    v_add_f32 v171, 1.0, v171
    v_exp_f32 v176, v176
    v_exp_f32 v177, v177
    s_waitcnt lgkmcnt(4)
    v_mfma_f32_32x32x16_bf16 v[64:79], v[132:135], a[72:75], v[64:79]
    v_exp_f32 v178, v178
    v_exp_f32 v179, v179
    v_mfma_f32_32x32x16_bf16 v[80:95], v[132:135], a[76:79], v[80:95]
    buffer_load_dwordx4 v34, s[8:11], s62 offen offset:2048 lds
    s_waitcnt lgkmcnt(0)
    s_waitcnt vmcnt(6)
    s_barrier
    v_mfma_f32_32x32x16_bf16 v[64:79], v[136:139], a[80:83], v[64:79]
    ds_read_b64_tr_b16 v[128:129], v43 offset:24576
    ds_read_b64_tr_b16 v[130:131], v43 offset:25088
    v_add_f32 v172, 1.0, v172
    v_add_f32 v173, 1.0, v173
    v_add_f32 v174, 1.0, v174
    v_add_f32 v175, 1.0, v175
    v_mfma_f32_32x32x16_bf16 v[80:95], v[136:139], a[84:87], v[80:95]
    v_rcp_f32 v168, v168
    v_rcp_f32 v169, v169
    v_rcp_f32 v170, v170
    v_mfma_f32_32x32x16_bf16 v[64:79], v[140:143], a[88:91], v[64:79]
    ds_read_b64_tr_b16 v[132:133], v43 offset:26624
    ds_read_b64_tr_b16 v[134:135], v43 offset:27136
    v_rcp_f32 v171, v171
    v_exp_f32 v180, v180
    v_mfma_f32_32x32x16_bf16 v[80:95], v[140:143], a[92:95], v[80:95]
    s_add_u32 m0, s47, 110592
    s_add_u32 s62, s41, 4424192
    buffer_load_dwordx4 v32, s[8:11], s62 offen lds
    v_exp_f32 v181, v181
    s_waitcnt lgkmcnt(2)
    v_mfma_f32_32x32x16_bf16 v[64:79], v[128:131], a[96:99], v[64:79]
    ds_read_b64_tr_b16 v[136:137], v43 offset:28672
    ds_read_b64_tr_b16 v[138:139], v43 offset:29184
    v_exp_f32 v182, v182
    v_exp_f32 v183, v183
    v_add_f32 v176, 1.0, v176
    v_mfma_f32_32x32x16_bf16 v[80:95], v[128:131], a[100:103], v[80:95]
    v_add_f32 v177, 1.0, v177
    v_add_f32 v178, 1.0, v178
    v_add_f32 v179, 1.0, v179
    v_rcp_f32 v172, v172
    v_rcp_f32 v173, v173
    s_waitcnt lgkmcnt(2)
    v_mfma_f32_32x32x16_bf16 v[64:79], v[132:135], a[104:107], v[64:79]
    ds_read_b64_tr_b16 v[140:141], v43 offset:30720
    ds_read_b64_tr_b16 v[142:143], v43 offset:31232
    v_rcp_f32 v174, v174
    v_rcp_f32 v175, v175
    v_mfma_f32_32x32x16_bf16 v[80:95], v[132:135], a[108:111], v[80:95]
    buffer_load_dwordx4 v33, s[8:11], s62 offen offset:1024 lds
    v_exp_f32 v184, v184
    s_waitcnt lgkmcnt(2)
    v_mfma_f32_32x32x16_bf16 v[64:79], v[136:139], a[112:115], v[64:79]
    ds_read_b64_tr_b16 v[128:129], v43 offset:32768
    ds_read_b64_tr_b16 v[130:131], v43 offset:33280
    ds_read_b64_tr_b16 v[132:133], v43 offset:34816
    ds_read_b64_tr_b16 v[134:135], v43 offset:35328
    v_exp_f32 v185, v185
    v_mfma_f32_32x32x16_bf16 v[80:95], v[136:139], a[116:119], v[80:95]
    v_exp_f32 v186, v186
    v_exp_f32 v187, v187
    v_add_f32 v180, 1.0, v180
    v_add_f32 v181, 1.0, v181
    v_add_f32 v182, 1.0, v182
    s_waitcnt lgkmcnt(4)
    v_mfma_f32_32x32x16_bf16 v[64:79], v[140:143], a[120:123], v[64:79]
    v_add_f32 v183, 1.0, v183
    v_rcp_f32 v176, v176
    v_rcp_f32 v177, v177
    v_mfma_f32_32x32x16_bf16 v[80:95], v[140:143], a[124:127], v[80:95]
    buffer_load_dwordx4 v34, s[8:11], s62 offen offset:2048 lds
    s_waitcnt lgkmcnt(0)
    s_waitcnt vmcnt(6)
    s_barrier
    v_mfma_f32_32x32x16_bf16 v[64:79], v[128:131], a[128:131], v[64:79]
    ds_read_b64_tr_b16 v[136:137], v43 offset:36864
    ds_read_b64_tr_b16 v[138:139], v43 offset:37376
    v_rcp_f32 v178, v178
    v_rcp_f32 v179, v179
    v_mfma_f32_32x32x16_bf16 v[80:95], v[128:131], a[132:135], v[80:95]
    v_exp_f32 v188, v188
    v_exp_f32 v189, v189
    v_exp_f32 v190, v190
    v_mfma_f32_32x32x16_bf16 v[64:79], v[132:135], a[136:139], v[64:79]
    ds_read_b64_tr_b16 v[140:141], v43 offset:38912
    ds_read_b64_tr_b16 v[142:143], v43 offset:39424
    v_exp_f32 v191, v191
    v_add_f32 v184, 1.0, v184
    v_add_f32 v185, 1.0, v185
    v_add_f32 v186, 1.0, v186
    v_mfma_f32_32x32x16_bf16 v[80:95], v[132:135], a[140:143], v[80:95]
    s_add_u32 m0, s47, 122880
    s_add_u32 s62, s41, 640
    buffer_load_dwordx4 v32, s[8:11], s62 offen lds
    v_add_f32 v187, 1.0, v187
    v_rcp_f32 v180, v180
    s_waitcnt lgkmcnt(2)
    v_mfma_f32_32x32x16_bf16 v[64:79], v[136:139], a[144:147], v[64:79]
    ds_read_b64_tr_b16 v[128:129], v43 offset:40960
    ds_read_b64_tr_b16 v[130:131], v43 offset:41472
    v_rcp_f32 v181, v181
    v_rcp_f32 v182, v182
    v_mfma_f32_32x32x16_bf16 v[80:95], v[136:139], a[148:151], v[80:95]
    v_rcp_f32 v183, v183
    v_exp_f32 v192, v192
    v_exp_f32 v193, v193
    s_waitcnt lgkmcnt(2)
    v_mfma_f32_32x32x16_bf16 v[64:79], v[140:143], a[152:155], v[64:79]
    ds_read_b64_tr_b16 v[132:133], v43 offset:43008
    ds_read_b64_tr_b16 v[134:135], v43 offset:43520
    v_exp_f32 v194, v194
    v_exp_f32 v195, v195
    v_mfma_f32_32x32x16_bf16 v[80:95], v[140:143], a[156:159], v[80:95]
    buffer_load_dwordx4 v33, s[8:11], s62 offen offset:1024 lds
    v_add_f32 v188, 1.0, v188
    v_add_f32 v189, 1.0, v189
    v_add_f32 v190, 1.0, v190
    s_waitcnt lgkmcnt(2)
    v_mfma_f32_32x32x16_bf16 v[64:79], v[128:131], a[160:163], v[64:79]
    ds_read_b64_tr_b16 v[136:137], v43 offset:45056
    ds_read_b64_tr_b16 v[138:139], v43 offset:45568
    ds_read_b64_tr_b16 v[140:141], v43 offset:47104
    ds_read_b64_tr_b16 v[142:143], v43 offset:47616
    ds_read_b128 v[152:155], v45 offset:1280
    v_add_f32 v191, 1.0, v191
    v_mfma_f32_32x32x16_bf16 v[80:95], v[128:131], a[164:167], v[80:95]
    v_rcp_f32 v184, v184
    v_rcp_f32 v185, v185
    v_rcp_f32 v186, v186
    s_waitcnt lgkmcnt(5)
    v_mfma_f32_32x32x16_bf16 v[64:79], v[132:135], a[168:171], v[64:79]
    ds_read_b128 v[156:159], v45 offset:1312
    v_rcp_f32 v187, v187
    v_exp_f32 v196, v196
    v_exp_f32 v197, v197
    v_mfma_f32_32x32x16_bf16 v[80:95], v[132:135], a[172:175], v[80:95]
    buffer_load_dwordx4 v34, s[8:11], s62 offen offset:2048 lds
    s_waitcnt lgkmcnt(2)
    s_waitcnt vmcnt(6)
    s_barrier
    v_mfma_f32_32x32x16_bf16 v[64:79], v[136:139], a[176:179], v[64:79]
    ds_read_b64_tr_b16 v[128:129], v43 offset:0
    ds_read_b64_tr_b16 v[130:131], v43 offset:512
    ds_read_b128 v[160:163], v45 offset:1344
    v_exp_f32 v198, v198
    v_exp_f32 v199, v199
    v_mfma_f32_32x32x16_bf16 v[80:95], v[136:139], a[180:183], v[80:95]
    v_add_f32 v192, 1.0, v192
    v_add_f32 v193, 1.0, v193
    v_add_f32 v194, 1.0, v194
    v_add_f32 v195, 1.0, v195
    v_rcp_f32 v188, v188
    v_mfma_f32_32x32x16_bf16 v[64:79], v[140:143], a[184:187], v[64:79]
    ds_read_b64_tr_b16 v[132:133], v43 offset:2048
    ds_read_b64_tr_b16 v[134:135], v43 offset:2560
    ds_read_b128 v[164:167], v45 offset:1376
    v_rcp_f32 v189, v189
    v_rcp_f32 v190, v190
    v_mfma_f32_32x32x16_bf16 v[80:95], v[140:143], a[188:191], v[80:95]
    s_add_u32 m0, s47, 135168
    s_add_u32 s62, s41, 885376
    buffer_load_dwordx4 v32, s[8:11], s62 offen lds
    v_rcp_f32 v191, v191
    v_add_f32 v196, 1.0, v196
    s_waitcnt lgkmcnt(4)
    v_mfma_f32_32x32x16_bf16 v[64:79], v[128:131], a[192:195], v[64:79]
    ds_read_b64_tr_b16 v[136:137], v43 offset:4096
    ds_read_b64_tr_b16 v[138:139], v43 offset:4608
    v_add_f32 v197, 1.0, v197
    v_add_f32 v198, 1.0, v198
    v_add_f32 v199, 1.0, v199
    v_rcp_f32 v192, v192
    v_mfma_f32_32x32x16_bf16 v[80:95], v[128:131], a[196:199], v[80:95]
    v_rcp_f32 v193, v193
    v_rcp_f32 v194, v194
    v_rcp_f32 v195, v195
    s_waitcnt lgkmcnt(3)
    v_mfma_f32_32x32x16_bf16 v[64:79], v[132:135], a[200:203], v[64:79]
    ds_read_b64_tr_b16 v[140:141], v43 offset:6144
    ds_read_b64_tr_b16 v[142:143], v43 offset:6656
    v_rcp_f32 v196, v196
    v_rcp_f32 v197, v197
    v_mfma_f32_32x32x16_bf16 v[80:95], v[132:135], a[204:207], v[80:95]
    buffer_load_dwordx4 v33, s[8:11], s62 offen offset:1024 lds
    v_rcp_f32 v198, v198
    s_waitcnt lgkmcnt(2)
    v_mfma_f32_32x32x16_bf16 v[64:79], v[136:139], a[208:211], v[64:79]
    ds_read_b64_tr_b16 v[128:129], v43 offset:8192
    ds_read_b64_tr_b16 v[130:131], v43 offset:8704
    ds_read_b64_tr_b16 v[132:133], v43 offset:10240
    ds_read_b64_tr_b16 v[134:135], v43 offset:10752
    v_rcp_f32 v199, v199
    v_mul_f32 v168, v168, v96
    v_mfma_f32_32x32x16_bf16 v[80:95], v[136:139], a[212:215], v[80:95]
    v_mul_f32 v169, v169, v97
    v_mul_f32 v170, v170, v98
    v_mul_f32 v171, v171, v99
    v_mul_f32 v172, v172, v100
    v_mul_f32 v173, v173, v101
    v_mul_f32 v174, v174, v102
    v_mul_f32 v175, v175, v103
    s_waitcnt lgkmcnt(4)
    v_mfma_f32_32x32x16_bf16 v[64:79], v[140:143], a[216:219], v[64:79]
    v_cvt_pk_bf16_f32 v200, v168, v169
    v_cvt_pk_bf16_f32 v201, v170, v171
    v_cvt_pk_bf16_f32 v202, v172, v173
    v_cvt_pk_bf16_f32 v203, v174, v175
    v_mfma_f32_32x32x16_bf16 v[80:95], v[140:143], a[220:223], v[80:95]
    buffer_load_dwordx4 v34, s[8:11], s62 offen offset:2048 lds
    s_waitcnt lgkmcnt(0)
    s_waitcnt vmcnt(6)
    s_barrier
    v_mfma_f32_32x32x16_bf16 v[64:79], v[128:131], a[224:227], v[64:79]
    ds_read_b64_tr_b16 v[136:137], v43 offset:12288
    ds_read_b64_tr_b16 v[138:139], v43 offset:12800
    ds_write_b128 v42, v[200:203] offset:24576
    v_mul_f32 v176, v176, v104
    v_mfma_f32_32x32x16_bf16 v[80:95], v[128:131], a[228:231], v[80:95]
    v_mul_f32 v177, v177, v105
    v_mul_f32 v178, v178, v106
    v_mul_f32 v179, v179, v107
    v_mul_f32 v180, v180, v108
    v_mul_f32 v181, v181, v109
    v_mul_f32 v182, v182, v110
    v_mul_f32 v183, v183, v111
    v_mfma_f32_32x32x16_bf16 v[64:79], v[132:135], a[232:235], v[64:79]
    ds_read_b64_tr_b16 v[140:141], v43 offset:14336
    ds_read_b64_tr_b16 v[142:143], v43 offset:14848
    v_cvt_pk_bf16_f32 v204, v176, v177
    v_cvt_pk_bf16_f32 v205, v178, v179
    v_cvt_pk_bf16_f32 v206, v180, v181
    v_cvt_pk_bf16_f32 v207, v182, v183
    v_mfma_f32_32x32x16_bf16 v[80:95], v[132:135], a[236:239], v[80:95]
    s_add_u32 m0, s47, 98304
    s_add_u32 s62, s41, 1770112
    buffer_load_dwordx4 v32, s[8:11], s62 offen lds
    ds_write_b128 v42, v[204:207] offset:26624
    s_waitcnt lgkmcnt(4)
    v_mfma_f32_32x32x16_bf16 v[64:79], v[136:139], a[240:243], v[64:79]
    ds_read_b64_tr_b16 v[128:129], v43 offset:16384
    ds_read_b64_tr_b16 v[130:131], v43 offset:16896
    v_mul_f32 v184, v184, v112
    v_mul_f32 v185, v185, v113
    v_mul_f32 v186, v186, v114
    v_mul_f32 v187, v187, v115
    v_mfma_f32_32x32x16_bf16 v[80:95], v[136:139], a[244:247], v[80:95]
    v_mul_f32 v188, v188, v116
    v_mul_f32 v189, v189, v117
    v_mul_f32 v190, v190, v118
    v_mul_f32 v191, v191, v119
    s_waitcnt lgkmcnt(3)
    v_mfma_f32_32x32x16_bf16 v[64:79], v[140:143], a[248:251], v[64:79]
    ds_read_b64_tr_b16 v[132:133], v43 offset:18432
    ds_read_b64_tr_b16 v[134:135], v43 offset:18944
    v_cvt_pk_bf16_f32 v208, v184, v185
    v_cvt_pk_bf16_f32 v209, v186, v187
    v_cvt_pk_bf16_f32 v210, v188, v189
    v_cvt_pk_bf16_f32 v211, v190, v191
    v_mfma_f32_32x32x16_bf16 v[80:95], v[140:143], a[252:255], v[80:95]
    buffer_load_dwordx4 v33, s[8:11], s62 offen offset:1024 lds
    ds_write_b128 v42, v[208:211] offset:25600
    s_waitcnt lgkmcnt(3)
    v_mfma_f32_32x32x16_bf16 v[64:79], v[128:131], v[224:227], v[64:79]
    ds_read_b64_tr_b16 v[136:137], v43 offset:20480
    ds_read_b64_tr_b16 v[138:139], v43 offset:20992
    ds_read_b64_tr_b16 v[140:141], v43 offset:22528
    ds_read_b64_tr_b16 v[142:143], v43 offset:23040
    v_mul_f32 v192, v192, v120
    v_mul_f32 v193, v193, v121
    v_mul_f32 v194, v194, v122
    v_mfma_f32_32x32x16_bf16 v[80:95], v[128:131], v[228:231], v[80:95]
    v_mul_f32 v195, v195, v123
    v_mul_f32 v196, v196, v124
    v_mul_f32 v197, v197, v125
    v_mul_f32 v198, v198, v126
    v_mul_f32 v199, v199, v127
    s_waitcnt lgkmcnt(5)
    v_mfma_f32_32x32x16_bf16 v[64:79], v[132:135], v[232:235], v[64:79]
    v_cvt_pk_bf16_f32 v212, v192, v193
    v_cvt_pk_bf16_f32 v213, v194, v195
    v_cvt_pk_bf16_f32 v214, v196, v197
    v_cvt_pk_bf16_f32 v215, v198, v199
    v_mfma_f32_32x32x16_bf16 v[80:95], v[132:135], v[236:239], v[80:95]
    buffer_load_dwordx4 v34, s[8:11], s62 offen offset:2048 lds
    s_waitcnt lgkmcnt(0)
    s_waitcnt vmcnt(6)
    s_barrier
    v_mfma_f32_32x32x16_bf16 v[64:79], v[136:139], v[240:243], v[64:79]
    ds_read_b64_tr_b16 v[128:129], v43 offset:24576
    ds_read_b64_tr_b16 v[130:131], v43 offset:25088
    ds_write_b128 v42, v[212:215] offset:27648
    v_mfma_f32_32x32x16_bf16 v[80:95], v[136:139], v[244:247], v[80:95]
    v_mfma_f32_32x32x16_bf16 v[64:79], v[140:143], v[248:251], v[64:79]
    ds_read_b64_tr_b16 v[132:133], v43 offset:26624
    ds_read_b64_tr_b16 v[134:135], v43 offset:27136
    v_mfma_f32_32x32x16_bf16 v[80:95], v[140:143], v[252:255], v[80:95]
    s_add_u32 m0, s47, 110592
    s_add_u32 s62, s41, 2654848
    buffer_load_dwordx4 v32, s[8:11], s62 offen lds
    s_waitcnt lgkmcnt(3)
    v_mfma_f32_32x32x16_bf16 v[96:111], v[128:131], a[0:3], v[152:167]
    ds_read_b64_tr_b16 v[136:137], v43 offset:28672
    ds_read_b64_tr_b16 v[138:139], v43 offset:29184
    v_mfma_f32_32x32x16_bf16 v[112:127], v[128:131], a[4:7], v[152:167]
    s_waitcnt lgkmcnt(2)
    v_mfma_f32_32x32x16_bf16 v[96:111], v[132:135], a[8:11], v[96:111]
    ds_read_b64_tr_b16 v[140:141], v43 offset:30720
    ds_read_b64_tr_b16 v[142:143], v43 offset:31232
    v_mul_f32 v168, v64, v64
    v_mul_f32 v169, v65, v65
    v_mul_f32 v170, v66, v66
    v_mul_f32 v171, v67, v67
    v_mfma_f32_32x32x16_bf16 v[112:127], v[132:135], a[12:15], v[112:127]
    buffer_load_dwordx4 v33, s[8:11], s62 offen offset:1024 lds
    v_mul_f32 v172, v68, v68
    v_mul_f32 v173, v69, v69
    v_mul_f32 v174, v70, v70
    s_waitcnt lgkmcnt(2)
    v_mfma_f32_32x32x16_bf16 v[96:111], v[136:139], a[16:19], v[96:111]
    ds_read_b64_tr_b16 v[128:129], v43 offset:32768
    ds_read_b64_tr_b16 v[130:131], v43 offset:33280
    ds_read_b64_tr_b16 v[132:133], v43 offset:34816
    ds_read_b64_tr_b16 v[134:135], v43 offset:35328
    v_mul_f32 v175, v71, v71
    v_mul_f32 v176, v72, v72
    v_mul_f32 v177, v73, v73
    v_mfma_f32_32x32x16_bf16 v[112:127], v[136:139], a[20:23], v[112:127]
    v_mul_f32 v178, v74, v74
    v_mul_f32 v179, v75, v75
    v_mul_f32 v180, v76, v76
    v_mul_f32 v181, v77, v77
    v_mul_f32 v182, v78, v78
    v_mul_f32 v183, v79, v79
    s_waitcnt lgkmcnt(4)
    v_mfma_f32_32x32x16_bf16 v[96:111], v[140:143], a[24:27], v[96:111]
    v_mul_f32 v184, v80, v80
    v_mul_f32 v185, v81, v81
    v_mul_f32 v186, v82, v82
    v_mul_f32 v187, v83, v83
    v_mfma_f32_32x32x16_bf16 v[112:127], v[140:143], a[28:31], v[112:127]
    buffer_load_dwordx4 v34, s[8:11], s62 offen offset:2048 lds
    s_waitcnt lgkmcnt(0)
    s_waitcnt vmcnt(6)
    s_barrier
    v_mfma_f32_32x32x16_bf16 v[96:111], v[128:131], a[32:35], v[96:111]
    ds_read_b64_tr_b16 v[136:137], v43 offset:36864
    ds_read_b64_tr_b16 v[138:139], v43 offset:37376
    v_mul_f32 v188, v84, v84
    v_mul_f32 v189, v85, v85
    v_mul_f32 v190, v86, v86
    v_mul_f32 v191, v87, v87
    v_mul_f32 v192, v88, v88
    v_mfma_f32_32x32x16_bf16 v[112:127], v[128:131], a[36:39], v[112:127]
    v_mul_f32 v193, v89, v89
    v_mul_f32 v194, v90, v90
    v_mul_f32 v195, v91, v91
    v_mul_f32 v196, v92, v92
    v_mul_f32 v197, v93, v93
    v_mul_f32 v198, v94, v94
    v_mul_f32 v199, v95, v95
    v_mfma_f32_32x32x16_bf16 v[96:111], v[132:135], a[40:43], v[96:111]
    ds_read_b64_tr_b16 v[140:141], v43 offset:38912
    ds_read_b64_tr_b16 v[142:143], v43 offset:39424
    v_mfma_f32_32x32x16_bf16 v[112:127], v[132:135], a[44:47], v[112:127]
    s_add_u32 m0, s47, 122880
    s_add_u32 s62, s41, 3539584
    buffer_load_dwordx4 v32, s[8:11], s62 offen lds
    v_pk_fma_f32 v[168:169], v[168:169], s[66:67], v[56:57]
    v_pk_fma_f32 v[170:171], v[170:171], s[66:67], v[56:57]
    v_pk_fma_f32 v[172:173], v[172:173], s[66:67], v[56:57]
    v_pk_fma_f32 v[174:175], v[174:175], s[66:67], v[56:57]
    v_pk_fma_f32 v[176:177], v[176:177], s[66:67], v[56:57]
    v_pk_fma_f32 v[178:179], v[178:179], s[66:67], v[56:57]
    v_pk_fma_f32 v[180:181], v[180:181], s[66:67], v[56:57]
    v_pk_fma_f32 v[182:183], v[182:183], s[66:67], v[56:57]
    v_pk_fma_f32 v[184:185], v[184:185], s[66:67], v[56:57]
    v_pk_fma_f32 v[186:187], v[186:187], s[66:67], v[56:57]
    v_pk_fma_f32 v[188:189], v[188:189], s[66:67], v[56:57]
    v_pk_fma_f32 v[190:191], v[190:191], s[66:67], v[56:57]
    v_pk_fma_f32 v[192:193], v[192:193], s[66:67], v[56:57]
    v_pk_fma_f32 v[194:195], v[194:195], s[66:67], v[56:57]
    v_pk_fma_f32 v[196:197], v[196:197], s[66:67], v[56:57]
    v_pk_fma_f32 v[198:199], v[198:199], s[66:67], v[56:57]
    v_pk_mul_f32 v[168:169], v[168:169], v[64:65]
    v_pk_mul_f32 v[170:171], v[170:171], v[66:67]
    v_pk_mul_f32 v[172:173], v[172:173], v[68:69]
    v_pk_mul_f32 v[174:175], v[174:175], v[70:71]
    v_pk_mul_f32 v[176:177], v[176:177], v[72:73]
    v_pk_mul_f32 v[178:179], v[178:179], v[74:75]
    v_pk_mul_f32 v[180:181], v[180:181], v[76:77]
    v_pk_mul_f32 v[182:183], v[182:183], v[78:79]
    v_pk_mul_f32 v[184:185], v[184:185], v[80:81]
    v_pk_mul_f32 v[186:187], v[186:187], v[82:83]
    v_pk_mul_f32 v[188:189], v[188:189], v[84:85]
    v_pk_mul_f32 v[190:191], v[190:191], v[86:87]
    v_pk_mul_f32 v[192:193], v[192:193], v[88:89]
    v_pk_mul_f32 v[194:195], v[194:195], v[90:91]
    v_pk_mul_f32 v[196:197], v[196:197], v[92:93]
    v_pk_mul_f32 v[198:199], v[198:199], v[94:95]
    s_waitcnt lgkmcnt(2)
    v_mfma_f32_32x32x16_bf16 v[96:111], v[136:139], a[48:51], v[96:111]
    ds_read_b64_tr_b16 v[128:129], v43 offset:40960
    ds_read_b64_tr_b16 v[130:131], v43 offset:41472
    v_exp_f32 v168, v168
    v_exp_f32 v169, v169
    v_mfma_f32_32x32x16_bf16 v[112:127], v[136:139], a[52:55], v[112:127]
    v_exp_f32 v170, v170
    v_exp_f32 v171, v171
    s_waitcnt lgkmcnt(2)
    v_mfma_f32_32x32x16_bf16 v[96:111], v[140:143], a[56:59], v[96:111]
    ds_read_b64_tr_b16 v[132:133], v43 offset:43008
    ds_read_b64_tr_b16 v[134:135], v43 offset:43520
    v_exp_f32 v172, v172
    v_exp_f32 v173, v173
    v_mfma_f32_32x32x16_bf16 v[112:127], v[140:143], a[60:63], v[112:127]
    buffer_load_dwordx4 v33, s[8:11], s62 offen offset:1024 lds
    v_exp_f32 v174, v174
    s_waitcnt lgkmcnt(2)
    v_mfma_f32_32x32x16_bf16 v[96:111], v[128:131], a[64:67], v[96:111]
    ds_read_b64_tr_b16 v[136:137], v43 offset:45056
    ds_read_b64_tr_b16 v[138:139], v43 offset:45568
    ds_read_b64_tr_b16 v[140:141], v43 offset:47104
    ds_read_b64_tr_b16 v[142:143], v43 offset:47616
    v_exp_f32 v175, v175
    v_add_f32 v168, 1.0, v168
    v_mfma_f32_32x32x16_bf16 v[112:127], v[128:131], a[68:71], v[112:127]
    v_add_f32 v169, 1.0, v169
    v_add_f32 v170, 1.0, v170
    v_add_f32 v171, 1.0, v171
    v_exp_f32 v176, v176
    v_exp_f32 v177, v177
    s_waitcnt lgkmcnt(4)
    v_mfma_f32_32x32x16_bf16 v[96:111], v[132:135], a[72:75], v[96:111]
    v_exp_f32 v178, v178
    v_exp_f32 v179, v179
    v_mfma_f32_32x32x16_bf16 v[112:127], v[132:135], a[76:79], v[112:127]
    buffer_load_dwordx4 v34, s[8:11], s62 offen offset:2048 lds
    s_waitcnt lgkmcnt(0)
    s_waitcnt vmcnt(6)
    s_barrier
    v_mfma_f32_32x32x16_bf16 v[96:111], v[136:139], a[80:83], v[96:111]
    ds_read_b64_tr_b16 v[128:129], v43 offset:0
    ds_read_b64_tr_b16 v[130:131], v43 offset:512
    v_add_f32 v172, 1.0, v172
    v_add_f32 v173, 1.0, v173
    v_add_f32 v174, 1.0, v174
    v_add_f32 v175, 1.0, v175
    v_mfma_f32_32x32x16_bf16 v[112:127], v[136:139], a[84:87], v[112:127]
    v_rcp_f32 v168, v168
    v_rcp_f32 v169, v169
    v_rcp_f32 v170, v170
    v_mfma_f32_32x32x16_bf16 v[96:111], v[140:143], a[88:91], v[96:111]
    ds_read_b64_tr_b16 v[132:133], v43 offset:2048
    ds_read_b64_tr_b16 v[134:135], v43 offset:2560
    v_rcp_f32 v171, v171
    v_exp_f32 v180, v180
    v_mfma_f32_32x32x16_bf16 v[112:127], v[140:143], a[92:95], v[112:127]
    s_add_u32 m0, s47, 135168
    s_add_u32 s62, s41, 4424320
    buffer_load_dwordx4 v32, s[8:11], s62 offen lds
    v_exp_f32 v181, v181
    s_waitcnt lgkmcnt(2)
    v_mfma_f32_32x32x16_bf16 v[96:111], v[128:131], a[96:99], v[96:111]
    ds_read_b64_tr_b16 v[136:137], v43 offset:4096
    ds_read_b64_tr_b16 v[138:139], v43 offset:4608
    v_exp_f32 v182, v182
    v_exp_f32 v183, v183
    v_add_f32 v176, 1.0, v176
    v_mfma_f32_32x32x16_bf16 v[112:127], v[128:131], a[100:103], v[112:127]
    v_add_f32 v177, 1.0, v177
    v_add_f32 v178, 1.0, v178
    v_add_f32 v179, 1.0, v179
    v_rcp_f32 v172, v172
    v_rcp_f32 v173, v173
    s_waitcnt lgkmcnt(2)
    v_mfma_f32_32x32x16_bf16 v[96:111], v[132:135], a[104:107], v[96:111]
    ds_read_b64_tr_b16 v[140:141], v43 offset:6144
    ds_read_b64_tr_b16 v[142:143], v43 offset:6656
    v_rcp_f32 v174, v174
    v_rcp_f32 v175, v175
    v_mfma_f32_32x32x16_bf16 v[112:127], v[132:135], a[108:111], v[112:127]
    buffer_load_dwordx4 v33, s[8:11], s62 offen offset:1024 lds
    v_exp_f32 v184, v184
    s_waitcnt lgkmcnt(2)
    v_mfma_f32_32x32x16_bf16 v[96:111], v[136:139], a[112:115], v[96:111]
    ds_read_b64_tr_b16 v[128:129], v43 offset:8192
    ds_read_b64_tr_b16 v[130:131], v43 offset:8704
    ds_read_b64_tr_b16 v[132:133], v43 offset:10240
    ds_read_b64_tr_b16 v[134:135], v43 offset:10752
    v_exp_f32 v185, v185
    v_mfma_f32_32x32x16_bf16 v[112:127], v[136:139], a[116:119], v[112:127]
    v_exp_f32 v186, v186
    v_exp_f32 v187, v187
    v_add_f32 v180, 1.0, v180
    v_add_f32 v181, 1.0, v181
    v_add_f32 v182, 1.0, v182
    s_waitcnt lgkmcnt(4)
    v_mfma_f32_32x32x16_bf16 v[96:111], v[140:143], a[120:123], v[96:111]
    v_add_f32 v183, 1.0, v183
    v_rcp_f32 v176, v176
    v_rcp_f32 v177, v177
    v_mfma_f32_32x32x16_bf16 v[112:127], v[140:143], a[124:127], v[112:127]
    buffer_load_dwordx4 v34, s[8:11], s62 offen offset:2048 lds
    s_waitcnt lgkmcnt(0)
    s_waitcnt vmcnt(6)
    s_barrier
    v_mfma_f32_32x32x16_bf16 v[96:111], v[128:131], a[128:131], v[96:111]
    ds_read_b64_tr_b16 v[136:137], v43 offset:12288
    ds_read_b64_tr_b16 v[138:139], v43 offset:12800
    v_rcp_f32 v178, v178
    v_rcp_f32 v179, v179
    v_mfma_f32_32x32x16_bf16 v[112:127], v[128:131], a[132:135], v[112:127]
    v_exp_f32 v188, v188
    v_exp_f32 v189, v189
    v_exp_f32 v190, v190
    v_mfma_f32_32x32x16_bf16 v[96:111], v[132:135], a[136:139], v[96:111]
    ds_read_b64_tr_b16 v[140:141], v43 offset:14336
    ds_read_b64_tr_b16 v[142:143], v43 offset:14848
    v_exp_f32 v191, v191
    v_add_f32 v184, 1.0, v184
    v_add_f32 v185, 1.0, v185
    v_add_f32 v186, 1.0, v186
    v_mfma_f32_32x32x16_bf16 v[112:127], v[132:135], a[140:143], v[112:127]
    s_add_u32 m0, s47, 98304
    s_add_u32 s62, s42, 0
    buffer_load_dwordx4 v35, s[12:15], s62 offen lds
    v_add_f32 v187, 1.0, v187
    v_rcp_f32 v180, v180
    s_waitcnt lgkmcnt(2)
    v_mfma_f32_32x32x16_bf16 v[96:111], v[136:139], a[144:147], v[96:111]
    ds_read_b64_tr_b16 v[128:129], v43 offset:16384
    ds_read_b64_tr_b16 v[130:131], v43 offset:16896
    v_rcp_f32 v181, v181
    v_rcp_f32 v182, v182
    v_mfma_f32_32x32x16_bf16 v[112:127], v[136:139], a[148:151], v[112:127]
    v_rcp_f32 v183, v183
    v_exp_f32 v192, v192
    v_exp_f32 v193, v193
    s_waitcnt lgkmcnt(2)
    v_mfma_f32_32x32x16_bf16 v[96:111], v[140:143], a[152:155], v[96:111]
    ds_read_b64_tr_b16 v[132:133], v43 offset:18432
    ds_read_b64_tr_b16 v[134:135], v43 offset:18944
    v_exp_f32 v194, v194
    v_exp_f32 v195, v195
    v_mfma_f32_32x32x16_bf16 v[112:127], v[140:143], a[156:159], v[112:127]
    buffer_load_dwordx4 v36, s[12:15], s62 offen offset:1024 lds
    v_add_f32 v188, 1.0, v188
    v_add_f32 v189, 1.0, v189
    v_add_f32 v190, 1.0, v190
    s_waitcnt lgkmcnt(2)
    v_mfma_f32_32x32x16_bf16 v[96:111], v[128:131], a[160:163], v[96:111]
    ds_read_b64_tr_b16 v[136:137], v43 offset:20480
    ds_read_b64_tr_b16 v[138:139], v43 offset:20992
    ds_read_b64_tr_b16 v[140:141], v43 offset:22528
    ds_read_b64_tr_b16 v[142:143], v43 offset:23040
    v_add_f32 v191, 1.0, v191
    v_rcp_f32 v184, v184
    v_mfma_f32_32x32x16_bf16 v[112:127], v[128:131], a[164:167], v[112:127]
    v_rcp_f32 v185, v185
    v_rcp_f32 v186, v186
    v_rcp_f32 v187, v187
    s_waitcnt lgkmcnt(4)
    v_mfma_f32_32x32x16_bf16 v[96:111], v[132:135], a[168:171], v[96:111]
    v_exp_f32 v196, v196
    v_exp_f32 v197, v197
    v_mfma_f32_32x32x16_bf16 v[112:127], v[132:135], a[172:175], v[112:127]
    buffer_load_dwordx4 v37, s[12:15], s62 offen offset:2048 lds
    s_waitcnt lgkmcnt(0)
    s_waitcnt vmcnt(6)
    s_barrier
    v_mfma_f32_32x32x16_bf16 v[96:111], v[136:139], a[176:179], v[96:111]
    ds_read_b64_tr_b16 v[128:129], v43 offset:24576
    ds_read_b64_tr_b16 v[130:131], v43 offset:25088
    v_exp_f32 v198, v198
    v_exp_f32 v199, v199
    v_add_f32 v192, 1.0, v192
    v_mfma_f32_32x32x16_bf16 v[112:127], v[136:139], a[180:183], v[112:127]
    v_add_f32 v193, 1.0, v193
    v_add_f32 v194, 1.0, v194
    v_add_f32 v195, 1.0, v195
    v_rcp_f32 v188, v188
    v_rcp_f32 v189, v189
    v_mfma_f32_32x32x16_bf16 v[96:111], v[140:143], a[184:187], v[96:111]
    ds_read_b64_tr_b16 v[132:133], v43 offset:26624
    ds_read_b64_tr_b16 v[134:135], v43 offset:27136
    v_rcp_f32 v190, v190
    v_rcp_f32 v191, v191
    v_mfma_f32_32x32x16_bf16 v[112:127], v[140:143], a[188:191], v[112:127]
    s_add_u32 m0, s47, 110592
    s_add_u32 s62, s42, 110592
    buffer_load_dwordx4 v35, s[12:15], s62 offen lds
    v_add_f32 v196, 1.0, v196
    v_add_f32 v197, 1.0, v197
    v_add_f32 v198, 1.0, v198
    s_waitcnt lgkmcnt(2)
    v_mfma_f32_32x32x16_bf16 v[96:111], v[128:131], a[192:195], v[96:111]
    ds_read_b64_tr_b16 v[136:137], v43 offset:28672
    ds_read_b64_tr_b16 v[138:139], v43 offset:29184
    v_add_f32 v199, 1.0, v199
    v_rcp_f32 v192, v192
    v_rcp_f32 v193, v193
    v_mfma_f32_32x32x16_bf16 v[112:127], v[128:131], a[196:199], v[112:127]
    v_rcp_f32 v194, v194
    v_rcp_f32 v195, v195
    s_waitcnt lgkmcnt(2)
    v_mfma_f32_32x32x16_bf16 v[96:111], v[132:135], a[200:203], v[96:111]
    ds_read_b64_tr_b16 v[140:141], v43 offset:30720
    ds_read_b64_tr_b16 v[142:143], v43 offset:31232
    v_rcp_f32 v196, v196
    v_rcp_f32 v197, v197
    v_mfma_f32_32x32x16_bf16 v[112:127], v[132:135], a[204:207], v[112:127]
    buffer_load_dwordx4 v36, s[12:15], s62 offen offset:1024 lds
    v_rcp_f32 v198, v198
    s_waitcnt lgkmcnt(2)
    v_mfma_f32_32x32x16_bf16 v[96:111], v[136:139], a[208:211], v[96:111]
    ds_read_b64_tr_b16 v[128:129], v43 offset:32768
    ds_read_b64_tr_b16 v[130:131], v43 offset:33280
    ds_read_b64_tr_b16 v[132:133], v43 offset:34816
    ds_read_b64_tr_b16 v[134:135], v43 offset:35328
    v_rcp_f32 v199, v199
    v_mul_f32 v168, v168, v64
    v_mfma_f32_32x32x16_bf16 v[112:127], v[136:139], a[212:215], v[112:127]
    v_mul_f32 v169, v169, v65
    v_mul_f32 v170, v170, v66
    v_mul_f32 v171, v171, v67
    v_mul_f32 v172, v172, v68
    v_mul_f32 v173, v173, v69
    v_mul_f32 v174, v174, v70
    v_mul_f32 v175, v175, v71
    s_waitcnt lgkmcnt(4)
    v_mfma_f32_32x32x16_bf16 v[96:111], v[140:143], a[216:219], v[96:111]
    v_cvt_pk_bf16_f32 v200, v168, v169
    v_cvt_pk_bf16_f32 v201, v170, v171
    v_cvt_pk_bf16_f32 v202, v172, v173
    v_cvt_pk_bf16_f32 v203, v174, v175
    v_mfma_f32_32x32x16_bf16 v[112:127], v[140:143], a[220:223], v[112:127]
    buffer_load_dwordx4 v37, s[12:15], s62 offen offset:2048 lds
    s_waitcnt lgkmcnt(0)
    s_waitcnt vmcnt(6)
    s_barrier
    v_mfma_f32_32x32x16_bf16 v[96:111], v[128:131], a[224:227], v[96:111]
    ds_read_b64_tr_b16 v[136:137], v43 offset:36864
    ds_read_b64_tr_b16 v[138:139], v43 offset:37376
    ds_write_b128 v42, v[200:203] offset:32768
    v_mul_f32 v176, v176, v72
    v_mfma_f32_32x32x16_bf16 v[112:127], v[128:131], a[228:231], v[112:127]
    v_mul_f32 v177, v177, v73
    v_mul_f32 v178, v178, v74
    v_mul_f32 v179, v179, v75
    v_mul_f32 v180, v180, v76
    v_mul_f32 v181, v181, v77
    v_mul_f32 v182, v182, v78
    v_mul_f32 v183, v183, v79
    v_mfma_f32_32x32x16_bf16 v[96:111], v[132:135], a[232:235], v[96:111]
    ds_read_b64_tr_b16 v[140:141], v43 offset:38912
    ds_read_b64_tr_b16 v[142:143], v43 offset:39424
    v_cvt_pk_bf16_f32 v204, v176, v177
    v_cvt_pk_bf16_f32 v205, v178, v179
    v_cvt_pk_bf16_f32 v206, v180, v181
    v_cvt_pk_bf16_f32 v207, v182, v183
    v_mfma_f32_32x32x16_bf16 v[112:127], v[132:135], a[236:239], v[112:127]
    s_add_u32 m0, s47, 122880
    s_add_u32 s62, s42, 221184
    buffer_load_dwordx4 v35, s[12:15], s62 offen lds
    ds_write_b128 v42, v[204:207] offset:34816
    s_waitcnt lgkmcnt(4)
    v_mfma_f32_32x32x16_bf16 v[96:111], v[136:139], a[240:243], v[96:111]
    ds_read_b64_tr_b16 v[128:129], v43 offset:40960
    ds_read_b64_tr_b16 v[130:131], v43 offset:41472
    v_mul_f32 v184, v184, v80
    v_mul_f32 v185, v185, v81
    v_mul_f32 v186, v186, v82
    v_mul_f32 v187, v187, v83
    v_mfma_f32_32x32x16_bf16 v[112:127], v[136:139], a[244:247], v[112:127]
    v_mul_f32 v188, v188, v84
    v_mul_f32 v189, v189, v85
    v_mul_f32 v190, v190, v86
    v_mul_f32 v191, v191, v87
    s_waitcnt lgkmcnt(3)
    v_mfma_f32_32x32x16_bf16 v[96:111], v[140:143], a[248:251], v[96:111]
    ds_read_b64_tr_b16 v[132:133], v43 offset:43008
    ds_read_b64_tr_b16 v[134:135], v43 offset:43520
    v_cvt_pk_bf16_f32 v208, v184, v185
    v_cvt_pk_bf16_f32 v209, v186, v187
    v_cvt_pk_bf16_f32 v210, v188, v189
    v_cvt_pk_bf16_f32 v211, v190, v191
    v_mfma_f32_32x32x16_bf16 v[112:127], v[140:143], a[252:255], v[112:127]
    buffer_load_dwordx4 v36, s[12:15], s62 offen offset:1024 lds
    ds_write_b128 v42, v[208:211] offset:33792
    s_waitcnt lgkmcnt(3)
    v_mfma_f32_32x32x16_bf16 v[96:111], v[128:131], v[224:227], v[96:111]
    ds_read_b64_tr_b16 v[136:137], v43 offset:45056
    ds_read_b64_tr_b16 v[138:139], v43 offset:45568
    ds_read_b64_tr_b16 v[140:141], v43 offset:47104
    ds_read_b64_tr_b16 v[142:143], v43 offset:47616
    v_mul_f32 v192, v192, v88
    v_mul_f32 v193, v193, v89
    v_mul_f32 v194, v194, v90
    v_mfma_f32_32x32x16_bf16 v[112:127], v[128:131], v[228:231], v[112:127]
    v_mul_f32 v195, v195, v91
    v_mul_f32 v196, v196, v92
    v_mul_f32 v197, v197, v93
    v_mul_f32 v198, v198, v94
    v_mul_f32 v199, v199, v95
    s_waitcnt lgkmcnt(5)
    v_mfma_f32_32x32x16_bf16 v[96:111], v[132:135], v[232:235], v[96:111]
    v_cvt_pk_bf16_f32 v212, v192, v193
    v_cvt_pk_bf16_f32 v213, v194, v195
    v_cvt_pk_bf16_f32 v214, v196, v197
    v_cvt_pk_bf16_f32 v215, v198, v199
    v_mfma_f32_32x32x16_bf16 v[112:127], v[132:135], v[236:239], v[112:127]
    buffer_load_dwordx4 v37, s[12:15], s62 offen offset:2048 lds
    s_waitcnt lgkmcnt(0)
    s_waitcnt vmcnt(6)
    s_barrier
    v_mfma_f32_32x32x16_bf16 v[96:111], v[136:139], v[240:243], v[96:111]
    ds_read_b64_tr_b16 v[128:129], v50 offset:36864
    ds_read_b64_tr_b16 v[130:131], v50 offset:37888
    ds_read_b128 a[0:3], v41 offset:0
    ds_read_b128 a[4:7], v41 offset:1024
    ds_write_b128 v42, v[212:215] offset:35840
    v_mfma_f32_32x32x16_bf16 v[112:127], v[136:139], v[244:247], v[112:127]
    v_mfma_f32_32x32x16_bf16 v[96:111], v[140:143], v[248:251], v[96:111]
    ds_read_b64_tr_b16 v[132:133], v50 offset:38912
    ds_read_b64_tr_b16 v[134:135], v50 offset:39936
    ds_read_b128 a[8:11], v41 offset:2048
    ds_read_b128 a[12:15], v41 offset:3072
    v_mfma_f32_32x32x16_bf16 v[112:127], v[140:143], v[252:255], v[112:127]
    s_add_u32 m0, s47, 135168
    s_add_u32 s62, s42, 331776
    buffer_load_dwordx4 v35, s[12:15], s62 offen lds
    s_waitcnt lgkmcnt(5)
    v_mfma_f32_32x32x16_bf16 v[64:79], v[128:131], a[0:3], 0
    ds_read_b64_tr_b16 v[136:137], v50 offset:40960
    ds_read_b64_tr_b16 v[138:139], v50 offset:41984
    ds_read_b128 a[16:19], v41 offset:4096
    ds_read_b128 a[20:23], v41 offset:5120
    v_mfma_f32_32x32x16_bf16 v[80:95], v[128:131], a[4:7], 0
    buffer_load_dwordx4 v36, s[12:15], s62 offen offset:1024 lds
    s_waitcnt lgkmcnt(4)
    v_mfma_f32_32x32x16_bf16 v[64:79], v[132:135], a[8:11], v[64:79]
    ds_read_b64_tr_b16 v[140:141], v50 offset:43008
    ds_read_b64_tr_b16 v[142:143], v50 offset:44032
    ds_read_b128 a[24:27], v41 offset:6144
    ds_read_b128 a[28:31], v41 offset:7168
    v_mul_f32 v168, v96, v96
    v_mul_f32 v169, v97, v97
    v_mul_f32 v170, v98, v98
    v_mfma_f32_32x32x16_bf16 v[80:95], v[132:135], a[12:15], v[80:95]
    buffer_load_dwordx4 v37, s[12:15], s62 offen offset:2048 lds
    v_mul_f32 v171, v99, v99
    v_mul_f32 v172, v100, v100
    v_mul_f32 v173, v101, v101
    s_waitcnt lgkmcnt(4)
    v_mfma_f32_32x32x16_bf16 v[64:79], v[136:139], a[16:19], v[64:79]
    ds_read_b64_tr_b16 v[128:129], v50 offset:45056
    ds_read_b64_tr_b16 v[130:131], v50 offset:46080
    ds_read_b128 a[32:35], v41 offset:8192
    ds_read_b128 a[36:39], v41 offset:9216
    ds_read_b64_tr_b16 v[132:133], v50 offset:47104
    ds_read_b64_tr_b16 v[134:135], v50 offset:48128
    ds_read_b128 a[40:43], v41 offset:10240
    ds_read_b128 a[44:47], v41 offset:11264
    v_mfma_f32_32x32x16_bf16 v[80:95], v[136:139], a[20:23], v[80:95]
    v_mul_f32 v174, v102, v102
    v_mul_f32 v175, v103, v103
    v_mul_f32 v176, v104, v104
    v_mul_f32 v177, v105, v105
    v_mul_f32 v178, v106, v106
    v_mul_f32 v179, v107, v107
    v_mul_f32 v180, v108, v108
    s_waitcnt lgkmcnt(8)
    v_mfma_f32_32x32x16_bf16 v[64:79], v[140:143], a[24:27], v[64:79]
    v_mul_f32 v181, v109, v109
    v_mul_f32 v182, v110, v110
    v_mul_f32 v183, v111, v111
    v_mul_f32 v184, v112, v112
    v_mul_f32 v185, v113, v113
    v_mul_f32 v186, v114, v114
    v_mul_f32 v187, v115, v115
    v_mfma_f32_32x32x16_bf16 v[80:95], v[140:143], a[28:31], v[80:95]
    v_mul_f32 v188, v116, v116
    v_mul_f32 v189, v117, v117
    s_waitcnt lgkmcnt(0)
    s_waitcnt vmcnt(6)
    s_barrier
    v_mfma_f32_32x32x16_bf16 v[64:79], v[128:131], a[32:35], v[64:79]
    ds_read_b64_tr_b16 v[136:137], v50 offset:49152
    ds_read_b64_tr_b16 v[138:139], v50 offset:50176
    ds_read_b128 a[48:51], v41 offset:12288
    ds_read_b128 a[52:55], v41 offset:13312
    v_mul_f32 v190, v118, v118
    v_mul_f32 v191, v119, v119
    v_mul_f32 v192, v120, v120
    v_mfma_f32_32x32x16_bf16 v[80:95], v[128:131], a[36:39], v[80:95]
    s_add_u32 m0, s47, 98304
    s_add_u32 s62, s42, 128
    buffer_load_dwordx4 v35, s[12:15], s62 offen lds
    v_mul_f32 v193, v121, v121
    v_mul_f32 v194, v122, v122
    v_mul_f32 v195, v123, v123
    v_mul_f32 v196, v124, v124
    v_mul_f32 v197, v125, v125
    v_mul_f32 v198, v126, v126
    v_mul_f32 v199, v127, v127
    v_mfma_f32_32x32x16_bf16 v[64:79], v[132:135], a[40:43], v[64:79]
    ds_read_b64_tr_b16 v[140:141], v50 offset:51200
    ds_read_b64_tr_b16 v[142:143], v50 offset:52224
    ds_read_b128 a[56:59], v41 offset:14336
    ds_read_b128 a[60:63], v41 offset:15360
    v_mfma_f32_32x32x16_bf16 v[80:95], v[132:135], a[44:47], v[80:95]
    buffer_load_dwordx4 v36, s[12:15], s62 offen offset:1024 lds
    v_pk_fma_f32 v[168:169], v[168:169], s[66:67], v[56:57]
    v_pk_fma_f32 v[170:171], v[170:171], s[66:67], v[56:57]
    v_pk_fma_f32 v[172:173], v[172:173], s[66:67], v[56:57]
    v_pk_fma_f32 v[174:175], v[174:175], s[66:67], v[56:57]
    v_pk_fma_f32 v[176:177], v[176:177], s[66:67], v[56:57]
    v_pk_fma_f32 v[178:179], v[178:179], s[66:67], v[56:57]
    v_pk_fma_f32 v[180:181], v[180:181], s[66:67], v[56:57]
    v_pk_fma_f32 v[182:183], v[182:183], s[66:67], v[56:57]
    v_pk_fma_f32 v[184:185], v[184:185], s[66:67], v[56:57]
    v_pk_fma_f32 v[186:187], v[186:187], s[66:67], v[56:57]
    v_pk_fma_f32 v[188:189], v[188:189], s[66:67], v[56:57]
    v_pk_fma_f32 v[190:191], v[190:191], s[66:67], v[56:57]
    v_pk_fma_f32 v[192:193], v[192:193], s[66:67], v[56:57]
    v_pk_fma_f32 v[194:195], v[194:195], s[66:67], v[56:57]
    v_pk_fma_f32 v[196:197], v[196:197], s[66:67], v[56:57]
    v_pk_fma_f32 v[198:199], v[198:199], s[66:67], v[56:57]
    v_pk_mul_f32 v[168:169], v[168:169], v[96:97]
    v_pk_mul_f32 v[170:171], v[170:171], v[98:99]
    v_pk_mul_f32 v[172:173], v[172:173], v[100:101]
    v_pk_mul_f32 v[174:175], v[174:175], v[102:103]
    v_pk_mul_f32 v[176:177], v[176:177], v[104:105]
    v_pk_mul_f32 v[178:179], v[178:179], v[106:107]
    v_pk_mul_f32 v[180:181], v[180:181], v[108:109]
    v_pk_mul_f32 v[182:183], v[182:183], v[110:111]
    v_pk_mul_f32 v[184:185], v[184:185], v[112:113]
    v_pk_mul_f32 v[186:187], v[186:187], v[114:115]
    v_pk_mul_f32 v[188:189], v[188:189], v[116:117]
    v_pk_mul_f32 v[190:191], v[190:191], v[118:119]
    v_pk_mul_f32 v[192:193], v[192:193], v[120:121]
    v_pk_mul_f32 v[194:195], v[194:195], v[122:123]
    v_pk_mul_f32 v[196:197], v[196:197], v[124:125]
    v_pk_mul_f32 v[198:199], v[198:199], v[126:127]
    s_waitcnt lgkmcnt(4)
    v_mfma_f32_32x32x16_bf16 v[64:79], v[136:139], a[48:51], v[64:79]
    ds_read_b64_tr_b16 v[128:129], v50 offset:53248
    ds_read_b64_tr_b16 v[130:131], v50 offset:54272
    ds_read_b128 a[64:67], v41 offset:16384
    ds_read_b128 a[68:71], v41 offset:17408
    v_exp_f32 v168, v168
    v_mfma_f32_32x32x16_bf16 v[80:95], v[136:139], a[52:55], v[80:95]
    buffer_load_dwordx4 v37, s[12:15], s62 offen offset:2048 lds
    v_exp_f32 v169, v169
    s_waitcnt lgkmcnt(4)
    v_mfma_f32_32x32x16_bf16 v[64:79], v[140:143], a[56:59], v[64:79]
    ds_read_b64_tr_b16 v[132:133], v50 offset:55296
    ds_read_b64_tr_b16 v[134:135], v50 offset:56320
    ds_read_b128 a[72:75], v41 offset:18432
    ds_read_b128 a[76:79], v41 offset:19456
    v_exp_f32 v170, v170
    v_mfma_f32_32x32x16_bf16 v[80:95], v[140:143], a[60:63], v[80:95]
    v_exp_f32 v171, v171
    v_exp_f32 v172, v172
    v_exp_f32 v173, v173
    s_waitcnt lgkmcnt(4)
    v_mfma_f32_32x32x16_bf16 v[64:79], v[128:131], a[64:67], v[64:79]
    ds_read_b64_tr_b16 v[136:137], v50 offset:57344
    ds_read_b64_tr_b16 v[138:139], v50 offset:58368
    ds_read_b128 a[80:83], v41 offset:20480
    ds_read_b128 a[84:87], v41 offset:21504
    ds_read_b64_tr_b16 v[140:141], v50 offset:59392
    ds_read_b64_tr_b16 v[142:143], v50 offset:60416
    ds_read_b128 a[88:91], v41 offset:22528
    ds_read_b128 a[92:95], v41 offset:23552
    v_mfma_f32_32x32x16_bf16 v[80:95], v[128:131], a[68:71], v[80:95]
    v_exp_f32 v174, v174
    v_exp_f32 v175, v175
    v_add_f32 v168, 1.0, v168
    v_add_f32 v169, 1.0, v169
    v_add_f32 v170, 1.0, v170
    s_waitcnt lgkmcnt(8)
    v_mfma_f32_32x32x16_bf16 v[64:79], v[132:135], a[72:75], v[64:79]
    v_add_f32 v171, 1.0, v171
    v_exp_f32 v176, v176
    v_exp_f32 v177, v177
    v_exp_f32 v178, v178
    v_mfma_f32_32x32x16_bf16 v[80:95], v[132:135], a[76:79], v[80:95]
    v_exp_f32 v179, v179
    s_waitcnt lgkmcnt(0)
    s_waitcnt vmcnt(6)
    s_barrier
    v_mfma_f32_32x32x16_bf16 v[64:79], v[136:139], a[80:83], v[64:79]
    ds_read_b64_tr_b16 v[128:129], v51 offset:0
    ds_read_b64_tr_b16 v[130:131], v51 offset:1024
    ds_read_b128 a[96:99], v41 offset:24576
    ds_read_b128 a[100:103], v41 offset:25600
    v_add_f32 v172, 1.0, v172
    v_add_f32 v173, 1.0, v173
    v_add_f32 v174, 1.0, v174
    v_mfma_f32_32x32x16_bf16 v[80:95], v[136:139], a[84:87], v[80:95]
    s_add_u32 m0, s47, 110592
    s_add_u32 s62, s42, 110720
    buffer_load_dwordx4 v35, s[12:15], s62 offen lds
    v_add_f32 v175, 1.0, v175
    v_rcp_f32 v168, v168
    v_mfma_f32_32x32x16_bf16 v[64:79], v[140:143], a[88:91], v[64:79]
    ds_read_b64_tr_b16 v[132:133], v51 offset:2048
    ds_read_b64_tr_b16 v[134:135], v51 offset:3072
    ds_read_b128 a[104:107], v41 offset:26624
    ds_read_b128 a[108:111], v41 offset:27648
    v_rcp_f32 v169, v169
    v_mfma_f32_32x32x16_bf16 v[80:95], v[140:143], a[92:95], v[80:95]
    buffer_load_dwordx4 v36, s[12:15], s62 offen offset:1024 lds
    v_rcp_f32 v170, v170
    s_waitcnt lgkmcnt(4)
    v_mfma_f32_32x32x16_bf16 v[64:79], v[128:131], a[96:99], v[64:79]
    ds_read_b64_tr_b16 v[136:137], v51 offset:4096
    ds_read_b64_tr_b16 v[138:139], v51 offset:5120
    ds_read_b128 a[112:115], v41 offset:28672
    ds_read_b128 a[116:119], v41 offset:29696
    v_rcp_f32 v171, v171
    v_mfma_f32_32x32x16_bf16 v[80:95], v[128:131], a[100:103], v[80:95]
    buffer_load_dwordx4 v37, s[12:15], s62 offen offset:2048 lds
    v_exp_f32 v180, v180
    s_waitcnt lgkmcnt(4)
    v_mfma_f32_32x32x16_bf16 v[64:79], v[132:135], a[104:107], v[64:79]
    ds_read_b64_tr_b16 v[140:141], v51 offset:6144
    ds_read_b64_tr_b16 v[142:143], v51 offset:7168
    ds_read_b128 a[120:123], v41 offset:30720
    ds_read_b128 a[124:127], v41 offset:31744
    v_exp_f32 v181, v181
    v_mfma_f32_32x32x16_bf16 v[80:95], v[132:135], a[108:111], v[80:95]
    v_exp_f32 v182, v182
    v_exp_f32 v183, v183
    v_add_f32 v176, 1.0, v176
    v_add_f32 v177, 1.0, v177
    v_add_f32 v178, 1.0, v178
    s_waitcnt lgkmcnt(4)
    v_mfma_f32_32x32x16_bf16 v[64:79], v[136:139], a[112:115], v[64:79]
    ds_read_b64_tr_b16 v[128:129], v51 offset:8192
    ds_read_b64_tr_b16 v[130:131], v51 offset:9216
    ds_read_b128 a[128:131], v41 offset:32768
    ds_read_b128 a[132:135], v41 offset:33792
    ds_read_b64_tr_b16 v[132:133], v51 offset:10240
    ds_read_b64_tr_b16 v[134:135], v51 offset:11264
    ds_read_b128 a[136:139], v41 offset:34816
    ds_read_b128 a[140:143], v41 offset:35840
    v_mfma_f32_32x32x16_bf16 v[80:95], v[136:139], a[116:119], v[80:95]
    v_add_f32 v179, 1.0, v179
    v_rcp_f32 v172, v172
    v_rcp_f32 v173, v173
    v_rcp_f32 v174, v174
    s_waitcnt lgkmcnt(8)
    v_mfma_f32_32x32x16_bf16 v[64:79], v[140:143], a[120:123], v[64:79]
    v_rcp_f32 v175, v175
    v_exp_f32 v184, v184
    v_exp_f32 v185, v185
    v_mfma_f32_32x32x16_bf16 v[80:95], v[140:143], a[124:127], v[80:95]
    v_exp_f32 v186, v186
    v_exp_f32 v187, v187
    v_add_f32 v180, 1.0, v180
    v_add_f32 v181, 1.0, v181
    v_add_f32 v182, 1.0, v182
    v_add_f32 v183, 1.0, v183
    v_rcp_f32 v176, v176
    v_rcp_f32 v177, v177
    v_rcp_f32 v178, v178
    v_rcp_f32 v179, v179
    v_exp_f32 v188, v188
    v_exp_f32 v189, v189
    v_exp_f32 v190, v190
    v_exp_f32 v191, v191
    v_add_f32 v184, 1.0, v184
    v_add_f32 v185, 1.0, v185
    v_add_f32 v186, 1.0, v186
    v_add_f32 v187, 1.0, v187
    v_rcp_f32 v180, v180
    v_rcp_f32 v181, v181
    v_rcp_f32 v182, v182
    v_rcp_f32 v183, v183
    v_exp_f32 v192, v192
    v_exp_f32 v193, v193
    v_exp_f32 v194, v194
    v_exp_f32 v195, v195
    v_add_f32 v188, 1.0, v188
    v_add_f32 v189, 1.0, v189
    v_add_f32 v190, 1.0, v190
    v_add_f32 v191, 1.0, v191
    v_rcp_f32 v184, v184
    v_rcp_f32 v185, v185
    v_rcp_f32 v186, v186
    v_rcp_f32 v187, v187
    v_exp_f32 v196, v196
    v_exp_f32 v197, v197
    v_exp_f32 v198, v198
    v_exp_f32 v199, v199
    v_add_f32 v192, 1.0, v192
    v_add_f32 v193, 1.0, v193
    v_add_f32 v194, 1.0, v194
    v_add_f32 v195, 1.0, v195
    v_rcp_f32 v188, v188
    v_rcp_f32 v189, v189
    v_rcp_f32 v190, v190
    v_rcp_f32 v191, v191
    v_add_f32 v196, 1.0, v196
    v_add_f32 v197, 1.0, v197
    v_add_f32 v198, 1.0, v198
    v_add_f32 v199, 1.0, v199
    v_rcp_f32 v192, v192
    v_rcp_f32 v193, v193
    v_rcp_f32 v194, v194
    v_rcp_f32 v195, v195
    v_rcp_f32 v196, v196
    v_rcp_f32 v197, v197
    v_rcp_f32 v198, v198
    v_rcp_f32 v199, v199
    v_mul_f32 v168, v168, v96
    v_mul_f32 v169, v169, v97
    v_mul_f32 v170, v170, v98
    v_mul_f32 v171, v171, v99
    v_mul_f32 v172, v172, v100
    v_mul_f32 v173, v173, v101
    v_mul_f32 v174, v174, v102
    v_mul_f32 v175, v175, v103
    v_cvt_pk_bf16_f32 v200, v168, v169
    v_cvt_pk_bf16_f32 v201, v170, v171
    v_cvt_pk_bf16_f32 v202, v172, v173
    v_cvt_pk_bf16_f32 v203, v174, v175
    ds_write_b128 v42, v[200:203] offset:40960
    v_mul_f32 v176, v176, v104
    v_mul_f32 v177, v177, v105
    v_mul_f32 v178, v178, v106
    v_mul_f32 v179, v179, v107
    v_mul_f32 v180, v180, v108
    v_mul_f32 v181, v181, v109
    v_mul_f32 v182, v182, v110
    v_mul_f32 v183, v183, v111
    v_cvt_pk_bf16_f32 v204, v176, v177
    v_cvt_pk_bf16_f32 v205, v178, v179
    v_cvt_pk_bf16_f32 v206, v180, v181
    v_cvt_pk_bf16_f32 v207, v182, v183
    ds_write_b128 v42, v[204:207] offset:43008
    v_mul_f32 v184, v184, v112
    v_mul_f32 v185, v185, v113
    v_mul_f32 v186, v186, v114
    v_mul_f32 v187, v187, v115
    v_mul_f32 v188, v188, v116
    v_mul_f32 v189, v189, v117
    v_mul_f32 v190, v190, v118
    v_mul_f32 v191, v191, v119
    v_cvt_pk_bf16_f32 v208, v184, v185
    v_cvt_pk_bf16_f32 v209, v186, v187
    v_cvt_pk_bf16_f32 v210, v188, v189
    v_cvt_pk_bf16_f32 v211, v190, v191
    ds_write_b128 v42, v[208:211] offset:41984
    v_mul_f32 v192, v192, v120
    v_mul_f32 v193, v193, v121
    v_mul_f32 v194, v194, v122
    v_mul_f32 v195, v195, v123
    v_mul_f32 v196, v196, v124
    v_mul_f32 v197, v197, v125
    v_mul_f32 v198, v198, v126
    v_mul_f32 v199, v199, v127
    v_cvt_pk_bf16_f32 v212, v192, v193
    v_cvt_pk_bf16_f32 v213, v194, v195
    v_cvt_pk_bf16_f32 v214, v196, v197
    v_cvt_pk_bf16_f32 v215, v198, v199
    ds_write_b128 v42, v[212:215] offset:44032
    s_waitcnt lgkmcnt(0)
    s_waitcnt vmcnt(6)
    s_barrier
    v_mfma_f32_32x32x16_bf16 v[64:79], v[128:131], a[128:131], v[64:79]
    ds_read_b64_tr_b16 v[136:137], v51 offset:12288
    ds_read_b64_tr_b16 v[138:139], v51 offset:13312
    ds_read_b128 a[144:147], v41 offset:36864
    ds_read_b128 a[148:151], v41 offset:37888
    v_mfma_f32_32x32x16_bf16 v[80:95], v[128:131], a[132:135], v[80:95]
    s_add_u32 m0, s47, 122880
    s_add_u32 s62, s42, 221312
    buffer_load_dwordx4 v35, s[12:15], s62 offen lds
    v_mfma_f32_32x32x16_bf16 v[64:79], v[132:135], a[136:139], v[64:79]
    ds_read_b64_tr_b16 v[140:141], v51 offset:14336
    ds_read_b64_tr_b16 v[142:143], v51 offset:15360
    ds_read_b128 a[152:155], v41 offset:38912
    ds_read_b128 a[156:159], v41 offset:39936
    v_mfma_f32_32x32x16_bf16 v[80:95], v[132:135], a[140:143], v[80:95]
    buffer_load_dwordx4 v36, s[12:15], s62 offen offset:1024 lds
    s_waitcnt lgkmcnt(4)
    v_mfma_f32_32x32x16_bf16 v[64:79], v[136:139], a[144:147], v[64:79]
    ds_read_b64_tr_b16 v[128:129], v51 offset:16384
    ds_read_b64_tr_b16 v[130:131], v51 offset:17408
    ds_read_b128 a[160:163], v41 offset:40960
    ds_read_b128 a[164:167], v41 offset:41984
    v_mfma_f32_32x32x16_bf16 v[80:95], v[136:139], a[148:151], v[80:95]
    buffer_load_dwordx4 v37, s[12:15], s62 offen offset:2048 lds
    s_waitcnt lgkmcnt(4)
    v_mfma_f32_32x32x16_bf16 v[64:79], v[140:143], a[152:155], v[64:79]
    ds_read_b64_tr_b16 v[132:133], v51 offset:18432
    ds_read_b64_tr_b16 v[134:135], v51 offset:19456
    ds_read_b128 a[168:171], v41 offset:43008
    ds_read_b128 a[172:175], v41 offset:44032
    v_mfma_f32_32x32x16_bf16 v[80:95], v[140:143], a[156:159], v[80:95]
    s_waitcnt lgkmcnt(4)
    v_mfma_f32_32x32x16_bf16 v[64:79], v[128:131], a[160:163], v[64:79]
    ds_read_b64_tr_b16 v[136:137], v51 offset:20480
    ds_read_b64_tr_b16 v[138:139], v51 offset:21504
    ds_read_b128 a[176:179], v41 offset:45056
    ds_read_b128 a[180:183], v41 offset:46080
    ds_read_b64_tr_b16 v[140:141], v51 offset:22528
    ds_read_b64_tr_b16 v[142:143], v51 offset:23552
    ds_read_b128 a[184:187], v41 offset:47104
    ds_read_b128 a[188:191], v41 offset:48128
    v_mfma_f32_32x32x16_bf16 v[80:95], v[128:131], a[164:167], v[80:95]
    s_waitcnt lgkmcnt(8)
    v_mfma_f32_32x32x16_bf16 v[64:79], v[132:135], a[168:171], v[64:79]
    v_mfma_f32_32x32x16_bf16 v[80:95], v[132:135], a[172:175], v[80:95]
    s_waitcnt lgkmcnt(0)
    s_waitcnt vmcnt(6)
    s_barrier
    v_mfma_f32_32x32x16_bf16 v[64:79], v[136:139], a[176:179], v[64:79]
    ds_read_b64_tr_b16 v[128:129], v50 offset:36864
    ds_read_b64_tr_b16 v[130:131], v50 offset:37888
    v_mfma_f32_32x32x16_bf16 v[80:95], v[136:139], a[180:183], v[80:95]
    s_add_u32 m0, s47, 135168
    s_add_u32 s62, s42, 331904
    buffer_load_dwordx4 v35, s[12:15], s62 offen lds
    v_mfma_f32_32x32x16_bf16 v[64:79], v[140:143], a[184:187], v[64:79]
    ds_read_b64_tr_b16 v[132:133], v50 offset:38912
    ds_read_b64_tr_b16 v[134:135], v50 offset:39936
    v_mfma_f32_32x32x16_bf16 v[80:95], v[140:143], a[188:191], v[80:95]
    buffer_load_dwordx4 v36, s[12:15], s62 offen offset:1024 lds
    s_waitcnt lgkmcnt(2)
    v_mfma_f32_32x32x16_bf16 v[96:111], v[128:131], a[0:3], 0
    ds_read_b64_tr_b16 v[136:137], v50 offset:40960
    ds_read_b64_tr_b16 v[138:139], v50 offset:41984
    v_mfma_f32_32x32x16_bf16 v[112:127], v[128:131], a[4:7], 0
    buffer_load_dwordx4 v37, s[12:15], s62 offen offset:2048 lds
    s_waitcnt lgkmcnt(2)
    v_mfma_f32_32x32x16_bf16 v[96:111], v[132:135], a[8:11], v[96:111]
    ds_read_b64_tr_b16 v[140:141], v50 offset:43008
    ds_read_b64_tr_b16 v[142:143], v50 offset:44032
    v_mfma_f32_32x32x16_bf16 v[112:127], v[132:135], a[12:15], v[112:127]
    s_waitcnt lgkmcnt(2)
    v_mfma_f32_32x32x16_bf16 v[96:111], v[136:139], a[16:19], v[96:111]
    ds_read_b64_tr_b16 v[128:129], v50 offset:45056
    ds_read_b64_tr_b16 v[130:131], v50 offset:46080
    ds_read_b64_tr_b16 v[132:133], v50 offset:47104
    ds_read_b64_tr_b16 v[134:135], v50 offset:48128
    v_cvt_pk_bf16_f32 v200, v64, v65
    v_cvt_pk_bf16_f32 v201, v66, v67
    v_mfma_f32_32x32x16_bf16 v[112:127], v[136:139], a[20:23], v[112:127]
    v_cvt_pk_bf16_f32 v202, v68, v69
    v_cvt_pk_bf16_f32 v203, v70, v71
    s_add_u32 s64, s49, 0
    s_waitcnt lgkmcnt(4)
    v_mfma_f32_32x32x16_bf16 v[96:111], v[140:143], a[24:27], v[96:111]
    v_mfma_f32_32x32x16_bf16 v[112:127], v[140:143], a[28:31], v[112:127]
    s_waitcnt lgkmcnt(0)
    s_waitcnt vmcnt(6)
    s_barrier
    v_mfma_f32_32x32x16_bf16 v[96:111], v[128:131], a[32:35], v[96:111]
    ds_read_b64_tr_b16 v[136:137], v50 offset:49152
    ds_read_b64_tr_b16 v[138:139], v50 offset:50176
    buffer_store_dwordx4 v[200:203], v46, s[16:19], s64 offen offset:0 sc1
    v_mfma_f32_32x32x16_bf16 v[112:127], v[128:131], a[36:39], v[112:127]
    s_add_u32 m0, s47, 98304
    s_add_u32 s62, s42, 256
    buffer_load_dwordx4 v35, s[12:15], s62 offen lds
    v_cvt_pk_bf16_f32 v204, v72, v73
    v_cvt_pk_bf16_f32 v205, v74, v75
    v_cvt_pk_bf16_f32 v206, v76, v77
    v_mfma_f32_32x32x16_bf16 v[96:111], v[132:135], a[40:43], v[96:111]
    ds_read_b64_tr_b16 v[140:141], v50 offset:51200
    ds_read_b64_tr_b16 v[142:143], v50 offset:52224
    v_cvt_pk_bf16_f32 v207, v78, v79
    v_mfma_f32_32x32x16_bf16 v[112:127], v[132:135], a[44:47], v[112:127]
    buffer_load_dwordx4 v36, s[12:15], s62 offen offset:1024 lds
    buffer_store_dwordx4 v[204:207], v46, s[16:19], s64 offen offset:1024 sc1
    s_waitcnt lgkmcnt(2)
    v_mfma_f32_32x32x16_bf16 v[96:111], v[136:139], a[48:51], v[96:111]
    ds_read_b64_tr_b16 v[128:129], v50 offset:53248
    ds_read_b64_tr_b16 v[130:131], v50 offset:54272
    v_cvt_pk_bf16_f32 v200, v80, v81
    v_cvt_pk_bf16_f32 v201, v82, v83
    v_mfma_f32_32x32x16_bf16 v[112:127], v[136:139], a[52:55], v[112:127]
    buffer_load_dwordx4 v37, s[12:15], s62 offen offset:2048 lds
    v_cvt_pk_bf16_f32 v202, v84, v85
    v_cvt_pk_bf16_f32 v203, v86, v87
    s_waitcnt lgkmcnt(2)
    v_mfma_f32_32x32x16_bf16 v[96:111], v[140:143], a[56:59], v[96:111]
    ds_read_b64_tr_b16 v[132:133], v50 offset:55296
    ds_read_b64_tr_b16 v[134:135], v50 offset:56320
    v_mfma_f32_32x32x16_bf16 v[112:127], v[140:143], a[60:63], v[112:127]
    buffer_store_dwordx4 v[200:203], v46, s[16:19], s64 offen offset:2048 sc1
    s_waitcnt lgkmcnt(2)
    v_mfma_f32_32x32x16_bf16 v[96:111], v[128:131], a[64:67], v[96:111]
    ds_read_b64_tr_b16 v[136:137], v50 offset:57344
    ds_read_b64_tr_b16 v[138:139], v50 offset:58368
    ds_read_b64_tr_b16 v[140:141], v50 offset:59392
    ds_read_b64_tr_b16 v[142:143], v50 offset:60416
    v_cvt_pk_bf16_f32 v204, v88, v89
    v_cvt_pk_bf16_f32 v205, v90, v91
    v_mfma_f32_32x32x16_bf16 v[112:127], v[128:131], a[68:71], v[112:127]
    v_cvt_pk_bf16_f32 v206, v92, v93
    v_cvt_pk_bf16_f32 v207, v94, v95
    s_waitcnt lgkmcnt(4)
    v_mfma_f32_32x32x16_bf16 v[96:111], v[132:135], a[72:75], v[96:111]
    v_mfma_f32_32x32x16_bf16 v[112:127], v[132:135], a[76:79], v[112:127]
    s_waitcnt lgkmcnt(0)
    s_waitcnt vmcnt(9)
    s_barrier
    v_mfma_f32_32x32x16_bf16 v[96:111], v[136:139], a[80:83], v[96:111]
    ds_read_b64_tr_b16 v[128:129], v51 offset:0
    ds_read_b64_tr_b16 v[130:131], v51 offset:1024
    buffer_store_dwordx4 v[204:207], v46, s[16:19], s64 offen offset:3072 sc1
    v_mfma_f32_32x32x16_bf16 v[112:127], v[136:139], a[84:87], v[112:127]
    s_add_u32 m0, s47, 110592
    s_add_u32 s62, s42, 110848
    buffer_load_dwordx4 v35, s[12:15], s62 offen lds
    v_mfma_f32_32x32x16_bf16 v[96:111], v[140:143], a[88:91], v[96:111]
    ds_read_b64_tr_b16 v[132:133], v51 offset:2048
    ds_read_b64_tr_b16 v[134:135], v51 offset:3072
    v_mfma_f32_32x32x16_bf16 v[112:127], v[140:143], a[92:95], v[112:127]
    buffer_load_dwordx4 v36, s[12:15], s62 offen offset:1024 lds
    s_waitcnt lgkmcnt(2)
    v_mfma_f32_32x32x16_bf16 v[96:111], v[128:131], a[96:99], v[96:111]
    ds_read_b64_tr_b16 v[136:137], v51 offset:4096
    ds_read_b64_tr_b16 v[138:139], v51 offset:5120
    v_mfma_f32_32x32x16_bf16 v[112:127], v[128:131], a[100:103], v[112:127]
    buffer_load_dwordx4 v37, s[12:15], s62 offen offset:2048 lds
    s_waitcnt lgkmcnt(2)
    v_mfma_f32_32x32x16_bf16 v[96:111], v[132:135], a[104:107], v[96:111]
    ds_read_b64_tr_b16 v[140:141], v51 offset:6144
    ds_read_b64_tr_b16 v[142:143], v51 offset:7168
    v_mfma_f32_32x32x16_bf16 v[112:127], v[132:135], a[108:111], v[112:127]
    s_waitcnt lgkmcnt(2)
    v_mfma_f32_32x32x16_bf16 v[96:111], v[136:139], a[112:115], v[96:111]
    ds_read_b64_tr_b16 v[128:129], v51 offset:8192
    ds_read_b64_tr_b16 v[130:131], v51 offset:9216
    ds_read_b64_tr_b16 v[132:133], v51 offset:10240
    ds_read_b64_tr_b16 v[134:135], v51 offset:11264
    v_mfma_f32_32x32x16_bf16 v[112:127], v[136:139], a[116:119], v[112:127]
    s_waitcnt lgkmcnt(4)
    v_mfma_f32_32x32x16_bf16 v[96:111], v[140:143], a[120:123], v[96:111]
    v_mfma_f32_32x32x16_bf16 v[112:127], v[140:143], a[124:127], v[112:127]
    s_waitcnt lgkmcnt(0)
    s_waitcnt vmcnt(10)
    s_barrier
    v_mfma_f32_32x32x16_bf16 v[96:111], v[128:131], a[128:131], v[96:111]
    ds_read_b64_tr_b16 v[136:137], v51 offset:12288
    ds_read_b64_tr_b16 v[138:139], v51 offset:13312
    v_mfma_f32_32x32x16_bf16 v[112:127], v[128:131], a[132:135], v[112:127]
    s_add_u32 m0, s47, 122880
    s_add_u32 s62, s42, 221440
    buffer_load_dwordx4 v35, s[12:15], s62 offen lds
    v_mfma_f32_32x32x16_bf16 v[96:111], v[132:135], a[136:139], v[96:111]
    ds_read_b64_tr_b16 v[140:141], v51 offset:14336
    ds_read_b64_tr_b16 v[142:143], v51 offset:15360
    v_mfma_f32_32x32x16_bf16 v[112:127], v[132:135], a[140:143], v[112:127]
    buffer_load_dwordx4 v36, s[12:15], s62 offen offset:1024 lds
    s_waitcnt lgkmcnt(2)
    v_mfma_f32_32x32x16_bf16 v[96:111], v[136:139], a[144:147], v[96:111]
    ds_read_b64_tr_b16 v[128:129], v51 offset:16384
    ds_read_b64_tr_b16 v[130:131], v51 offset:17408
    v_mfma_f32_32x32x16_bf16 v[112:127], v[136:139], a[148:151], v[112:127]
    buffer_load_dwordx4 v37, s[12:15], s62 offen offset:2048 lds
    s_waitcnt lgkmcnt(2)
    v_mfma_f32_32x32x16_bf16 v[96:111], v[140:143], a[152:155], v[96:111]
    ds_read_b64_tr_b16 v[132:133], v51 offset:18432
    ds_read_b64_tr_b16 v[134:135], v51 offset:19456
    v_mfma_f32_32x32x16_bf16 v[112:127], v[140:143], a[156:159], v[112:127]
    s_waitcnt lgkmcnt(2)
    v_mfma_f32_32x32x16_bf16 v[96:111], v[128:131], a[160:163], v[96:111]
    ds_read_b64_tr_b16 v[136:137], v51 offset:20480
    ds_read_b64_tr_b16 v[138:139], v51 offset:21504
    ds_read_b64_tr_b16 v[140:141], v51 offset:22528
    ds_read_b64_tr_b16 v[142:143], v51 offset:23552
    v_mfma_f32_32x32x16_bf16 v[112:127], v[128:131], a[164:167], v[112:127]
    s_waitcnt lgkmcnt(4)
    v_mfma_f32_32x32x16_bf16 v[96:111], v[132:135], a[168:171], v[96:111]
    v_mfma_f32_32x32x16_bf16 v[112:127], v[132:135], a[172:175], v[112:127]
    s_waitcnt lgkmcnt(0)
    s_waitcnt vmcnt(8)
    s_barrier
    v_mfma_f32_32x32x16_bf16 v[96:111], v[136:139], a[176:179], v[96:111]
    ds_read_b64_tr_b16 v[128:129], v50 offset:36864
    ds_read_b64_tr_b16 v[130:131], v50 offset:37888
    v_mfma_f32_32x32x16_bf16 v[112:127], v[136:139], a[180:183], v[112:127]
    s_add_u32 m0, s47, 135168
    s_add_u32 s62, s42, 332032
    buffer_load_dwordx4 v35, s[12:15], s62 offen lds
    v_mfma_f32_32x32x16_bf16 v[96:111], v[140:143], a[184:187], v[96:111]
    ds_read_b64_tr_b16 v[132:133], v50 offset:38912
    ds_read_b64_tr_b16 v[134:135], v50 offset:39936
    v_mfma_f32_32x32x16_bf16 v[112:127], v[140:143], a[188:191], v[112:127]
    buffer_load_dwordx4 v36, s[12:15], s62 offen offset:1024 lds
    s_waitcnt lgkmcnt(2)
    v_mfma_f32_32x32x16_bf16 v[64:79], v[128:131], a[0:3], 0
    ds_read_b64_tr_b16 v[136:137], v50 offset:40960
    ds_read_b64_tr_b16 v[138:139], v50 offset:41984
    v_mfma_f32_32x32x16_bf16 v[80:95], v[128:131], a[4:7], 0
    buffer_load_dwordx4 v37, s[12:15], s62 offen offset:2048 lds
    s_waitcnt lgkmcnt(2)
    v_mfma_f32_32x32x16_bf16 v[64:79], v[132:135], a[8:11], v[64:79]
    ds_read_b64_tr_b16 v[140:141], v50 offset:43008
    ds_read_b64_tr_b16 v[142:143], v50 offset:44032
    v_mfma_f32_32x32x16_bf16 v[80:95], v[132:135], a[12:15], v[80:95]
    s_waitcnt lgkmcnt(2)
    v_mfma_f32_32x32x16_bf16 v[64:79], v[136:139], a[16:19], v[64:79]
    ds_read_b64_tr_b16 v[128:129], v50 offset:45056
    ds_read_b64_tr_b16 v[130:131], v50 offset:46080
    ds_read_b64_tr_b16 v[132:133], v50 offset:47104
    ds_read_b64_tr_b16 v[134:135], v50 offset:48128
    v_cvt_pk_bf16_f32 v200, v96, v97
    v_cvt_pk_bf16_f32 v201, v98, v99
    v_mfma_f32_32x32x16_bf16 v[80:95], v[136:139], a[20:23], v[80:95]
    v_cvt_pk_bf16_f32 v202, v100, v101
    v_cvt_pk_bf16_f32 v203, v102, v103
    s_add_u32 s64, s49, 196608
    s_waitcnt lgkmcnt(4)
    v_mfma_f32_32x32x16_bf16 v[64:79], v[140:143], a[24:27], v[64:79]
    v_mfma_f32_32x32x16_bf16 v[80:95], v[140:143], a[28:31], v[80:95]
    s_waitcnt lgkmcnt(0)
    s_waitcnt vmcnt(6)
    s_barrier
    v_mfma_f32_32x32x16_bf16 v[64:79], v[128:131], a[32:35], v[64:79]
    ds_read_b64_tr_b16 v[136:137], v50 offset:49152
    ds_read_b64_tr_b16 v[138:139], v50 offset:50176
    buffer_store_dwordx4 v[200:203], v46, s[16:19], s64 offen offset:0 sc1
    v_mfma_f32_32x32x16_bf16 v[80:95], v[128:131], a[36:39], v[80:95]
    s_add_u32 m0, s47, 98304
    s_add_u32 s62, s42, 384
    buffer_load_dwordx4 v35, s[12:15], s62 offen lds
    v_cvt_pk_bf16_f32 v204, v104, v105
    v_cvt_pk_bf16_f32 v205, v106, v107
    v_cvt_pk_bf16_f32 v206, v108, v109
    v_mfma_f32_32x32x16_bf16 v[64:79], v[132:135], a[40:43], v[64:79]
    ds_read_b64_tr_b16 v[140:141], v50 offset:51200
    ds_read_b64_tr_b16 v[142:143], v50 offset:52224
    v_cvt_pk_bf16_f32 v207, v110, v111
    v_mfma_f32_32x32x16_bf16 v[80:95], v[132:135], a[44:47], v[80:95]
    buffer_load_dwordx4 v36, s[12:15], s62 offen offset:1024 lds
    buffer_store_dwordx4 v[204:207], v46, s[16:19], s64 offen offset:1024 sc1
    s_waitcnt lgkmcnt(2)
    v_mfma_f32_32x32x16_bf16 v[64:79], v[136:139], a[48:51], v[64:79]
    ds_read_b64_tr_b16 v[128:129], v50 offset:53248
    ds_read_b64_tr_b16 v[130:131], v50 offset:54272
    v_cvt_pk_bf16_f32 v200, v112, v113
    v_cvt_pk_bf16_f32 v201, v114, v115
    v_mfma_f32_32x32x16_bf16 v[80:95], v[136:139], a[52:55], v[80:95]
    buffer_load_dwordx4 v37, s[12:15], s62 offen offset:2048 lds
    v_cvt_pk_bf16_f32 v202, v116, v117
    v_cvt_pk_bf16_f32 v203, v118, v119
    s_waitcnt lgkmcnt(2)
    v_mfma_f32_32x32x16_bf16 v[64:79], v[140:143], a[56:59], v[64:79]
    ds_read_b64_tr_b16 v[132:133], v50 offset:55296
    ds_read_b64_tr_b16 v[134:135], v50 offset:56320
    v_mfma_f32_32x32x16_bf16 v[80:95], v[140:143], a[60:63], v[80:95]
    buffer_store_dwordx4 v[200:203], v46, s[16:19], s64 offen offset:2048 sc1
    s_waitcnt lgkmcnt(2)
    v_mfma_f32_32x32x16_bf16 v[64:79], v[128:131], a[64:67], v[64:79]
    ds_read_b64_tr_b16 v[136:137], v50 offset:57344
    ds_read_b64_tr_b16 v[138:139], v50 offset:58368
    ds_read_b64_tr_b16 v[140:141], v50 offset:59392
    ds_read_b64_tr_b16 v[142:143], v50 offset:60416
    v_cvt_pk_bf16_f32 v204, v120, v121
    v_cvt_pk_bf16_f32 v205, v122, v123
    v_mfma_f32_32x32x16_bf16 v[80:95], v[128:131], a[68:71], v[80:95]
    v_cvt_pk_bf16_f32 v206, v124, v125
    v_cvt_pk_bf16_f32 v207, v126, v127
    s_waitcnt lgkmcnt(4)
    v_mfma_f32_32x32x16_bf16 v[64:79], v[132:135], a[72:75], v[64:79]
    v_mfma_f32_32x32x16_bf16 v[80:95], v[132:135], a[76:79], v[80:95]
    s_waitcnt lgkmcnt(0)
    s_waitcnt vmcnt(9)
    s_barrier
    s_add_u32 s4, s90, 1
    v_mov_b32 v48, s4
    buffer_store_dword v48, v47, s[16:19], 0 offen sc1
    v_mfma_f32_32x32x16_bf16 v[64:79], v[136:139], a[80:83], v[64:79]
    ds_read_b64_tr_b16 v[128:129], v51 offset:0
    ds_read_b64_tr_b16 v[130:131], v51 offset:1024
    buffer_store_dwordx4 v[204:207], v46, s[16:19], s64 offen offset:3072 sc1
    v_mfma_f32_32x32x16_bf16 v[80:95], v[136:139], a[84:87], v[80:95]
    s_add_u32 m0, s47, 110592
    s_add_u32 s62, s42, 110976
    buffer_load_dwordx4 v35, s[12:15], s62 offen lds
    v_mfma_f32_32x32x16_bf16 v[64:79], v[140:143], a[88:91], v[64:79]
    ds_read_b64_tr_b16 v[132:133], v51 offset:2048
    ds_read_b64_tr_b16 v[134:135], v51 offset:3072
    v_mfma_f32_32x32x16_bf16 v[80:95], v[140:143], a[92:95], v[80:95]
    buffer_load_dwordx4 v36, s[12:15], s62 offen offset:1024 lds
    s_waitcnt lgkmcnt(2)
    v_mfma_f32_32x32x16_bf16 v[64:79], v[128:131], a[96:99], v[64:79]
    ds_read_b64_tr_b16 v[136:137], v51 offset:4096
    ds_read_b64_tr_b16 v[138:139], v51 offset:5120
    v_mfma_f32_32x32x16_bf16 v[80:95], v[128:131], a[100:103], v[80:95]
    buffer_load_dwordx4 v37, s[12:15], s62 offen offset:2048 lds
    s_waitcnt lgkmcnt(2)
    v_mfma_f32_32x32x16_bf16 v[64:79], v[132:135], a[104:107], v[64:79]
    ds_read_b64_tr_b16 v[140:141], v51 offset:6144
    ds_read_b64_tr_b16 v[142:143], v51 offset:7168
    v_mfma_f32_32x32x16_bf16 v[80:95], v[132:135], a[108:111], v[80:95]
    s_waitcnt lgkmcnt(2)
    v_mfma_f32_32x32x16_bf16 v[64:79], v[136:139], a[112:115], v[64:79]
    ds_read_b64_tr_b16 v[128:129], v51 offset:8192
    ds_read_b64_tr_b16 v[130:131], v51 offset:9216
    ds_read_b64_tr_b16 v[132:133], v51 offset:10240
    ds_read_b64_tr_b16 v[134:135], v51 offset:11264
    v_mfma_f32_32x32x16_bf16 v[80:95], v[136:139], a[116:119], v[80:95]
    s_waitcnt lgkmcnt(4)
    v_mfma_f32_32x32x16_bf16 v[64:79], v[140:143], a[120:123], v[64:79]
    v_mfma_f32_32x32x16_bf16 v[80:95], v[140:143], a[124:127], v[80:95]
    s_waitcnt lgkmcnt(0)
    s_waitcnt vmcnt(11)
    s_barrier
    v_mfma_f32_32x32x16_bf16 v[64:79], v[128:131], a[128:131], v[64:79]
    ds_read_b64_tr_b16 v[136:137], v51 offset:12288
    ds_read_b64_tr_b16 v[138:139], v51 offset:13312
    v_mfma_f32_32x32x16_bf16 v[80:95], v[128:131], a[132:135], v[80:95]
    s_add_u32 m0, s47, 122880
    s_add_u32 s62, s42, 221568
    buffer_load_dwordx4 v35, s[12:15], s62 offen lds
    v_mfma_f32_32x32x16_bf16 v[64:79], v[132:135], a[136:139], v[64:79]
    ds_read_b64_tr_b16 v[140:141], v51 offset:14336
    ds_read_b64_tr_b16 v[142:143], v51 offset:15360
    v_mfma_f32_32x32x16_bf16 v[80:95], v[132:135], a[140:143], v[80:95]
    buffer_load_dwordx4 v36, s[12:15], s62 offen offset:1024 lds
    s_waitcnt lgkmcnt(2)
    v_mfma_f32_32x32x16_bf16 v[64:79], v[136:139], a[144:147], v[64:79]
    ds_read_b64_tr_b16 v[128:129], v51 offset:16384
    ds_read_b64_tr_b16 v[130:131], v51 offset:17408
    v_mfma_f32_32x32x16_bf16 v[80:95], v[136:139], a[148:151], v[80:95]
    buffer_load_dwordx4 v37, s[12:15], s62 offen offset:2048 lds
    s_waitcnt lgkmcnt(2)
    v_mfma_f32_32x32x16_bf16 v[64:79], v[140:143], a[152:155], v[64:79]
    ds_read_b64_tr_b16 v[132:133], v51 offset:18432
    ds_read_b64_tr_b16 v[134:135], v51 offset:19456
    v_mfma_f32_32x32x16_bf16 v[80:95], v[140:143], a[156:159], v[80:95]
    s_waitcnt lgkmcnt(2)
    v_mfma_f32_32x32x16_bf16 v[64:79], v[128:131], a[160:163], v[64:79]
    ds_read_b64_tr_b16 v[136:137], v51 offset:20480
    ds_read_b64_tr_b16 v[138:139], v51 offset:21504
    ds_read_b64_tr_b16 v[140:141], v51 offset:22528
    ds_read_b64_tr_b16 v[142:143], v51 offset:23552
    v_mfma_f32_32x32x16_bf16 v[80:95], v[128:131], a[164:167], v[80:95]
    s_waitcnt lgkmcnt(4)
    v_mfma_f32_32x32x16_bf16 v[64:79], v[132:135], a[168:171], v[64:79]
    v_mfma_f32_32x32x16_bf16 v[80:95], v[132:135], a[172:175], v[80:95]
    s_waitcnt lgkmcnt(0)
    s_waitcnt vmcnt(9)
    s_barrier
    v_mfma_f32_32x32x16_bf16 v[64:79], v[136:139], a[176:179], v[64:79]
    ds_read_b64_tr_b16 v[128:129], v50 offset:36864
    ds_read_b64_tr_b16 v[130:131], v50 offset:37888
    v_mfma_f32_32x32x16_bf16 v[80:95], v[136:139], a[180:183], v[80:95]
    s_add_u32 m0, s47, 135168
    s_add_u32 s62, s42, 332160
    buffer_load_dwordx4 v35, s[12:15], s62 offen lds
    v_mfma_f32_32x32x16_bf16 v[64:79], v[140:143], a[184:187], v[64:79]
    ds_read_b64_tr_b16 v[132:133], v50 offset:38912
    ds_read_b64_tr_b16 v[134:135], v50 offset:39936
    v_mfma_f32_32x32x16_bf16 v[80:95], v[140:143], a[188:191], v[80:95]
    buffer_load_dwordx4 v36, s[12:15], s62 offen offset:1024 lds
    s_waitcnt lgkmcnt(2)
    v_mfma_f32_32x32x16_bf16 v[96:111], v[128:131], a[0:3], 0
    ds_read_b64_tr_b16 v[136:137], v50 offset:40960
    ds_read_b64_tr_b16 v[138:139], v50 offset:41984
    v_mfma_f32_32x32x16_bf16 v[112:127], v[128:131], a[4:7], 0
    buffer_load_dwordx4 v37, s[12:15], s62 offen offset:2048 lds
    s_waitcnt lgkmcnt(2)
    v_mfma_f32_32x32x16_bf16 v[96:111], v[132:135], a[8:11], v[96:111]
    ds_read_b64_tr_b16 v[140:141], v50 offset:43008
    ds_read_b64_tr_b16 v[142:143], v50 offset:44032
    v_mfma_f32_32x32x16_bf16 v[112:127], v[132:135], a[12:15], v[112:127]
    s_waitcnt lgkmcnt(2)
    v_mfma_f32_32x32x16_bf16 v[96:111], v[136:139], a[16:19], v[96:111]
    ds_read_b64_tr_b16 v[128:129], v50 offset:45056
    ds_read_b64_tr_b16 v[130:131], v50 offset:46080
    ds_read_b64_tr_b16 v[132:133], v50 offset:47104
    ds_read_b64_tr_b16 v[134:135], v50 offset:48128
    v_cvt_pk_bf16_f32 v200, v64, v65
    v_cvt_pk_bf16_f32 v201, v66, v67
    v_mfma_f32_32x32x16_bf16 v[112:127], v[136:139], a[20:23], v[112:127]
    v_cvt_pk_bf16_f32 v202, v68, v69
    v_cvt_pk_bf16_f32 v203, v70, v71
    s_add_u32 s64, s49, 393216
    s_waitcnt lgkmcnt(4)
    v_mfma_f32_32x32x16_bf16 v[96:111], v[140:143], a[24:27], v[96:111]
    v_mfma_f32_32x32x16_bf16 v[112:127], v[140:143], a[28:31], v[112:127]
    s_waitcnt lgkmcnt(0)
    s_waitcnt vmcnt(6)
    s_barrier
    v_mfma_f32_32x32x16_bf16 v[96:111], v[128:131], a[32:35], v[96:111]
    ds_read_b64_tr_b16 v[136:137], v50 offset:49152
    ds_read_b64_tr_b16 v[138:139], v50 offset:50176
    buffer_store_dwordx4 v[200:203], v46, s[16:19], s64 offen offset:0 sc1
    v_mfma_f32_32x32x16_bf16 v[112:127], v[128:131], a[36:39], v[112:127]
    s_add_u32 m0, s47, 98304
    s_add_u32 s62, s42, 512
    buffer_load_dwordx4 v35, s[12:15], s62 offen lds
    v_cvt_pk_bf16_f32 v204, v72, v73
    v_cvt_pk_bf16_f32 v205, v74, v75
    v_cvt_pk_bf16_f32 v206, v76, v77
    v_mfma_f32_32x32x16_bf16 v[96:111], v[132:135], a[40:43], v[96:111]
    ds_read_b64_tr_b16 v[140:141], v50 offset:51200
    ds_read_b64_tr_b16 v[142:143], v50 offset:52224
    v_cvt_pk_bf16_f32 v207, v78, v79
    v_mfma_f32_32x32x16_bf16 v[112:127], v[132:135], a[44:47], v[112:127]
    buffer_load_dwordx4 v36, s[12:15], s62 offen offset:1024 lds
    buffer_store_dwordx4 v[204:207], v46, s[16:19], s64 offen offset:1024 sc1
    s_waitcnt lgkmcnt(2)
    v_mfma_f32_32x32x16_bf16 v[96:111], v[136:139], a[48:51], v[96:111]
    ds_read_b64_tr_b16 v[128:129], v50 offset:53248
    ds_read_b64_tr_b16 v[130:131], v50 offset:54272
    v_cvt_pk_bf16_f32 v200, v80, v81
    v_cvt_pk_bf16_f32 v201, v82, v83
    v_mfma_f32_32x32x16_bf16 v[112:127], v[136:139], a[52:55], v[112:127]
    buffer_load_dwordx4 v37, s[12:15], s62 offen offset:2048 lds
    v_cvt_pk_bf16_f32 v202, v84, v85
    v_cvt_pk_bf16_f32 v203, v86, v87
    s_waitcnt lgkmcnt(2)
    v_mfma_f32_32x32x16_bf16 v[96:111], v[140:143], a[56:59], v[96:111]
    ds_read_b64_tr_b16 v[132:133], v50 offset:55296
    ds_read_b64_tr_b16 v[134:135], v50 offset:56320
    v_mfma_f32_32x32x16_bf16 v[112:127], v[140:143], a[60:63], v[112:127]
    buffer_store_dwordx4 v[200:203], v46, s[16:19], s64 offen offset:2048 sc1
    s_waitcnt lgkmcnt(2)
    v_mfma_f32_32x32x16_bf16 v[96:111], v[128:131], a[64:67], v[96:111]
    ds_read_b64_tr_b16 v[136:137], v50 offset:57344
    ds_read_b64_tr_b16 v[138:139], v50 offset:58368
    ds_read_b64_tr_b16 v[140:141], v50 offset:59392
    ds_read_b64_tr_b16 v[142:143], v50 offset:60416
    v_cvt_pk_bf16_f32 v204, v88, v89
    v_cvt_pk_bf16_f32 v205, v90, v91
    v_mfma_f32_32x32x16_bf16 v[112:127], v[128:131], a[68:71], v[112:127]
    v_cvt_pk_bf16_f32 v206, v92, v93
    v_cvt_pk_bf16_f32 v207, v94, v95
    s_waitcnt lgkmcnt(4)
    v_mfma_f32_32x32x16_bf16 v[96:111], v[132:135], a[72:75], v[96:111]
    v_mfma_f32_32x32x16_bf16 v[112:127], v[132:135], a[76:79], v[112:127]
    s_waitcnt lgkmcnt(0)
    s_waitcnt vmcnt(9)
    s_barrier
    s_add_u32 s4, s90, 2
    v_mov_b32 v48, s4
    buffer_store_dword v48, v47, s[16:19], 0 offen sc1
    v_mfma_f32_32x32x16_bf16 v[96:111], v[136:139], a[80:83], v[96:111]
    ds_read_b64_tr_b16 v[128:129], v51 offset:0
    ds_read_b64_tr_b16 v[130:131], v51 offset:1024
    buffer_store_dwordx4 v[204:207], v46, s[16:19], s64 offen offset:3072 sc1
    v_mfma_f32_32x32x16_bf16 v[112:127], v[136:139], a[84:87], v[112:127]
    s_add_u32 m0, s47, 110592
    s_add_u32 s62, s42, 111104
    buffer_load_dwordx4 v35, s[12:15], s62 offen lds
    v_mfma_f32_32x32x16_bf16 v[96:111], v[140:143], a[88:91], v[96:111]
    ds_read_b64_tr_b16 v[132:133], v51 offset:2048
    ds_read_b64_tr_b16 v[134:135], v51 offset:3072
    v_mfma_f32_32x32x16_bf16 v[112:127], v[140:143], a[92:95], v[112:127]
    buffer_load_dwordx4 v36, s[12:15], s62 offen offset:1024 lds
    s_waitcnt lgkmcnt(2)
    v_mfma_f32_32x32x16_bf16 v[96:111], v[128:131], a[96:99], v[96:111]
    ds_read_b64_tr_b16 v[136:137], v51 offset:4096
    ds_read_b64_tr_b16 v[138:139], v51 offset:5120
    v_mfma_f32_32x32x16_bf16 v[112:127], v[128:131], a[100:103], v[112:127]
    buffer_load_dwordx4 v37, s[12:15], s62 offen offset:2048 lds
    s_waitcnt lgkmcnt(2)
    v_mfma_f32_32x32x16_bf16 v[96:111], v[132:135], a[104:107], v[96:111]
    ds_read_b64_tr_b16 v[140:141], v51 offset:6144
    ds_read_b64_tr_b16 v[142:143], v51 offset:7168
    v_mfma_f32_32x32x16_bf16 v[112:127], v[132:135], a[108:111], v[112:127]
    s_waitcnt lgkmcnt(2)
    v_mfma_f32_32x32x16_bf16 v[96:111], v[136:139], a[112:115], v[96:111]
    ds_read_b64_tr_b16 v[128:129], v51 offset:8192
    ds_read_b64_tr_b16 v[130:131], v51 offset:9216
    ds_read_b64_tr_b16 v[132:133], v51 offset:10240
    ds_read_b64_tr_b16 v[134:135], v51 offset:11264
    v_mfma_f32_32x32x16_bf16 v[112:127], v[136:139], a[116:119], v[112:127]
    s_waitcnt lgkmcnt(4)
    v_mfma_f32_32x32x16_bf16 v[96:111], v[140:143], a[120:123], v[96:111]
    v_mfma_f32_32x32x16_bf16 v[112:127], v[140:143], a[124:127], v[112:127]
    s_waitcnt lgkmcnt(0)
    s_waitcnt vmcnt(11)
    s_barrier
    v_mfma_f32_32x32x16_bf16 v[96:111], v[128:131], a[128:131], v[96:111]
    ds_read_b64_tr_b16 v[136:137], v51 offset:12288
    ds_read_b64_tr_b16 v[138:139], v51 offset:13312
    v_mfma_f32_32x32x16_bf16 v[112:127], v[128:131], a[132:135], v[112:127]
    s_add_u32 m0, s47, 122880
    s_add_u32 s62, s42, 221696
    buffer_load_dwordx4 v35, s[12:15], s62 offen lds
    v_mfma_f32_32x32x16_bf16 v[96:111], v[132:135], a[136:139], v[96:111]
    ds_read_b64_tr_b16 v[140:141], v51 offset:14336
    ds_read_b64_tr_b16 v[142:143], v51 offset:15360
    v_mfma_f32_32x32x16_bf16 v[112:127], v[132:135], a[140:143], v[112:127]
    buffer_load_dwordx4 v36, s[12:15], s62 offen offset:1024 lds
    s_waitcnt lgkmcnt(2)
    v_mfma_f32_32x32x16_bf16 v[96:111], v[136:139], a[144:147], v[96:111]
    ds_read_b64_tr_b16 v[128:129], v51 offset:16384
    ds_read_b64_tr_b16 v[130:131], v51 offset:17408
    v_mfma_f32_32x32x16_bf16 v[112:127], v[136:139], a[148:151], v[112:127]
    buffer_load_dwordx4 v37, s[12:15], s62 offen offset:2048 lds
    s_waitcnt lgkmcnt(2)
    v_mfma_f32_32x32x16_bf16 v[96:111], v[140:143], a[152:155], v[96:111]
    ds_read_b64_tr_b16 v[132:133], v51 offset:18432
    ds_read_b64_tr_b16 v[134:135], v51 offset:19456
    v_mfma_f32_32x32x16_bf16 v[112:127], v[140:143], a[156:159], v[112:127]
    s_waitcnt lgkmcnt(2)
    v_mfma_f32_32x32x16_bf16 v[96:111], v[128:131], a[160:163], v[96:111]
    ds_read_b64_tr_b16 v[136:137], v51 offset:20480
    ds_read_b64_tr_b16 v[138:139], v51 offset:21504
    ds_read_b64_tr_b16 v[140:141], v51 offset:22528
    ds_read_b64_tr_b16 v[142:143], v51 offset:23552
    v_mfma_f32_32x32x16_bf16 v[112:127], v[128:131], a[164:167], v[112:127]
    s_waitcnt lgkmcnt(4)
    v_mfma_f32_32x32x16_bf16 v[96:111], v[132:135], a[168:171], v[96:111]
    v_mfma_f32_32x32x16_bf16 v[112:127], v[132:135], a[172:175], v[112:127]
    s_waitcnt lgkmcnt(0)
    s_waitcnt vmcnt(9)
    s_barrier
    v_mfma_f32_32x32x16_bf16 v[96:111], v[136:139], a[176:179], v[96:111]
    ds_read_b64_tr_b16 v[128:129], v50 offset:36864
    ds_read_b64_tr_b16 v[130:131], v50 offset:37888
    v_mfma_f32_32x32x16_bf16 v[112:127], v[136:139], a[180:183], v[112:127]
    s_add_u32 m0, s47, 135168
    s_add_u32 s62, s42, 332288
    buffer_load_dwordx4 v35, s[12:15], s62 offen lds
    v_mfma_f32_32x32x16_bf16 v[96:111], v[140:143], a[184:187], v[96:111]
    ds_read_b64_tr_b16 v[132:133], v50 offset:38912
    ds_read_b64_tr_b16 v[134:135], v50 offset:39936
    v_mfma_f32_32x32x16_bf16 v[112:127], v[140:143], a[188:191], v[112:127]
    buffer_load_dwordx4 v36, s[12:15], s62 offen offset:1024 lds
    s_waitcnt lgkmcnt(2)
    v_mfma_f32_32x32x16_bf16 v[64:79], v[128:131], a[0:3], 0
    ds_read_b64_tr_b16 v[136:137], v50 offset:40960
    ds_read_b64_tr_b16 v[138:139], v50 offset:41984
    v_mfma_f32_32x32x16_bf16 v[80:95], v[128:131], a[4:7], 0
    buffer_load_dwordx4 v37, s[12:15], s62 offen offset:2048 lds
    s_waitcnt lgkmcnt(2)
    v_mfma_f32_32x32x16_bf16 v[64:79], v[132:135], a[8:11], v[64:79]
    ds_read_b64_tr_b16 v[140:141], v50 offset:43008
    ds_read_b64_tr_b16 v[142:143], v50 offset:44032
    v_mfma_f32_32x32x16_bf16 v[80:95], v[132:135], a[12:15], v[80:95]
    s_waitcnt lgkmcnt(2)
    v_mfma_f32_32x32x16_bf16 v[64:79], v[136:139], a[16:19], v[64:79]
    ds_read_b64_tr_b16 v[128:129], v50 offset:45056
    ds_read_b64_tr_b16 v[130:131], v50 offset:46080
    ds_read_b64_tr_b16 v[132:133], v50 offset:47104
    ds_read_b64_tr_b16 v[134:135], v50 offset:48128
    v_cvt_pk_bf16_f32 v200, v96, v97
    v_cvt_pk_bf16_f32 v201, v98, v99
    v_mfma_f32_32x32x16_bf16 v[80:95], v[136:139], a[20:23], v[80:95]
    v_cvt_pk_bf16_f32 v202, v100, v101
    v_cvt_pk_bf16_f32 v203, v102, v103
    s_add_u32 s64, s49, 589824
    s_waitcnt lgkmcnt(4)
    v_mfma_f32_32x32x16_bf16 v[64:79], v[140:143], a[24:27], v[64:79]
    v_mfma_f32_32x32x16_bf16 v[80:95], v[140:143], a[28:31], v[80:95]
    s_waitcnt lgkmcnt(0)
    s_waitcnt vmcnt(6)
    s_barrier
    v_mfma_f32_32x32x16_bf16 v[64:79], v[128:131], a[32:35], v[64:79]
    ds_read_b64_tr_b16 v[136:137], v50 offset:49152
    ds_read_b64_tr_b16 v[138:139], v50 offset:50176
    buffer_store_dwordx4 v[200:203], v46, s[16:19], s64 offen offset:0 sc1
    v_mfma_f32_32x32x16_bf16 v[80:95], v[128:131], a[36:39], v[80:95]
    s_add_u32 m0, s47, 98304
    s_add_u32 s62, s42, 640
    buffer_load_dwordx4 v35, s[12:15], s62 offen lds
    v_cvt_pk_bf16_f32 v204, v104, v105
    v_cvt_pk_bf16_f32 v205, v106, v107
    v_cvt_pk_bf16_f32 v206, v108, v109
    v_mfma_f32_32x32x16_bf16 v[64:79], v[132:135], a[40:43], v[64:79]
    ds_read_b64_tr_b16 v[140:141], v50 offset:51200
    ds_read_b64_tr_b16 v[142:143], v50 offset:52224
    v_cvt_pk_bf16_f32 v207, v110, v111
    v_mfma_f32_32x32x16_bf16 v[80:95], v[132:135], a[44:47], v[80:95]
    buffer_load_dwordx4 v36, s[12:15], s62 offen offset:1024 lds
    buffer_store_dwordx4 v[204:207], v46, s[16:19], s64 offen offset:1024 sc1
    s_waitcnt lgkmcnt(2)
    v_mfma_f32_32x32x16_bf16 v[64:79], v[136:139], a[48:51], v[64:79]
    ds_read_b64_tr_b16 v[128:129], v50 offset:53248
    ds_read_b64_tr_b16 v[130:131], v50 offset:54272
    v_cvt_pk_bf16_f32 v200, v112, v113
    v_cvt_pk_bf16_f32 v201, v114, v115
    v_mfma_f32_32x32x16_bf16 v[80:95], v[136:139], a[52:55], v[80:95]
    buffer_load_dwordx4 v37, s[12:15], s62 offen offset:2048 lds
    v_cvt_pk_bf16_f32 v202, v116, v117
    v_cvt_pk_bf16_f32 v203, v118, v119
    s_waitcnt lgkmcnt(2)
    v_mfma_f32_32x32x16_bf16 v[64:79], v[140:143], a[56:59], v[64:79]
    ds_read_b64_tr_b16 v[132:133], v50 offset:55296
    ds_read_b64_tr_b16 v[134:135], v50 offset:56320
    v_mfma_f32_32x32x16_bf16 v[80:95], v[140:143], a[60:63], v[80:95]
    buffer_store_dwordx4 v[200:203], v46, s[16:19], s64 offen offset:2048 sc1
    s_waitcnt lgkmcnt(2)
    v_mfma_f32_32x32x16_bf16 v[64:79], v[128:131], a[64:67], v[64:79]
    ds_read_b64_tr_b16 v[136:137], v50 offset:57344
    ds_read_b64_tr_b16 v[138:139], v50 offset:58368
    ds_read_b64_tr_b16 v[140:141], v50 offset:59392
    ds_read_b64_tr_b16 v[142:143], v50 offset:60416
    v_cvt_pk_bf16_f32 v204, v120, v121
    v_cvt_pk_bf16_f32 v205, v122, v123
    v_mfma_f32_32x32x16_bf16 v[80:95], v[128:131], a[68:71], v[80:95]
    v_cvt_pk_bf16_f32 v206, v124, v125
    v_cvt_pk_bf16_f32 v207, v126, v127
    s_waitcnt lgkmcnt(4)
    v_mfma_f32_32x32x16_bf16 v[64:79], v[132:135], a[72:75], v[64:79]
    v_mfma_f32_32x32x16_bf16 v[80:95], v[132:135], a[76:79], v[80:95]
    s_waitcnt lgkmcnt(0)
    s_waitcnt vmcnt(9)
    s_barrier
    s_add_u32 s4, s90, 3
    v_mov_b32 v48, s4
    buffer_store_dword v48, v47, s[16:19], 0 offen sc1
    v_mfma_f32_32x32x16_bf16 v[64:79], v[136:139], a[80:83], v[64:79]
    ds_read_b64_tr_b16 v[128:129], v51 offset:0
    ds_read_b64_tr_b16 v[130:131], v51 offset:1024
    buffer_store_dwordx4 v[204:207], v46, s[16:19], s64 offen offset:3072 sc1
    v_mfma_f32_32x32x16_bf16 v[80:95], v[136:139], a[84:87], v[80:95]
    s_add_u32 m0, s47, 110592
    s_add_u32 s62, s42, 111232
    buffer_load_dwordx4 v35, s[12:15], s62 offen lds
    v_mfma_f32_32x32x16_bf16 v[64:79], v[140:143], a[88:91], v[64:79]
    ds_read_b64_tr_b16 v[132:133], v51 offset:2048
    ds_read_b64_tr_b16 v[134:135], v51 offset:3072
    v_mfma_f32_32x32x16_bf16 v[80:95], v[140:143], a[92:95], v[80:95]
    buffer_load_dwordx4 v36, s[12:15], s62 offen offset:1024 lds
    s_waitcnt lgkmcnt(2)
    v_mfma_f32_32x32x16_bf16 v[64:79], v[128:131], a[96:99], v[64:79]
    ds_read_b64_tr_b16 v[136:137], v51 offset:4096
    ds_read_b64_tr_b16 v[138:139], v51 offset:5120
    v_mfma_f32_32x32x16_bf16 v[80:95], v[128:131], a[100:103], v[80:95]
    buffer_load_dwordx4 v37, s[12:15], s62 offen offset:2048 lds
    s_waitcnt lgkmcnt(2)
    v_mfma_f32_32x32x16_bf16 v[64:79], v[132:135], a[104:107], v[64:79]
    ds_read_b64_tr_b16 v[140:141], v51 offset:6144
    ds_read_b64_tr_b16 v[142:143], v51 offset:7168
    v_mfma_f32_32x32x16_bf16 v[80:95], v[132:135], a[108:111], v[80:95]
    s_waitcnt lgkmcnt(2)
    v_mfma_f32_32x32x16_bf16 v[64:79], v[136:139], a[112:115], v[64:79]
    ds_read_b64_tr_b16 v[128:129], v51 offset:8192
    ds_read_b64_tr_b16 v[130:131], v51 offset:9216
    ds_read_b64_tr_b16 v[132:133], v51 offset:10240
    ds_read_b64_tr_b16 v[134:135], v51 offset:11264
    v_mfma_f32_32x32x16_bf16 v[80:95], v[136:139], a[116:119], v[80:95]
    s_waitcnt lgkmcnt(4)
    v_mfma_f32_32x32x16_bf16 v[64:79], v[140:143], a[120:123], v[64:79]
    v_mfma_f32_32x32x16_bf16 v[80:95], v[140:143], a[124:127], v[80:95]
    s_waitcnt lgkmcnt(0)
    s_waitcnt vmcnt(11)
    s_barrier
    v_mfma_f32_32x32x16_bf16 v[64:79], v[128:131], a[128:131], v[64:79]
    ds_read_b64_tr_b16 v[136:137], v51 offset:12288
    ds_read_b64_tr_b16 v[138:139], v51 offset:13312
    v_mfma_f32_32x32x16_bf16 v[80:95], v[128:131], a[132:135], v[80:95]
    s_add_u32 m0, s47, 122880
    s_add_u32 s62, s42, 221824
    buffer_load_dwordx4 v35, s[12:15], s62 offen lds
    v_mfma_f32_32x32x16_bf16 v[64:79], v[132:135], a[136:139], v[64:79]
    ds_read_b64_tr_b16 v[140:141], v51 offset:14336
    ds_read_b64_tr_b16 v[142:143], v51 offset:15360
    v_mfma_f32_32x32x16_bf16 v[80:95], v[132:135], a[140:143], v[80:95]
    buffer_load_dwordx4 v36, s[12:15], s62 offen offset:1024 lds
    s_waitcnt lgkmcnt(2)
    v_mfma_f32_32x32x16_bf16 v[64:79], v[136:139], a[144:147], v[64:79]
    ds_read_b64_tr_b16 v[128:129], v51 offset:16384
    ds_read_b64_tr_b16 v[130:131], v51 offset:17408
    v_mfma_f32_32x32x16_bf16 v[80:95], v[136:139], a[148:151], v[80:95]
    buffer_load_dwordx4 v37, s[12:15], s62 offen offset:2048 lds
    s_waitcnt lgkmcnt(2)
    v_mfma_f32_32x32x16_bf16 v[64:79], v[140:143], a[152:155], v[64:79]
    ds_read_b64_tr_b16 v[132:133], v51 offset:18432
    ds_read_b64_tr_b16 v[134:135], v51 offset:19456
    v_mfma_f32_32x32x16_bf16 v[80:95], v[140:143], a[156:159], v[80:95]
    s_waitcnt lgkmcnt(2)
    v_mfma_f32_32x32x16_bf16 v[64:79], v[128:131], a[160:163], v[64:79]
    ds_read_b64_tr_b16 v[136:137], v51 offset:20480
    ds_read_b64_tr_b16 v[138:139], v51 offset:21504
    ds_read_b64_tr_b16 v[140:141], v51 offset:22528
    ds_read_b64_tr_b16 v[142:143], v51 offset:23552
    v_mfma_f32_32x32x16_bf16 v[80:95], v[128:131], a[164:167], v[80:95]
    s_waitcnt lgkmcnt(4)
    v_mfma_f32_32x32x16_bf16 v[64:79], v[132:135], a[168:171], v[64:79]
    v_mfma_f32_32x32x16_bf16 v[80:95], v[132:135], a[172:175], v[80:95]
    s_waitcnt lgkmcnt(0)
    s_waitcnt vmcnt(9)
    s_barrier
    v_mfma_f32_32x32x16_bf16 v[64:79], v[136:139], a[176:179], v[64:79]
    ds_read_b64_tr_b16 v[128:129], v50 offset:36864
    ds_read_b64_tr_b16 v[130:131], v50 offset:37888
    v_mfma_f32_32x32x16_bf16 v[80:95], v[136:139], a[180:183], v[80:95]
    s_add_u32 m0, s47, 135168
    s_add_u32 s62, s42, 332416
    buffer_load_dwordx4 v35, s[12:15], s62 offen lds
    v_mfma_f32_32x32x16_bf16 v[64:79], v[140:143], a[184:187], v[64:79]
    ds_read_b64_tr_b16 v[132:133], v50 offset:38912
    ds_read_b64_tr_b16 v[134:135], v50 offset:39936
    v_mfma_f32_32x32x16_bf16 v[80:95], v[140:143], a[188:191], v[80:95]
    buffer_load_dwordx4 v36, s[12:15], s62 offen offset:1024 lds
    s_waitcnt lgkmcnt(2)
    v_mfma_f32_32x32x16_bf16 v[96:111], v[128:131], a[0:3], 0
    ds_read_b64_tr_b16 v[136:137], v50 offset:40960
    ds_read_b64_tr_b16 v[138:139], v50 offset:41984
    v_mfma_f32_32x32x16_bf16 v[112:127], v[128:131], a[4:7], 0
    buffer_load_dwordx4 v37, s[12:15], s62 offen offset:2048 lds
    s_waitcnt lgkmcnt(2)
    v_mfma_f32_32x32x16_bf16 v[96:111], v[132:135], a[8:11], v[96:111]
    ds_read_b64_tr_b16 v[140:141], v50 offset:43008
    ds_read_b64_tr_b16 v[142:143], v50 offset:44032
    v_mfma_f32_32x32x16_bf16 v[112:127], v[132:135], a[12:15], v[112:127]
    s_waitcnt lgkmcnt(2)
    v_mfma_f32_32x32x16_bf16 v[96:111], v[136:139], a[16:19], v[96:111]
    ds_read_b64_tr_b16 v[128:129], v50 offset:45056
    ds_read_b64_tr_b16 v[130:131], v50 offset:46080
    ds_read_b64_tr_b16 v[132:133], v50 offset:47104
    ds_read_b64_tr_b16 v[134:135], v50 offset:48128
    v_cvt_pk_bf16_f32 v200, v64, v65
    v_cvt_pk_bf16_f32 v201, v66, v67
    v_mfma_f32_32x32x16_bf16 v[112:127], v[136:139], a[20:23], v[112:127]
    v_cvt_pk_bf16_f32 v202, v68, v69
    v_cvt_pk_bf16_f32 v203, v70, v71
    s_add_u32 s64, s49, 786432
    s_waitcnt lgkmcnt(4)
    v_mfma_f32_32x32x16_bf16 v[96:111], v[140:143], a[24:27], v[96:111]
    v_mfma_f32_32x32x16_bf16 v[112:127], v[140:143], a[28:31], v[112:127]
    s_waitcnt lgkmcnt(0)
    s_waitcnt vmcnt(6)
    s_barrier
    v_mfma_f32_32x32x16_bf16 v[96:111], v[128:131], a[32:35], v[96:111]
    ds_read_b64_tr_b16 v[136:137], v50 offset:49152
    ds_read_b64_tr_b16 v[138:139], v50 offset:50176
    buffer_store_dwordx4 v[200:203], v46, s[16:19], s64 offen offset:0 sc1
    v_mfma_f32_32x32x16_bf16 v[112:127], v[128:131], a[36:39], v[112:127]
    s_add_u32 m0, s47, 98304
    s_add_u32 s62, s42, 768
    buffer_load_dwordx4 v35, s[12:15], s62 offen lds
    v_cvt_pk_bf16_f32 v204, v72, v73
    v_cvt_pk_bf16_f32 v205, v74, v75
    v_cvt_pk_bf16_f32 v206, v76, v77
    v_mfma_f32_32x32x16_bf16 v[96:111], v[132:135], a[40:43], v[96:111]
    ds_read_b64_tr_b16 v[140:141], v50 offset:51200
    ds_read_b64_tr_b16 v[142:143], v50 offset:52224
    v_cvt_pk_bf16_f32 v207, v78, v79
    v_mfma_f32_32x32x16_bf16 v[112:127], v[132:135], a[44:47], v[112:127]
    buffer_load_dwordx4 v36, s[12:15], s62 offen offset:1024 lds
    buffer_store_dwordx4 v[204:207], v46, s[16:19], s64 offen offset:1024 sc1
    s_waitcnt lgkmcnt(2)
    v_mfma_f32_32x32x16_bf16 v[96:111], v[136:139], a[48:51], v[96:111]
    ds_read_b64_tr_b16 v[128:129], v50 offset:53248
    ds_read_b64_tr_b16 v[130:131], v50 offset:54272
    v_cvt_pk_bf16_f32 v200, v80, v81
    v_cvt_pk_bf16_f32 v201, v82, v83
    v_mfma_f32_32x32x16_bf16 v[112:127], v[136:139], a[52:55], v[112:127]
    buffer_load_dwordx4 v37, s[12:15], s62 offen offset:2048 lds
    v_cvt_pk_bf16_f32 v202, v84, v85
    v_cvt_pk_bf16_f32 v203, v86, v87
    s_waitcnt lgkmcnt(2)
    v_mfma_f32_32x32x16_bf16 v[96:111], v[140:143], a[56:59], v[96:111]
    ds_read_b64_tr_b16 v[132:133], v50 offset:55296
    ds_read_b64_tr_b16 v[134:135], v50 offset:56320
    v_mfma_f32_32x32x16_bf16 v[112:127], v[140:143], a[60:63], v[112:127]
    buffer_store_dwordx4 v[200:203], v46, s[16:19], s64 offen offset:2048 sc1
    s_waitcnt lgkmcnt(2)
    v_mfma_f32_32x32x16_bf16 v[96:111], v[128:131], a[64:67], v[96:111]
    ds_read_b64_tr_b16 v[136:137], v50 offset:57344
    ds_read_b64_tr_b16 v[138:139], v50 offset:58368
    ds_read_b64_tr_b16 v[140:141], v50 offset:59392
    ds_read_b64_tr_b16 v[142:143], v50 offset:60416
    v_cvt_pk_bf16_f32 v204, v88, v89
    v_cvt_pk_bf16_f32 v205, v90, v91
    v_mfma_f32_32x32x16_bf16 v[112:127], v[128:131], a[68:71], v[112:127]
    v_cvt_pk_bf16_f32 v206, v92, v93
    v_cvt_pk_bf16_f32 v207, v94, v95
    s_waitcnt lgkmcnt(4)
    v_mfma_f32_32x32x16_bf16 v[96:111], v[132:135], a[72:75], v[96:111]
    v_mfma_f32_32x32x16_bf16 v[112:127], v[132:135], a[76:79], v[112:127]
    s_waitcnt lgkmcnt(0)
    s_waitcnt vmcnt(9)
    s_barrier
    s_add_u32 s4, s90, 4
    v_mov_b32 v48, s4
    buffer_store_dword v48, v47, s[16:19], 0 offen sc1
    v_mfma_f32_32x32x16_bf16 v[96:111], v[136:139], a[80:83], v[96:111]
    ds_read_b64_tr_b16 v[128:129], v51 offset:0
    ds_read_b64_tr_b16 v[130:131], v51 offset:1024
    buffer_store_dwordx4 v[204:207], v46, s[16:19], s64 offen offset:3072 sc1
    v_mfma_f32_32x32x16_bf16 v[112:127], v[136:139], a[84:87], v[112:127]
    s_add_u32 m0, s47, 110592
    s_add_u32 s62, s42, 111360
    buffer_load_dwordx4 v35, s[12:15], s62 offen lds
    v_mfma_f32_32x32x16_bf16 v[96:111], v[140:143], a[88:91], v[96:111]
    ds_read_b64_tr_b16 v[132:133], v51 offset:2048
    ds_read_b64_tr_b16 v[134:135], v51 offset:3072
    v_mfma_f32_32x32x16_bf16 v[112:127], v[140:143], a[92:95], v[112:127]
    buffer_load_dwordx4 v36, s[12:15], s62 offen offset:1024 lds
    s_waitcnt lgkmcnt(2)
    v_mfma_f32_32x32x16_bf16 v[96:111], v[128:131], a[96:99], v[96:111]
    ds_read_b64_tr_b16 v[136:137], v51 offset:4096
    ds_read_b64_tr_b16 v[138:139], v51 offset:5120
    v_mfma_f32_32x32x16_bf16 v[112:127], v[128:131], a[100:103], v[112:127]
    buffer_load_dwordx4 v37, s[12:15], s62 offen offset:2048 lds
    s_waitcnt lgkmcnt(2)
    v_mfma_f32_32x32x16_bf16 v[96:111], v[132:135], a[104:107], v[96:111]
    ds_read_b64_tr_b16 v[140:141], v51 offset:6144
    ds_read_b64_tr_b16 v[142:143], v51 offset:7168
    v_mfma_f32_32x32x16_bf16 v[112:127], v[132:135], a[108:111], v[112:127]
    s_waitcnt lgkmcnt(2)
    v_mfma_f32_32x32x16_bf16 v[96:111], v[136:139], a[112:115], v[96:111]
    ds_read_b64_tr_b16 v[128:129], v51 offset:8192
    ds_read_b64_tr_b16 v[130:131], v51 offset:9216
    ds_read_b64_tr_b16 v[132:133], v51 offset:10240
    ds_read_b64_tr_b16 v[134:135], v51 offset:11264
    v_mfma_f32_32x32x16_bf16 v[112:127], v[136:139], a[116:119], v[112:127]
    s_waitcnt lgkmcnt(4)
    v_mfma_f32_32x32x16_bf16 v[96:111], v[140:143], a[120:123], v[96:111]
    v_mfma_f32_32x32x16_bf16 v[112:127], v[140:143], a[124:127], v[112:127]
    s_waitcnt lgkmcnt(0)
    s_waitcnt vmcnt(11)
    s_barrier
    v_mfma_f32_32x32x16_bf16 v[96:111], v[128:131], a[128:131], v[96:111]
    ds_read_b64_tr_b16 v[136:137], v51 offset:12288
    ds_read_b64_tr_b16 v[138:139], v51 offset:13312
    v_mfma_f32_32x32x16_bf16 v[112:127], v[128:131], a[132:135], v[112:127]
    s_add_u32 m0, s47, 122880
    s_add_u32 s62, s42, 221952
    buffer_load_dwordx4 v35, s[12:15], s62 offen lds
    v_mfma_f32_32x32x16_bf16 v[96:111], v[132:135], a[136:139], v[96:111]
    ds_read_b64_tr_b16 v[140:141], v51 offset:14336
    ds_read_b64_tr_b16 v[142:143], v51 offset:15360
    v_mfma_f32_32x32x16_bf16 v[112:127], v[132:135], a[140:143], v[112:127]
    buffer_load_dwordx4 v36, s[12:15], s62 offen offset:1024 lds
    s_waitcnt lgkmcnt(2)
    v_mfma_f32_32x32x16_bf16 v[96:111], v[136:139], a[144:147], v[96:111]
    ds_read_b64_tr_b16 v[128:129], v51 offset:16384
    ds_read_b64_tr_b16 v[130:131], v51 offset:17408
    v_mfma_f32_32x32x16_bf16 v[112:127], v[136:139], a[148:151], v[112:127]
    buffer_load_dwordx4 v37, s[12:15], s62 offen offset:2048 lds
    s_waitcnt lgkmcnt(2)
    v_mfma_f32_32x32x16_bf16 v[96:111], v[140:143], a[152:155], v[96:111]
    ds_read_b64_tr_b16 v[132:133], v51 offset:18432
    ds_read_b64_tr_b16 v[134:135], v51 offset:19456
    v_mfma_f32_32x32x16_bf16 v[112:127], v[140:143], a[156:159], v[112:127]
    s_waitcnt lgkmcnt(2)
    v_mfma_f32_32x32x16_bf16 v[96:111], v[128:131], a[160:163], v[96:111]
    ds_read_b64_tr_b16 v[136:137], v51 offset:20480
    ds_read_b64_tr_b16 v[138:139], v51 offset:21504
    ds_read_b64_tr_b16 v[140:141], v51 offset:22528
    ds_read_b64_tr_b16 v[142:143], v51 offset:23552
    v_mfma_f32_32x32x16_bf16 v[112:127], v[128:131], a[164:167], v[112:127]
    s_waitcnt lgkmcnt(4)
    v_mfma_f32_32x32x16_bf16 v[96:111], v[132:135], a[168:171], v[96:111]
    v_mfma_f32_32x32x16_bf16 v[112:127], v[132:135], a[172:175], v[112:127]
    s_waitcnt lgkmcnt(0)
    s_waitcnt vmcnt(9)
    s_barrier
    v_mfma_f32_32x32x16_bf16 v[96:111], v[136:139], a[176:179], v[96:111]
    ds_read_b64_tr_b16 v[128:129], v50 offset:36864
    ds_read_b64_tr_b16 v[130:131], v50 offset:37888
    v_mfma_f32_32x32x16_bf16 v[112:127], v[136:139], a[180:183], v[112:127]
    s_add_u32 m0, s47, 135168
    s_add_u32 s62, s42, 332544
    buffer_load_dwordx4 v35, s[12:15], s62 offen lds
    v_mfma_f32_32x32x16_bf16 v[96:111], v[140:143], a[184:187], v[96:111]
    ds_read_b64_tr_b16 v[132:133], v50 offset:38912
    ds_read_b64_tr_b16 v[134:135], v50 offset:39936
    v_mfma_f32_32x32x16_bf16 v[112:127], v[140:143], a[188:191], v[112:127]
    buffer_load_dwordx4 v36, s[12:15], s62 offen offset:1024 lds
    s_waitcnt lgkmcnt(2)
    v_mfma_f32_32x32x16_bf16 v[64:79], v[128:131], a[0:3], 0
    ds_read_b64_tr_b16 v[136:137], v50 offset:40960
    ds_read_b64_tr_b16 v[138:139], v50 offset:41984
    v_mfma_f32_32x32x16_bf16 v[80:95], v[128:131], a[4:7], 0
    buffer_load_dwordx4 v37, s[12:15], s62 offen offset:2048 lds
    s_waitcnt lgkmcnt(2)
    v_mfma_f32_32x32x16_bf16 v[64:79], v[132:135], a[8:11], v[64:79]
    ds_read_b64_tr_b16 v[140:141], v50 offset:43008
    ds_read_b64_tr_b16 v[142:143], v50 offset:44032
    v_mfma_f32_32x32x16_bf16 v[80:95], v[132:135], a[12:15], v[80:95]
    s_waitcnt lgkmcnt(2)
    v_mfma_f32_32x32x16_bf16 v[64:79], v[136:139], a[16:19], v[64:79]
    ds_read_b64_tr_b16 v[128:129], v50 offset:45056
    ds_read_b64_tr_b16 v[130:131], v50 offset:46080
    ds_read_b64_tr_b16 v[132:133], v50 offset:47104
    ds_read_b64_tr_b16 v[134:135], v50 offset:48128
    v_cvt_pk_bf16_f32 v200, v96, v97
    v_cvt_pk_bf16_f32 v201, v98, v99
    v_mfma_f32_32x32x16_bf16 v[80:95], v[136:139], a[20:23], v[80:95]
    v_cvt_pk_bf16_f32 v202, v100, v101
    v_cvt_pk_bf16_f32 v203, v102, v103
    s_add_u32 s64, s49, 983040
    s_waitcnt lgkmcnt(4)
    v_mfma_f32_32x32x16_bf16 v[64:79], v[140:143], a[24:27], v[64:79]
    v_mfma_f32_32x32x16_bf16 v[80:95], v[140:143], a[28:31], v[80:95]
    s_waitcnt lgkmcnt(0)
    s_waitcnt vmcnt(6)
    s_barrier
    v_mfma_f32_32x32x16_bf16 v[64:79], v[128:131], a[32:35], v[64:79]
    ds_read_b64_tr_b16 v[136:137], v50 offset:49152
    ds_read_b64_tr_b16 v[138:139], v50 offset:50176
    buffer_store_dwordx4 v[200:203], v46, s[16:19], s64 offen offset:0 sc1
    v_mfma_f32_32x32x16_bf16 v[80:95], v[128:131], a[36:39], v[80:95]
    s_add_u32 m0, s47, 98304
    s_add_u32 s62, s42, 896
    buffer_load_dwordx4 v35, s[12:15], s62 offen lds
    v_cvt_pk_bf16_f32 v204, v104, v105
    v_cvt_pk_bf16_f32 v205, v106, v107
    v_cvt_pk_bf16_f32 v206, v108, v109
    v_mfma_f32_32x32x16_bf16 v[64:79], v[132:135], a[40:43], v[64:79]
    ds_read_b64_tr_b16 v[140:141], v50 offset:51200
    ds_read_b64_tr_b16 v[142:143], v50 offset:52224
    v_cvt_pk_bf16_f32 v207, v110, v111
    v_mfma_f32_32x32x16_bf16 v[80:95], v[132:135], a[44:47], v[80:95]
    buffer_load_dwordx4 v36, s[12:15], s62 offen offset:1024 lds
    buffer_store_dwordx4 v[204:207], v46, s[16:19], s64 offen offset:1024 sc1
    s_waitcnt lgkmcnt(2)
    v_mfma_f32_32x32x16_bf16 v[64:79], v[136:139], a[48:51], v[64:79]
    ds_read_b64_tr_b16 v[128:129], v50 offset:53248
    ds_read_b64_tr_b16 v[130:131], v50 offset:54272
    v_cvt_pk_bf16_f32 v200, v112, v113
    v_cvt_pk_bf16_f32 v201, v114, v115
    v_mfma_f32_32x32x16_bf16 v[80:95], v[136:139], a[52:55], v[80:95]
    buffer_load_dwordx4 v37, s[12:15], s62 offen offset:2048 lds
    v_cvt_pk_bf16_f32 v202, v116, v117
    v_cvt_pk_bf16_f32 v203, v118, v119
    s_waitcnt lgkmcnt(2)
    v_mfma_f32_32x32x16_bf16 v[64:79], v[140:143], a[56:59], v[64:79]
    ds_read_b64_tr_b16 v[132:133], v50 offset:55296
    ds_read_b64_tr_b16 v[134:135], v50 offset:56320
    v_mfma_f32_32x32x16_bf16 v[80:95], v[140:143], a[60:63], v[80:95]
    buffer_store_dwordx4 v[200:203], v46, s[16:19], s64 offen offset:2048 sc1
    s_waitcnt lgkmcnt(2)
    v_mfma_f32_32x32x16_bf16 v[64:79], v[128:131], a[64:67], v[64:79]
    ds_read_b64_tr_b16 v[136:137], v50 offset:57344
    ds_read_b64_tr_b16 v[138:139], v50 offset:58368
    ds_read_b64_tr_b16 v[140:141], v50 offset:59392
    ds_read_b64_tr_b16 v[142:143], v50 offset:60416
    v_cvt_pk_bf16_f32 v204, v120, v121
    v_cvt_pk_bf16_f32 v205, v122, v123
    v_mfma_f32_32x32x16_bf16 v[80:95], v[128:131], a[68:71], v[80:95]
    v_cvt_pk_bf16_f32 v206, v124, v125
    v_cvt_pk_bf16_f32 v207, v126, v127
    s_waitcnt lgkmcnt(4)
    v_mfma_f32_32x32x16_bf16 v[64:79], v[132:135], a[72:75], v[64:79]
    v_mfma_f32_32x32x16_bf16 v[80:95], v[132:135], a[76:79], v[80:95]
    s_waitcnt lgkmcnt(0)
    s_waitcnt vmcnt(9)
    s_barrier
    s_add_u32 s4, s90, 5
    v_mov_b32 v48, s4
    buffer_store_dword v48, v47, s[16:19], 0 offen sc1
    v_mfma_f32_32x32x16_bf16 v[64:79], v[136:139], a[80:83], v[64:79]
    ds_read_b64_tr_b16 v[128:129], v51 offset:0
    ds_read_b64_tr_b16 v[130:131], v51 offset:1024
    buffer_store_dwordx4 v[204:207], v46, s[16:19], s64 offen offset:3072 sc1
    v_mfma_f32_32x32x16_bf16 v[80:95], v[136:139], a[84:87], v[80:95]
    s_add_u32 m0, s47, 110592
    s_add_u32 s62, s42, 111488
    buffer_load_dwordx4 v35, s[12:15], s62 offen lds
    v_mfma_f32_32x32x16_bf16 v[64:79], v[140:143], a[88:91], v[64:79]
    ds_read_b64_tr_b16 v[132:133], v51 offset:2048
    ds_read_b64_tr_b16 v[134:135], v51 offset:3072
    v_mfma_f32_32x32x16_bf16 v[80:95], v[140:143], a[92:95], v[80:95]
    buffer_load_dwordx4 v36, s[12:15], s62 offen offset:1024 lds
    s_waitcnt lgkmcnt(2)
    v_mfma_f32_32x32x16_bf16 v[64:79], v[128:131], a[96:99], v[64:79]
    ds_read_b64_tr_b16 v[136:137], v51 offset:4096
    ds_read_b64_tr_b16 v[138:139], v51 offset:5120
    v_mfma_f32_32x32x16_bf16 v[80:95], v[128:131], a[100:103], v[80:95]
    buffer_load_dwordx4 v37, s[12:15], s62 offen offset:2048 lds
    s_waitcnt lgkmcnt(2)
    v_mfma_f32_32x32x16_bf16 v[64:79], v[132:135], a[104:107], v[64:79]
    ds_read_b64_tr_b16 v[140:141], v51 offset:6144
    ds_read_b64_tr_b16 v[142:143], v51 offset:7168
    v_mfma_f32_32x32x16_bf16 v[80:95], v[132:135], a[108:111], v[80:95]
    s_waitcnt lgkmcnt(2)
    v_mfma_f32_32x32x16_bf16 v[64:79], v[136:139], a[112:115], v[64:79]
    ds_read_b64_tr_b16 v[128:129], v51 offset:8192
    ds_read_b64_tr_b16 v[130:131], v51 offset:9216
    ds_read_b64_tr_b16 v[132:133], v51 offset:10240
    ds_read_b64_tr_b16 v[134:135], v51 offset:11264
    v_mfma_f32_32x32x16_bf16 v[80:95], v[136:139], a[116:119], v[80:95]
    s_waitcnt lgkmcnt(4)
    v_mfma_f32_32x32x16_bf16 v[64:79], v[140:143], a[120:123], v[64:79]
    v_mfma_f32_32x32x16_bf16 v[80:95], v[140:143], a[124:127], v[80:95]
    s_waitcnt lgkmcnt(0)
    s_waitcnt vmcnt(11)
    s_barrier
    v_mfma_f32_32x32x16_bf16 v[64:79], v[128:131], a[128:131], v[64:79]
    ds_read_b64_tr_b16 v[136:137], v51 offset:12288
    ds_read_b64_tr_b16 v[138:139], v51 offset:13312
    v_mfma_f32_32x32x16_bf16 v[80:95], v[128:131], a[132:135], v[80:95]
    s_add_u32 m0, s47, 122880
    s_add_u32 s62, s42, 222080
    buffer_load_dwordx4 v35, s[12:15], s62 offen lds
    v_mfma_f32_32x32x16_bf16 v[64:79], v[132:135], a[136:139], v[64:79]
    ds_read_b64_tr_b16 v[140:141], v51 offset:14336
    ds_read_b64_tr_b16 v[142:143], v51 offset:15360
    v_mfma_f32_32x32x16_bf16 v[80:95], v[132:135], a[140:143], v[80:95]
    buffer_load_dwordx4 v36, s[12:15], s62 offen offset:1024 lds
    s_waitcnt lgkmcnt(2)
    v_mfma_f32_32x32x16_bf16 v[64:79], v[136:139], a[144:147], v[64:79]
    ds_read_b64_tr_b16 v[128:129], v51 offset:16384
    ds_read_b64_tr_b16 v[130:131], v51 offset:17408
    v_mfma_f32_32x32x16_bf16 v[80:95], v[136:139], a[148:151], v[80:95]
    buffer_load_dwordx4 v37, s[12:15], s62 offen offset:2048 lds
    s_waitcnt lgkmcnt(2)
    v_mfma_f32_32x32x16_bf16 v[64:79], v[140:143], a[152:155], v[64:79]
    ds_read_b64_tr_b16 v[132:133], v51 offset:18432
    ds_read_b64_tr_b16 v[134:135], v51 offset:19456
    v_mfma_f32_32x32x16_bf16 v[80:95], v[140:143], a[156:159], v[80:95]
    s_waitcnt lgkmcnt(2)
    v_mfma_f32_32x32x16_bf16 v[64:79], v[128:131], a[160:163], v[64:79]
    ds_read_b64_tr_b16 v[136:137], v51 offset:20480
    ds_read_b64_tr_b16 v[138:139], v51 offset:21504
    ds_read_b64_tr_b16 v[140:141], v51 offset:22528
    ds_read_b64_tr_b16 v[142:143], v51 offset:23552
    v_mfma_f32_32x32x16_bf16 v[80:95], v[128:131], a[164:167], v[80:95]
    s_waitcnt lgkmcnt(4)
    v_mfma_f32_32x32x16_bf16 v[64:79], v[132:135], a[168:171], v[64:79]
    v_mfma_f32_32x32x16_bf16 v[80:95], v[132:135], a[172:175], v[80:95]
    s_waitcnt lgkmcnt(0)
    s_waitcnt vmcnt(9)
    s_barrier
    v_mfma_f32_32x32x16_bf16 v[64:79], v[136:139], a[176:179], v[64:79]
    ds_read_b64_tr_b16 v[128:129], v50 offset:36864
    ds_read_b64_tr_b16 v[130:131], v50 offset:37888
    v_mfma_f32_32x32x16_bf16 v[80:95], v[136:139], a[180:183], v[80:95]
    s_add_u32 m0, s47, 135168
    s_add_u32 s62, s42, 332672
    buffer_load_dwordx4 v35, s[12:15], s62 offen lds
    v_mfma_f32_32x32x16_bf16 v[64:79], v[140:143], a[184:187], v[64:79]
    ds_read_b64_tr_b16 v[132:133], v50 offset:38912
    ds_read_b64_tr_b16 v[134:135], v50 offset:39936
    v_mfma_f32_32x32x16_bf16 v[80:95], v[140:143], a[188:191], v[80:95]
    buffer_load_dwordx4 v36, s[12:15], s62 offen offset:1024 lds
    s_waitcnt lgkmcnt(2)
    v_mfma_f32_32x32x16_bf16 v[96:111], v[128:131], a[0:3], 0
    ds_read_b64_tr_b16 v[136:137], v50 offset:40960
    ds_read_b64_tr_b16 v[138:139], v50 offset:41984
    v_mfma_f32_32x32x16_bf16 v[112:127], v[128:131], a[4:7], 0
    buffer_load_dwordx4 v37, s[12:15], s62 offen offset:2048 lds
    s_waitcnt lgkmcnt(2)
    v_mfma_f32_32x32x16_bf16 v[96:111], v[132:135], a[8:11], v[96:111]
    ds_read_b64_tr_b16 v[140:141], v50 offset:43008
    ds_read_b64_tr_b16 v[142:143], v50 offset:44032
    v_mfma_f32_32x32x16_bf16 v[112:127], v[132:135], a[12:15], v[112:127]
    s_waitcnt lgkmcnt(2)
    v_mfma_f32_32x32x16_bf16 v[96:111], v[136:139], a[16:19], v[96:111]
    ds_read_b64_tr_b16 v[128:129], v50 offset:45056
    ds_read_b64_tr_b16 v[130:131], v50 offset:46080
    ds_read_b64_tr_b16 v[132:133], v50 offset:47104
    ds_read_b64_tr_b16 v[134:135], v50 offset:48128
    v_cvt_pk_bf16_f32 v200, v64, v65
    v_cvt_pk_bf16_f32 v201, v66, v67
    v_mfma_f32_32x32x16_bf16 v[112:127], v[136:139], a[20:23], v[112:127]
    v_cvt_pk_bf16_f32 v202, v68, v69
    v_cvt_pk_bf16_f32 v203, v70, v71
    s_add_u32 s64, s49, 1179648
    s_waitcnt lgkmcnt(4)
    v_mfma_f32_32x32x16_bf16 v[96:111], v[140:143], a[24:27], v[96:111]
    v_mfma_f32_32x32x16_bf16 v[112:127], v[140:143], a[28:31], v[112:127]
    s_waitcnt lgkmcnt(0)
    s_waitcnt vmcnt(6)
    s_barrier
    v_mfma_f32_32x32x16_bf16 v[96:111], v[128:131], a[32:35], v[96:111]
    ds_read_b64_tr_b16 v[136:137], v50 offset:49152
    ds_read_b64_tr_b16 v[138:139], v50 offset:50176
    buffer_store_dwordx4 v[200:203], v46, s[16:19], s64 offen offset:0 sc1
    v_mfma_f32_32x32x16_bf16 v[112:127], v[128:131], a[36:39], v[112:127]
    s_add_u32 m0, s47, 98304
    s_add_u32 s62, s42, 1024
    buffer_load_dwordx4 v35, s[12:15], s62 offen lds
    v_cvt_pk_bf16_f32 v204, v72, v73
    v_cvt_pk_bf16_f32 v205, v74, v75
    v_cvt_pk_bf16_f32 v206, v76, v77
    v_mfma_f32_32x32x16_bf16 v[96:111], v[132:135], a[40:43], v[96:111]
    ds_read_b64_tr_b16 v[140:141], v50 offset:51200
    ds_read_b64_tr_b16 v[142:143], v50 offset:52224
    v_cvt_pk_bf16_f32 v207, v78, v79
    v_mfma_f32_32x32x16_bf16 v[112:127], v[132:135], a[44:47], v[112:127]
    buffer_load_dwordx4 v36, s[12:15], s62 offen offset:1024 lds
    buffer_store_dwordx4 v[204:207], v46, s[16:19], s64 offen offset:1024 sc1
    s_waitcnt lgkmcnt(2)
    v_mfma_f32_32x32x16_bf16 v[96:111], v[136:139], a[48:51], v[96:111]
    ds_read_b64_tr_b16 v[128:129], v50 offset:53248
    ds_read_b64_tr_b16 v[130:131], v50 offset:54272
    v_cvt_pk_bf16_f32 v200, v80, v81
    v_cvt_pk_bf16_f32 v201, v82, v83
    v_mfma_f32_32x32x16_bf16 v[112:127], v[136:139], a[52:55], v[112:127]
    buffer_load_dwordx4 v37, s[12:15], s62 offen offset:2048 lds
    v_cvt_pk_bf16_f32 v202, v84, v85
    v_cvt_pk_bf16_f32 v203, v86, v87
    s_waitcnt lgkmcnt(2)
    v_mfma_f32_32x32x16_bf16 v[96:111], v[140:143], a[56:59], v[96:111]
    ds_read_b64_tr_b16 v[132:133], v50 offset:55296
    ds_read_b64_tr_b16 v[134:135], v50 offset:56320
    v_mfma_f32_32x32x16_bf16 v[112:127], v[140:143], a[60:63], v[112:127]
    buffer_store_dwordx4 v[200:203], v46, s[16:19], s64 offen offset:2048 sc1
    s_waitcnt lgkmcnt(2)
    v_mfma_f32_32x32x16_bf16 v[96:111], v[128:131], a[64:67], v[96:111]
    ds_read_b64_tr_b16 v[136:137], v50 offset:57344
    ds_read_b64_tr_b16 v[138:139], v50 offset:58368
    ds_read_b64_tr_b16 v[140:141], v50 offset:59392
    ds_read_b64_tr_b16 v[142:143], v50 offset:60416
    v_cvt_pk_bf16_f32 v204, v88, v89
    v_cvt_pk_bf16_f32 v205, v90, v91
    v_mfma_f32_32x32x16_bf16 v[112:127], v[128:131], a[68:71], v[112:127]
    v_cvt_pk_bf16_f32 v206, v92, v93
    v_cvt_pk_bf16_f32 v207, v94, v95
    s_waitcnt lgkmcnt(4)
    v_mfma_f32_32x32x16_bf16 v[96:111], v[132:135], a[72:75], v[96:111]
    v_mfma_f32_32x32x16_bf16 v[112:127], v[132:135], a[76:79], v[112:127]
    s_waitcnt lgkmcnt(0)
    s_waitcnt vmcnt(9)
    s_barrier
    s_add_u32 s4, s90, 6
    v_mov_b32 v48, s4
    buffer_store_dword v48, v47, s[16:19], 0 offen sc1
    v_mfma_f32_32x32x16_bf16 v[96:111], v[136:139], a[80:83], v[96:111]
    ds_read_b64_tr_b16 v[128:129], v51 offset:0
    ds_read_b64_tr_b16 v[130:131], v51 offset:1024
    buffer_store_dwordx4 v[204:207], v46, s[16:19], s64 offen offset:3072 sc1
    v_mfma_f32_32x32x16_bf16 v[112:127], v[136:139], a[84:87], v[112:127]
    s_add_u32 m0, s47, 110592
    s_add_u32 s62, s42, 111616
    buffer_load_dwordx4 v35, s[12:15], s62 offen lds
    v_mfma_f32_32x32x16_bf16 v[96:111], v[140:143], a[88:91], v[96:111]
    ds_read_b64_tr_b16 v[132:133], v51 offset:2048
    ds_read_b64_tr_b16 v[134:135], v51 offset:3072
    v_mfma_f32_32x32x16_bf16 v[112:127], v[140:143], a[92:95], v[112:127]
    buffer_load_dwordx4 v36, s[12:15], s62 offen offset:1024 lds
    s_waitcnt lgkmcnt(2)
    v_mfma_f32_32x32x16_bf16 v[96:111], v[128:131], a[96:99], v[96:111]
    ds_read_b64_tr_b16 v[136:137], v51 offset:4096
    ds_read_b64_tr_b16 v[138:139], v51 offset:5120
    v_mfma_f32_32x32x16_bf16 v[112:127], v[128:131], a[100:103], v[112:127]
    buffer_load_dwordx4 v37, s[12:15], s62 offen offset:2048 lds
    s_waitcnt lgkmcnt(2)
    v_mfma_f32_32x32x16_bf16 v[96:111], v[132:135], a[104:107], v[96:111]
    ds_read_b64_tr_b16 v[140:141], v51 offset:6144
    ds_read_b64_tr_b16 v[142:143], v51 offset:7168
    v_mfma_f32_32x32x16_bf16 v[112:127], v[132:135], a[108:111], v[112:127]
    s_waitcnt lgkmcnt(2)
    v_mfma_f32_32x32x16_bf16 v[96:111], v[136:139], a[112:115], v[96:111]
    ds_read_b64_tr_b16 v[128:129], v51 offset:8192
    ds_read_b64_tr_b16 v[130:131], v51 offset:9216
    ds_read_b64_tr_b16 v[132:133], v51 offset:10240
    ds_read_b64_tr_b16 v[134:135], v51 offset:11264
    v_mfma_f32_32x32x16_bf16 v[112:127], v[136:139], a[116:119], v[112:127]
    s_waitcnt lgkmcnt(4)
    v_mfma_f32_32x32x16_bf16 v[96:111], v[140:143], a[120:123], v[96:111]
    v_mfma_f32_32x32x16_bf16 v[112:127], v[140:143], a[124:127], v[112:127]
    s_waitcnt lgkmcnt(0)
    s_waitcnt vmcnt(11)
    s_barrier
    v_mfma_f32_32x32x16_bf16 v[96:111], v[128:131], a[128:131], v[96:111]
    ds_read_b64_tr_b16 v[136:137], v51 offset:12288
    ds_read_b64_tr_b16 v[138:139], v51 offset:13312
    v_mfma_f32_32x32x16_bf16 v[112:127], v[128:131], a[132:135], v[112:127]
    s_add_u32 m0, s47, 122880
    s_add_u32 s62, s42, 222208
    buffer_load_dwordx4 v35, s[12:15], s62 offen lds
    v_mfma_f32_32x32x16_bf16 v[96:111], v[132:135], a[136:139], v[96:111]
    ds_read_b64_tr_b16 v[140:141], v51 offset:14336
    ds_read_b64_tr_b16 v[142:143], v51 offset:15360
    v_mfma_f32_32x32x16_bf16 v[112:127], v[132:135], a[140:143], v[112:127]
    buffer_load_dwordx4 v36, s[12:15], s62 offen offset:1024 lds
    s_waitcnt lgkmcnt(2)
    v_mfma_f32_32x32x16_bf16 v[96:111], v[136:139], a[144:147], v[96:111]
    ds_read_b64_tr_b16 v[128:129], v51 offset:16384
    ds_read_b64_tr_b16 v[130:131], v51 offset:17408
    v_mfma_f32_32x32x16_bf16 v[112:127], v[136:139], a[148:151], v[112:127]
    buffer_load_dwordx4 v37, s[12:15], s62 offen offset:2048 lds
    s_waitcnt lgkmcnt(2)
    v_mfma_f32_32x32x16_bf16 v[96:111], v[140:143], a[152:155], v[96:111]
    ds_read_b64_tr_b16 v[132:133], v51 offset:18432
    ds_read_b64_tr_b16 v[134:135], v51 offset:19456
    v_mfma_f32_32x32x16_bf16 v[112:127], v[140:143], a[156:159], v[112:127]
    s_waitcnt lgkmcnt(2)
    v_mfma_f32_32x32x16_bf16 v[96:111], v[128:131], a[160:163], v[96:111]
    ds_read_b64_tr_b16 v[136:137], v51 offset:20480
    ds_read_b64_tr_b16 v[138:139], v51 offset:21504
    ds_read_b64_tr_b16 v[140:141], v51 offset:22528
    ds_read_b64_tr_b16 v[142:143], v51 offset:23552
    v_mfma_f32_32x32x16_bf16 v[112:127], v[128:131], a[164:167], v[112:127]
    s_waitcnt lgkmcnt(4)
    v_mfma_f32_32x32x16_bf16 v[96:111], v[132:135], a[168:171], v[96:111]
    v_mfma_f32_32x32x16_bf16 v[112:127], v[132:135], a[172:175], v[112:127]
    s_waitcnt lgkmcnt(0)
    s_waitcnt vmcnt(9)
    s_barrier
    v_mfma_f32_32x32x16_bf16 v[96:111], v[136:139], a[176:179], v[96:111]
    ds_read_b64_tr_b16 v[128:129], v50 offset:36864
    ds_read_b64_tr_b16 v[130:131], v50 offset:37888
    v_mfma_f32_32x32x16_bf16 v[112:127], v[136:139], a[180:183], v[112:127]
    s_add_u32 m0, s47, 135168
    s_add_u32 s62, s42, 332800
    buffer_load_dwordx4 v35, s[12:15], s62 offen lds
    v_mfma_f32_32x32x16_bf16 v[96:111], v[140:143], a[184:187], v[96:111]
    ds_read_b64_tr_b16 v[132:133], v50 offset:38912
    ds_read_b64_tr_b16 v[134:135], v50 offset:39936
    v_mfma_f32_32x32x16_bf16 v[112:127], v[140:143], a[188:191], v[112:127]
    buffer_load_dwordx4 v36, s[12:15], s62 offen offset:1024 lds
    s_waitcnt lgkmcnt(2)
    v_mfma_f32_32x32x16_bf16 v[64:79], v[128:131], a[0:3], 0
    ds_read_b64_tr_b16 v[136:137], v50 offset:40960
    ds_read_b64_tr_b16 v[138:139], v50 offset:41984
    v_mfma_f32_32x32x16_bf16 v[80:95], v[128:131], a[4:7], 0
    buffer_load_dwordx4 v37, s[12:15], s62 offen offset:2048 lds
    s_waitcnt lgkmcnt(2)
    v_mfma_f32_32x32x16_bf16 v[64:79], v[132:135], a[8:11], v[64:79]
    ds_read_b64_tr_b16 v[140:141], v50 offset:43008
    ds_read_b64_tr_b16 v[142:143], v50 offset:44032
    v_mfma_f32_32x32x16_bf16 v[80:95], v[132:135], a[12:15], v[80:95]
    s_waitcnt lgkmcnt(2)
    v_mfma_f32_32x32x16_bf16 v[64:79], v[136:139], a[16:19], v[64:79]
    ds_read_b64_tr_b16 v[128:129], v50 offset:45056
    ds_read_b64_tr_b16 v[130:131], v50 offset:46080
    ds_read_b64_tr_b16 v[132:133], v50 offset:47104
    ds_read_b64_tr_b16 v[134:135], v50 offset:48128
    v_cvt_pk_bf16_f32 v200, v96, v97
    v_cvt_pk_bf16_f32 v201, v98, v99
    v_mfma_f32_32x32x16_bf16 v[80:95], v[136:139], a[20:23], v[80:95]
    v_cvt_pk_bf16_f32 v202, v100, v101
    v_cvt_pk_bf16_f32 v203, v102, v103
    s_add_u32 s64, s49, 1376256
    s_waitcnt lgkmcnt(4)
    v_mfma_f32_32x32x16_bf16 v[64:79], v[140:143], a[24:27], v[64:79]
    v_mfma_f32_32x32x16_bf16 v[80:95], v[140:143], a[28:31], v[80:95]
    s_waitcnt lgkmcnt(0)
    s_waitcnt vmcnt(6)
    s_barrier
    v_mfma_f32_32x32x16_bf16 v[64:79], v[128:131], a[32:35], v[64:79]
    ds_read_b64_tr_b16 v[136:137], v50 offset:49152
    ds_read_b64_tr_b16 v[138:139], v50 offset:50176
    buffer_store_dwordx4 v[200:203], v46, s[16:19], s64 offen offset:0 sc1
    v_mfma_f32_32x32x16_bf16 v[80:95], v[128:131], a[36:39], v[80:95]
    v_cvt_pk_bf16_f32 v204, v104, v105
    v_cvt_pk_bf16_f32 v205, v106, v107
    v_cvt_pk_bf16_f32 v206, v108, v109
    v_cvt_pk_bf16_f32 v207, v110, v111
    v_mfma_f32_32x32x16_bf16 v[64:79], v[132:135], a[40:43], v[64:79]
    ds_read_b64_tr_b16 v[140:141], v50 offset:51200
    ds_read_b64_tr_b16 v[142:143], v50 offset:52224
    v_mfma_f32_32x32x16_bf16 v[80:95], v[132:135], a[44:47], v[80:95]
    buffer_store_dwordx4 v[204:207], v46, s[16:19], s64 offen offset:1024 sc1
    s_waitcnt lgkmcnt(2)
    v_mfma_f32_32x32x16_bf16 v[64:79], v[136:139], a[48:51], v[64:79]
    ds_read_b64_tr_b16 v[128:129], v50 offset:53248
    ds_read_b64_tr_b16 v[130:131], v50 offset:54272
    v_cvt_pk_bf16_f32 v200, v112, v113
    v_cvt_pk_bf16_f32 v201, v114, v115
    v_mfma_f32_32x32x16_bf16 v[80:95], v[136:139], a[52:55], v[80:95]
    v_cvt_pk_bf16_f32 v202, v116, v117
    v_cvt_pk_bf16_f32 v203, v118, v119
    s_waitcnt lgkmcnt(2)
    v_mfma_f32_32x32x16_bf16 v[64:79], v[140:143], a[56:59], v[64:79]
    ds_read_b64_tr_b16 v[132:133], v50 offset:55296
    ds_read_b64_tr_b16 v[134:135], v50 offset:56320
    v_mfma_f32_32x32x16_bf16 v[80:95], v[140:143], a[60:63], v[80:95]
    buffer_store_dwordx4 v[200:203], v46, s[16:19], s64 offen offset:2048 sc1
    s_waitcnt lgkmcnt(2)
    v_mfma_f32_32x32x16_bf16 v[64:79], v[128:131], a[64:67], v[64:79]
    ds_read_b64_tr_b16 v[136:137], v50 offset:57344
    ds_read_b64_tr_b16 v[138:139], v50 offset:58368
    ds_read_b64_tr_b16 v[140:141], v50 offset:59392
    ds_read_b64_tr_b16 v[142:143], v50 offset:60416
    v_cvt_pk_bf16_f32 v204, v120, v121
    v_cvt_pk_bf16_f32 v205, v122, v123
    v_mfma_f32_32x32x16_bf16 v[80:95], v[128:131], a[68:71], v[80:95]
    v_cvt_pk_bf16_f32 v206, v124, v125
    v_cvt_pk_bf16_f32 v207, v126, v127
    s_waitcnt lgkmcnt(4)
    v_mfma_f32_32x32x16_bf16 v[64:79], v[132:135], a[72:75], v[64:79]
    v_mfma_f32_32x32x16_bf16 v[80:95], v[132:135], a[76:79], v[80:95]
    s_waitcnt lgkmcnt(0)
    s_waitcnt vmcnt(6)
    s_barrier
    s_add_u32 s4, s90, 7
    v_mov_b32 v48, s4
    buffer_store_dword v48, v47, s[16:19], 0 offen sc1
    v_mfma_f32_32x32x16_bf16 v[64:79], v[136:139], a[80:83], v[64:79]
    ds_read_b64_tr_b16 v[128:129], v51 offset:0
    ds_read_b64_tr_b16 v[130:131], v51 offset:1024
    buffer_store_dwordx4 v[204:207], v46, s[16:19], s64 offen offset:3072 sc1
    v_mfma_f32_32x32x16_bf16 v[80:95], v[136:139], a[84:87], v[80:95]
    v_mfma_f32_32x32x16_bf16 v[64:79], v[140:143], a[88:91], v[64:79]
    ds_read_b64_tr_b16 v[132:133], v51 offset:2048
    ds_read_b64_tr_b16 v[134:135], v51 offset:3072
    v_mfma_f32_32x32x16_bf16 v[80:95], v[140:143], a[92:95], v[80:95]
    s_waitcnt lgkmcnt(2)
    v_mfma_f32_32x32x16_bf16 v[64:79], v[128:131], a[96:99], v[64:79]
    ds_read_b64_tr_b16 v[136:137], v51 offset:4096
    ds_read_b64_tr_b16 v[138:139], v51 offset:5120
    v_mfma_f32_32x32x16_bf16 v[80:95], v[128:131], a[100:103], v[80:95]
    s_waitcnt lgkmcnt(2)
    v_mfma_f32_32x32x16_bf16 v[64:79], v[132:135], a[104:107], v[64:79]
    ds_read_b64_tr_b16 v[140:141], v51 offset:6144
    ds_read_b64_tr_b16 v[142:143], v51 offset:7168
    v_mfma_f32_32x32x16_bf16 v[80:95], v[132:135], a[108:111], v[80:95]
    s_waitcnt lgkmcnt(2)
    v_mfma_f32_32x32x16_bf16 v[64:79], v[136:139], a[112:115], v[64:79]
    ds_read_b64_tr_b16 v[128:129], v51 offset:8192
    ds_read_b64_tr_b16 v[130:131], v51 offset:9216
    ds_read_b64_tr_b16 v[132:133], v51 offset:10240
    ds_read_b64_tr_b16 v[134:135], v51 offset:11264
    v_mfma_f32_32x32x16_bf16 v[80:95], v[136:139], a[116:119], v[80:95]
    s_waitcnt lgkmcnt(4)
    v_mfma_f32_32x32x16_bf16 v[64:79], v[140:143], a[120:123], v[64:79]
    v_mfma_f32_32x32x16_bf16 v[80:95], v[140:143], a[124:127], v[80:95]
    s_waitcnt lgkmcnt(0)
    s_waitcnt vmcnt(5)
    s_barrier
    v_mfma_f32_32x32x16_bf16 v[64:79], v[128:131], a[128:131], v[64:79]
    ds_read_b64_tr_b16 v[136:137], v51 offset:12288
    ds_read_b64_tr_b16 v[138:139], v51 offset:13312
    v_mfma_f32_32x32x16_bf16 v[80:95], v[128:131], a[132:135], v[80:95]
    v_mfma_f32_32x32x16_bf16 v[64:79], v[132:135], a[136:139], v[64:79]
    ds_read_b64_tr_b16 v[140:141], v51 offset:14336
    ds_read_b64_tr_b16 v[142:143], v51 offset:15360
    v_mfma_f32_32x32x16_bf16 v[80:95], v[132:135], a[140:143], v[80:95]
    s_waitcnt lgkmcnt(2)
    v_mfma_f32_32x32x16_bf16 v[64:79], v[136:139], a[144:147], v[64:79]
    ds_read_b64_tr_b16 v[128:129], v51 offset:16384
    ds_read_b64_tr_b16 v[130:131], v51 offset:17408
    v_mfma_f32_32x32x16_bf16 v[80:95], v[136:139], a[148:151], v[80:95]
    s_waitcnt lgkmcnt(2)
    v_mfma_f32_32x32x16_bf16 v[64:79], v[140:143], a[152:155], v[64:79]
    ds_read_b64_tr_b16 v[132:133], v51 offset:18432
    ds_read_b64_tr_b16 v[134:135], v51 offset:19456
    v_mfma_f32_32x32x16_bf16 v[80:95], v[140:143], a[156:159], v[80:95]
    s_waitcnt lgkmcnt(2)
    v_mfma_f32_32x32x16_bf16 v[64:79], v[128:131], a[160:163], v[64:79]
    ds_read_b64_tr_b16 v[136:137], v51 offset:20480
    ds_read_b64_tr_b16 v[138:139], v51 offset:21504
    ds_read_b64_tr_b16 v[140:141], v51 offset:22528
    ds_read_b64_tr_b16 v[142:143], v51 offset:23552
    v_mfma_f32_32x32x16_bf16 v[80:95], v[128:131], a[164:167], v[80:95]
    s_waitcnt lgkmcnt(4)
    v_mfma_f32_32x32x16_bf16 v[64:79], v[132:135], a[168:171], v[64:79]
    v_mfma_f32_32x32x16_bf16 v[80:95], v[132:135], a[172:175], v[80:95]
    s_waitcnt lgkmcnt(2)
    v_mfma_f32_32x32x16_bf16 v[64:79], v[136:139], a[176:179], v[64:79]
    v_mfma_f32_32x32x16_bf16 v[80:95], v[136:139], a[180:183], v[80:95]
    s_waitcnt lgkmcnt(0)
    v_mfma_f32_32x32x16_bf16 v[64:79], v[140:143], a[184:187], v[64:79]
    v_mfma_f32_32x32x16_bf16 v[80:95], v[140:143], a[188:191], v[80:95]
    s_load_dwordx2 s[54:55], s[0:1], 72
    s_load_dwordx2 s[56:57], s[0:1], 0
    s_load_dwordx2 s[58:59], s[0:1], 96
    s_load_dwordx2 s[60:61], s[0:1], 88

    s_nop 7
    s_nop 3
    v_cvt_pk_bf16_f32 v200, v64, v65
    v_cvt_pk_bf16_f32 v201, v66, v67
    v_cvt_pk_bf16_f32 v202, v68, v69
    v_cvt_pk_bf16_f32 v203, v70, v71
    s_add_u32 s64, s49, 1572864
    buffer_store_dwordx4 v[200:203], v46, s[16:19], s64 offen offset:0 sc1
    v_cvt_pk_bf16_f32 v204, v72, v73
    v_cvt_pk_bf16_f32 v205, v74, v75
    v_cvt_pk_bf16_f32 v206, v76, v77
    v_cvt_pk_bf16_f32 v207, v78, v79
    buffer_store_dwordx4 v[204:207], v46, s[16:19], s64 offen offset:1024 sc1
    v_cvt_pk_bf16_f32 v200, v80, v81
    v_cvt_pk_bf16_f32 v201, v82, v83
    v_cvt_pk_bf16_f32 v202, v84, v85
    v_cvt_pk_bf16_f32 v203, v86, v87
    buffer_store_dwordx4 v[200:203], v46, s[16:19], s64 offen offset:2048 sc1
    v_cvt_pk_bf16_f32 v204, v88, v89
    v_cvt_pk_bf16_f32 v205, v90, v91
    v_cvt_pk_bf16_f32 v206, v92, v93
    v_cvt_pk_bf16_f32 v207, v94, v95
    buffer_store_dwordx4 v[204:207], v46, s[16:19], s64 offen offset:3072 sc1
    s_waitcnt lgkmcnt(0)
    s_mov_b32 s20, s54
    s_mov_b32 s21, s55
    s_mov_b32 s22, 9216
    s_mov_b32 s23, 0x20000

    s_mov_b32 s24, s56
    s_mov_b32 s25, s57
    s_mov_b32 s26, 2359296
    s_mov_b32 s27, 0x20000

    s_mov_b32 s28, s58
    s_mov_b32 s29, s59
    s_mov_b32 s30, 2359296
    s_mov_b32 s31, 0x20000

    s_mov_b32 s32, s60
    s_mov_b32 s33, s61
    s_mov_b32 s34, 1152
    s_mov_b32 s35, 0x20000

    s_mov_b32 s91, s39
    s_and_b32 s92, s40, 3
    s_lshr_b32 s100, s40, 2
    s_add_u32 s100, s100, 6
    s_add_u32 s101, s100, 1

    s_lshr_b32 s93, s36, 1
    s_and_b32 s94, s36, 1
    s_lshl_b32 s95, s91, 7
    s_lshl_b32 s3, s92, 5
    s_add_u32 s95, s95, s3
    s_lshl_b32 s3, s93, 5
    s_lshl_b32 s4, s94, 4
    s_add_u32 s96, s3, s4
    s_lshl_b32 s3, s100, 6
    s_add_u32 s5, s96, s3
    v_and_b32 v8, 15, v60
    v_lshrrev_b32 v9, 5, v60
    v_lshl_add_u32 v8, v9, 4, v8
    v_bfe_u32 v9, v60, 4, 1
    v_add_u32 v10, s95, v8
    v_mul_u32_u24 v10, 1152, v10
    v_lshl_add_u32 v10, v9, 4, v10
    s_lshl_b32 s6, s5, 1
    v_add_u32 v36, s6, v10
    v_lshlrev_b32 v11, 4, v9
    v_add_u32 v41, s6, v11
    s_mul_i32 s3, s91, 9
    s_add_u32 s3, s3, s100
    s_mul_i32 s97, s3, 196608
    s_lshr_b32 s3, s92, 1
    s_lshl_b32 s3, s3, 1
    s_add_u32 s3, s3, s93
    s_lshl_b32 s3, s3, 12
    s_add_u32 s97, s97, s3
    s_and_b32 s3, s92, 1
    s_lshl_b32 s3, s3, 1
    s_add_u32 s3, s3, s94
    s_lshl_b32 s3, s3, 10
    s_add_u32 s97, s97, s3
    s_add_u32 s97, s97, 7340032
    v_lshlrev_b32 v38, 4, v60
    v_lshrrev_b32 v8, 2, v60
    v_lshlrev_b32 v8, 12, v8
    v_and_b32 v9, 3, v60
    v_lshl_add_u32 v42, v9, 4, v8
    s_lshl_b32 s3, s5, 12
    s_lshl_b32 s4, s95, 1
    s_add_u32 s3, s3, s4
    s_add_u32 s98, s3, 4718592
    s_mul_i32 s99, s36, 6144
    v_bfe_u32 v9, v60, 2, 2
    v_bfe_u32 v10, v60, 4, 1
    v_lshl_add_u32 v9, v10, 3, v9
    v_lshlrev_b32 v9, 6, v9
    v_lshrrev_b32 v10, 5, v60
    v_lshl_add_u32 v9, v10, 5, v9
    v_and_b32 v10, 3, v60
    v_lshl_add_u32 v9, v10, 3, v9
    v_add_u32 v39, s99, v9
    v_and_b32 v12, 15, v60
    v_lshrrev_b32 v13, 4, v60
    v_lshrrev_b32 v14, 3, v12
    v_and_b32 v15, 7, v12
    v_lshrrev_b32 v16, 1, v15
    v_and_b32 v17, 1, v15
    v_lshlrev_b32 v17, 4, v17
    v_mov_b32 v18, 0x3f80
    v_lshlrev_b32 v18, v17, v18
    v_add_u32 v19, 2, v14

    v_cmp_eq_u32 s[50:51], v13, v14
    v_cmp_eq_u32 vcc, 0, v16
    s_nop 1
    s_and_b64 vcc, vcc, s[50:51]
    s_nop 1
    v_cndmask_b32 v88, 0, v18, vcc
    v_cmp_eq_u32 vcc, 1, v16
    s_nop 1
    s_and_b64 vcc, vcc, s[50:51]
    s_nop 1
    v_cndmask_b32 v89, 0, v18, vcc
    v_cmp_eq_u32 vcc, 2, v16
    s_nop 1
    s_and_b64 vcc, vcc, s[50:51]
    s_nop 1
    v_cndmask_b32 v90, 0, v18, vcc
    v_cmp_eq_u32 vcc, 3, v16
    s_nop 1
    s_and_b64 vcc, vcc, s[50:51]
    s_nop 1
    v_cndmask_b32 v91, 0, v18, vcc
    v_cmp_eq_u32 s[50:51], v13, v19
    v_cmp_eq_u32 vcc, 0, v16
    s_nop 1
    s_and_b64 vcc, vcc, s[50:51]
    s_nop 1
    v_cndmask_b32 v92, 0, v18, vcc
    v_cmp_eq_u32 vcc, 1, v16
    s_nop 1
    s_and_b64 vcc, vcc, s[50:51]
    s_nop 1
    v_cndmask_b32 v93, 0, v18, vcc
    v_cmp_eq_u32 vcc, 2, v16
    s_nop 1
    s_and_b64 vcc, vcc, s[50:51]
    s_nop 1
    v_cndmask_b32 v94, 0, v18, vcc
    v_cmp_eq_u32 vcc, 3, v16
    s_nop 1
    s_and_b64 vcc, vcc, s[50:51]
    s_nop 1
    v_cndmask_b32 v95, 0, v18, vcc
    buffer_load_dwordx4 v[64:67], v36, s[24:27], 0 offen offset:0
    buffer_load_dwordx4 v[228:231], v41, s[32:35], 0 offen offset:0
    v_lshlrev_b32 v37, 6, v60
    v_add_u32 v37, 42057728, v37
    buffer_load_dword v43, v37, s[16:19], 0 offen sc1
    s_waitcnt vmcnt(3)
    s_add_u32 s4, s90, 9
    v_mov_b32 v48, s4
    buffer_store_dword v48, v47, s[16:19], 0 offen sc1
    s_waitcnt vmcnt(1)
    s_add_u32 s4, s90, 1
    v_subrev_u32 v7, s4, v43
    v_cmp_le_u32 vcc, 15, v7
    s_nop 3
    s_cmp_eq_u64 vcc, 0
    s_cbranch_scc1 L_ok_6
    s_mov_b32 s69, 20000
    L_poll_5:
    buffer_load_dword v43, v37, s[16:19], 0 offen sc1
    s_waitcnt vmcnt(0)
    s_add_u32 s4, s90, 1
    v_subrev_u32 v7, s4, v43
    v_cmp_le_u32 vcc, 15, v7
    s_sub_u32 s69, s69, 1
    s_cbranch_scc1 L_ok_6
    s_nop 1
    s_cmp_eq_u64 vcc, 0
    s_cbranch_scc1 L_ok_6
    s_sleep 8
    s_branch L_poll_5
    L_ok_6:
    s_or_b32 s4, s2, s36
    s_cmp_lg_u32 s4, 0
    s_cbranch_scc1 L_tag_7
    v_mov_b32 v61, 0x7ffffff0
    v_mov_b32 v62, 42070016
    v_cmp_eq_u32 vcc, 0, v60
    v_mov_b32 v63, s90
    s_nop 0
    v_cndmask_b32 v61, v61, v62, vcc
    buffer_store_dword v63, v61, s[16:19], 0 offen sc1
    L_tag_7:

    s_add_u32 m0, s99, 0
    s_add_u32 s50, s98, 0
    buffer_load_dwordx4 v42, s[16:19], s50 offen sc1 lds
    v_min_u32 v8, 11, v60
    s_mul_i32 s3, s91, 12
    v_add_u32 v8, s3, v8
    v_lshlrev_b32 v8, 2, v8
    s_lshr_b32 s3, s92, 1
    s_lshl_b32 s3, s3, 1
    s_add_u32 s3, s3, s93
    v_add_u32 v8, s3, v8
    v_lshlrev_b32 v8, 6, v8
    v_add_u32 v37, 42008576, v8

    s_mov_b32 s69, 20000
    L_poll_8:
    buffer_load_dword v40, v37, s[16:19], 0 offen sc1
    s_waitcnt vmcnt(0)
    s_add_u32 s4, s90, s101
    s_sub_u32 s5, 16, s101
    v_subrev_u32 v7, s4, v40
    v_cmp_le_u32 vcc, s5, v7
    s_sub_u32 s69, s69, 1
    s_cbranch_scc1 L_ok_9
    s_nop 1
    s_cmp_eq_u64 vcc, 0
    s_cbranch_scc1 L_ok_9
    s_sleep 2
    s_branch L_poll_8
    L_ok_9:
    s_add_u32 s50, s97, 0
    buffer_load_dwordx4 a[0:3], v38, s[16:19], s50 offen sc1
    s_add_u32 s50, s50, 16384
    buffer_load_dwordx4 a[4:7], v38, s[16:19], s50 offen sc1
    s_add_u32 s50, s50, 16384
    buffer_load_dwordx4 a[8:11], v38, s[16:19], s50 offen sc1
    s_add_u32 s50, s50, 16384
    buffer_load_dwordx4 a[12:15], v38, s[16:19], s50 offen sc1
    s_add_u32 s50, s50, 16384
    buffer_load_dwordx4 a[16:19], v38, s[16:19], s50 offen sc1
    s_add_u32 s50, s50, 16384
    buffer_load_dwordx4 a[20:23], v38, s[16:19], s50 offen sc1
    s_add_u32 s50, s50, 16384
    buffer_load_dwordx4 a[24:27], v38, s[16:19], s50 offen sc1
    s_add_u32 s50, s50, 16384
    buffer_load_dwordx4 a[28:31], v38, s[16:19], s50 offen sc1
    s_add_u32 s50, s50, 16384
    buffer_load_dwordx4 a[32:35], v38, s[16:19], s50 offen sc1
    s_add_u32 s50, s50, 16384
    buffer_load_dwordx4 a[36:39], v38, s[16:19], s50 offen sc1
    s_add_u32 s50, s50, 16384
    buffer_load_dwordx4 a[40:43], v38, s[16:19], s50 offen sc1
    s_add_u32 s50, s50, 16384
    buffer_load_dwordx4 a[44:47], v38, s[16:19], s50 offen sc1
    s_waitcnt vmcnt(0)
    ds_read_b64_tr_b16 v[20:21], v39 offset:0
    ds_read_b64_tr_b16 v[22:23], v39 offset:256
    v_mfma_f32_16x16x32_bf16 v[8:11], v[88:91], a[0:3], 0
    v_mfma_f32_16x16x32_bf16 v[12:15], v[92:95], a[0:3], 0
    v_mfma_f32_16x16x32_bf16 v[8:11], v[88:91], a[4:7], v[8:11]
    v_mfma_f32_16x16x32_bf16 v[12:15], v[92:95], a[4:7], v[12:15]
    v_mfma_f32_16x16x32_bf16 v[8:11], v[88:91], a[8:11], v[8:11]
    v_mfma_f32_16x16x32_bf16 v[12:15], v[92:95], a[8:11], v[12:15]
    v_mfma_f32_16x16x32_bf16 v[8:11], v[88:91], a[12:15], v[8:11]
    v_mfma_f32_16x16x32_bf16 v[12:15], v[92:95], a[12:15], v[12:15]
    v_mfma_f32_16x16x32_bf16 v[8:11], v[88:91], a[16:19], v[8:11]
    v_mfma_f32_16x16x32_bf16 v[12:15], v[92:95], a[16:19], v[12:15]
    v_mfma_f32_16x16x32_bf16 v[8:11], v[88:91], a[20:23], v[8:11]
    v_mfma_f32_16x16x32_bf16 v[12:15], v[92:95], a[20:23], v[12:15]
    v_mfma_f32_16x16x32_bf16 v[8:11], v[88:91], a[24:27], v[8:11]
    v_mfma_f32_16x16x32_bf16 v[12:15], v[92:95], a[24:27], v[12:15]
    v_mfma_f32_16x16x32_bf16 v[8:11], v[88:91], a[28:31], v[8:11]
    v_mfma_f32_16x16x32_bf16 v[12:15], v[92:95], a[28:31], v[12:15]
    v_mfma_f32_16x16x32_bf16 v[8:11], v[88:91], a[32:35], v[8:11]
    v_mfma_f32_16x16x32_bf16 v[12:15], v[92:95], a[32:35], v[12:15]
    v_mfma_f32_16x16x32_bf16 v[8:11], v[88:91], a[36:39], v[8:11]
    v_mfma_f32_16x16x32_bf16 v[12:15], v[92:95], a[36:39], v[12:15]
    v_mfma_f32_16x16x32_bf16 v[8:11], v[88:91], a[40:43], v[8:11]
    v_mfma_f32_16x16x32_bf16 v[12:15], v[92:95], a[40:43], v[12:15]
    v_mfma_f32_16x16x32_bf16 v[8:11], v[88:91], a[44:47], v[8:11]
    v_mfma_f32_16x16x32_bf16 v[12:15], v[92:95], a[44:47], v[12:15]
    s_nop 7
    v_cvt_pk_bf16_f32 v16, v8, v9
    v_cvt_pk_bf16_f32 v17, v10, v11
    v_cvt_pk_bf16_f32 v18, v12, v13
    v_cvt_pk_bf16_f32 v19, v14, v15
    s_waitcnt lgkmcnt(0)
    v_lshlrev_b32 v44, 16, v16
    v_and_b32 v45, 0xffff0000, v16
    v_lshlrev_b32 v46, 16, v17
    v_and_b32 v47, 0xffff0000, v17
    v_lshlrev_b32 v48, 16, v18
    v_and_b32 v49, 0xffff0000, v18
    v_lshlrev_b32 v50, 16, v19
    v_and_b32 v51, 0xffff0000, v19
    v_lshlrev_b32 v52, 16, v228
    v_and_b32 v53, 0xffff0000, v228
    v_lshlrev_b32 v54, 16, v229
    v_and_b32 v55, 0xffff0000, v229
    v_lshlrev_b32 v56, 16, v230
    v_and_b32 v57, 0xffff0000, v230
    v_lshlrev_b32 v58, 16, v231
    v_and_b32 v59, 0xffff0000, v231
    v_pk_add_f32 v[44:45], v[44:45], v[52:53]
    v_pk_add_f32 v[46:47], v[46:47], v[54:55]
    v_pk_add_f32 v[48:49], v[48:49], v[56:57]
    v_pk_add_f32 v[50:51], v[50:51], v[58:59]
    v_cvt_pk_bf16_f32 v16, v44, v45
    v_cvt_pk_bf16_f32 v17, v46, v47
    v_cvt_pk_bf16_f32 v18, v48, v49
    v_cvt_pk_bf16_f32 v19, v50, v51
    v_lshlrev_b32 v44, 16, v16
    v_and_b32 v45, 0xffff0000, v16
    v_lshlrev_b32 v46, 16, v17
    v_and_b32 v47, 0xffff0000, v17
    v_lshlrev_b32 v48, 16, v18
    v_and_b32 v49, 0xffff0000, v18
    v_lshlrev_b32 v50, 16, v19
    v_and_b32 v51, 0xffff0000, v19
    v_mul_f32 v52, 0xbfb8aa3b, v44
    v_mul_f32 v53, 0xbfb8aa3b, v45
    v_mul_f32 v54, 0xbfb8aa3b, v46
    v_mul_f32 v55, 0xbfb8aa3b, v47
    v_mul_f32 v56, 0xbfb8aa3b, v48
    v_mul_f32 v57, 0xbfb8aa3b, v49
    v_mul_f32 v58, 0xbfb8aa3b, v50
    v_mul_f32 v59, 0xbfb8aa3b, v51
    v_exp_f32 v52, v52
    v_exp_f32 v53, v53
    v_exp_f32 v54, v54
    v_exp_f32 v55, v55
    v_exp_f32 v56, v56
    v_exp_f32 v57, v57
    v_exp_f32 v58, v58
    v_exp_f32 v59, v59
    v_add_f32 v52, 1.0, v52
    v_add_f32 v53, 1.0, v53
    v_add_f32 v54, 1.0, v54
    v_add_f32 v55, 1.0, v55
    v_add_f32 v56, 1.0, v56
    v_add_f32 v57, 1.0, v57
    v_add_f32 v58, 1.0, v58
    v_add_f32 v59, 1.0, v59
    v_rcp_f32 v52, v52
    v_rcp_f32 v53, v53
    v_rcp_f32 v54, v54
    v_rcp_f32 v55, v55
    v_rcp_f32 v56, v56
    v_rcp_f32 v57, v57
    v_rcp_f32 v58, v58
    v_rcp_f32 v59, v59
    s_nop 0
    v_pk_mul_f32 v[44:45], v[44:45], v[52:53]
    v_pk_mul_f32 v[46:47], v[46:47], v[54:55]
    v_pk_mul_f32 v[48:49], v[48:49], v[56:57]
    v_pk_mul_f32 v[50:51], v[50:51], v[58:59]
    v_cvt_pk_bf16_f32 v16, v44, v45
    v_cvt_pk_bf16_f32 v17, v46, v47
    v_cvt_pk_bf16_f32 v18, v48, v49
    v_cvt_pk_bf16_f32 v19, v50, v51
    v_lshlrev_b32 v44, 16, v16
    v_and_b32 v45, 0xffff0000, v16
    v_lshlrev_b32 v46, 16, v17
    v_and_b32 v47, 0xffff0000, v17
    v_lshlrev_b32 v48, 16, v18
    v_and_b32 v49, 0xffff0000, v18
    v_lshlrev_b32 v50, 16, v19
    v_and_b32 v51, 0xffff0000, v19
    v_lshlrev_b32 v52, 16, v20
    v_and_b32 v53, 0xffff0000, v20
    v_lshlrev_b32 v54, 16, v21
    v_and_b32 v55, 0xffff0000, v21
    v_lshlrev_b32 v56, 16, v22
    v_and_b32 v57, 0xffff0000, v22
    v_lshlrev_b32 v58, 16, v23
    v_and_b32 v59, 0xffff0000, v23
    v_pk_mul_f32 v[44:45], v[44:45], v[52:53]
    v_pk_mul_f32 v[46:47], v[46:47], v[54:55]
    v_pk_mul_f32 v[48:49], v[48:49], v[56:57]
    v_pk_mul_f32 v[50:51], v[50:51], v[58:59]
    v_cvt_pk_bf16_f32 v16, v44, v45
    v_cvt_pk_bf16_f32 v17, v46, v47
    v_cvt_pk_bf16_f32 v18, v48, v49
    v_cvt_pk_bf16_f32 v19, v50, v51
    v_lshlrev_b32 v44, 16, v16
    v_and_b32 v45, 0xffff0000, v16
    v_lshlrev_b32 v46, 16, v17
    v_and_b32 v47, 0xffff0000, v17
    v_lshlrev_b32 v48, 16, v18
    v_and_b32 v49, 0xffff0000, v18
    v_lshlrev_b32 v50, 16, v19
    v_and_b32 v51, 0xffff0000, v19
    v_lshlrev_b32 v52, 16, v64
    v_and_b32 v53, 0xffff0000, v64
    v_lshlrev_b32 v54, 16, v65
    v_and_b32 v55, 0xffff0000, v65
    v_lshlrev_b32 v56, 16, v66
    v_and_b32 v57, 0xffff0000, v66
    v_lshlrev_b32 v58, 16, v67
    v_and_b32 v59, 0xffff0000, v67
    v_pk_add_f32 v[44:45], v[44:45], v[52:53]
    v_pk_add_f32 v[46:47], v[46:47], v[54:55]
    v_pk_add_f32 v[48:49], v[48:49], v[56:57]
    v_pk_add_f32 v[50:51], v[50:51], v[58:59]
    v_cvt_pk_bf16_f32 v24, v44, v45
    v_cvt_pk_bf16_f32 v25, v46, v47
    v_cvt_pk_bf16_f32 v26, v48, v49
    v_cvt_pk_bf16_f32 v27, v50, v51
    buffer_store_dwordx4 v[24:27], v36, s[28:31], 0 offen offset:0
    s_waitcnt vmcnt(0)
    s_branch L_main_done
    L_conv_role:
    v_and_b32 v65, 31, v0
    v_lshrrev_b32 v66, 5, v0
    s_lshl_b32 s91, s2, 3
    v_add_u32 v67, s91, v66
    v_mul_u32_u24 v67, 1152, v67
    v_lshl_add_u32 v67, v65, 2, v67

    buffer_load_dword v92, v67, s[24:27], 0 offen offset:0
    buffer_load_dword v93, v67, s[24:27], 0 offen offset:128
    buffer_load_dword v94, v67, s[24:27], 0 offen offset:256
    buffer_load_dword v95, v67, s[24:27], 0 offen offset:384
    buffer_load_dword v96, v67, s[24:27], 0 offen offset:512
    buffer_load_dword v97, v67, s[24:27], 0 offen offset:640
    buffer_load_dword v98, v67, s[24:27], 0 offen offset:768
    buffer_load_dword v99, v67, s[24:27], 0 offen offset:896
    buffer_load_dword v100, v67, s[24:27], 0 offen offset:1024
    v_mov_b32 v120, 42070016

    buffer_load_dword v121, v120, s[16:19], 0 offen sc1

    v_mul_u32_u24 v68, 1184, v66
    v_lshl_add_u32 v68, v65, 2, v68
    v_add_u32 v68, 0, v68
    v_lshrrev_b32 v69, 6, v0
    v_mul_u32_u24 v69, 2304, v69
    v_bfe_u32 v70, v0, 5, 1
    v_lshlrev_b32 v71, 3, v65
    v_lshl_add_u32 v71, v70, 2, v71
    v_add_u32 v69, v69, v71
    v_add_u32 v69, 9472, v69
    v_mov_b32 v72, 0x05040100
    v_mov_b32 v73, 0x07060302
    v_cmp_eq_u32 vcc, 1, v70
    s_nop 1
    v_cndmask_b32 v72, v72, v73, vcc
    s_waitcnt vmcnt(0)
    v_add_u32 v121, 16, v121
    v_and_b32 v121, 0xfffffff0, v121
    v_or_b32 v121, 0x80000000, v121
    s_nop 0
    v_readfirstlane_b32 s90, v121

    v_lshlrev_b32 v74, 16, v92
    v_and_b32 v75, 0xffff0000, v92
    v_lshlrev_b32 v76, 16, v93
    v_and_b32 v77, 0xffff0000, v93
    v_lshlrev_b32 v78, 16, v94
    v_and_b32 v79, 0xffff0000, v94
    v_lshlrev_b32 v80, 16, v95
    v_and_b32 v81, 0xffff0000, v95
    v_lshlrev_b32 v82, 16, v96
    v_and_b32 v83, 0xffff0000, v96
    v_lshlrev_b32 v84, 16, v97
    v_and_b32 v85, 0xffff0000, v97
    v_lshlrev_b32 v86, 16, v98
    v_and_b32 v87, 0xffff0000, v98
    v_lshlrev_b32 v88, 16, v99
    v_and_b32 v89, 0xffff0000, v99
    v_lshlrev_b32 v90, 16, v100
    v_and_b32 v91, 0xffff0000, v100
    v_pk_add_f32 v[106:107], v[74:75], v[76:77]
    v_pk_add_f32 v[106:107], v[106:107], v[78:79]
    v_pk_add_f32 v[106:107], v[106:107], v[80:81]
    v_pk_add_f32 v[106:107], v[106:107], v[82:83]
    v_pk_add_f32 v[106:107], v[106:107], v[84:85]
    v_pk_add_f32 v[106:107], v[106:107], v[86:87]
    v_pk_add_f32 v[106:107], v[106:107], v[88:89]
    v_pk_add_f32 v[106:107], v[106:107], v[90:91]
    v_add_f32 v102, v106, v107
    s_nop 1
    v_add_f32_dpp v102, v102, v102 quad_perm:[1,0,3,2] row_mask:0xf bank_mask:0xf
    s_nop 1
    v_add_f32_dpp v102, v102, v102 quad_perm:[2,3,0,1] row_mask:0xf bank_mask:0xf
    s_nop 1
    v_add_f32_dpp v102, v102, v102 row_half_mirror row_mask:0xf bank_mask:0xf
    s_nop 1
    v_add_f32_dpp v102, v102, v102 row_mirror row_mask:0xf bank_mask:0xf
    s_nop 0
    v_mov_b32 v103, v102
    s_nop 1
    v_permlane16_swap_b32 v102, v103
    s_nop 1
    v_add_f32 v102, v102, v103

    v_mul_f32 v102, 0x3ae38e39, v102
    v_sub_f32 v104, 0, v102
    v_mov_b32 v105, v104
    v_pk_add_f32 v[108:109], v[74:75], v[104:105]
    v_pk_mul_f32 v[106:107], v[108:109], v[108:109]
    v_pk_add_f32 v[108:109], v[76:77], v[104:105]
    v_pk_fma_f32 v[106:107], v[108:109], v[108:109], v[106:107]
    v_pk_add_f32 v[108:109], v[78:79], v[104:105]
    v_pk_fma_f32 v[106:107], v[108:109], v[108:109], v[106:107]
    v_pk_add_f32 v[108:109], v[80:81], v[104:105]
    v_pk_fma_f32 v[106:107], v[108:109], v[108:109], v[106:107]
    v_pk_add_f32 v[108:109], v[82:83], v[104:105]
    v_pk_fma_f32 v[106:107], v[108:109], v[108:109], v[106:107]
    v_pk_add_f32 v[108:109], v[84:85], v[104:105]
    v_pk_fma_f32 v[106:107], v[108:109], v[108:109], v[106:107]
    v_pk_add_f32 v[108:109], v[86:87], v[104:105]
    v_pk_fma_f32 v[106:107], v[108:109], v[108:109], v[106:107]
    v_pk_add_f32 v[108:109], v[88:89], v[104:105]
    v_pk_fma_f32 v[106:107], v[108:109], v[108:109], v[106:107]
    v_pk_add_f32 v[108:109], v[90:91], v[104:105]
    v_pk_fma_f32 v[106:107], v[108:109], v[108:109], v[106:107]
    v_add_f32 v106, v106, v107
    s_nop 1
    v_add_f32_dpp v106, v106, v106 quad_perm:[1,0,3,2] row_mask:0xf bank_mask:0xf
    s_nop 1
    v_add_f32_dpp v106, v106, v106 quad_perm:[2,3,0,1] row_mask:0xf bank_mask:0xf
    s_nop 1
    v_add_f32_dpp v106, v106, v106 row_half_mirror row_mask:0xf bank_mask:0xf
    s_nop 1
    v_add_f32_dpp v106, v106, v106 row_mirror row_mask:0xf bank_mask:0xf
    s_nop 0
    v_mov_b32 v103, v106
    s_nop 1
    v_permlane16_swap_b32 v106, v103
    s_nop 1
    v_add_f32 v106, v106, v103

    v_mul_f32 v106, 0x3ae38e39, v106
    v_cvt_pk_bf16_f32 v106, v106, v106
    v_and_b32 v106, 0xffff0000, v106
    v_add_f32 v106, 0x3727c5ac, v106
    v_cvt_pk_bf16_f32 v106, v106, v106
    v_and_b32 v106, 0xffff0000, v106
    v_sqrt_f32 v106, v106
    s_nop 0
    v_cvt_pk_bf16_f32 v106, v106, v106
    v_and_b32 v106, 0xffff0000, v106
    v_rcp_f32 v108, v106
    v_cvt_pk_bf16_f32 v102, v102, v102
    v_and_b32 v102, 0xffff0000, v102
    v_sub_f32 v104, 0, v102
    v_mov_b32 v105, v104
    v_mov_b32 v109, v108
    v_pk_add_f32 v[74:75], v[74:75], v[104:105]
    v_cvt_pk_bf16_f32 v92, v74, v75
    v_pk_add_f32 v[76:77], v[76:77], v[104:105]
    v_cvt_pk_bf16_f32 v93, v76, v77
    v_pk_add_f32 v[78:79], v[78:79], v[104:105]
    v_cvt_pk_bf16_f32 v94, v78, v79
    v_pk_add_f32 v[80:81], v[80:81], v[104:105]
    v_cvt_pk_bf16_f32 v95, v80, v81
    v_pk_add_f32 v[82:83], v[82:83], v[104:105]
    v_cvt_pk_bf16_f32 v96, v82, v83
    v_pk_add_f32 v[84:85], v[84:85], v[104:105]
    v_cvt_pk_bf16_f32 v97, v84, v85
    v_pk_add_f32 v[86:87], v[86:87], v[104:105]
    v_cvt_pk_bf16_f32 v98, v86, v87
    v_pk_add_f32 v[88:89], v[88:89], v[104:105]
    v_cvt_pk_bf16_f32 v99, v88, v89
    v_pk_add_f32 v[90:91], v[90:91], v[104:105]
    v_cvt_pk_bf16_f32 v100, v90, v91
    v_lshlrev_b32 v74, 16, v92
    v_and_b32 v75, 0xffff0000, v92
    v_pk_mul_f32 v[74:75], v[74:75], v[108:109]
    v_cvt_pk_bf16_f32 v92, v74, v75
    v_lshlrev_b32 v76, 16, v93
    v_and_b32 v77, 0xffff0000, v93
    v_pk_mul_f32 v[76:77], v[76:77], v[108:109]
    v_cvt_pk_bf16_f32 v93, v76, v77
    v_lshlrev_b32 v78, 16, v94
    v_and_b32 v79, 0xffff0000, v94
    v_pk_mul_f32 v[78:79], v[78:79], v[108:109]
    v_cvt_pk_bf16_f32 v94, v78, v79
    v_lshlrev_b32 v80, 16, v95
    v_and_b32 v81, 0xffff0000, v95
    v_pk_mul_f32 v[80:81], v[80:81], v[108:109]
    v_cvt_pk_bf16_f32 v95, v80, v81
    v_lshlrev_b32 v82, 16, v96
    v_and_b32 v83, 0xffff0000, v96
    v_pk_mul_f32 v[82:83], v[82:83], v[108:109]
    v_cvt_pk_bf16_f32 v96, v82, v83
    v_lshlrev_b32 v84, 16, v97
    v_and_b32 v85, 0xffff0000, v97
    v_pk_mul_f32 v[84:85], v[84:85], v[108:109]
    v_cvt_pk_bf16_f32 v97, v84, v85
    v_lshlrev_b32 v86, 16, v98
    v_and_b32 v87, 0xffff0000, v98
    v_pk_mul_f32 v[86:87], v[86:87], v[108:109]
    v_cvt_pk_bf16_f32 v98, v86, v87
    v_lshlrev_b32 v88, 16, v99
    v_and_b32 v89, 0xffff0000, v99
    v_pk_mul_f32 v[88:89], v[88:89], v[108:109]
    v_cvt_pk_bf16_f32 v99, v88, v89
    v_lshlrev_b32 v90, 16, v100
    v_and_b32 v91, 0xffff0000, v100
    v_pk_mul_f32 v[90:91], v[90:91], v[108:109]
    v_cvt_pk_bf16_f32 v100, v90, v91
    v_lshlrev_b32 v74, 16, v92
    v_and_b32 v75, 0xffff0000, v92
    v_lshlrev_b32 v76, 16, v93
    v_and_b32 v77, 0xffff0000, v93
    v_lshlrev_b32 v78, 16, v94
    v_and_b32 v79, 0xffff0000, v94
    v_lshlrev_b32 v80, 16, v95
    v_and_b32 v81, 0xffff0000, v95
    v_lshlrev_b32 v82, 16, v96
    v_and_b32 v83, 0xffff0000, v96
    v_lshlrev_b32 v84, 16, v97
    v_and_b32 v85, 0xffff0000, v97
    v_lshlrev_b32 v86, 16, v98
    v_and_b32 v87, 0xffff0000, v98
    v_lshlrev_b32 v88, 16, v99
    v_and_b32 v89, 0xffff0000, v99
    v_lshlrev_b32 v90, 16, v100
    v_and_b32 v91, 0xffff0000, v100
    v_cvt_pk_f16_f32 v110, v74, v75
    v_cvt_pk_f16_f32 v111, v76, v77
    v_cvt_pk_f16_f32 v112, v78, v79
    v_cvt_pk_f16_f32 v113, v80, v81
    v_cvt_pk_f16_f32 v114, v82, v83
    v_cvt_pk_f16_f32 v115, v84, v85
    v_cvt_pk_f16_f32 v116, v86, v87
    v_cvt_pk_f16_f32 v117, v88, v89
    v_cvt_pk_f16_f32 v118, v90, v91
    v_mov_b32 v124, v110
    v_mov_b32 v125, v111
    v_mov_b32 v126, v112
    v_mov_b32 v127, v113
    v_mov_b32 v128, v114
    v_mov_b32 v129, v115
    v_mov_b32 v130, v116
    v_mov_b32 v131, v117
    v_mov_b32 v132, v118
    v_permlane32_swap_b32 v110, v124
    v_permlane32_swap_b32 v111, v125
    v_permlane32_swap_b32 v112, v126
    v_permlane32_swap_b32 v113, v127
    v_permlane32_swap_b32 v114, v128
    v_permlane32_swap_b32 v115, v129
    v_permlane32_swap_b32 v116, v130
    v_permlane32_swap_b32 v117, v131
    v_permlane32_swap_b32 v118, v132
    s_nop 0
    v_perm_b32 v110, v124, v110, v72
    v_perm_b32 v111, v125, v111, v72
    v_perm_b32 v112, v126, v112, v72
    v_perm_b32 v113, v127, v113, v72
    v_perm_b32 v114, v128, v114, v72
    v_perm_b32 v115, v129, v115, v72
    v_perm_b32 v116, v130, v116, v72
    v_perm_b32 v117, v131, v117, v72
    v_perm_b32 v118, v132, v118, v72
    ds_write_b32 v69, v110 offset:0
    ds_write_b32 v69, v111 offset:256
    ds_write_b32 v69, v112 offset:512
    ds_write_b32 v69, v113 offset:768
    ds_write_b32 v69, v114 offset:1024
    ds_write_b32 v69, v115 offset:1280
    ds_write_b32 v69, v116 offset:1536
    ds_write_b32 v69, v117 offset:1792
    ds_write_b32 v69, v118 offset:2048
    v_pk_add_f32 v[106:107], v[74:75], v[76:77]
    v_pk_add_f32 v[106:107], v[106:107], v[78:79]
    v_pk_add_f32 v[106:107], v[106:107], v[80:81]
    v_pk_add_f32 v[106:107], v[106:107], v[82:83]
    v_pk_add_f32 v[106:107], v[106:107], v[84:85]
    v_pk_add_f32 v[106:107], v[106:107], v[86:87]
    v_pk_add_f32 v[106:107], v[106:107], v[88:89]
    v_pk_add_f32 v[106:107], v[106:107], v[90:91]
    v_add_f32 v102, v106, v107
    s_nop 1
    v_add_f32_dpp v102, v102, v102 quad_perm:[1,0,3,2] row_mask:0xf bank_mask:0xf
    s_nop 1
    v_add_f32_dpp v102, v102, v102 quad_perm:[2,3,0,1] row_mask:0xf bank_mask:0xf
    s_nop 1
    v_add_f32_dpp v102, v102, v102 row_half_mirror row_mask:0xf bank_mask:0xf
    s_nop 1
    v_add_f32_dpp v102, v102, v102 row_mirror row_mask:0xf bank_mask:0xf
    s_nop 0
    v_mov_b32 v103, v102
    s_nop 1
    v_permlane16_swap_b32 v102, v103
    s_nop 1
    v_add_f32 v102, v102, v103

    v_mul_f32 v102, 0x3ae38e39, v102
    v_sub_f32 v104, 0, v102
    v_mov_b32 v105, v104
    v_pk_add_f32 v[108:109], v[74:75], v[104:105]
    v_pk_mul_f32 v[106:107], v[108:109], v[108:109]
    v_pk_add_f32 v[108:109], v[76:77], v[104:105]
    v_pk_fma_f32 v[106:107], v[108:109], v[108:109], v[106:107]
    v_pk_add_f32 v[108:109], v[78:79], v[104:105]
    v_pk_fma_f32 v[106:107], v[108:109], v[108:109], v[106:107]
    v_pk_add_f32 v[108:109], v[80:81], v[104:105]
    v_pk_fma_f32 v[106:107], v[108:109], v[108:109], v[106:107]
    v_pk_add_f32 v[108:109], v[82:83], v[104:105]
    v_pk_fma_f32 v[106:107], v[108:109], v[108:109], v[106:107]
    v_pk_add_f32 v[108:109], v[84:85], v[104:105]
    v_pk_fma_f32 v[106:107], v[108:109], v[108:109], v[106:107]
    v_pk_add_f32 v[108:109], v[86:87], v[104:105]
    v_pk_fma_f32 v[106:107], v[108:109], v[108:109], v[106:107]
    v_pk_add_f32 v[108:109], v[88:89], v[104:105]
    v_pk_fma_f32 v[106:107], v[108:109], v[108:109], v[106:107]
    v_pk_add_f32 v[108:109], v[90:91], v[104:105]
    v_pk_fma_f32 v[106:107], v[108:109], v[108:109], v[106:107]
    v_add_f32 v106, v106, v107
    s_nop 1
    v_add_f32_dpp v106, v106, v106 quad_perm:[1,0,3,2] row_mask:0xf bank_mask:0xf
    s_nop 1
    v_add_f32_dpp v106, v106, v106 quad_perm:[2,3,0,1] row_mask:0xf bank_mask:0xf
    s_nop 1
    v_add_f32_dpp v106, v106, v106 row_half_mirror row_mask:0xf bank_mask:0xf
    s_nop 1
    v_add_f32_dpp v106, v106, v106 row_mirror row_mask:0xf bank_mask:0xf
    s_nop 0
    v_mov_b32 v103, v106
    s_nop 1
    v_permlane16_swap_b32 v106, v103
    s_nop 1
    v_add_f32 v106, v106, v103

    v_mul_f32 v106, 0x3ae38e39, v106
    v_cvt_pk_bf16_f32 v106, v106, v106
    v_and_b32 v106, 0xffff0000, v106
    v_add_f32 v106, 0x3727c5ac, v106
    v_cvt_pk_bf16_f32 v106, v106, v106
    v_and_b32 v106, 0xffff0000, v106
    v_sqrt_f32 v106, v106
    s_nop 0
    v_cvt_pk_bf16_f32 v106, v106, v106
    v_and_b32 v106, 0xffff0000, v106
    v_rcp_f32 v108, v106
    v_cvt_pk_bf16_f32 v102, v102, v102
    v_and_b32 v102, 0xffff0000, v102
    v_sub_f32 v104, 0, v102
    v_mov_b32 v105, v104
    v_mov_b32 v109, v108
    v_pk_add_f32 v[74:75], v[74:75], v[104:105]
    v_cvt_pk_bf16_f32 v92, v74, v75
    v_pk_add_f32 v[76:77], v[76:77], v[104:105]
    v_cvt_pk_bf16_f32 v93, v76, v77
    v_pk_add_f32 v[78:79], v[78:79], v[104:105]
    v_cvt_pk_bf16_f32 v94, v78, v79
    v_pk_add_f32 v[80:81], v[80:81], v[104:105]
    v_cvt_pk_bf16_f32 v95, v80, v81
    v_pk_add_f32 v[82:83], v[82:83], v[104:105]
    v_cvt_pk_bf16_f32 v96, v82, v83
    v_pk_add_f32 v[84:85], v[84:85], v[104:105]
    v_cvt_pk_bf16_f32 v97, v84, v85
    v_pk_add_f32 v[86:87], v[86:87], v[104:105]
    v_cvt_pk_bf16_f32 v98, v86, v87
    v_pk_add_f32 v[88:89], v[88:89], v[104:105]
    v_cvt_pk_bf16_f32 v99, v88, v89
    v_pk_add_f32 v[90:91], v[90:91], v[104:105]
    v_cvt_pk_bf16_f32 v100, v90, v91
    v_lshlrev_b32 v74, 16, v92
    v_and_b32 v75, 0xffff0000, v92
    v_pk_mul_f32 v[74:75], v[74:75], v[108:109]
    v_cvt_pk_bf16_f32 v92, v74, v75
    v_lshlrev_b32 v76, 16, v93
    v_and_b32 v77, 0xffff0000, v93
    v_pk_mul_f32 v[76:77], v[76:77], v[108:109]
    v_cvt_pk_bf16_f32 v93, v76, v77
    v_lshlrev_b32 v78, 16, v94
    v_and_b32 v79, 0xffff0000, v94
    v_pk_mul_f32 v[78:79], v[78:79], v[108:109]
    v_cvt_pk_bf16_f32 v94, v78, v79
    v_lshlrev_b32 v80, 16, v95
    v_and_b32 v81, 0xffff0000, v95
    v_pk_mul_f32 v[80:81], v[80:81], v[108:109]
    v_cvt_pk_bf16_f32 v95, v80, v81
    v_lshlrev_b32 v82, 16, v96
    v_and_b32 v83, 0xffff0000, v96
    v_pk_mul_f32 v[82:83], v[82:83], v[108:109]
    v_cvt_pk_bf16_f32 v96, v82, v83
    v_lshlrev_b32 v84, 16, v97
    v_and_b32 v85, 0xffff0000, v97
    v_pk_mul_f32 v[84:85], v[84:85], v[108:109]
    v_cvt_pk_bf16_f32 v97, v84, v85
    v_lshlrev_b32 v86, 16, v98
    v_and_b32 v87, 0xffff0000, v98
    v_pk_mul_f32 v[86:87], v[86:87], v[108:109]
    v_cvt_pk_bf16_f32 v98, v86, v87
    v_lshlrev_b32 v88, 16, v99
    v_and_b32 v89, 0xffff0000, v99
    v_pk_mul_f32 v[88:89], v[88:89], v[108:109]
    v_cvt_pk_bf16_f32 v99, v88, v89
    v_lshlrev_b32 v90, 16, v100
    v_and_b32 v91, 0xffff0000, v100
    v_pk_mul_f32 v[90:91], v[90:91], v[108:109]
    v_cvt_pk_bf16_f32 v100, v90, v91
    v_lshlrev_b32 v74, 16, v92
    v_and_b32 v75, 0xffff0000, v92
    v_lshlrev_b32 v76, 16, v93
    v_and_b32 v77, 0xffff0000, v93
    v_lshlrev_b32 v78, 16, v94
    v_and_b32 v79, 0xffff0000, v94
    v_lshlrev_b32 v80, 16, v95
    v_and_b32 v81, 0xffff0000, v95
    v_lshlrev_b32 v82, 16, v96
    v_and_b32 v83, 0xffff0000, v96
    v_lshlrev_b32 v84, 16, v97
    v_and_b32 v85, 0xffff0000, v97
    v_lshlrev_b32 v86, 16, v98
    v_and_b32 v87, 0xffff0000, v98
    v_lshlrev_b32 v88, 16, v99
    v_and_b32 v89, 0xffff0000, v99
    v_lshlrev_b32 v90, 16, v100
    v_and_b32 v91, 0xffff0000, v100
    ds_write_b32 v68, v92 offset:0
    ds_write_b32 v68, v93 offset:128
    ds_write_b32 v68, v94 offset:256
    ds_write_b32 v68, v95 offset:384
    ds_write_b32 v68, v96 offset:512
    ds_write_b32 v68, v97 offset:640
    ds_write_b32 v68, v98 offset:768
    ds_write_b32 v68, v99 offset:896
    ds_write_b32 v68, v100 offset:1024
    v_and_b32 v65, 7, v0
    v_bfe_u32 v66, v0, 3, 1
    v_lshrrev_b32 v67, 4, v0
    v_mul_u32_u24 v68, 1184, v65
    v_lshl_add_u32 v68, v66, 4, v68
    v_lshl_add_u32 v68, v67, 5, v68
    v_add_u32 v68, 0, v68
    s_lshr_b32 s94, s2, 4
    s_mul_i32 s94, s94, 147456
    s_bfe_u32 s95, s2, 0x20002
    s_lshl_b32 s95, s95, 10
    s_add_u32 s94, s94, s95
    s_and_b32 s95, s2, 3
    s_lshl_b32 s95, s95, 7
    s_add_u32 s94, s94, s95
    s_add_u32 s94, s94, 0
    v_lshlrev_b32 v69, 12, v67
    v_lshl_add_u32 v69, v66, 9, v69
    v_lshl_add_u32 v69, v65, 4, v69
    v_lshlrev_b32 v70, 2, v0
    v_add_u32 v70, 9472, v70
    v_lshlrev_b32 v71, 4, v0
    s_mul_i32 s96, s2, 9216
    s_add_u32 s96, s96, 2359296
    s_waitcnt lgkmcnt(0)
    s_barrier
    s_waitcnt vmcnt(0)

    ds_read_b128 v[76:79], v68 offset:0
    ds_read_b32 v80, v70 offset:0
    ds_read_b32 v81, v70 offset:2304
    ds_read_b32 v82, v70 offset:4608
    ds_read_b32 v83, v70 offset:6912
    ds_read_b128 v[84:87], v68 offset:512
    ds_read_b32 v88, v70 offset:1024
    ds_read_b32 v89, v70 offset:3328
    ds_read_b32 v90, v70 offset:5632
    ds_read_b32 v91, v70 offset:7936
    s_cmp_lg_u32 s36, 0
    s_cbranch_scc1 L_ln_skip_c
    ds_read_b128 v[92:95], v68 offset:1024
    ds_read_b32 v96, v70 offset:2048
    ds_read_b32 v97, v70 offset:4352
    ds_read_b32 v98, v70 offset:6656
    ds_read_b32 v99, v70 offset:8960
    s_waitcnt lgkmcnt(0)
    s_add_u32 s97, s94, 131072
    buffer_store_dwordx4 v[92:95], v69, s[16:19], s97 offen sc1
    s_add_u32 s97, s96, 8192
    buffer_store_dwordx4 v[96:99], v71, s[16:19], s97 offen sc1
    L_ln_skip_c:
    s_waitcnt lgkmcnt(0)
    s_add_u32 s97, s94, 0
    buffer_store_dwordx4 v[76:79], v69, s[16:19], s97 offen sc1
    s_add_u32 s97, s96, 0
    buffer_store_dwordx4 v[80:83], v71, s[16:19], s97 offen sc1
    s_add_u32 s97, s94, 65536
    buffer_store_dwordx4 v[84:87], v69, s[16:19], s97 offen sc1
    s_add_u32 s97, s96, 4096
    buffer_store_dwordx4 v[88:91], v71, s[16:19], s97 offen sc1
    s_load_dwordx4 s[4:7], s[0:1], 8
    s_load_dwordx2 s[62:63], s[0:1], 24
    s_load_dwordx2 s[64:65], s[0:1], 32
    s_load_dwordx2 s[60:61], s[0:1], 40
    s_sub_u32 s54, s2, 192
    s_mul_i32 s54, s54, 3
    s_add_u32 s54, s54, s36
    s_add_u32 s54, s54, 384
    s_min_u32 s54, s54, 575
    s_mul_i32 s55, s36, 17408
    s_add_u32 s55, s55, 36864
    v_and_b32 v1, 63, v0
    v_lshlrev_b32 v3, 2, v1
    s_waitcnt lgkmcnt(0)

    s_mov_b32 s20, s4
    s_mov_b32 s21, s5
    s_mov_b32 s22, 147456
    s_mov_b32 s23, 0x20000
    s_mov_b32 s24, s6
    s_mov_b32 s25, s7
    s_mov_b32 s26, 147456
    s_mov_b32 s27, 0x20000
    s_mov_b32 s28, s62
    s_mov_b32 s29, s63
    s_mov_b32 s30, 147456
    s_mov_b32 s31, 0x20000
    s_mov_b32 s32, s64
    s_mov_b32 s33, s65
    s_mov_b32 s34, 147456
    s_mov_b32 s35, 0x20000
    s_lshl_b32 s56, s54, 8
    buffer_load_dword v64, v3, s[20:23], s56 offen
    buffer_load_dword v65, v3, s[24:27], s56 offen
    buffer_load_dword v66, v3, s[28:31], s56 offen
    buffer_load_dword v67, v3, s[32:35], s56 offen
    s_mov_b32 s4, s60
    s_mov_b32 s5, s61
    s_mov_b32 s6, 1152
    s_mov_b32 s7, 0x20000
    s_lshl_b32 s57, s54, 1
    v_mov_b32 v6, s57
    buffer_load_ushort v68, v6, s[4:7], 0 offen
    v_add_u32 v4, s55, v3
    v_and_b32 v30, 15, v1
    v_lshrrev_b32 v31, 4, v1
    v_mul_u32_u24 v5, 272, v30
    v_lshl_add_u32 v5, v31, 4, v5
    v_add_u32 v5, s55, v5
    v_lshlrev_b32 v34, 6, v31
    v_lshl_add_u32 v35, v30, 2, v34
    v_lshl_add_u32 v36, v30, 1, v34
    v_cmp_gt_u32 vcc, 2, v31

    v_add_u32 v37, 0, v35
    v_add_u32 v38, 0, v36
    v_cndmask_b32 v37, v38, v37, vcc
    v_lshlrev_b32 v37, 2, v37
    v_add_u32 v8, s55, v37
    v_add_u32 v37, 1, v35
    v_add_u32 v38, 1, v36
    v_cndmask_b32 v37, v38, v37, vcc
    v_lshlrev_b32 v37, 2, v37
    v_add_u32 v9, s55, v37
    v_add_u32 v37, 2, v35
    v_add_u32 v38, 32, v36
    v_cndmask_b32 v37, v38, v37, vcc
    v_lshlrev_b32 v37, 2, v37
    v_add_u32 v10, s55, v37
    v_add_u32 v37, 3, v35
    v_add_u32 v38, 33, v36
    v_cndmask_b32 v37, v38, v37, vcc
    v_lshlrev_b32 v37, 2, v37
    v_add_u32 v11, s55, v37
    v_add_u32 v35, v34, v30
    v_cmp_eq_u32 s[58:59], 47, v1
    v_add_u32 v37, 256, v35
    v_mov_b32 v38, 400
    v_cndmask_b32 v37, v38, v37, vcc
    v_mov_b32 v38, 384
    s_nop 0
    v_cndmask_b32 v37, v37, v38, s[58:59]
    v_lshlrev_b32 v37, 2, v37
    v_add_u32 v12, s55, v37
    v_add_u32 v37, 272, v35
    v_mov_b32 v38, 400
    v_cndmask_b32 v37, v38, v37, vcc
    v_lshlrev_b32 v37, 2, v37
    v_add_u32 v13, s55, v37
    v_add_u32 v37, 288, v35
    v_mov_b32 v38, 400
    v_cndmask_b32 v37, v38, v37, vcc
    v_lshlrev_b32 v37, 2, v37
    v_add_u32 v14, s55, v37
    v_add_u32 v37, 304, v35
    v_mov_b32 v38, 400
    v_cndmask_b32 v37, v38, v37, vcc
    v_lshlrev_b32 v37, 2, v37
    v_add_u32 v15, s55, v37
    v_lshrrev_b32 v34, 1, v31
    v_lshl_add_u32 v34, v34, 4, v30
    v_and_b32 v35, 1, v31
    v_lshlrev_b32 v35, 3, v35
    v_and_b32 v37, 3, v34
    v_lshrrev_b32 v38, 2, v34
    v_lshlrev_b32 v37, 10, v37
    v_lshl_add_u32 v16, v38, 4, v37

    v_add_u32 v16, v16, v35
    v_lshrrev_b32 v34, 1, v1
    v_add_u32 v34, 32, v34
    v_and_b32 v35, 1, v1
    v_lshlrev_b32 v35, 3, v35
    v_and_b32 v37, 3, v34
    v_lshrrev_b32 v38, 2, v34
    v_lshlrev_b32 v37, 10, v37
    v_lshl_add_u32 v20, v38, 4, v37

    v_add_u32 v20, v20, v35
    v_add_u32 v34, 64, v1
    v_and_b32 v37, 3, v34
    v_lshrrev_b32 v38, 2, v34
    v_lshlrev_b32 v37, 10, v37
    v_lshl_add_u32 v21, v38, 4, v37

    v_lshlrev_b32 v34, 1, v1
    v_add_u32 v34, 128, v34
    v_and_b32 v37, 3, v34
    v_lshrrev_b32 v38, 2, v34
    v_lshlrev_b32 v37, 10, v37
    v_lshl_add_u32 v22, v38, 4, v37

    v_lshlrev_b32 v34, 3, v1
    v_add_u32 v17, s55, v34
    v_add_u32 v18, 512, v17
    v_add_u32 v19, 1024, v17

    s_waitcnt vmcnt(5)
    s_barrier
    s_lshl_b32 s62, s2, 6
    s_add_u32 s62, s62, 41943040
    v_mov_b32 v24, s62
    v_mov_b32 v25, 0x7ffffff0
    v_cmp_eq_u32 vcc, 0, v0
    s_add_u32 s62, s90, 1
    v_mov_b32 v26, s62
    v_cndmask_b32 v25, v25, v24, vcc
    buffer_store_dword v26, v25, s[16:19], 0 offen sc1

    s_cmp_eq_u32 s36, 3
    s_cbranch_scc1 L_kg_w3_c
    s_waitcnt vmcnt(0)
    v_lshlrev_b32 v68, 16, v68
    v_mul_f32 v68, 0x3fb8aa3b, v68
    v_exp_f32 v68, v68
    s_nop 0
    v_cvt_pk_bf16_f32 v68, v68, v68
    v_and_b32 v68, 0xffff0000, v68
    v_lshlrev_b32 v70, 16, v64
    v_and_b32 v78, 0xffff0000, v64
    v_lshlrev_b32 v71, 16, v65
    v_and_b32 v79, 0xffff0000, v65
    v_lshlrev_b32 v72, 16, v66
    v_and_b32 v80, 0xffff0000, v66
    v_lshlrev_b32 v73, 16, v67
    v_and_b32 v81, 0xffff0000, v67
    v_mul_f32 v70, 0x3fb8aa3b, v70
    v_mul_f32 v78, 0x3fb8aa3b, v78
    v_mul_f32 v71, v71, v68
    v_mul_f32 v79, v79, v68
    v_exp_f32 v70, v70
    v_exp_f32 v78, v78
    v_mul_f32 v72, v72, v68
    v_mul_f32 v80, v80, v68
    v_mul_f32 v73, v73, v68
    v_mul_f32 v81, v81, v68
    v_cvt_pk_bf16_f32 v70, v70, v70
    v_cvt_pk_bf16_f32 v78, v78, v78
    v_mul_f32 v71, 0x3e22f983, v71
    v_mul_f32 v79, 0x3e22f983, v79
    v_and_b32 v70, 0xffff0000, v70
    v_and_b32 v78, 0xffff0000, v78
    v_mul_f32 v70, v70, v68
    v_mul_f32 v78, v78, v68
    v_mul_f32 v70, 0xbfb8aa3b, v70
    v_mul_f32 v78, 0xbfb8aa3b, v78
    v_max3_f32 v86, abs(v72), abs(v73), abs(v80)
    v_max_f32 v86, v86, abs(v81)
    s_nop 1
    v_max_f32_dpp v86, v86, v86 quad_perm:[1,0,3,2] row_mask:0xf bank_mask:0xf
    s_nop 1
    v_max_f32_dpp v86, v86, v86 quad_perm:[2,3,0,1] row_mask:0xf bank_mask:0xf
    s_nop 1
    v_max_f32_dpp v86, v86, v86 row_half_mirror row_mask:0xf bank_mask:0xf
    s_nop 1
    v_max_f32_dpp v86, v86, v86 row_mirror row_mask:0xf bank_mask:0xf
    s_nop 0
    v_mov_b32 v87, v86
    s_nop 1
    v_permlane16_swap_b32 v86, v87
    s_nop 1
    v_max_f32 v86, v86, v87
    v_mov_b32 v87, v86
    s_nop 1
    v_permlane32_swap_b32 v86, v87
    s_nop 1
    v_max_f32 v86, v86, v87
    v_max_f32 v86, 0x0d800000, v86
    v_min_f32 v86, 0x71800000, v86
    v_add_u32 v86, 0x7fffff, v86
    v_and_b32 v86, 0x7f800000, v86
    v_sub_u32 v87, 0x7f000000, v86
    v_add_f32 v69, v86, v86
    v_mul_f32 v72, v72, v87
    v_mul_f32 v73, v73, v87
    v_mul_f32 v80, v80, v87
    v_mul_f32 v81, v81, v87

    v_mul_f32 v140, 0x3f800000, v70
    v_mul_f32 v142, 0x41000000, v70
    v_mul_f32 v144, 0x43000000, v70
    v_mul_f32 v146, 0x3f800000, v78
    v_mul_f32 v148, 0x41000000, v78
    v_mul_f32 v150, 0x43000000, v78
    v_mul_f32 v141, 0x3f800000, v71
    v_mul_f32 v143, 0x41000000, v71
    v_mul_f32 v145, 0x43000000, v71
    v_mul_f32 v147, 0x3f800000, v79
    v_mul_f32 v149, 0x41000000, v79
    v_mul_f32 v151, 0x43000000, v79
    v_exp_f32 v140, v140
    v_exp_f32 v142, v142
    v_exp_f32 v144, v144
    v_exp_f32 v146, v146
    v_exp_f32 v148, v148
    v_exp_f32 v150, v150
    v_fract_f32 v141, v141
    v_fract_f32 v143, v143
    v_fract_f32 v145, v145
    v_fract_f32 v147, v147
    v_fract_f32 v149, v149
    v_fract_f32 v151, v151
    s_nop 0
    s_nop 0
    s_nop 0
    s_nop 0
    s_nop 0
    s_nop 0
    v_cos_f32 v100, v141
    v_cos_f32 v114, v143
    v_cos_f32 v116, v145
    v_cos_f32 v120, v147
    v_cos_f32 v134, v149
    v_cos_f32 v136, v151
    v_sin_f32 v101, v141
    v_sin_f32 v115, v143
    v_sin_f32 v117, v145
    v_sin_f32 v121, v147
    v_sin_f32 v135, v149
    v_sin_f32 v137, v151
    s_nop 0
    s_nop 0
    s_nop 0
    s_nop 0
    s_nop 0
    s_nop 0
    v_mul_f32 v100, v100, v140
    v_mul_f32 v114, v114, v142
    v_mul_f32 v116, v116, v144
    v_mul_f32 v120, v120, v146
    v_mul_f32 v134, v134, v148
    v_mul_f32 v136, v136, v150
    v_mul_f32 v101, v101, v140
    v_mul_f32 v115, v115, v142
    v_mul_f32 v117, v117, v144
    v_mul_f32 v121, v121, v146
    v_mul_f32 v135, v135, v148
    v_mul_f32 v137, v137, v150
    v_pk_mul_f32 v[102:103], v[100:101], v[100:101] op_sel_hi:[1,0]
    v_pk_mul_f32 v[122:123], v[120:121], v[120:121] op_sel_hi:[1,0]
    v_pk_fma_f32 v[102:103], v[100:101], v[100:101], v[102:103] op_sel:[1,1,0] op_sel_hi:[0,1,1] neg_lo:[1,0,0]
    v_pk_fma_f32 v[122:123], v[120:121], v[120:121], v[122:123] op_sel:[1,1,0] op_sel_hi:[0,1,1] neg_lo:[1,0,0]
    s_nop 0
    v_pk_mul_f32 v[104:105], v[102:103], v[100:101] op_sel_hi:[1,0]
    v_pk_mul_f32 v[106:107], v[102:103], v[102:103] op_sel_hi:[1,0]
    v_pk_mul_f32 v[124:125], v[122:123], v[120:121] op_sel_hi:[1,0]
    v_pk_mul_f32 v[126:127], v[122:123], v[122:123] op_sel_hi:[1,0]
    v_pk_fma_f32 v[104:105], v[102:103], v[100:101], v[104:105] op_sel:[1,1,0] op_sel_hi:[0,1,1] neg_lo:[1,0,0]
    v_pk_fma_f32 v[106:107], v[102:103], v[102:103], v[106:107] op_sel:[1,1,0] op_sel_hi:[0,1,1] neg_lo:[1,0,0]
    v_pk_fma_f32 v[124:125], v[122:123], v[120:121], v[124:125] op_sel:[1,1,0] op_sel_hi:[0,1,1] neg_lo:[1,0,0]
    v_pk_fma_f32 v[126:127], v[122:123], v[122:123], v[126:127] op_sel:[1,1,0] op_sel_hi:[0,1,1] neg_lo:[1,0,0]
    v_pk_mul_f32 v[108:109], v[106:107], v[100:101] op_sel_hi:[1,0]
    v_pk_mul_f32 v[110:111], v[106:107], v[102:103] op_sel_hi:[1,0]
    v_pk_mul_f32 v[112:113], v[106:107], v[104:105] op_sel_hi:[1,0]
    v_pk_mul_f32 v[128:129], v[126:127], v[120:121] op_sel_hi:[1,0]
    v_pk_mul_f32 v[130:131], v[126:127], v[122:123] op_sel_hi:[1,0]
    v_pk_mul_f32 v[132:133], v[126:127], v[124:125] op_sel_hi:[1,0]
    v_pk_fma_f32 v[108:109], v[106:107], v[100:101], v[108:109] op_sel:[1,1,0] op_sel_hi:[0,1,1] neg_lo:[1,0,0]
    v_pk_fma_f32 v[110:111], v[106:107], v[102:103], v[110:111] op_sel:[1,1,0] op_sel_hi:[0,1,1] neg_lo:[1,0,0]
    v_pk_fma_f32 v[112:113], v[106:107], v[104:105], v[112:113] op_sel:[1,1,0] op_sel_hi:[0,1,1] neg_lo:[1,0,0]
    v_pk_fma_f32 v[128:129], v[126:127], v[120:121], v[128:129] op_sel:[1,1,0] op_sel_hi:[0,1,1] neg_lo:[1,0,0]
    v_pk_fma_f32 v[130:131], v[126:127], v[122:123], v[130:131] op_sel:[1,1,0] op_sel_hi:[0,1,1] neg_lo:[1,0,0]
    v_pk_fma_f32 v[132:133], v[126:127], v[124:125], v[132:133] op_sel:[1,1,0] op_sel_hi:[0,1,1] neg_lo:[1,0,0]
    v_pk_mul_f32 v[140:141], v[72:73], v[116:117] op_sel_hi:[1,0]
    v_pk_mul_f32 v[170:171], v[80:81], v[136:137] op_sel_hi:[1,0]
    v_pk_mul_f32 v[200:201], v[114:115], v[114:115] op_sel_hi:[1,0]
    v_pk_fma_f32 v[140:141], v[72:73], v[116:117], v[140:141] op_sel:[1,1,0] op_sel_hi:[0,1,1] neg_lo:[1,0,0]
    v_pk_fma_f32 v[170:171], v[80:81], v[136:137], v[170:171] op_sel:[1,1,0] op_sel_hi:[0,1,1] neg_lo:[1,0,0]
    v_pk_fma_f32 v[200:201], v[114:115], v[114:115], v[200:201] op_sel:[1,1,0] op_sel_hi:[0,1,1] neg_lo:[1,0,0]
    v_pk_mul_f32 v[142:143], v[140:141], v[116:117] op_sel_hi:[1,0]
    v_pk_mul_f32 v[172:173], v[170:171], v[136:137] op_sel_hi:[1,0]
    v_pk_mul_f32 v[202:203], v[200:201], v[114:115] op_sel_hi:[1,0]
    v_pk_fma_f32 v[142:143], v[140:141], v[116:117], v[142:143] op_sel:[1,1,0] op_sel_hi:[0,1,1] neg_lo:[1,0,0]
    v_pk_fma_f32 v[172:173], v[170:171], v[136:137], v[172:173] op_sel:[1,1,0] op_sel_hi:[0,1,1] neg_lo:[1,0,0]
    v_pk_fma_f32 v[202:203], v[200:201], v[114:115], v[202:203] op_sel:[1,1,0] op_sel_hi:[0,1,1] neg_lo:[1,0,0]
    v_pk_mul_f32 v[144:145], v[142:143], v[116:117] op_sel_hi:[1,0]
    v_pk_mul_f32 v[174:175], v[172:173], v[136:137] op_sel_hi:[1,0]
    v_pk_mul_f32 v[204:205], v[202:203], v[114:115] op_sel_hi:[1,0]
    v_pk_fma_f32 v[144:145], v[142:143], v[116:117], v[144:145] op_sel:[1,1,0] op_sel_hi:[0,1,1] neg_lo:[1,0,0]
    v_pk_fma_f32 v[174:175], v[172:173], v[136:137], v[174:175] op_sel:[1,1,0] op_sel_hi:[0,1,1] neg_lo:[1,0,0]
    v_pk_fma_f32 v[204:205], v[202:203], v[114:115], v[204:205] op_sel:[1,1,0] op_sel_hi:[0,1,1] neg_lo:[1,0,0]
    v_pk_mul_f32 v[146:147], v[144:145], v[116:117] op_sel_hi:[1,0]
    v_pk_mul_f32 v[176:177], v[174:175], v[136:137] op_sel_hi:[1,0]
    v_pk_mul_f32 v[206:207], v[204:205], v[114:115] op_sel_hi:[1,0]
    v_pk_fma_f32 v[146:147], v[144:145], v[116:117], v[146:147] op_sel:[1,1,0] op_sel_hi:[0,1,1] neg_lo:[1,0,0]
    v_pk_fma_f32 v[176:177], v[174:175], v[136:137], v[176:177] op_sel:[1,1,0] op_sel_hi:[0,1,1] neg_lo:[1,0,0]
    v_pk_fma_f32 v[206:207], v[204:205], v[114:115], v[206:207] op_sel:[1,1,0] op_sel_hi:[0,1,1] neg_lo:[1,0,0]
    v_pk_mul_f32 v[148:149], v[146:147], v[116:117] op_sel_hi:[1,0]
    v_pk_mul_f32 v[178:179], v[176:177], v[136:137] op_sel_hi:[1,0]
    v_pk_mul_f32 v[208:209], v[206:207], v[114:115] op_sel_hi:[1,0]
    v_pk_fma_f32 v[148:149], v[146:147], v[116:117], v[148:149] op_sel:[1,1,0] op_sel_hi:[0,1,1] neg_lo:[1,0,0]
    v_pk_fma_f32 v[178:179], v[176:177], v[136:137], v[178:179] op_sel:[1,1,0] op_sel_hi:[0,1,1] neg_lo:[1,0,0]
    v_pk_fma_f32 v[208:209], v[206:207], v[114:115], v[208:209] op_sel:[1,1,0] op_sel_hi:[0,1,1] neg_lo:[1,0,0]
    v_pk_mul_f32 v[150:151], v[148:149], v[116:117] op_sel_hi:[1,0]
    v_pk_mul_f32 v[180:181], v[178:179], v[136:137] op_sel_hi:[1,0]
    v_pk_mul_f32 v[210:211], v[208:209], v[114:115] op_sel_hi:[1,0]
    v_pk_fma_f32 v[150:151], v[148:149], v[116:117], v[150:151] op_sel:[1,1,0] op_sel_hi:[0,1,1] neg_lo:[1,0,0]
    v_pk_fma_f32 v[180:181], v[178:179], v[136:137], v[180:181] op_sel:[1,1,0] op_sel_hi:[0,1,1] neg_lo:[1,0,0]
    v_pk_fma_f32 v[210:211], v[208:209], v[114:115], v[210:211] op_sel:[1,1,0] op_sel_hi:[0,1,1] neg_lo:[1,0,0]
    v_pk_mul_f32 v[152:153], v[150:151], v[116:117] op_sel_hi:[1,0]
    v_pk_mul_f32 v[182:183], v[180:181], v[136:137] op_sel_hi:[1,0]
    v_pk_mul_f32 v[212:213], v[210:211], v[114:115] op_sel_hi:[1,0]
    v_pk_fma_f32 v[152:153], v[150:151], v[116:117], v[152:153] op_sel:[1,1,0] op_sel_hi:[0,1,1] neg_lo:[1,0,0]
    v_pk_fma_f32 v[182:183], v[180:181], v[136:137], v[182:183] op_sel:[1,1,0] op_sel_hi:[0,1,1] neg_lo:[1,0,0]
    v_pk_fma_f32 v[212:213], v[210:211], v[114:115], v[212:213] op_sel:[1,1,0] op_sel_hi:[0,1,1] neg_lo:[1,0,0]
    v_pk_mul_f32 v[154:155], v[152:153], v[116:117] op_sel_hi:[1,0]
    v_pk_mul_f32 v[184:185], v[182:183], v[136:137] op_sel_hi:[1,0]
    v_pk_mul_f32 v[214:215], v[212:213], v[114:115] op_sel_hi:[1,0]
    v_pk_fma_f32 v[154:155], v[152:153], v[116:117], v[154:155] op_sel:[1,1,0] op_sel_hi:[0,1,1] neg_lo:[1,0,0]
    v_pk_fma_f32 v[184:185], v[182:183], v[136:137], v[184:185] op_sel:[1,1,0] op_sel_hi:[0,1,1] neg_lo:[1,0,0]
    v_pk_fma_f32 v[214:215], v[212:213], v[114:115], v[214:215] op_sel:[1,1,0] op_sel_hi:[0,1,1] neg_lo:[1,0,0]
    v_pk_mul_f32 v[156:157], v[154:155], v[116:117] op_sel_hi:[1,0]
    v_pk_mul_f32 v[186:187], v[184:185], v[136:137] op_sel_hi:[1,0]
    v_pk_mul_f32 v[216:217], v[214:215], v[114:115] op_sel_hi:[1,0]
    v_pk_fma_f32 v[156:157], v[154:155], v[116:117], v[156:157] op_sel:[1,1,0] op_sel_hi:[0,1,1] neg_lo:[1,0,0]
    v_pk_fma_f32 v[186:187], v[184:185], v[136:137], v[186:187] op_sel:[1,1,0] op_sel_hi:[0,1,1] neg_lo:[1,0,0]
    v_pk_fma_f32 v[216:217], v[214:215], v[114:115], v[216:217] op_sel:[1,1,0] op_sel_hi:[0,1,1] neg_lo:[1,0,0]
    v_pk_mul_f32 v[158:159], v[156:157], v[116:117] op_sel_hi:[1,0]
    v_pk_mul_f32 v[188:189], v[186:187], v[136:137] op_sel_hi:[1,0]
    v_pk_mul_f32 v[218:219], v[216:217], v[114:115] op_sel_hi:[1,0]
    v_pk_fma_f32 v[158:159], v[156:157], v[116:117], v[158:159] op_sel:[1,1,0] op_sel_hi:[0,1,1] neg_lo:[1,0,0]
    v_pk_fma_f32 v[188:189], v[186:187], v[136:137], v[188:189] op_sel:[1,1,0] op_sel_hi:[0,1,1] neg_lo:[1,0,0]
    v_pk_fma_f32 v[218:219], v[216:217], v[114:115], v[218:219] op_sel:[1,1,0] op_sel_hi:[0,1,1] neg_lo:[1,0,0]
    v_pk_mul_f32 v[160:161], v[158:159], v[116:117] op_sel_hi:[1,0]
    v_pk_mul_f32 v[190:191], v[188:189], v[136:137] op_sel_hi:[1,0]
    v_pk_mul_f32 v[220:221], v[218:219], v[114:115] op_sel_hi:[1,0]
    v_pk_fma_f32 v[160:161], v[158:159], v[116:117], v[160:161] op_sel:[1,1,0] op_sel_hi:[0,1,1] neg_lo:[1,0,0]
    v_pk_fma_f32 v[190:191], v[188:189], v[136:137], v[190:191] op_sel:[1,1,0] op_sel_hi:[0,1,1] neg_lo:[1,0,0]
    v_pk_fma_f32 v[220:221], v[218:219], v[114:115], v[220:221] op_sel:[1,1,0] op_sel_hi:[0,1,1] neg_lo:[1,0,0]
    v_pk_mul_f32 v[162:163], v[160:161], v[116:117] op_sel_hi:[1,0]
    v_pk_mul_f32 v[192:193], v[190:191], v[136:137] op_sel_hi:[1,0]
    v_pk_mul_f32 v[222:223], v[220:221], v[114:115] op_sel_hi:[1,0]
    v_pk_fma_f32 v[162:163], v[160:161], v[116:117], v[162:163] op_sel:[1,1,0] op_sel_hi:[0,1,1] neg_lo:[1,0,0]
    v_pk_fma_f32 v[192:193], v[190:191], v[136:137], v[192:193] op_sel:[1,1,0] op_sel_hi:[0,1,1] neg_lo:[1,0,0]
    v_pk_fma_f32 v[222:223], v[220:221], v[114:115], v[222:223] op_sel:[1,1,0] op_sel_hi:[0,1,1] neg_lo:[1,0,0]
    v_pk_mul_f32 v[164:165], v[162:163], v[116:117] op_sel_hi:[1,0]
    v_pk_mul_f32 v[194:195], v[192:193], v[136:137] op_sel_hi:[1,0]
    v_pk_mul_f32 v[224:225], v[222:223], v[114:115] op_sel_hi:[1,0]
    v_pk_fma_f32 v[164:165], v[162:163], v[116:117], v[164:165] op_sel:[1,1,0] op_sel_hi:[0,1,1] neg_lo:[1,0,0]
    v_pk_fma_f32 v[194:195], v[192:193], v[136:137], v[194:195] op_sel:[1,1,0] op_sel_hi:[0,1,1] neg_lo:[1,0,0]
    v_pk_fma_f32 v[224:225], v[222:223], v[114:115], v[224:225] op_sel:[1,1,0] op_sel_hi:[0,1,1] neg_lo:[1,0,0]
    v_pk_mul_f32 v[166:167], v[164:165], v[116:117] op_sel_hi:[1,0]
    v_pk_mul_f32 v[196:197], v[194:195], v[136:137] op_sel_hi:[1,0]
    v_pk_mul_f32 v[226:227], v[224:225], v[114:115] op_sel_hi:[1,0]
    v_pk_fma_f32 v[166:167], v[164:165], v[116:117], v[166:167] op_sel:[1,1,0] op_sel_hi:[0,1,1] neg_lo:[1,0,0]
    v_pk_fma_f32 v[196:197], v[194:195], v[136:137], v[196:197] op_sel:[1,1,0] op_sel_hi:[0,1,1] neg_lo:[1,0,0]
    v_pk_fma_f32 v[226:227], v[224:225], v[114:115], v[226:227] op_sel:[1,1,0] op_sel_hi:[0,1,1] neg_lo:[1,0,0]
    v_pk_mul_f32 v[168:169], v[166:167], v[116:117] op_sel_hi:[1,0]
    v_pk_mul_f32 v[198:199], v[196:197], v[136:137] op_sel_hi:[1,0]
    v_pk_fma_f32 v[168:169], v[166:167], v[116:117], v[168:169] op_sel:[1,1,0] op_sel_hi:[0,1,1] neg_lo:[1,0,0]
    v_pk_fma_f32 v[198:199], v[196:197], v[136:137], v[198:199] op_sel:[1,1,0] op_sel_hi:[0,1,1] neg_lo:[1,0,0]
    s_nop 0
    v_mov_b32 v232, 1.0
    v_mov_b32 v233, 0
    v_cvt_pk_f16_f32 v48, v72, -v73
    v_cvt_pk_f16_f32 v49, v140, -v141
    v_cvt_pk_f16_f32 v50, v142, -v143
    v_cvt_pk_f16_f32 v51, v144, -v145
    v_cvt_pk_f16_f32 v52, v146, -v147
    v_cvt_pk_f16_f32 v53, v148, -v149
    v_cvt_pk_f16_f32 v54, v150, -v151
    v_cvt_pk_f16_f32 v55, v152, -v153
    ds_write_b32 v4, v48 offset:0
    ds_write_b32 v4, v49 offset:2176
    ds_write_b32 v4, v50 offset:4352
    ds_write_b32 v4, v51 offset:5440
    ds_write_b32 v4, v52 offset:6528
    ds_write_b32 v4, v53 offset:7072
    ds_write_b32 v4, v54 offset:7616
    ds_write_b32 v4, v55 offset:8160
    v_cvt_pk_f16_f32 v48, v154, -v155
    v_cvt_pk_f16_f32 v49, v156, -v157
    v_cvt_pk_f16_f32 v50, v158, -v159
    v_cvt_pk_f16_f32 v51, v160, -v161
    v_cvt_pk_f16_f32 v52, v162, -v163
    v_cvt_pk_f16_f32 v53, v164, -v165
    v_cvt_pk_f16_f32 v54, v166, -v167
    v_cvt_pk_f16_f32 v55, v168, -v169
    ds_write_b32 v4, v48 offset:8704
    ds_write_b32 v4, v49 offset:8976
    ds_write_b32 v4, v50 offset:9248
    ds_write_b32 v4, v51 offset:9520
    ds_write_b32 v4, v52 offset:9792
    ds_write_b32 v4, v53 offset:10064
    ds_write_b32 v4, v54 offset:10336
    ds_write_b32 v4, v55 offset:10608
    v_cvt_pk_f16_f32 v48, v232, v233
    v_cvt_pk_f16_f32 v49, v114, v115
    v_cvt_pk_f16_f32 v50, v200, v201
    v_cvt_pk_f16_f32 v51, v202, v203
    v_cvt_pk_f16_f32 v52, v204, v205
    v_cvt_pk_f16_f32 v53, v206, v207
    v_cvt_pk_f16_f32 v54, v208, v209
    v_cvt_pk_f16_f32 v55, v210, v211
    ds_write_b32 v4, v48 offset:13056
    ds_write_b32 v4, v49 offset:13328
    ds_write_b32 v4, v50 offset:13600
    ds_write_b32 v4, v51 offset:13872
    ds_write_b32 v4, v52 offset:14144
    ds_write_b32 v4, v53 offset:14416
    ds_write_b32 v4, v54 offset:14688
    ds_write_b32 v4, v55 offset:14960
    v_cvt_pk_f16_f32 v48, v212, v213
    v_cvt_pk_f16_f32 v49, v214, v215
    v_cvt_pk_f16_f32 v50, v216, v217
    v_cvt_pk_f16_f32 v51, v218, v219
    v_cvt_pk_f16_f32 v52, v220, v221
    v_cvt_pk_f16_f32 v53, v222, v223
    v_cvt_pk_f16_f32 v54, v224, v225
    v_cvt_pk_f16_f32 v55, v226, v227
    ds_write_b32 v4, v48 offset:15232
    ds_write_b32 v4, v49 offset:15504
    ds_write_b32 v4, v50 offset:15776
    ds_write_b32 v4, v51 offset:16048
    ds_write_b32 v4, v52 offset:16320
    ds_write_b32 v4, v53 offset:16592
    ds_write_b32 v4, v54 offset:16864
    ds_write_b32 v4, v55 offset:17136
    v_pk_mul_f32 v[200:201], v[134:135], v[134:135] op_sel_hi:[1,0]
    v_pk_mul_f32 v[32:33], v[72:73], v[100:101] op_sel_hi:[1,0]
    v_pk_mul_f32 v[34:35], v[72:73], v[102:103] op_sel_hi:[1,0]
    v_pk_mul_f32 v[36:37], v[72:73], v[104:105] op_sel_hi:[1,0]
    v_pk_mul_f32 v[38:39], v[72:73], v[106:107] op_sel_hi:[1,0]
    v_pk_fma_f32 v[200:201], v[134:135], v[134:135], v[200:201] op_sel:[1,1,0] op_sel_hi:[0,1,1] neg_lo:[1,0,0]
    v_pk_mul_f32 v[40:41], v[72:73], v[108:109] op_sel_hi:[1,0]
    v_pk_mul_f32 v[42:43], v[72:73], v[110:111] op_sel_hi:[1,0]
    v_pk_mul_f32 v[44:45], v[72:73], v[112:113] op_sel_hi:[1,0]
    v_pk_mul_f32 v[46:47], v[140:141], v[100:101] op_sel_hi:[1,0]
    v_pk_mul_f32 v[202:203], v[200:201], v[134:135] op_sel_hi:[1,0]
    v_pk_fma_f32 v[32:33], v[72:73], v[100:101], v[32:33] op_sel:[1,1,0] op_sel_hi:[0,1,1] neg_lo:[1,0,0]
    v_pk_fma_f32 v[34:35], v[72:73], v[102:103], v[34:35] op_sel:[1,1,0] op_sel_hi:[0,1,1] neg_lo:[1,0,0]
    v_pk_fma_f32 v[36:37], v[72:73], v[104:105], v[36:37] op_sel:[1,1,0] op_sel_hi:[0,1,1] neg_lo:[1,0,0]
    v_pk_fma_f32 v[38:39], v[72:73], v[106:107], v[38:39] op_sel:[1,1,0] op_sel_hi:[0,1,1] neg_lo:[1,0,0]
    v_pk_fma_f32 v[202:203], v[200:201], v[134:135], v[202:203] op_sel:[1,1,0] op_sel_hi:[0,1,1] neg_lo:[1,0,0]
    v_pk_fma_f32 v[40:41], v[72:73], v[108:109], v[40:41] op_sel:[1,1,0] op_sel_hi:[0,1,1] neg_lo:[1,0,0]
    v_pk_fma_f32 v[42:43], v[72:73], v[110:111], v[42:43] op_sel:[1,1,0] op_sel_hi:[0,1,1] neg_lo:[1,0,0]
    v_pk_fma_f32 v[44:45], v[72:73], v[112:113], v[44:45] op_sel:[1,1,0] op_sel_hi:[0,1,1] neg_lo:[1,0,0]
    v_pk_fma_f32 v[46:47], v[140:141], v[100:101], v[46:47] op_sel:[1,1,0] op_sel_hi:[0,1,1] neg_lo:[1,0,0]
    v_pk_mul_f32 v[204:205], v[202:203], v[134:135] op_sel_hi:[1,0]
    v_cvt_pk_f16_f32 v48, v32, -v33
    v_cvt_pk_f16_f32 v49, v34, -v35
    v_cvt_pk_f16_f32 v50, v36, -v37
    v_cvt_pk_f16_f32 v51, v38, -v39
    v_pk_fma_f32 v[204:205], v[202:203], v[134:135], v[204:205] op_sel:[1,1,0] op_sel_hi:[0,1,1] neg_lo:[1,0,0]
    v_cvt_pk_f16_f32 v52, v40, -v41
    v_cvt_pk_f16_f32 v53, v42, -v43
    v_cvt_pk_f16_f32 v54, v44, -v45
    v_cvt_pk_f16_f32 v55, v46, -v47
    v_pk_mul_f32 v[206:207], v[204:205], v[134:135] op_sel_hi:[1,0]
    ds_write_b32 v4, v48 offset:272
    ds_write_b32 v4, v49 offset:544
    ds_write_b32 v4, v50 offset:816
    ds_write_b32 v4, v51 offset:1088
    v_pk_fma_f32 v[206:207], v[204:205], v[134:135], v[206:207] op_sel:[1,1,0] op_sel_hi:[0,1,1] neg_lo:[1,0,0]
    ds_write_b32 v4, v52 offset:1360
    ds_write_b32 v4, v53 offset:1632
    ds_write_b32 v4, v54 offset:1904
    ds_write_b32 v4, v55 offset:2448
    v_pk_mul_f32 v[208:209], v[206:207], v[134:135] op_sel_hi:[1,0]
    v_pk_mul_f32 v[32:33], v[140:141], v[102:103] op_sel_hi:[1,0]
    v_pk_mul_f32 v[34:35], v[140:141], v[104:105] op_sel_hi:[1,0]
    v_pk_mul_f32 v[36:37], v[140:141], v[106:107] op_sel_hi:[1,0]
    v_pk_mul_f32 v[38:39], v[140:141], v[108:109] op_sel_hi:[1,0]
    v_pk_fma_f32 v[208:209], v[206:207], v[134:135], v[208:209] op_sel:[1,1,0] op_sel_hi:[0,1,1] neg_lo:[1,0,0]
    v_pk_mul_f32 v[40:41], v[140:141], v[110:111] op_sel_hi:[1,0]
    v_pk_mul_f32 v[42:43], v[140:141], v[112:113] op_sel_hi:[1,0]
    v_pk_mul_f32 v[44:45], v[142:143], v[102:103] op_sel_hi:[1,0]
    v_pk_mul_f32 v[46:47], v[142:143], v[106:107] op_sel_hi:[1,0]
    v_pk_mul_f32 v[210:211], v[208:209], v[134:135] op_sel_hi:[1,0]
    v_pk_fma_f32 v[32:33], v[140:141], v[102:103], v[32:33] op_sel:[1,1,0] op_sel_hi:[0,1,1] neg_lo:[1,0,0]
    v_pk_fma_f32 v[34:35], v[140:141], v[104:105], v[34:35] op_sel:[1,1,0] op_sel_hi:[0,1,1] neg_lo:[1,0,0]
    v_pk_fma_f32 v[36:37], v[140:141], v[106:107], v[36:37] op_sel:[1,1,0] op_sel_hi:[0,1,1] neg_lo:[1,0,0]
    v_pk_fma_f32 v[38:39], v[140:141], v[108:109], v[38:39] op_sel:[1,1,0] op_sel_hi:[0,1,1] neg_lo:[1,0,0]
    v_pk_fma_f32 v[210:211], v[208:209], v[134:135], v[210:211] op_sel:[1,1,0] op_sel_hi:[0,1,1] neg_lo:[1,0,0]
    v_pk_fma_f32 v[40:41], v[140:141], v[110:111], v[40:41] op_sel:[1,1,0] op_sel_hi:[0,1,1] neg_lo:[1,0,0]
    v_pk_fma_f32 v[42:43], v[140:141], v[112:113], v[42:43] op_sel:[1,1,0] op_sel_hi:[0,1,1] neg_lo:[1,0,0]
    v_pk_fma_f32 v[44:45], v[142:143], v[102:103], v[44:45] op_sel:[1,1,0] op_sel_hi:[0,1,1] neg_lo:[1,0,0]
    v_pk_fma_f32 v[46:47], v[142:143], v[106:107], v[46:47] op_sel:[1,1,0] op_sel_hi:[0,1,1] neg_lo:[1,0,0]
    v_pk_mul_f32 v[212:213], v[210:211], v[134:135] op_sel_hi:[1,0]
    v_cvt_pk_f16_f32 v48, v32, -v33
    v_cvt_pk_f16_f32 v49, v34, -v35
    v_cvt_pk_f16_f32 v50, v36, -v37
    v_cvt_pk_f16_f32 v51, v38, -v39
    v_pk_fma_f32 v[212:213], v[210:211], v[134:135], v[212:213] op_sel:[1,1,0] op_sel_hi:[0,1,1] neg_lo:[1,0,0]
    v_cvt_pk_f16_f32 v52, v40, -v41
    v_cvt_pk_f16_f32 v53, v42, -v43
    v_cvt_pk_f16_f32 v54, v44, -v45
    v_cvt_pk_f16_f32 v55, v46, -v47
    v_pk_mul_f32 v[214:215], v[212:213], v[134:135] op_sel_hi:[1,0]
    ds_write_b32 v4, v48 offset:2720
    ds_write_b32 v4, v49 offset:2992
    ds_write_b32 v4, v50 offset:3264
    ds_write_b32 v4, v51 offset:3536
    v_pk_fma_f32 v[214:215], v[212:213], v[134:135], v[214:215] op_sel:[1,1,0] op_sel_hi:[0,1,1] neg_lo:[1,0,0]
    ds_write_b32 v4, v52 offset:3808
    ds_write_b32 v4, v53 offset:4080
    ds_write_b32 v4, v54 offset:4624
    ds_write_b32 v4, v55 offset:4896
    v_pk_mul_f32 v[216:217], v[214:215], v[134:135] op_sel_hi:[1,0]
    v_pk_mul_f32 v[32:33], v[142:143], v[110:111] op_sel_hi:[1,0]
    v_pk_mul_f32 v[34:35], v[144:145], v[102:103] op_sel_hi:[1,0]
    v_pk_mul_f32 v[36:37], v[144:145], v[106:107] op_sel_hi:[1,0]
    v_pk_mul_f32 v[38:39], v[144:145], v[110:111] op_sel_hi:[1,0]
    v_pk_fma_f32 v[216:217], v[214:215], v[134:135], v[216:217] op_sel:[1,1,0] op_sel_hi:[0,1,1] neg_lo:[1,0,0]
    v_pk_mul_f32 v[40:41], v[146:147], v[106:107] op_sel_hi:[1,0]
    v_pk_mul_f32 v[42:43], v[148:149], v[106:107] op_sel_hi:[1,0]
    v_pk_mul_f32 v[44:45], v[150:151], v[106:107] op_sel_hi:[1,0]
    v_pk_mul_f32 v[46:47], v[152:153], v[106:107] op_sel_hi:[1,0]
    v_pk_mul_f32 v[218:219], v[216:217], v[134:135] op_sel_hi:[1,0]
    v_pk_fma_f32 v[32:33], v[142:143], v[110:111], v[32:33] op_sel:[1,1,0] op_sel_hi:[0,1,1] neg_lo:[1,0,0]
    v_pk_fma_f32 v[34:35], v[144:145], v[102:103], v[34:35] op_sel:[1,1,0] op_sel_hi:[0,1,1] neg_lo:[1,0,0]
    v_pk_fma_f32 v[36:37], v[144:145], v[106:107], v[36:37] op_sel:[1,1,0] op_sel_hi:[0,1,1] neg_lo:[1,0,0]
    v_pk_fma_f32 v[38:39], v[144:145], v[110:111], v[38:39] op_sel:[1,1,0] op_sel_hi:[0,1,1] neg_lo:[1,0,0]
    v_pk_fma_f32 v[218:219], v[216:217], v[134:135], v[218:219] op_sel:[1,1,0] op_sel_hi:[0,1,1] neg_lo:[1,0,0]
    v_pk_fma_f32 v[40:41], v[146:147], v[106:107], v[40:41] op_sel:[1,1,0] op_sel_hi:[0,1,1] neg_lo:[1,0,0]
    v_pk_fma_f32 v[42:43], v[148:149], v[106:107], v[42:43] op_sel:[1,1,0] op_sel_hi:[0,1,1] neg_lo:[1,0,0]
    v_pk_fma_f32 v[44:45], v[150:151], v[106:107], v[44:45] op_sel:[1,1,0] op_sel_hi:[0,1,1] neg_lo:[1,0,0]
    v_pk_fma_f32 v[46:47], v[152:153], v[106:107], v[46:47] op_sel:[1,1,0] op_sel_hi:[0,1,1] neg_lo:[1,0,0]
    v_pk_mul_f32 v[220:221], v[218:219], v[134:135] op_sel_hi:[1,0]
    v_cvt_pk_f16_f32 v48, v32, -v33
    v_cvt_pk_f16_f32 v49, v34, -v35
    v_cvt_pk_f16_f32 v50, v36, -v37
    v_cvt_pk_f16_f32 v51, v38, -v39
    v_pk_fma_f32 v[220:221], v[218:219], v[134:135], v[220:221] op_sel:[1,1,0] op_sel_hi:[0,1,1] neg_lo:[1,0,0]
    v_cvt_pk_f16_f32 v52, v40, -v41
    v_cvt_pk_f16_f32 v53, v42, -v43
    v_cvt_pk_f16_f32 v54, v44, -v45
    v_cvt_pk_f16_f32 v55, v46, -v47
    v_pk_mul_f32 v[222:223], v[220:221], v[134:135] op_sel_hi:[1,0]
    ds_write_b32 v4, v48 offset:5168
    ds_write_b32 v4, v49 offset:5712
    ds_write_b32 v4, v50 offset:5984
    ds_write_b32 v4, v51 offset:6256
    v_pk_fma_f32 v[222:223], v[220:221], v[134:135], v[222:223] op_sel:[1,1,0] op_sel_hi:[0,1,1] neg_lo:[1,0,0]
    ds_write_b32 v4, v52 offset:6800
    ds_write_b32 v4, v53 offset:7344
    ds_write_b32 v4, v54 offset:7888
    ds_write_b32 v4, v55 offset:8432
    v_pk_mul_f32 v[224:225], v[222:223], v[134:135] op_sel_hi:[1,0]
    v_pk_mul_f32 v[32:33], v[168:169], v[114:115] op_sel_hi:[1,0]
    v_pk_fma_f32 v[224:225], v[222:223], v[134:135], v[224:225] op_sel:[1,1,0] op_sel_hi:[0,1,1] neg_lo:[1,0,0]
    v_pk_fma_f32 v[32:33], v[168:169], v[114:115], v[32:33] op_sel:[1,1,0] op_sel_hi:[0,1,1] neg_lo:[1,0,0]
    v_pk_mul_f32 v[226:227], v[224:225], v[134:135] op_sel_hi:[1,0]
    v_cvt_pk_f16_f32 v48, v32, -v33
    v_pk_fma_f32 v[226:227], v[224:225], v[134:135], v[226:227] op_sel:[1,1,0] op_sel_hi:[0,1,1] neg_lo:[1,0,0]
    ds_write_b32 v4, v48 offset:10880
    s_waitcnt lgkmcnt(0)
    ds_read_b128 v[32:35], v5 offset:13056
    ds_read_b128 v[36:39], v5 offset:0
    ds_read_b128 v[40:43], v5 offset:4352
    ds_read_b128 v[44:47], v5 offset:8704
    ds_read_b128 v[48:51], v5 offset:13120
    ds_read_b128 v[52:55], v5 offset:64
    ds_read_b128 v[56:59], v5 offset:4416
    ds_read_b128 v[60:63], v5 offset:8768
    s_waitcnt lgkmcnt(4)
    v_mfma_f32_16x16x32_f16 v[88:91], v[36:39], v[32:35], 0
    v_mfma_f32_16x16x32_f16 v[92:95], v[40:43], v[32:35], 0
    v_mfma_f32_16x16x32_f16 v[96:99], v[44:47], v[32:35], 0
    s_waitcnt lgkmcnt(0)
    v_mfma_f32_16x16x32_f16 v[88:91], v[52:55], v[48:51], v[88:91]
    v_mfma_f32_16x16x32_f16 v[92:95], v[56:59], v[48:51], v[92:95]
    v_mfma_f32_16x16x32_f16 v[96:99], v[60:63], v[48:51], v[96:99]
    ds_read_b128 v[32:35], v5 offset:13184
    ds_read_b128 v[36:39], v5 offset:128
    ds_read_b128 v[40:43], v5 offset:4480
    ds_read_b128 v[44:47], v5 offset:8832
    ds_read_b128 v[48:51], v5 offset:13248
    ds_read_b128 v[52:55], v5 offset:192
    ds_read_b128 v[56:59], v5 offset:4544
    ds_read_b128 v[60:63], v5 offset:8896
    s_waitcnt lgkmcnt(4)
    v_mfma_f32_16x16x32_f16 v[88:91], v[36:39], v[32:35], v[88:91]
    v_mfma_f32_16x16x32_f16 v[92:95], v[40:43], v[32:35], v[92:95]
    v_mfma_f32_16x16x32_f16 v[96:99], v[44:47], v[32:35], v[96:99]
    s_waitcnt lgkmcnt(0)
    v_mfma_f32_16x16x32_f16 v[88:91], v[52:55], v[48:51], v[88:91]
    v_mfma_f32_16x16x32_f16 v[92:95], v[56:59], v[48:51], v[92:95]
    v_lshlrev_b32 v250, 6, v1
    v_add_u32 v251, 41943040, v250
    buffer_load_dword v252, v251, s[16:19], 0 offen sc1
    v_add_u32 v251, 41947136, v250
    buffer_load_dword v253, v251, s[16:19], 0 offen sc1
    v_add_u32 v251, 41951232, v250
    buffer_load_dword v254, v251, s[16:19], 0 offen sc1
    v_add_u32 v251, 41955328, v250
    buffer_load_dword v255, v251, s[16:19], 0 offen sc1
    v_mfma_f32_16x16x32_f16 v[96:99], v[60:63], v[48:51], v[96:99]
    v_mov_b32 v232, 1.0
    v_mov_b32 v233, 0
    v_cvt_pk_f16_f32 v48, v80, -v81
    v_cvt_pk_f16_f32 v49, v170, -v171
    v_cvt_pk_f16_f32 v50, v172, -v173
    v_cvt_pk_f16_f32 v51, v174, -v175
    v_cvt_pk_f16_f32 v52, v176, -v177
    v_cvt_pk_f16_f32 v53, v178, -v179
    v_cvt_pk_f16_f32 v54, v180, -v181
    v_cvt_pk_f16_f32 v55, v182, -v183
    ds_write_b32 v4, v48 offset:0
    ds_write_b32 v4, v49 offset:2176
    ds_write_b32 v4, v50 offset:4352
    ds_write_b32 v4, v51 offset:5440
    ds_write_b32 v4, v52 offset:6528
    ds_write_b32 v4, v53 offset:7072
    ds_write_b32 v4, v54 offset:7616
    ds_write_b32 v4, v55 offset:8160
    v_cvt_pk_f16_f32 v48, v184, -v185
    v_cvt_pk_f16_f32 v49, v186, -v187
    v_cvt_pk_f16_f32 v50, v188, -v189
    v_cvt_pk_f16_f32 v51, v190, -v191
    v_cvt_pk_f16_f32 v52, v192, -v193
    v_cvt_pk_f16_f32 v53, v194, -v195
    v_cvt_pk_f16_f32 v54, v196, -v197
    v_cvt_pk_f16_f32 v55, v198, -v199
    ds_write_b32 v4, v48 offset:8704
    ds_write_b32 v4, v49 offset:8976
    ds_write_b32 v4, v50 offset:9248
    ds_write_b32 v4, v51 offset:9520
    ds_write_b32 v4, v52 offset:9792
    ds_write_b32 v4, v53 offset:10064
    ds_write_b32 v4, v54 offset:10336
    ds_write_b32 v4, v55 offset:10608
    v_cvt_pk_f16_f32 v48, v232, v233
    v_cvt_pk_f16_f32 v49, v134, v135
    v_cvt_pk_f16_f32 v50, v200, v201
    v_cvt_pk_f16_f32 v51, v202, v203
    v_cvt_pk_f16_f32 v52, v204, v205
    v_cvt_pk_f16_f32 v53, v206, v207
    v_cvt_pk_f16_f32 v54, v208, v209
    v_cvt_pk_f16_f32 v55, v210, v211
    ds_write_b32 v4, v48 offset:13056
    ds_write_b32 v4, v49 offset:13328
    ds_write_b32 v4, v50 offset:13600
    ds_write_b32 v4, v51 offset:13872
    ds_write_b32 v4, v52 offset:14144
    ds_write_b32 v4, v53 offset:14416
    ds_write_b32 v4, v54 offset:14688
    ds_write_b32 v4, v55 offset:14960
    v_cvt_pk_f16_f32 v48, v212, v213
    v_cvt_pk_f16_f32 v49, v214, v215
    v_cvt_pk_f16_f32 v50, v216, v217
    v_cvt_pk_f16_f32 v51, v218, v219
    v_cvt_pk_f16_f32 v52, v220, v221
    v_cvt_pk_f16_f32 v53, v222, v223
    v_cvt_pk_f16_f32 v54, v224, v225
    v_cvt_pk_f16_f32 v55, v226, v227
    ds_write_b32 v4, v48 offset:15232
    ds_write_b32 v4, v49 offset:15504
    ds_write_b32 v4, v50 offset:15776
    ds_write_b32 v4, v51 offset:16048
    ds_write_b32 v4, v52 offset:16320
    ds_write_b32 v4, v53 offset:16592
    ds_write_b32 v4, v54 offset:16864
    ds_write_b32 v4, v55 offset:17136
    v_pk_mul_f32 v[32:33], v[80:81], v[120:121] op_sel_hi:[1,0]
    v_pk_mul_f32 v[34:35], v[80:81], v[122:123] op_sel_hi:[1,0]
    v_pk_mul_f32 v[36:37], v[80:81], v[124:125] op_sel_hi:[1,0]
    v_pk_mul_f32 v[38:39], v[80:81], v[126:127] op_sel_hi:[1,0]
    v_pk_mul_f32 v[40:41], v[80:81], v[128:129] op_sel_hi:[1,0]
    v_pk_mul_f32 v[42:43], v[80:81], v[130:131] op_sel_hi:[1,0]
    v_pk_mul_f32 v[44:45], v[80:81], v[132:133] op_sel_hi:[1,0]
    v_pk_mul_f32 v[46:47], v[170:171], v[120:121] op_sel_hi:[1,0]
    v_pk_fma_f32 v[32:33], v[80:81], v[120:121], v[32:33] op_sel:[1,1,0] op_sel_hi:[0,1,1] neg_lo:[1,0,0]
    v_pk_fma_f32 v[34:35], v[80:81], v[122:123], v[34:35] op_sel:[1,1,0] op_sel_hi:[0,1,1] neg_lo:[1,0,0]
    v_pk_fma_f32 v[36:37], v[80:81], v[124:125], v[36:37] op_sel:[1,1,0] op_sel_hi:[0,1,1] neg_lo:[1,0,0]
    v_pk_fma_f32 v[38:39], v[80:81], v[126:127], v[38:39] op_sel:[1,1,0] op_sel_hi:[0,1,1] neg_lo:[1,0,0]
    v_pk_fma_f32 v[40:41], v[80:81], v[128:129], v[40:41] op_sel:[1,1,0] op_sel_hi:[0,1,1] neg_lo:[1,0,0]
    v_pk_fma_f32 v[42:43], v[80:81], v[130:131], v[42:43] op_sel:[1,1,0] op_sel_hi:[0,1,1] neg_lo:[1,0,0]
    v_pk_fma_f32 v[44:45], v[80:81], v[132:133], v[44:45] op_sel:[1,1,0] op_sel_hi:[0,1,1] neg_lo:[1,0,0]
    v_pk_fma_f32 v[46:47], v[170:171], v[120:121], v[46:47] op_sel:[1,1,0] op_sel_hi:[0,1,1] neg_lo:[1,0,0]
    v_cvt_pk_f16_f32 v48, v32, -v33
    v_cvt_pk_f16_f32 v49, v34, -v35
    v_cvt_pk_f16_f32 v50, v36, -v37
    v_cvt_pk_f16_f32 v51, v38, -v39
    v_cvt_pk_f16_f32 v52, v40, -v41
    v_cvt_pk_f16_f32 v53, v42, -v43
    v_cvt_pk_f16_f32 v54, v44, -v45
    v_cvt_pk_f16_f32 v55, v46, -v47
    ds_write_b32 v4, v48 offset:272
    ds_write_b32 v4, v49 offset:544
    ds_write_b32 v4, v50 offset:816
    ds_write_b32 v4, v51 offset:1088
    ds_write_b32 v4, v52 offset:1360
    ds_write_b32 v4, v53 offset:1632
    ds_write_b32 v4, v54 offset:1904
    ds_write_b32 v4, v55 offset:2448
    v_pk_mul_f32 v[32:33], v[170:171], v[122:123] op_sel_hi:[1,0]
    v_pk_mul_f32 v[34:35], v[170:171], v[124:125] op_sel_hi:[1,0]
    v_pk_mul_f32 v[36:37], v[170:171], v[126:127] op_sel_hi:[1,0]
    v_pk_mul_f32 v[38:39], v[170:171], v[128:129] op_sel_hi:[1,0]
    v_pk_mul_f32 v[40:41], v[170:171], v[130:131] op_sel_hi:[1,0]
    v_pk_mul_f32 v[42:43], v[170:171], v[132:133] op_sel_hi:[1,0]
    v_pk_mul_f32 v[44:45], v[172:173], v[122:123] op_sel_hi:[1,0]
    v_pk_mul_f32 v[46:47], v[172:173], v[126:127] op_sel_hi:[1,0]
    v_pk_fma_f32 v[32:33], v[170:171], v[122:123], v[32:33] op_sel:[1,1,0] op_sel_hi:[0,1,1] neg_lo:[1,0,0]
    v_pk_fma_f32 v[34:35], v[170:171], v[124:125], v[34:35] op_sel:[1,1,0] op_sel_hi:[0,1,1] neg_lo:[1,0,0]
    v_pk_fma_f32 v[36:37], v[170:171], v[126:127], v[36:37] op_sel:[1,1,0] op_sel_hi:[0,1,1] neg_lo:[1,0,0]
    v_pk_fma_f32 v[38:39], v[170:171], v[128:129], v[38:39] op_sel:[1,1,0] op_sel_hi:[0,1,1] neg_lo:[1,0,0]
    v_pk_fma_f32 v[40:41], v[170:171], v[130:131], v[40:41] op_sel:[1,1,0] op_sel_hi:[0,1,1] neg_lo:[1,0,0]
    v_pk_fma_f32 v[42:43], v[170:171], v[132:133], v[42:43] op_sel:[1,1,0] op_sel_hi:[0,1,1] neg_lo:[1,0,0]
    v_pk_fma_f32 v[44:45], v[172:173], v[122:123], v[44:45] op_sel:[1,1,0] op_sel_hi:[0,1,1] neg_lo:[1,0,0]
    v_pk_fma_f32 v[46:47], v[172:173], v[126:127], v[46:47] op_sel:[1,1,0] op_sel_hi:[0,1,1] neg_lo:[1,0,0]
    v_cvt_pk_f16_f32 v48, v32, -v33
    v_cvt_pk_f16_f32 v49, v34, -v35
    v_cvt_pk_f16_f32 v50, v36, -v37
    v_cvt_pk_f16_f32 v51, v38, -v39
    v_cvt_pk_f16_f32 v52, v40, -v41
    v_cvt_pk_f16_f32 v53, v42, -v43
    v_cvt_pk_f16_f32 v54, v44, -v45
    v_cvt_pk_f16_f32 v55, v46, -v47
    ds_write_b32 v4, v48 offset:2720
    ds_write_b32 v4, v49 offset:2992
    ds_write_b32 v4, v50 offset:3264
    ds_write_b32 v4, v51 offset:3536
    ds_write_b32 v4, v52 offset:3808
    ds_write_b32 v4, v53 offset:4080
    ds_write_b32 v4, v54 offset:4624
    ds_write_b32 v4, v55 offset:4896
    v_pk_mul_f32 v[32:33], v[172:173], v[130:131] op_sel_hi:[1,0]
    v_pk_mul_f32 v[34:35], v[174:175], v[122:123] op_sel_hi:[1,0]
    v_pk_mul_f32 v[36:37], v[174:175], v[126:127] op_sel_hi:[1,0]
    v_pk_mul_f32 v[38:39], v[174:175], v[130:131] op_sel_hi:[1,0]
    v_pk_mul_f32 v[40:41], v[176:177], v[126:127] op_sel_hi:[1,0]
    v_pk_mul_f32 v[42:43], v[178:179], v[126:127] op_sel_hi:[1,0]
    v_pk_mul_f32 v[44:45], v[180:181], v[126:127] op_sel_hi:[1,0]
    v_pk_mul_f32 v[46:47], v[182:183], v[126:127] op_sel_hi:[1,0]
    v_pk_fma_f32 v[32:33], v[172:173], v[130:131], v[32:33] op_sel:[1,1,0] op_sel_hi:[0,1,1] neg_lo:[1,0,0]
    v_pk_fma_f32 v[34:35], v[174:175], v[122:123], v[34:35] op_sel:[1,1,0] op_sel_hi:[0,1,1] neg_lo:[1,0,0]
    v_pk_fma_f32 v[36:37], v[174:175], v[126:127], v[36:37] op_sel:[1,1,0] op_sel_hi:[0,1,1] neg_lo:[1,0,0]
    v_pk_fma_f32 v[38:39], v[174:175], v[130:131], v[38:39] op_sel:[1,1,0] op_sel_hi:[0,1,1] neg_lo:[1,0,0]
    v_pk_fma_f32 v[40:41], v[176:177], v[126:127], v[40:41] op_sel:[1,1,0] op_sel_hi:[0,1,1] neg_lo:[1,0,0]
    v_pk_fma_f32 v[42:43], v[178:179], v[126:127], v[42:43] op_sel:[1,1,0] op_sel_hi:[0,1,1] neg_lo:[1,0,0]
    v_pk_fma_f32 v[44:45], v[180:181], v[126:127], v[44:45] op_sel:[1,1,0] op_sel_hi:[0,1,1] neg_lo:[1,0,0]
    v_pk_fma_f32 v[46:47], v[182:183], v[126:127], v[46:47] op_sel:[1,1,0] op_sel_hi:[0,1,1] neg_lo:[1,0,0]
    v_cvt_pk_f16_f32 v48, v32, -v33
    v_cvt_pk_f16_f32 v49, v34, -v35
    v_cvt_pk_f16_f32 v50, v36, -v37
    v_cvt_pk_f16_f32 v51, v38, -v39
    v_cvt_pk_f16_f32 v52, v40, -v41
    v_cvt_pk_f16_f32 v53, v42, -v43
    v_cvt_pk_f16_f32 v54, v44, -v45
    v_cvt_pk_f16_f32 v55, v46, -v47
    ds_write_b32 v4, v48 offset:5168
    ds_write_b32 v4, v49 offset:5712
    ds_write_b32 v4, v50 offset:5984
    ds_write_b32 v4, v51 offset:6256
    ds_write_b32 v4, v52 offset:6800
    ds_write_b32 v4, v53 offset:7344
    ds_write_b32 v4, v54 offset:7888
    ds_write_b32 v4, v55 offset:8432
    v_pk_mul_f32 v[32:33], v[198:199], v[134:135] op_sel_hi:[1,0]
    v_pk_fma_f32 v[32:33], v[198:199], v[134:135], v[32:33] op_sel:[1,1,0] op_sel_hi:[0,1,1] neg_lo:[1,0,0]
    v_cvt_pk_f16_f32 v48, v32, -v33
    ds_write_b32 v4, v48 offset:10880
    s_waitcnt lgkmcnt(0)
    ds_read_b128 v[100:103], v5 offset:13056
    ds_read_b128 v[104:107], v5 offset:0
    ds_read_b128 v[108:111], v5 offset:4352
    ds_read_b128 v[112:115], v5 offset:8704
    ds_read_b128 v[116:119], v5 offset:13120
    ds_read_b128 v[120:123], v5 offset:64
    ds_read_b128 v[124:127], v5 offset:4416
    ds_read_b128 v[128:131], v5 offset:8768
    s_waitcnt lgkmcnt(4)
    v_mfma_f32_16x16x32_f16 v[88:91], v[104:107], v[100:103], v[88:91]
    v_mfma_f32_16x16x32_f16 v[92:95], v[108:111], v[100:103], v[92:95]
    v_mfma_f32_16x16x32_f16 v[96:99], v[112:115], v[100:103], v[96:99]
    s_waitcnt lgkmcnt(0)
    v_mfma_f32_16x16x32_f16 v[88:91], v[120:123], v[116:119], v[88:91]
    v_mfma_f32_16x16x32_f16 v[92:95], v[124:127], v[116:119], v[92:95]
    v_mfma_f32_16x16x32_f16 v[96:99], v[128:131], v[116:119], v[96:99]
    ds_read_b128 v[100:103], v5 offset:13184
    ds_read_b128 v[104:107], v5 offset:128
    ds_read_b128 v[108:111], v5 offset:4480
    ds_read_b128 v[112:115], v5 offset:8832
    ds_read_b128 v[116:119], v5 offset:13248
    ds_read_b128 v[120:123], v5 offset:192
    ds_read_b128 v[124:127], v5 offset:4544
    ds_read_b128 v[128:131], v5 offset:8896
    s_waitcnt lgkmcnt(4)
    v_mfma_f32_16x16x32_f16 v[88:91], v[104:107], v[100:103], v[88:91]
    v_mfma_f32_16x16x32_f16 v[92:95], v[108:111], v[100:103], v[92:95]
    v_mfma_f32_16x16x32_f16 v[96:99], v[112:115], v[100:103], v[96:99]
    s_waitcnt lgkmcnt(0)
    v_mfma_f32_16x16x32_f16 v[88:91], v[120:123], v[116:119], v[88:91]
    v_mfma_f32_16x16x32_f16 v[92:95], v[124:127], v[116:119], v[92:95]
    v_mfma_f32_16x16x32_f16 v[96:99], v[128:131], v[116:119], v[96:99]
    s_nop 7
    s_add_u32 s56, s55, 4096
    v_add_u32 v16, s56, v16
    v_add_u32 v20, s56, v20
    v_add_u32 v21, s56, v21
    v_add_u32 v22, s56, v22
    v_cvt_pk_f16_f32 v100, v88, v89
    v_cvt_pk_f16_f32 v101, v90, v91
    ds_write_b64 v16, v[100:101]

    ds_write_b32 v8, v92
    ds_write_b32 v9, v93
    ds_write_b32 v10, v94
    ds_write_b32 v11, v95
    ds_write_b32 v12, v96
    ds_write_b32 v13, v97
    ds_write_b32 v14, v98
    ds_write_b32 v15, v99
    s_waitcnt lgkmcnt(0)
    ds_read_b64 v[104:105], v17
    ds_read_b32 v106, v17 offset:8
    ds_read_b64 v[108:109], v18
    ds_read_b32 v110, v18 offset:8
    ds_read_b64 v[112:113], v19
    ds_read_b32 v114, v19 offset:8
    s_lshl_b32 s57, s54, 2
    s_add_u32 s57, s57, 7143424
    v_mov_b32 v126, 0x7ffffff0
    v_cmp_eq_u32 vcc, 0, v1
    v_mov_b32 v127, s57
    s_nop 0
    v_cndmask_b32 v126, v126, v127, vcc
    buffer_store_dword v69, v126, s[16:19], 0 offen sc1
    s_waitcnt lgkmcnt(0)
    v_cvt_pk_f16_f32 v120, v104, v104
    v_cvt_pk_f16_f32 v121, v105, v106
    ds_write_b64 v20, v[120:121]
    v_cvt_pk_f16_f32 v124, v108, v108
    v_cvt_pk_f16_f32 v125, v108, v109
    v_cvt_pk_f16_f32 v126, v109, v109
    v_cvt_pk_f16_f32 v127, v110, v110
    ds_write_b128 v21, v[124:127]
    v_cvt_pk_f16_f32 v128, v112, v112
    v_mov_b32 v129, v128
    v_cvt_pk_f16_f32 v130, v112, v113
    v_cvt_pk_f16_f32 v131, v113, v113
    ds_write_b128 v22, v[128:131]
    v_mov_b32 v132, v131
    v_mov_b32 v133, v131
    v_cvt_pk_f16_f32 v134, v114, v114
    v_mov_b32 v135, v134
    ds_write_b128 v22, v[132:135] offset:1024
    v_lshlrev_b32 v2, 4, v1
    v_add_u32 v3, s56, v2
    s_waitcnt lgkmcnt(0)
    ds_read_b128 v[136:139], v3
    ds_read_b128 v[140:143], v3 offset:1024
    ds_read_b128 v[144:147], v3 offset:2048
    ds_read_b128 v[148:151], v3 offset:3072
    s_lshl_b32 s57, s54, 12
    s_add_u32 s57, s57, 38797312
    s_waitcnt lgkmcnt(0)
    buffer_store_dwordx4 v[136:139], v2, s[16:19], s57 offen sc1
    buffer_store_dwordx4 v[140:143], v2, s[16:19], s57 offen offset:1024 sc1
    buffer_store_dwordx4 v[144:147], v2, s[16:19], s57 offen offset:2048 sc1
    buffer_store_dwordx4 v[148:151], v2, s[16:19], s57 offen offset:3072 sc1
    s_branch L_kg_skip_c
    L_kg_w3_c:

    v_lshlrev_b32 v250, 6, v1
    v_add_u32 v251, 41943040, v250
    buffer_load_dword v252, v251, s[16:19], 0 offen sc1
    v_add_u32 v251, 41947136, v250
    buffer_load_dword v253, v251, s[16:19], 0 offen sc1
    v_add_u32 v251, 41951232, v250
    buffer_load_dword v254, v251, s[16:19], 0 offen sc1
    v_add_u32 v251, 41955328, v250
    buffer_load_dword v255, v251, s[16:19], 0 offen sc1
    L_kg_skip_c:
    s_nop 1
    s_lshl_b32 s60, s54, 6
    s_add_u32 s60, s60, 41959424
    v_mov_b32 v162, s60
    v_mov_b32 v163, 0x7ffffff0
    v_cmp_eq_u32 vcc, 0, v1
    s_cmp_eq_u32 s36, 3
    s_cselect_b64 s[62:63], 0, -1
    s_and_b64 vcc, vcc, s[62:63]
    s_add_u32 s60, s90, 1
    v_mov_b32 v164, s60
    v_cndmask_b32 v163, v163, v162, vcc
    s_waitcnt vmcnt(0)
    buffer_store_dword v164, v163, s[16:19], 0 offen sc1

    v_add_u32 v251, 41943040, v250
    s_add_u32 s62, s90, 1
    v_subrev_u32 v249, s62, v252
    v_cmp_le_u32 vcc, 15, v249
    s_nop 3
    s_cmp_eq_u64 vcc, 0
    s_cbranch_scc1 L_ok_11
    s_mov_b32 s69, 20000
    L_poll_10:
    buffer_load_dword v252, v251, s[16:19], 0 offen sc1
    s_waitcnt vmcnt(0)
    s_add_u32 s62, s90, 1
    v_subrev_u32 v249, s62, v252
    v_cmp_le_u32 vcc, 15, v249
    s_sub_u32 s69, s69, 1
    s_cbranch_scc1 L_ok_11
    s_nop 1
    s_cmp_eq_u64 vcc, 0
    s_cbranch_scc1 L_ok_11
    s_sleep 2
    s_branch L_poll_10
    L_ok_11:
    v_add_u32 v251, 41947136, v250
    s_add_u32 s62, s90, 1
    v_subrev_u32 v249, s62, v253
    v_cmp_le_u32 vcc, 15, v249
    s_nop 3
    s_cmp_eq_u64 vcc, 0
    s_cbranch_scc1 L_ok_13
    s_mov_b32 s69, 20000
    L_poll_12:
    buffer_load_dword v253, v251, s[16:19], 0 offen sc1
    s_waitcnt vmcnt(0)
    s_add_u32 s62, s90, 1
    v_subrev_u32 v249, s62, v253
    v_cmp_le_u32 vcc, 15, v249
    s_sub_u32 s69, s69, 1
    s_cbranch_scc1 L_ok_13
    s_nop 1
    s_cmp_eq_u64 vcc, 0
    s_cbranch_scc1 L_ok_13
    s_sleep 2
    s_branch L_poll_12
    L_ok_13:
    v_add_u32 v251, 41951232, v250
    s_add_u32 s62, s90, 1
    v_subrev_u32 v249, s62, v254
    v_cmp_le_u32 vcc, 15, v249
    s_nop 3
    s_cmp_eq_u64 vcc, 0
    s_cbranch_scc1 L_ok_15
    s_mov_b32 s69, 20000
    L_poll_14:
    buffer_load_dword v254, v251, s[16:19], 0 offen sc1
    s_waitcnt vmcnt(0)
    s_add_u32 s62, s90, 1
    v_subrev_u32 v249, s62, v254
    v_cmp_le_u32 vcc, 15, v249
    s_sub_u32 s69, s69, 1
    s_cbranch_scc1 L_ok_15
    s_nop 1
    s_cmp_eq_u64 vcc, 0
    s_cbranch_scc1 L_ok_15
    s_sleep 2
    s_branch L_poll_14
    L_ok_15:
    v_add_u32 v251, 41955328, v250
    s_add_u32 s62, s90, 1
    v_subrev_u32 v249, s62, v255
    v_cmp_le_u32 vcc, 15, v249
    s_nop 3
    s_cmp_eq_u64 vcc, 0
    s_cbranch_scc1 L_ok_17
    s_mov_b32 s69, 20000
    L_poll_16:
    buffer_load_dword v255, v251, s[16:19], 0 offen sc1
    s_waitcnt vmcnt(0)
    s_add_u32 s62, s90, 1
    v_subrev_u32 v249, s62, v255
    v_cmp_le_u32 vcc, 15, v249
    s_sub_u32 s69, s69, 1
    s_cbranch_scc1 L_ok_17
    s_nop 1
    s_cmp_eq_u64 vcc, 0
    s_cbranch_scc1 L_ok_17
    s_sleep 2
    s_branch L_poll_16
    L_ok_17:
    s_sub_u32 s62, s2, 192
    s_mul_i32 s62, s62, 144
    s_mul_i32 s63, s36, 589824
    s_add_u32 s62, s62, s63
    s_add_u32 s62, s62, 2359296
    s_mul_i32 s63, s36, 9216

    v_add_u32 v250, 0, v1
    v_mul_u32_u24 v251, 7282, v250
    v_lshrrev_b32 v251, 16, v251
    v_mul_u32_u24 v252, 9, v251
    v_sub_u32 v252, v250, v252
    v_mul_u32_u24 v251, 9216, v251
    v_lshl_add_u32 v251, v252, 4, v251
    s_add_u32 m0, s63, 0
    s_nop 0
    buffer_load_dwordx4 v251, s[16:19], s62 offen sc1 lds

    v_add_u32 v250, 64, v1
    v_mul_u32_u24 v251, 7282, v250
    v_lshrrev_b32 v251, 16, v251
    v_mul_u32_u24 v252, 9, v251
    v_sub_u32 v252, v250, v252
    v_mul_u32_u24 v251, 9216, v251
    v_lshl_add_u32 v251, v252, 4, v251
    s_add_u32 m0, s63, 1024
    s_nop 0
    buffer_load_dwordx4 v251, s[16:19], s62 offen sc1 lds

    v_add_u32 v250, 128, v1
    v_mul_u32_u24 v251, 7282, v250
    v_lshrrev_b32 v251, 16, v251
    v_mul_u32_u24 v252, 9, v251
    v_sub_u32 v252, v250, v252
    v_mul_u32_u24 v251, 9216, v251
    v_lshl_add_u32 v251, v252, 4, v251
    s_add_u32 m0, s63, 2048
    s_nop 0
    buffer_load_dwordx4 v251, s[16:19], s62 offen sc1 lds

    v_add_u32 v250, 192, v1
    v_mul_u32_u24 v251, 7282, v250
    v_lshrrev_b32 v251, 16, v251
    v_mul_u32_u24 v252, 9, v251
    v_sub_u32 v252, v250, v252
    v_mul_u32_u24 v251, 9216, v251
    v_lshl_add_u32 v251, v252, 4, v251
    s_add_u32 m0, s63, 3072
    s_nop 0
    buffer_load_dwordx4 v251, s[16:19], s62 offen sc1 lds

    v_add_u32 v250, 256, v1
    v_mul_u32_u24 v251, 7282, v250
    v_lshrrev_b32 v251, 16, v251
    v_mul_u32_u24 v252, 9, v251
    v_sub_u32 v252, v250, v252
    v_mul_u32_u24 v251, 9216, v251
    v_lshl_add_u32 v251, v252, 4, v251
    s_add_u32 m0, s63, 4096
    s_nop 0
    buffer_load_dwordx4 v251, s[16:19], s62 offen sc1 lds

    v_add_u32 v250, 320, v1
    v_mul_u32_u24 v251, 7282, v250
    v_lshrrev_b32 v251, 16, v251
    v_mul_u32_u24 v252, 9, v251
    v_sub_u32 v252, v250, v252
    v_mul_u32_u24 v251, 9216, v251
    v_lshl_add_u32 v251, v252, 4, v251
    s_add_u32 m0, s63, 5120
    s_nop 0
    buffer_load_dwordx4 v251, s[16:19], s62 offen sc1 lds

    v_add_u32 v250, 384, v1
    v_mul_u32_u24 v251, 7282, v250
    v_lshrrev_b32 v251, 16, v251
    v_mul_u32_u24 v252, 9, v251
    v_sub_u32 v252, v250, v252
    v_mul_u32_u24 v251, 9216, v251
    v_lshl_add_u32 v251, v252, 4, v251
    s_add_u32 m0, s63, 6144
    s_nop 0
    buffer_load_dwordx4 v251, s[16:19], s62 offen sc1 lds

    v_add_u32 v250, 448, v1
    v_mul_u32_u24 v251, 7282, v250
    v_lshrrev_b32 v251, 16, v251
    v_mul_u32_u24 v252, 9, v251
    v_sub_u32 v252, v250, v252
    v_mul_u32_u24 v251, 9216, v251
    v_lshl_add_u32 v251, v252, 4, v251
    s_add_u32 m0, s63, 7168
    s_nop 0
    buffer_load_dwordx4 v251, s[16:19], s62 offen sc1 lds

    v_add_u32 v250, 512, v1
    v_mul_u32_u24 v251, 7282, v250
    v_lshrrev_b32 v251, 16, v251
    v_mul_u32_u24 v252, 9, v251
    v_sub_u32 v252, v250, v252
    v_mul_u32_u24 v251, 9216, v251
    v_lshl_add_u32 v251, v252, 4, v251
    s_add_u32 m0, s63, 8192
    s_nop 0
    buffer_load_dwordx4 v251, s[16:19], s62 offen sc1 lds

    s_load_dwordx2 s[54:55], s[0:1], 72
    s_load_dwordx2 s[56:57], s[0:1], 0
    s_load_dwordx2 s[58:59], s[0:1], 96
    s_load_dwordx2 s[60:61], s[0:1], 88

    s_waitcnt lgkmcnt(0)
    s_mov_b32 s20, s54
    s_mov_b32 s21, s55
    s_mov_b32 s22, 9216
    s_mov_b32 s23, 0x20000

    s_mov_b32 s24, s56
    s_mov_b32 s25, s57
    s_mov_b32 s26, 2359296
    s_mov_b32 s27, 0x20000

    s_mov_b32 s28, s58
    s_mov_b32 s29, s59
    s_mov_b32 s30, 2359296
    s_mov_b32 s31, 0x20000

    s_mov_b32 s32, s60
    s_mov_b32 s33, s61
    s_mov_b32 s34, 1152
    s_mov_b32 s35, 0x20000

    v_and_b32 v60, 63, v0
    s_barrier
    s_sub_u32 s3, s2, 192
    s_mul_i32 s40, s3, 9
    s_mul_i32 s41, s36, 30976
    s_add_u32 s41, s41, 36864
    s_load_dwordx2 s[46:47], s[0:1], 48
    s_mul_i32 s42, s36, 589824
    s_lshl_b32 s43, s40, 4
    s_add_u32 s42, s42, s43
    s_add_u32 s42, s42, 2359296
    s_mul_i32 s43, s36, 9216
    v_lshlrev_b32 v26, 4, v60

    v_and_b32 v30, 15, v60
    v_lshrrev_b32 v31, 4, v60
    v_and_b32 v32, 3, v60
    v_bfe_u32 v33, v60, 2, 2
    v_mul_u32_u24 v4, 4160, v33
    v_lshl_add_u32 v4, v32, 3, v4
    v_lshlrev_b32 v34, 4, v31
    v_sub_u32 v4, v4, v34
    v_add_u32 v4, 56, v4
    v_add_u32 v4, s41, v4
    v_mul_u32_u24 v5, 1280, v31
    v_lshl_add_u32 v5, v30, 4, v5
    v_add_u32 v5, 16656, v5
    v_add_u32 v5, s41, v5
    v_mul_u32_u24 v6, 144, v60
    v_add_u32 v7, 64, v26
    v_add_u32 v7, s41, v7
    v_lshlrev_b32 v34, 6, v30
    v_lshl_add_u32 v34, v31, 3, v34
    v_add_u32 v34, s41, v34
    v_add_u32 v23, 64, v34
    v_add_u32 v24, 26880, v34
    v_add_u32 v25, s41, v26
    v_add_u32 v25, 26880, v25
    v_mul_u32_u24 v34, 1280, v31
    v_lshl_add_u32 v34, v30, 4, v34
    v_add_u32 v34, 16640, v34
    v_add_u32 v34, s41, v34
    v_mov_b32 v36, 0
    v_mov_b32 v37, 0
    v_mov_b32 v38, 0
    v_mov_b32 v39, 0
    ds_write_b128 v34, v[36:39]
    ds_write_b128 v34, v[36:39] offset:5120
    v_lshrrev_b32 v35, 2, v60
    v_and_b32 v35, 3, v35
    v_mul_u32_u24 v35, 4160, v35
    v_and_b32 v34, 3, v60
    v_lshl_add_u32 v35, v34, 4, v35
    v_add_u32 v35, s41, v35
    ds_write_b128 v35, v[36:39] offset:0

    s_waitcnt vmcnt(0) lgkmcnt(0)
    s_barrier
    s_mov_b32 s62, s36
    s_add_u32 s63, s36, 4
    s_mov_b32 s64, 8
    s_sub_u32 s3, s2, 192
    s_and_b32 s4, s3, 7
    s_lshr_b32 s4, s4, 1
    s_mul_i32 s4, s4, 1327104
    s_lshr_b32 s5, s3, 3

    s_lshl_b32 s5, s5, 2
    s_add_u32 s5, s5, s36
    s_mul_i32 s5, s5, 41472
    s_add_u32 s61, s4, s5

    s_sub_u32 s3, s2, 192
    s_lshr_b32 s91, s3, 2
    s_and_b32 s92, s3, 3

    s_lshr_b32 s93, s36, 1
    s_and_b32 s94, s36, 1
    s_lshl_b32 s95, s91, 7
    s_lshl_b32 s3, s92, 5
    s_add_u32 s95, s95, s3
    s_lshl_b32 s3, s93, 5
    s_lshl_b32 s4, s94, 4
    s_add_u32 s96, s3, s4
    s_lshl_b32 s3, 0, 6
    s_add_u32 s5, s96, s3
    v_and_b32 v8, 15, v60
    v_lshrrev_b32 v9, 5, v60
    v_lshl_add_u32 v8, v9, 4, v8
    v_bfe_u32 v9, v60, 4, 1
    v_add_u32 v10, s95, v8
    v_mul_u32_u24 v10, 1152, v10
    v_lshl_add_u32 v10, v9, 4, v10
    s_lshl_b32 s6, s5, 1
    v_add_u32 v36, s6, v10
    v_lshlrev_b32 v11, 4, v9
    v_add_u32 v41, s6, v11
    s_mul_i32 s3, s91, 9
    s_add_u32 s3, s3, 0
    s_mul_i32 s97, s3, 196608
    s_lshr_b32 s3, s92, 1
    s_lshl_b32 s3, s3, 1
    s_add_u32 s3, s3, s93
    s_lshl_b32 s3, s3, 12
    s_add_u32 s97, s97, s3
    s_and_b32 s3, s92, 1
    s_lshl_b32 s3, s3, 1
    s_add_u32 s3, s3, s94
    s_lshl_b32 s3, s3, 10
    s_add_u32 s97, s97, s3
    s_add_u32 s97, s97, 7340032
    v_lshlrev_b32 v38, 4, v60
    v_lshrrev_b32 v8, 2, v60
    v_lshlrev_b32 v8, 12, v8
    v_and_b32 v9, 3, v60
    v_lshl_add_u32 v42, v9, 4, v8
    s_lshl_b32 s3, s5, 12
    s_lshl_b32 s4, s95, 1
    s_add_u32 s3, s3, s4
    s_add_u32 s98, s3, 4718592
    s_mul_i32 s99, s36, 6144
    v_bfe_u32 v9, v60, 2, 2
    v_bfe_u32 v10, v60, 4, 1
    v_lshl_add_u32 v9, v10, 3, v9
    v_lshlrev_b32 v9, 6, v9
    v_lshrrev_b32 v10, 5, v60
    v_lshl_add_u32 v9, v10, 5, v9
    v_and_b32 v10, 3, v60
    v_lshl_add_u32 v9, v10, 3, v9
    v_add_u32 v39, s99, v9
    v_and_b32 v12, 15, v60
    v_lshrrev_b32 v13, 4, v60
    v_lshrrev_b32 v14, 3, v12
    v_and_b32 v15, 7, v12
    v_lshrrev_b32 v16, 1, v15
    v_and_b32 v17, 1, v15
    v_lshlrev_b32 v17, 4, v17
    v_mov_b32 v18, 0x3f80
    v_lshlrev_b32 v18, v17, v18
    v_add_u32 v19, 2, v14

    v_cmp_eq_u32 s[50:51], v13, v14
    v_cmp_eq_u32 vcc, 0, v16
    s_nop 1
    s_and_b64 vcc, vcc, s[50:51]
    s_nop 1
    v_cndmask_b32 v88, 0, v18, vcc
    v_cmp_eq_u32 vcc, 1, v16
    s_nop 1
    s_and_b64 vcc, vcc, s[50:51]
    s_nop 1
    v_cndmask_b32 v89, 0, v18, vcc
    v_cmp_eq_u32 vcc, 2, v16
    s_nop 1
    s_and_b64 vcc, vcc, s[50:51]
    s_nop 1
    v_cndmask_b32 v90, 0, v18, vcc
    v_cmp_eq_u32 vcc, 3, v16
    s_nop 1
    s_and_b64 vcc, vcc, s[50:51]
    s_nop 1
    v_cndmask_b32 v91, 0, v18, vcc
    v_cmp_eq_u32 s[50:51], v13, v19
    v_cmp_eq_u32 vcc, 0, v16
    s_nop 1
    s_and_b64 vcc, vcc, s[50:51]
    s_nop 1
    v_cndmask_b32 v92, 0, v18, vcc
    v_cmp_eq_u32 vcc, 1, v16
    s_nop 1
    s_and_b64 vcc, vcc, s[50:51]
    s_nop 1
    v_cndmask_b32 v93, 0, v18, vcc
    v_cmp_eq_u32 vcc, 2, v16
    s_nop 1
    s_and_b64 vcc, vcc, s[50:51]
    s_nop 1
    v_cndmask_b32 v94, 0, v18, vcc
    v_cmp_eq_u32 vcc, 3, v16
    s_nop 1
    s_and_b64 vcc, vcc, s[50:51]
    s_nop 1
    v_cndmask_b32 v95, 0, v18, vcc
    buffer_load_dwordx4 v[64:67], v36, s[24:27], 0 offen offset:0
    buffer_load_dwordx4 v[228:231], v41, s[32:35], 0 offen offset:0
    buffer_load_dwordx4 v[68:71], v36, s[24:27], 0 offen offset:128
    buffer_load_dwordx4 v[232:235], v41, s[32:35], 0 offen offset:128
    buffer_load_dwordx4 v[72:75], v36, s[24:27], 0 offen offset:256
    buffer_load_dwordx4 v[236:239], v41, s[32:35], 0 offen offset:256
    buffer_load_dwordx4 v[76:79], v36, s[24:27], 0 offen offset:384
    buffer_load_dwordx4 v[240:243], v41, s[32:35], 0 offen offset:384
    buffer_load_dwordx4 v[80:83], v36, s[24:27], 0 offen offset:512
    buffer_load_dwordx4 v[244:247], v41, s[32:35], 0 offen offset:512
    buffer_load_dwordx4 v[84:87], v36, s[24:27], 0 offen offset:640
    buffer_load_dwordx4 v[248:251], v41, s[32:35], 0 offen offset:640
    s_add_u32 s54, s40, s62
    s_lshl_b32 s55, s62, 4
    v_add_u32 v100, s55, v6
    v_subrev_u32 v101, 136, v100
    v_max_i32 v102, 0, v101

    ds_read_b64 v[104:105], v102 offset:0
    ds_read_b128 v[106:109], v100 offset:0
    ds_read_b64 v[110:111], v101 offset:9216
    ds_read_b128 v[112:115], v100 offset:9216
    ds_read_b64 v[116:117], v101 offset:18432
    ds_read_b128 v[118:121], v100 offset:18432
    ds_read_b64 v[122:123], v101 offset:27648
    ds_read_b128 v[124:127], v100 offset:27648
    s_waitcnt lgkmcnt(6)
    v_cmp_eq_u32 vcc, 0, v60
    v_mov_b32 v103, 0
    s_nop 0
    v_cndmask_b32 v104, v104, v103, vcc
    v_cndmask_b32 v105, v105, v103, vcc
    v_alignbit_b32 v128, v105, v104, 16
    v_alignbit_b32 v129, v106, v105, 16
    v_alignbit_b32 v130, v107, v106, 16
    v_alignbit_b32 v131, v108, v107, 16
    ds_write_b128 v7, v[106:109] offset:0
    v_alignbit_b32 v132, v106, v105, 16
    v_alignbit_b32 v133, v107, v106, 16
    v_alignbit_b32 v134, v108, v107, 16
    v_alignbit_b32 v135, v109, v108, 16
    ds_write_b128 v7, v[128:131] offset:12480
    v_mov_b32 v136, v105
    v_mov_b32 v137, v106
    v_mov_b32 v138, v107
    v_mov_b32 v139, v108
    ds_write_b128 v7, v[132:135] offset:4160
    ds_write_b128 v7, v[136:139] offset:8320

    s_waitcnt lgkmcnt(8)
    v_alignbit_b32 v140, v111, v110, 16
    v_alignbit_b32 v141, v112, v111, 16
    v_alignbit_b32 v142, v113, v112, 16
    v_alignbit_b32 v143, v114, v113, 16
    ds_write_b128 v7, v[112:115] offset:1024
    v_alignbit_b32 v144, v112, v111, 16
    v_alignbit_b32 v145, v113, v112, 16
    v_alignbit_b32 v146, v114, v113, 16
    v_alignbit_b32 v147, v115, v114, 16
    ds_write_b128 v7, v[140:143] offset:13504
    v_mov_b32 v148, v111
    v_mov_b32 v149, v112
    v_mov_b32 v150, v113
    v_mov_b32 v151, v114
    ds_write_b128 v7, v[144:147] offset:5184
    ds_write_b128 v7, v[148:151] offset:9344

    s_waitcnt lgkmcnt(10)
    v_alignbit_b32 v128, v117, v116, 16
    v_alignbit_b32 v129, v118, v117, 16
    v_alignbit_b32 v130, v119, v118, 16
    v_alignbit_b32 v131, v120, v119, 16
    ds_write_b128 v7, v[118:121] offset:2048
    v_alignbit_b32 v132, v118, v117, 16
    v_alignbit_b32 v133, v119, v118, 16
    v_alignbit_b32 v134, v120, v119, 16
    v_alignbit_b32 v135, v121, v120, 16
    ds_write_b128 v7, v[128:131] offset:14528
    v_mov_b32 v136, v117
    v_mov_b32 v137, v118
    v_mov_b32 v138, v119
    v_mov_b32 v139, v120
    ds_write_b128 v7, v[132:135] offset:6208
    ds_write_b128 v7, v[136:139] offset:10368

    s_waitcnt lgkmcnt(12)
    v_alignbit_b32 v140, v123, v122, 16
    v_alignbit_b32 v141, v124, v123, 16
    v_alignbit_b32 v142, v125, v124, 16
    v_alignbit_b32 v143, v126, v125, 16
    ds_write_b128 v7, v[124:127] offset:3072
    v_alignbit_b32 v144, v124, v123, 16
    v_alignbit_b32 v145, v125, v124, 16
    v_alignbit_b32 v146, v126, v125, 16
    v_alignbit_b32 v147, v127, v126, 16
    ds_write_b128 v7, v[140:143] offset:15552
    v_mov_b32 v148, v123
    v_mov_b32 v149, v124
    v_mov_b32 v150, v125
    v_mov_b32 v151, v126
    ds_write_b128 v7, v[144:147] offset:7232
    ds_write_b128 v7, v[148:151] offset:11392

    v_min_u32 v8, 8, v60
    v_add_u32 v8, s40, v8
    v_lshlrev_b32 v8, 6, v8
    v_add_u32 v9, 41959424, v8

    s_mov_b32 s69, 20000
    L_poll_18:
    buffer_load_dword v10, v9, s[16:19], 0 offen sc1
    s_waitcnt vmcnt(0)
    s_add_u32 s4, s90, 1
    v_subrev_u32 v11, s4, v10
    v_cmp_le_u32 vcc, 15, v11
    s_sub_u32 s69, s69, 1
    s_cbranch_scc1 L_ok_19
    s_nop 1
    s_cmp_eq_u64 vcc, 0
    s_cbranch_scc1 L_ok_19
    s_sleep 2
    s_branch L_poll_18
    L_ok_19:
    s_add_u32 s55, s40, s36
    s_lshl_b32 s55, s55, 12
    s_add_u32 s55, s55, 38797312

    s_add_u32 m0, s41, 16896
    s_add_u32 s56, s55, 0
    buffer_load_dwordx4 v26, s[16:19], s56 offen sc1 lds
    s_add_u32 m0, s41, 18176
    s_add_u32 s56, s55, 1024
    buffer_load_dwordx4 v26, s[16:19], s56 offen sc1 lds
    s_add_u32 m0, s41, 19456
    s_add_u32 s56, s55, 2048
    buffer_load_dwordx4 v26, s[16:19], s56 offen sc1 lds
    s_add_u32 m0, s41, 20736
    s_add_u32 s56, s55, 3072
    buffer_load_dwordx4 v26, s[16:19], s56 offen sc1 lds
    s_lshl_b32 s56, s54, 1
    s_and_b32 s57, s56, 0xfffffffc
    s_load_dword s59, s[46:47], s57
    s_lshl_b32 s56, s54, 2
    s_add_u32 s56, s56, 7143424

    v_mov_b32 v61, s56
    buffer_load_dword v61, v61, s[16:19], 0 offen sc1
    s_bitcmp1_b32 s54, 0
    s_cselect_b32 s60, 0, 16
    s_waitcnt vmcnt(0) lgkmcnt(0)
    s_add_u32 s55, s40, s63
    s_lshl_b32 s55, s55, 12
    s_add_u32 s55, s55, 38797312

    s_add_u32 m0, s41, 22016
    s_add_u32 s56, s55, 0
    buffer_load_dwordx4 v26, s[16:19], s56 offen sc1 lds
    s_add_u32 m0, s41, 23296
    s_add_u32 s56, s55, 1024
    buffer_load_dwordx4 v26, s[16:19], s56 offen sc1 lds
    s_add_u32 m0, s41, 24576
    s_add_u32 s56, s55, 2048
    buffer_load_dwordx4 v26, s[16:19], s56 offen sc1 lds
    s_add_u32 m0, s41, 25856
    s_add_u32 s56, s55, 3072
    buffer_load_dwordx4 v26, s[16:19], s56 offen sc1 lds
    ds_read_b128 v[132:135], v5 offset:240
    ds_read_b64_tr_b16 v[100:101], v4 offset:8
    ds_read_b64_tr_b16 v[102:103], v4 offset:0
    ds_read_b64_tr_b16 v[104:105], v4 offset:40
    ds_read_b64_tr_b16 v[106:107], v4 offset:32
    ds_read_b128 v[136:139], v5 offset:496
    ds_read_b128 v[140:143], v5 offset:752
    ds_read_b128 v[144:147], v5 offset:1008
    ds_read_b64_tr_b16 v[108:109], v4 offset:1032
    ds_read_b64_tr_b16 v[110:111], v4 offset:1024
    ds_read_b64_tr_b16 v[112:113], v4 offset:1064
    ds_read_b64_tr_b16 v[114:115], v4 offset:1056
    ds_read_b64_tr_b16 v[116:117], v4 offset:2056
    ds_read_b64_tr_b16 v[118:119], v4 offset:2048
    ds_read_b64_tr_b16 v[120:121], v4 offset:2088
    ds_read_b64_tr_b16 v[122:123], v4 offset:2080
    ds_read_b64_tr_b16 v[124:125], v4 offset:3080
    ds_read_b64_tr_b16 v[126:127], v4 offset:3072
    ds_read_b64_tr_b16 v[128:129], v4 offset:3112
    ds_read_b64_tr_b16 v[130:131], v4 offset:3104
    s_waitcnt lgkmcnt(15)
    v_mfma_f32_16x16x32_f16 v[196:199], v[100:103], v[132:135], 0
    ds_read_b128 v[180:183], v5 offset:224
    v_mfma_f32_16x16x32_f16 v[200:203], v[104:107], v[132:135], 0
    ds_read_b64_tr_b16 v[148:149], v4 offset:72
    s_waitcnt lgkmcnt(15)
    v_mfma_f32_16x16x32_f16 v[204:207], v[100:103], v[136:139], 0
    ds_read_b64_tr_b16 v[150:151], v4 offset:64
    v_mfma_f32_16x16x32_f16 v[208:211], v[104:107], v[136:139], 0
    ds_read_b64_tr_b16 v[152:153], v4 offset:104
    v_mfma_f32_16x16x32_f16 v[212:215], v[100:103], v[140:143], 0
    ds_read_b64_tr_b16 v[154:155], v4 offset:96
    v_mfma_f32_16x16x32_f16 v[216:219], v[104:107], v[140:143], 0
    ds_read_b128 v[184:187], v5 offset:480
    s_waitcnt lgkmcnt(15)
    v_mfma_f32_16x16x32_f16 v[220:223], v[100:103], v[144:147], 0
    ds_read_b128 v[188:191], v5 offset:736
    s_add_u32 s69, s61, 0
    buffer_load_dwordx4 v[252:255], v26, s[12:15], s69 offen
    v_mfma_f32_16x16x32_f16 v[224:227], v[104:107], v[144:147], 0
    ds_read_b128 v[192:195], v5 offset:992
    v_mfma_f32_16x16x32_f16 v[204:207], v[108:111], v[132:135], v[204:207]
    ds_read_b64_tr_b16 v[156:157], v4 offset:1096
    s_waitcnt lgkmcnt(15)
    v_mfma_f32_16x16x32_f16 v[208:211], v[112:115], v[132:135], v[208:211]
    ds_read_b64_tr_b16 v[158:159], v4 offset:1088
    v_mfma_f32_16x16x32_f16 v[212:215], v[108:111], v[136:139], v[212:215]
    ds_read_b64_tr_b16 v[160:161], v4 offset:1128
    v_mfma_f32_16x16x32_f16 v[216:219], v[112:115], v[136:139], v[216:219]
    ds_read_b64_tr_b16 v[162:163], v4 offset:1120
    v_mfma_f32_16x16x32_f16 v[220:223], v[108:111], v[140:143], v[220:223]
    ds_read_b64_tr_b16 v[164:165], v4 offset:2120
    v_mfma_f32_16x16x32_f16 v[224:227], v[112:115], v[140:143], v[224:227]
    ds_read_b64_tr_b16 v[166:167], v4 offset:2112
    s_add_u32 s69, s61, 1024
    buffer_load_dwordx4 v[252:255], v26, s[12:15], s69 offen
    v_mfma_f32_16x16x32_f16 v[212:215], v[116:119], v[132:135], v[212:215]
    ds_read_b64_tr_b16 v[168:169], v4 offset:2152
    s_waitcnt lgkmcnt(15)
    v_mfma_f32_16x16x32_f16 v[216:219], v[120:123], v[132:135], v[216:219]
    ds_read_b64_tr_b16 v[170:171], v4 offset:2144
    v_mfma_f32_16x16x32_f16 v[220:223], v[116:119], v[136:139], v[220:223]
    ds_read_b64_tr_b16 v[172:173], v4 offset:3144
    v_mfma_f32_16x16x32_f16 v[224:227], v[120:123], v[136:139], v[224:227]
    ds_read_b64_tr_b16 v[174:175], v4 offset:3136
    v_mfma_f32_16x16x32_f16 v[220:223], v[124:127], v[132:135], v[220:223]
    ds_read_b64_tr_b16 v[176:177], v4 offset:3176
    v_mfma_f32_16x16x32_f16 v[224:227], v[128:131], v[132:135], v[224:227]
    ds_read_b64_tr_b16 v[178:179], v4 offset:3168
    s_waitcnt lgkmcnt(15)
    v_mfma_f32_16x16x32_f16 v[196:199], v[148:151], v[180:183], v[196:199]
    ds_read_b128 v[132:135], v5 offset:208
    s_add_u32 s69, s61, 2048
    buffer_load_dwordx4 v[252:255], v26, s[12:15], s69 offen
    v_mfma_f32_16x16x32_f16 v[200:203], v[152:155], v[180:183], v[200:203]
    ds_read_b64_tr_b16 v[100:101], v4 offset:136
    s_waitcnt lgkmcnt(15)
    v_mfma_f32_16x16x32_f16 v[204:207], v[148:151], v[184:187], v[204:207]
    ds_read_b64_tr_b16 v[102:103], v4 offset:128
    v_mfma_f32_16x16x32_f16 v[208:211], v[152:155], v[184:187], v[208:211]
    ds_read_b64_tr_b16 v[104:105], v4 offset:168
    v_mfma_f32_16x16x32_f16 v[212:215], v[148:151], v[188:191], v[212:215]
    ds_read_b64_tr_b16 v[106:107], v4 offset:160
    v_mfma_f32_16x16x32_f16 v[216:219], v[152:155], v[188:191], v[216:219]
    ds_read_b128 v[136:139], v5 offset:464
    s_waitcnt lgkmcnt(15)
    v_mfma_f32_16x16x32_f16 v[220:223], v[148:151], v[192:195], v[220:223]
    ds_read_b128 v[140:143], v5 offset:720
    v_mfma_f32_16x16x32_f16 v[224:227], v[152:155], v[192:195], v[224:227]
    ds_read_b128 v[144:147], v5 offset:976
    s_add_u32 s69, s61, 3072
    buffer_load_dwordx4 v[252:255], v26, s[12:15], s69 offen
    v_mfma_f32_16x16x32_f16 v[204:207], v[156:159], v[180:183], v[204:207]
    ds_read_b64_tr_b16 v[108:109], v4 offset:1160
    s_waitcnt lgkmcnt(15)
    v_mfma_f32_16x16x32_f16 v[208:211], v[160:163], v[180:183], v[208:211]
    ds_read_b64_tr_b16 v[110:111], v4 offset:1152
    v_mfma_f32_16x16x32_f16 v[212:215], v[156:159], v[184:187], v[212:215]
    ds_read_b64_tr_b16 v[112:113], v4 offset:1192
    v_mfma_f32_16x16x32_f16 v[216:219], v[160:163], v[184:187], v[216:219]
    ds_read_b64_tr_b16 v[114:115], v4 offset:1184
    v_mfma_f32_16x16x32_f16 v[220:223], v[156:159], v[188:191], v[220:223]
    ds_read_b64_tr_b16 v[116:117], v4 offset:2184
    v_mfma_f32_16x16x32_f16 v[224:227], v[160:163], v[188:191], v[224:227]
    ds_read_b64_tr_b16 v[118:119], v4 offset:2176
    v_mfma_f32_16x16x32_f16 v[212:215], v[164:167], v[180:183], v[212:215]
    ds_read_b64_tr_b16 v[120:121], v4 offset:2216
    s_add_u32 s69, s61, 4096
    buffer_load_dwordx4 v[252:255], v26, s[12:15], s69 offen
    s_waitcnt lgkmcnt(15)
    v_mfma_f32_16x16x32_f16 v[216:219], v[168:171], v[180:183], v[216:219]
    ds_read_b64_tr_b16 v[122:123], v4 offset:2208
    v_mfma_f32_16x16x32_f16 v[220:223], v[164:167], v[184:187], v[220:223]
    ds_read_b64_tr_b16 v[124:125], v4 offset:3208
    v_mfma_f32_16x16x32_f16 v[224:227], v[168:171], v[184:187], v[224:227]
    ds_read_b64_tr_b16 v[126:127], v4 offset:3200
    v_mfma_f32_16x16x32_f16 v[220:223], v[172:175], v[180:183], v[220:223]
    ds_read_b64_tr_b16 v[128:129], v4 offset:3240
    v_mfma_f32_16x16x32_f16 v[224:227], v[176:179], v[180:183], v[224:227]
    ds_read_b64_tr_b16 v[130:131], v4 offset:3232
    s_waitcnt lgkmcnt(15)
    v_mfma_f32_16x16x32_f16 v[196:199], v[100:103], v[132:135], v[196:199]
    ds_read_b128 v[180:183], v5 offset:192
    v_mfma_f32_16x16x32_f16 v[200:203], v[104:107], v[132:135], v[200:203]
    ds_read_b64_tr_b16 v[148:149], v4 offset:200
    s_add_u32 s69, s61, 5120
    buffer_load_dwordx4 v[252:255], v26, s[12:15], s69 offen
    s_waitcnt lgkmcnt(15)
    v_mfma_f32_16x16x32_f16 v[204:207], v[100:103], v[136:139], v[204:207]
    ds_read_b64_tr_b16 v[150:151], v4 offset:192
    v_mfma_f32_16x16x32_f16 v[208:211], v[104:107], v[136:139], v[208:211]
    ds_read_b64_tr_b16 v[152:153], v4 offset:232
    v_mfma_f32_16x16x32_f16 v[212:215], v[100:103], v[140:143], v[212:215]
    ds_read_b64_tr_b16 v[154:155], v4 offset:224
    v_mfma_f32_16x16x32_f16 v[216:219], v[104:107], v[140:143], v[216:219]
    ds_read_b128 v[184:187], v5 offset:448
    s_waitcnt lgkmcnt(15)
    v_mfma_f32_16x16x32_f16 v[220:223], v[100:103], v[144:147], v[220:223]
    ds_read_b128 v[188:191], v5 offset:704
    v_mfma_f32_16x16x32_f16 v[224:227], v[104:107], v[144:147], v[224:227]
    ds_read_b128 v[192:195], v5 offset:960
    v_mfma_f32_16x16x32_f16 v[204:207], v[108:111], v[132:135], v[204:207]
    ds_read_b64_tr_b16 v[156:157], v4 offset:1224
    s_add_u32 s69, s61, 6144
    buffer_load_dwordx4 v[252:255], v26, s[12:15], s69 offen
    s_waitcnt lgkmcnt(15)
    v_mfma_f32_16x16x32_f16 v[208:211], v[112:115], v[132:135], v[208:211]
    ds_read_b64_tr_b16 v[158:159], v4 offset:1216
    v_mfma_f32_16x16x32_f16 v[212:215], v[108:111], v[136:139], v[212:215]
    ds_read_b64_tr_b16 v[160:161], v4 offset:1256
    v_mfma_f32_16x16x32_f16 v[216:219], v[112:115], v[136:139], v[216:219]
    ds_read_b64_tr_b16 v[162:163], v4 offset:1248
    v_mfma_f32_16x16x32_f16 v[220:223], v[108:111], v[140:143], v[220:223]
    ds_read_b64_tr_b16 v[164:165], v4 offset:2248
    v_mfma_f32_16x16x32_f16 v[224:227], v[112:115], v[140:143], v[224:227]
    ds_read_b64_tr_b16 v[166:167], v4 offset:2240
    v_mfma_f32_16x16x32_f16 v[212:215], v[116:119], v[132:135], v[212:215]
    ds_read_b64_tr_b16 v[168:169], v4 offset:2280
    s_waitcnt lgkmcnt(15)
    v_mfma_f32_16x16x32_f16 v[216:219], v[120:123], v[132:135], v[216:219]
    ds_read_b64_tr_b16 v[170:171], v4 offset:2272
    s_add_u32 s69, s61, 7168
    buffer_load_dwordx4 v[252:255], v26, s[12:15], s69 offen
    v_mfma_f32_16x16x32_f16 v[220:223], v[116:119], v[136:139], v[220:223]
    ds_read_b64_tr_b16 v[172:173], v4 offset:3272
    v_mfma_f32_16x16x32_f16 v[224:227], v[120:123], v[136:139], v[224:227]
    ds_read_b64_tr_b16 v[174:175], v4 offset:3264
    v_mfma_f32_16x16x32_f16 v[220:223], v[124:127], v[132:135], v[220:223]
    ds_read_b64_tr_b16 v[176:177], v4 offset:3304
    v_mfma_f32_16x16x32_f16 v[224:227], v[128:131], v[132:135], v[224:227]
    ds_read_b64_tr_b16 v[178:179], v4 offset:3296
    s_waitcnt lgkmcnt(15)
    v_mfma_f32_16x16x32_f16 v[196:199], v[148:151], v[180:183], v[196:199]
    ds_read_b128 v[132:135], v5 offset:176
    v_mfma_f32_16x16x32_f16 v[200:203], v[152:155], v[180:183], v[200:203]
    ds_read_b64_tr_b16 v[100:101], v4 offset:264
    s_waitcnt lgkmcnt(15)
    v_mfma_f32_16x16x32_f16 v[204:207], v[148:151], v[184:187], v[204:207]
    ds_read_b64_tr_b16 v[102:103], v4 offset:256
    s_add_u32 s69, s61, 8192
    buffer_load_dwordx4 v[252:255], v26, s[12:15], s69 offen
    v_mfma_f32_16x16x32_f16 v[208:211], v[152:155], v[184:187], v[208:211]
    ds_read_b64_tr_b16 v[104:105], v4 offset:296
    v_mfma_f32_16x16x32_f16 v[212:215], v[148:151], v[188:191], v[212:215]
    ds_read_b64_tr_b16 v[106:107], v4 offset:288
    v_mfma_f32_16x16x32_f16 v[216:219], v[152:155], v[188:191], v[216:219]
    ds_read_b128 v[136:139], v5 offset:432
    s_waitcnt lgkmcnt(15)
    v_mfma_f32_16x16x32_f16 v[220:223], v[148:151], v[192:195], v[220:223]
    ds_read_b128 v[140:143], v5 offset:688
    v_mfma_f32_16x16x32_f16 v[224:227], v[152:155], v[192:195], v[224:227]
    ds_read_b128 v[144:147], v5 offset:944
    v_mfma_f32_16x16x32_f16 v[204:207], v[156:159], v[180:183], v[204:207]
    ds_read_b64_tr_b16 v[108:109], v4 offset:1288
    s_waitcnt lgkmcnt(15)
    v_mfma_f32_16x16x32_f16 v[208:211], v[160:163], v[180:183], v[208:211]
    ds_read_b64_tr_b16 v[110:111], v4 offset:1280
    s_add_u32 s69, s61, 9216
    buffer_load_dwordx4 v[252:255], v26, s[12:15], s69 offen
    v_mfma_f32_16x16x32_f16 v[212:215], v[156:159], v[184:187], v[212:215]
    ds_read_b64_tr_b16 v[112:113], v4 offset:1320
    v_mfma_f32_16x16x32_f16 v[216:219], v[160:163], v[184:187], v[216:219]
    ds_read_b64_tr_b16 v[114:115], v4 offset:1312
    v_mfma_f32_16x16x32_f16 v[220:223], v[156:159], v[188:191], v[220:223]
    ds_read_b64_tr_b16 v[116:117], v4 offset:2312
    v_mfma_f32_16x16x32_f16 v[224:227], v[160:163], v[188:191], v[224:227]
    ds_read_b64_tr_b16 v[118:119], v4 offset:2304
    v_mfma_f32_16x16x32_f16 v[212:215], v[164:167], v[180:183], v[212:215]
    ds_read_b64_tr_b16 v[120:121], v4 offset:2344
    s_waitcnt lgkmcnt(15)
    v_mfma_f32_16x16x32_f16 v[216:219], v[168:171], v[180:183], v[216:219]
    ds_read_b64_tr_b16 v[122:123], v4 offset:2336
    v_mfma_f32_16x16x32_f16 v[220:223], v[164:167], v[184:187], v[220:223]
    ds_read_b64_tr_b16 v[124:125], v4 offset:3336
    s_add_u32 s69, s61, 10240
    buffer_load_dwordx4 v[252:255], v26, s[12:15], s69 offen
    v_mfma_f32_16x16x32_f16 v[224:227], v[168:171], v[184:187], v[224:227]
    ds_read_b64_tr_b16 v[126:127], v4 offset:3328
    v_mfma_f32_16x16x32_f16 v[220:223], v[172:175], v[180:183], v[220:223]
    ds_read_b64_tr_b16 v[128:129], v4 offset:3368
    v_mfma_f32_16x16x32_f16 v[224:227], v[176:179], v[180:183], v[224:227]
    ds_read_b64_tr_b16 v[130:131], v4 offset:3360
    s_waitcnt lgkmcnt(15)
    v_mfma_f32_16x16x32_f16 v[196:199], v[100:103], v[132:135], v[196:199]
    ds_read_b128 v[180:183], v5 offset:160
    v_mfma_f32_16x16x32_f16 v[200:203], v[104:107], v[132:135], v[200:203]
    ds_read_b64_tr_b16 v[148:149], v4 offset:328
    s_waitcnt lgkmcnt(15)
    v_mfma_f32_16x16x32_f16 v[204:207], v[100:103], v[136:139], v[204:207]
    ds_read_b64_tr_b16 v[150:151], v4 offset:320
    v_mfma_f32_16x16x32_f16 v[208:211], v[104:107], v[136:139], v[208:211]
    ds_read_b64_tr_b16 v[152:153], v4 offset:360
    s_add_u32 s69, s61, 11264
    buffer_load_dwordx4 v[252:255], v26, s[12:15], s69 offen
    v_mfma_f32_16x16x32_f16 v[212:215], v[100:103], v[140:143], v[212:215]
    ds_read_b64_tr_b16 v[154:155], v4 offset:352
    v_mfma_f32_16x16x32_f16 v[216:219], v[104:107], v[140:143], v[216:219]
    ds_read_b128 v[184:187], v5 offset:416
    s_waitcnt lgkmcnt(15)
    v_mfma_f32_16x16x32_f16 v[220:223], v[100:103], v[144:147], v[220:223]
    ds_read_b128 v[188:191], v5 offset:672
    v_mfma_f32_16x16x32_f16 v[224:227], v[104:107], v[144:147], v[224:227]
    ds_read_b128 v[192:195], v5 offset:928
    v_mfma_f32_16x16x32_f16 v[204:207], v[108:111], v[132:135], v[204:207]
    ds_read_b64_tr_b16 v[156:157], v4 offset:1352
    s_waitcnt lgkmcnt(15)
    v_mfma_f32_16x16x32_f16 v[208:211], v[112:115], v[132:135], v[208:211]
    ds_read_b64_tr_b16 v[158:159], v4 offset:1344
    v_mfma_f32_16x16x32_f16 v[212:215], v[108:111], v[136:139], v[212:215]
    ds_read_b64_tr_b16 v[160:161], v4 offset:1384
    s_add_u32 s69, s61, 12288
    buffer_load_dwordx4 v[252:255], v26, s[12:15], s69 offen
    v_mfma_f32_16x16x32_f16 v[216:219], v[112:115], v[136:139], v[216:219]
    ds_read_b64_tr_b16 v[162:163], v4 offset:1376
    v_mfma_f32_16x16x32_f16 v[220:223], v[108:111], v[140:143], v[220:223]
    ds_read_b64_tr_b16 v[164:165], v4 offset:2376
    v_mfma_f32_16x16x32_f16 v[224:227], v[112:115], v[140:143], v[224:227]
    ds_read_b64_tr_b16 v[166:167], v4 offset:2368
    v_mfma_f32_16x16x32_f16 v[212:215], v[116:119], v[132:135], v[212:215]
    ds_read_b64_tr_b16 v[168:169], v4 offset:2408
    s_waitcnt lgkmcnt(15)
    v_mfma_f32_16x16x32_f16 v[216:219], v[120:123], v[132:135], v[216:219]
    ds_read_b64_tr_b16 v[170:171], v4 offset:2400
    v_mfma_f32_16x16x32_f16 v[220:223], v[116:119], v[136:139], v[220:223]
    ds_read_b64_tr_b16 v[172:173], v4 offset:3400
    v_mfma_f32_16x16x32_f16 v[224:227], v[120:123], v[136:139], v[224:227]
    ds_read_b64_tr_b16 v[174:175], v4 offset:3392
    s_add_u32 s69, s61, 13312
    buffer_load_dwordx4 v[252:255], v26, s[12:15], s69 offen
    v_mfma_f32_16x16x32_f16 v[220:223], v[124:127], v[132:135], v[220:223]
    ds_read_b64_tr_b16 v[176:177], v4 offset:3432
    v_mfma_f32_16x16x32_f16 v[224:227], v[128:131], v[132:135], v[224:227]
    ds_read_b64_tr_b16 v[178:179], v4 offset:3424
    s_waitcnt lgkmcnt(15)
    v_mfma_f32_16x16x32_f16 v[196:199], v[148:151], v[180:183], v[196:199]
    ds_read_b128 v[132:135], v5 offset:144
    v_mfma_f32_16x16x32_f16 v[200:203], v[152:155], v[180:183], v[200:203]
    ds_read_b64_tr_b16 v[100:101], v4 offset:392
    s_waitcnt lgkmcnt(15)
    v_mfma_f32_16x16x32_f16 v[204:207], v[148:151], v[184:187], v[204:207]
    ds_read_b64_tr_b16 v[102:103], v4 offset:384
    v_mfma_f32_16x16x32_f16 v[208:211], v[152:155], v[184:187], v[208:211]
    ds_read_b64_tr_b16 v[104:105], v4 offset:424
    v_mfma_f32_16x16x32_f16 v[212:215], v[148:151], v[188:191], v[212:215]
    ds_read_b64_tr_b16 v[106:107], v4 offset:416
    s_add_u32 s69, s61, 14336
    buffer_load_dwordx4 v[252:255], v26, s[12:15], s69 offen
    v_mfma_f32_16x16x32_f16 v[216:219], v[152:155], v[188:191], v[216:219]
    ds_read_b128 v[136:139], v5 offset:400
    s_waitcnt lgkmcnt(15)
    v_mfma_f32_16x16x32_f16 v[220:223], v[148:151], v[192:195], v[220:223]
    ds_read_b128 v[140:143], v5 offset:656
    v_mfma_f32_16x16x32_f16 v[224:227], v[152:155], v[192:195], v[224:227]
    ds_read_b128 v[144:147], v5 offset:912
    v_mfma_f32_16x16x32_f16 v[204:207], v[156:159], v[180:183], v[204:207]
    ds_read_b64_tr_b16 v[108:109], v4 offset:1416
    s_waitcnt lgkmcnt(15)
    v_mfma_f32_16x16x32_f16 v[208:211], v[160:163], v[180:183], v[208:211]
    ds_read_b64_tr_b16 v[110:111], v4 offset:1408
    v_mfma_f32_16x16x32_f16 v[212:215], v[156:159], v[184:187], v[212:215]
    ds_read_b64_tr_b16 v[112:113], v4 offset:1448
    v_mfma_f32_16x16x32_f16 v[216:219], v[160:163], v[184:187], v[216:219]
    ds_read_b64_tr_b16 v[114:115], v4 offset:1440
    s_add_u32 s69, s61, 15360
    buffer_load_dwordx4 v[252:255], v26, s[12:15], s69 offen
    v_mfma_f32_16x16x32_f16 v[220:223], v[156:159], v[188:191], v[220:223]
    ds_read_b64_tr_b16 v[116:117], v4 offset:2440
    v_mfma_f32_16x16x32_f16 v[224:227], v[160:163], v[188:191], v[224:227]
    ds_read_b64_tr_b16 v[118:119], v4 offset:2432
    v_mfma_f32_16x16x32_f16 v[212:215], v[164:167], v[180:183], v[212:215]
    ds_read_b64_tr_b16 v[120:121], v4 offset:2472
    s_waitcnt lgkmcnt(15)
    v_mfma_f32_16x16x32_f16 v[216:219], v[168:171], v[180:183], v[216:219]
    ds_read_b64_tr_b16 v[122:123], v4 offset:2464
    v_mfma_f32_16x16x32_f16 v[220:223], v[164:167], v[184:187], v[220:223]
    ds_read_b64_tr_b16 v[124:125], v4 offset:3464
    v_mfma_f32_16x16x32_f16 v[224:227], v[168:171], v[184:187], v[224:227]
    ds_read_b64_tr_b16 v[126:127], v4 offset:3456
    v_mfma_f32_16x16x32_f16 v[220:223], v[172:175], v[180:183], v[220:223]
    ds_read_b64_tr_b16 v[128:129], v4 offset:3496
    s_add_u32 s69, s61, 16384
    buffer_load_dwordx4 v[252:255], v26, s[12:15], s69 offen
    v_mfma_f32_16x16x32_f16 v[224:227], v[176:179], v[180:183], v[224:227]
    ds_read_b64_tr_b16 v[130:131], v4 offset:3488
    s_waitcnt lgkmcnt(15)
    v_mfma_f32_16x16x32_f16 v[196:199], v[100:103], v[132:135], v[196:199]
    ds_read_b128 v[180:183], v5 offset:128
    v_mfma_f32_16x16x32_f16 v[200:203], v[104:107], v[132:135], v[200:203]
    ds_read_b64_tr_b16 v[148:149], v4 offset:456
    s_waitcnt lgkmcnt(15)
    v_mfma_f32_16x16x32_f16 v[204:207], v[100:103], v[136:139], v[204:207]
    ds_read_b64_tr_b16 v[150:151], v4 offset:448
    v_mfma_f32_16x16x32_f16 v[208:211], v[104:107], v[136:139], v[208:211]
    ds_read_b64_tr_b16 v[152:153], v4 offset:488
    v_mfma_f32_16x16x32_f16 v[212:215], v[100:103], v[140:143], v[212:215]
    ds_read_b64_tr_b16 v[154:155], v4 offset:480
    v_mfma_f32_16x16x32_f16 v[216:219], v[104:107], v[140:143], v[216:219]
    ds_read_b128 v[184:187], v5 offset:384
    s_add_u32 s69, s61, 17408
    buffer_load_dwordx4 v[252:255], v26, s[12:15], s69 offen
    s_waitcnt lgkmcnt(15)
    v_mfma_f32_16x16x32_f16 v[220:223], v[100:103], v[144:147], v[220:223]
    ds_read_b128 v[188:191], v5 offset:640
    v_mfma_f32_16x16x32_f16 v[224:227], v[104:107], v[144:147], v[224:227]
    ds_read_b128 v[192:195], v5 offset:896
    v_mfma_f32_16x16x32_f16 v[204:207], v[108:111], v[132:135], v[204:207]
    ds_read_b64_tr_b16 v[156:157], v4 offset:1480
    s_waitcnt lgkmcnt(15)
    v_mfma_f32_16x16x32_f16 v[208:211], v[112:115], v[132:135], v[208:211]
    ds_read_b64_tr_b16 v[158:159], v4 offset:1472
    v_mfma_f32_16x16x32_f16 v[212:215], v[108:111], v[136:139], v[212:215]
    ds_read_b64_tr_b16 v[160:161], v4 offset:1512
    v_mfma_f32_16x16x32_f16 v[216:219], v[112:115], v[136:139], v[216:219]
    ds_read_b64_tr_b16 v[162:163], v4 offset:1504
    v_mfma_f32_16x16x32_f16 v[220:223], v[108:111], v[140:143], v[220:223]
    ds_read_b64_tr_b16 v[164:165], v4 offset:2504
    s_add_u32 s69, s61, 18432
    buffer_load_dwordx4 v[252:255], v26, s[12:15], s69 offen
    v_mfma_f32_16x16x32_f16 v[224:227], v[112:115], v[140:143], v[224:227]
    ds_read_b64_tr_b16 v[166:167], v4 offset:2496
    v_mfma_f32_16x16x32_f16 v[212:215], v[116:119], v[132:135], v[212:215]
    ds_read_b64_tr_b16 v[168:169], v4 offset:2536
    s_waitcnt lgkmcnt(15)
    v_mfma_f32_16x16x32_f16 v[216:219], v[120:123], v[132:135], v[216:219]
    ds_read_b64_tr_b16 v[170:171], v4 offset:2528
    v_mfma_f32_16x16x32_f16 v[220:223], v[116:119], v[136:139], v[220:223]
    ds_read_b64_tr_b16 v[172:173], v4 offset:3528
    v_mfma_f32_16x16x32_f16 v[224:227], v[120:123], v[136:139], v[224:227]
    ds_read_b64_tr_b16 v[174:175], v4 offset:3520
    v_mfma_f32_16x16x32_f16 v[220:223], v[124:127], v[132:135], v[220:223]
    ds_read_b64_tr_b16 v[176:177], v4 offset:3560
    v_mfma_f32_16x16x32_f16 v[224:227], v[128:131], v[132:135], v[224:227]
    ds_read_b64_tr_b16 v[178:179], v4 offset:3552
    s_add_u32 s69, s61, 19456
    buffer_load_dwordx4 v[252:255], v26, s[12:15], s69 offen
    s_waitcnt lgkmcnt(15)
    v_mfma_f32_16x16x32_f16 v[196:199], v[148:151], v[180:183], v[196:199]
    ds_read_b128 v[132:135], v5 offset:112
    v_mfma_f32_16x16x32_f16 v[200:203], v[152:155], v[180:183], v[200:203]
    ds_read_b64_tr_b16 v[100:101], v4 offset:520
    s_waitcnt lgkmcnt(15)
    v_mfma_f32_16x16x32_f16 v[204:207], v[148:151], v[184:187], v[204:207]
    ds_read_b64_tr_b16 v[102:103], v4 offset:512
    v_mfma_f32_16x16x32_f16 v[208:211], v[152:155], v[184:187], v[208:211]
    ds_read_b64_tr_b16 v[104:105], v4 offset:552
    v_mfma_f32_16x16x32_f16 v[212:215], v[148:151], v[188:191], v[212:215]
    ds_read_b64_tr_b16 v[106:107], v4 offset:544
    v_mfma_f32_16x16x32_f16 v[216:219], v[152:155], v[188:191], v[216:219]
    ds_read_b128 v[136:139], v5 offset:368
    s_waitcnt lgkmcnt(15)
    v_mfma_f32_16x16x32_f16 v[220:223], v[148:151], v[192:195], v[220:223]
    ds_read_b128 v[140:143], v5 offset:624
    s_add_u32 s69, s61, 20480
    buffer_load_dwordx4 v[252:255], v26, s[12:15], s69 offen
    v_mfma_f32_16x16x32_f16 v[224:227], v[152:155], v[192:195], v[224:227]
    ds_read_b128 v[144:147], v5 offset:880
    v_mfma_f32_16x16x32_f16 v[204:207], v[156:159], v[180:183], v[204:207]
    ds_read_b64_tr_b16 v[108:109], v4 offset:1544
    s_waitcnt lgkmcnt(15)
    v_mfma_f32_16x16x32_f16 v[208:211], v[160:163], v[180:183], v[208:211]
    ds_read_b64_tr_b16 v[110:111], v4 offset:1536
    v_mfma_f32_16x16x32_f16 v[212:215], v[156:159], v[184:187], v[212:215]
    ds_read_b64_tr_b16 v[112:113], v4 offset:1576
    v_mfma_f32_16x16x32_f16 v[216:219], v[160:163], v[184:187], v[216:219]
    ds_read_b64_tr_b16 v[114:115], v4 offset:1568
    v_mfma_f32_16x16x32_f16 v[220:223], v[156:159], v[188:191], v[220:223]
    ds_read_b64_tr_b16 v[116:117], v4 offset:2568
    v_mfma_f32_16x16x32_f16 v[224:227], v[160:163], v[188:191], v[224:227]
    ds_read_b64_tr_b16 v[118:119], v4 offset:2560
    s_add_u32 s69, s61, 21504
    buffer_load_dwordx4 v[252:255], v26, s[12:15], s69 offen
    v_mfma_f32_16x16x32_f16 v[212:215], v[164:167], v[180:183], v[212:215]
    ds_read_b64_tr_b16 v[120:121], v4 offset:2600
    s_waitcnt lgkmcnt(15)
    v_mfma_f32_16x16x32_f16 v[216:219], v[168:171], v[180:183], v[216:219]
    ds_read_b64_tr_b16 v[122:123], v4 offset:2592
    v_mfma_f32_16x16x32_f16 v[220:223], v[164:167], v[184:187], v[220:223]
    ds_read_b64_tr_b16 v[124:125], v4 offset:3592
    v_mfma_f32_16x16x32_f16 v[224:227], v[168:171], v[184:187], v[224:227]
    ds_read_b64_tr_b16 v[126:127], v4 offset:3584
    v_mfma_f32_16x16x32_f16 v[220:223], v[172:175], v[180:183], v[220:223]
    ds_read_b64_tr_b16 v[128:129], v4 offset:3624
    v_mfma_f32_16x16x32_f16 v[224:227], v[176:179], v[180:183], v[224:227]
    ds_read_b64_tr_b16 v[130:131], v4 offset:3616
    s_waitcnt lgkmcnt(15)
    v_mfma_f32_16x16x32_f16 v[196:199], v[100:103], v[132:135], v[196:199]
    ds_read_b128 v[180:183], v5 offset:96
    s_add_u32 s69, s61, 22528
    buffer_load_dwordx4 v[252:255], v26, s[12:15], s69 offen
    v_mfma_f32_16x16x32_f16 v[200:203], v[104:107], v[132:135], v[200:203]
    ds_read_b64_tr_b16 v[148:149], v4 offset:584
    s_waitcnt lgkmcnt(15)
    v_mfma_f32_16x16x32_f16 v[204:207], v[100:103], v[136:139], v[204:207]
    ds_read_b64_tr_b16 v[150:151], v4 offset:576
    v_mfma_f32_16x16x32_f16 v[208:211], v[104:107], v[136:139], v[208:211]
    ds_read_b64_tr_b16 v[152:153], v4 offset:616
    v_mfma_f32_16x16x32_f16 v[212:215], v[100:103], v[140:143], v[212:215]
    ds_read_b64_tr_b16 v[154:155], v4 offset:608
    v_mfma_f32_16x16x32_f16 v[216:219], v[104:107], v[140:143], v[216:219]
    ds_read_b128 v[184:187], v5 offset:352
    s_waitcnt lgkmcnt(15)
    v_mfma_f32_16x16x32_f16 v[220:223], v[100:103], v[144:147], v[220:223]
    ds_read_b128 v[188:191], v5 offset:608
    v_mfma_f32_16x16x32_f16 v[224:227], v[104:107], v[144:147], v[224:227]
    ds_read_b128 v[192:195], v5 offset:864
    s_add_u32 s69, s61, 23552
    buffer_load_dwordx4 v[252:255], v26, s[12:15], s69 offen
    v_mfma_f32_16x16x32_f16 v[204:207], v[108:111], v[132:135], v[204:207]
    ds_read_b64_tr_b16 v[156:157], v4 offset:1608
    s_waitcnt lgkmcnt(15)
    v_mfma_f32_16x16x32_f16 v[208:211], v[112:115], v[132:135], v[208:211]
    ds_read_b64_tr_b16 v[158:159], v4 offset:1600
    v_mfma_f32_16x16x32_f16 v[212:215], v[108:111], v[136:139], v[212:215]
    ds_read_b64_tr_b16 v[160:161], v4 offset:1640
    v_mfma_f32_16x16x32_f16 v[216:219], v[112:115], v[136:139], v[216:219]
    ds_read_b64_tr_b16 v[162:163], v4 offset:1632
    v_mfma_f32_16x16x32_f16 v[220:223], v[108:111], v[140:143], v[220:223]
    ds_read_b64_tr_b16 v[164:165], v4 offset:2632
    v_mfma_f32_16x16x32_f16 v[224:227], v[112:115], v[140:143], v[224:227]
    ds_read_b64_tr_b16 v[166:167], v4 offset:2624
    v_mfma_f32_16x16x32_f16 v[212:215], v[116:119], v[132:135], v[212:215]
    ds_read_b64_tr_b16 v[168:169], v4 offset:2664
    s_add_u32 s69, s61, 24576
    buffer_load_dwordx4 v[252:255], v26, s[12:15], s69 offen
    s_waitcnt lgkmcnt(15)
    v_mfma_f32_16x16x32_f16 v[216:219], v[120:123], v[132:135], v[216:219]
    ds_read_b64_tr_b16 v[170:171], v4 offset:2656
    v_mfma_f32_16x16x32_f16 v[220:223], v[116:119], v[136:139], v[220:223]
    ds_read_b64_tr_b16 v[172:173], v4 offset:3656
    v_mfma_f32_16x16x32_f16 v[224:227], v[120:123], v[136:139], v[224:227]
    ds_read_b64_tr_b16 v[174:175], v4 offset:3648
    v_mfma_f32_16x16x32_f16 v[220:223], v[124:127], v[132:135], v[220:223]
    ds_read_b64_tr_b16 v[176:177], v4 offset:3688
    v_mfma_f32_16x16x32_f16 v[224:227], v[128:131], v[132:135], v[224:227]
    ds_read_b64_tr_b16 v[178:179], v4 offset:3680
    s_waitcnt lgkmcnt(15)
    v_mfma_f32_16x16x32_f16 v[196:199], v[148:151], v[180:183], v[196:199]
    ds_read_b128 v[132:135], v5 offset:80
    v_mfma_f32_16x16x32_f16 v[200:203], v[152:155], v[180:183], v[200:203]
    ds_read_b64_tr_b16 v[100:101], v4 offset:648
    s_add_u32 s69, s61, 25600
    buffer_load_dwordx4 v[252:255], v26, s[12:15], s69 offen
    s_waitcnt lgkmcnt(15)
    v_mfma_f32_16x16x32_f16 v[204:207], v[148:151], v[184:187], v[204:207]
    ds_read_b64_tr_b16 v[102:103], v4 offset:640
    v_mfma_f32_16x16x32_f16 v[208:211], v[152:155], v[184:187], v[208:211]
    ds_read_b64_tr_b16 v[104:105], v4 offset:680
    v_mfma_f32_16x16x32_f16 v[212:215], v[148:151], v[188:191], v[212:215]
    ds_read_b64_tr_b16 v[106:107], v4 offset:672
    v_mfma_f32_16x16x32_f16 v[216:219], v[152:155], v[188:191], v[216:219]
    ds_read_b128 v[136:139], v5 offset:336
    s_waitcnt lgkmcnt(15)
    v_mfma_f32_16x16x32_f16 v[220:223], v[148:151], v[192:195], v[220:223]
    ds_read_b128 v[140:143], v5 offset:592
    v_mfma_f32_16x16x32_f16 v[224:227], v[152:155], v[192:195], v[224:227]
    ds_read_b128 v[144:147], v5 offset:848
    v_mfma_f32_16x16x32_f16 v[204:207], v[156:159], v[180:183], v[204:207]
    ds_read_b64_tr_b16 v[108:109], v4 offset:1672
    s_add_u32 s69, s61, 26624
    buffer_load_dwordx4 v[252:255], v26, s[12:15], s69 offen
    s_waitcnt lgkmcnt(15)
    v_mfma_f32_16x16x32_f16 v[208:211], v[160:163], v[180:183], v[208:211]
    ds_read_b64_tr_b16 v[110:111], v4 offset:1664
    v_mfma_f32_16x16x32_f16 v[212:215], v[156:159], v[184:187], v[212:215]
    ds_read_b64_tr_b16 v[112:113], v4 offset:1704
    v_mfma_f32_16x16x32_f16 v[216:219], v[160:163], v[184:187], v[216:219]
    ds_read_b64_tr_b16 v[114:115], v4 offset:1696
    v_mfma_f32_16x16x32_f16 v[220:223], v[156:159], v[188:191], v[220:223]
    ds_read_b64_tr_b16 v[116:117], v4 offset:2696
    v_mfma_f32_16x16x32_f16 v[224:227], v[160:163], v[188:191], v[224:227]
    ds_read_b64_tr_b16 v[118:119], v4 offset:2688
    v_mfma_f32_16x16x32_f16 v[212:215], v[164:167], v[180:183], v[212:215]
    ds_read_b64_tr_b16 v[120:121], v4 offset:2728
    s_waitcnt lgkmcnt(15)
    v_mfma_f32_16x16x32_f16 v[216:219], v[168:171], v[180:183], v[216:219]
    ds_read_b64_tr_b16 v[122:123], v4 offset:2720
    s_add_u32 s69, s61, 27648
    buffer_load_dwordx4 v[252:255], v26, s[12:15], s69 offen
    v_mfma_f32_16x16x32_f16 v[220:223], v[164:167], v[184:187], v[220:223]
    ds_read_b64_tr_b16 v[124:125], v4 offset:3720
    v_mfma_f32_16x16x32_f16 v[224:227], v[168:171], v[184:187], v[224:227]
    ds_read_b64_tr_b16 v[126:127], v4 offset:3712
    v_mfma_f32_16x16x32_f16 v[220:223], v[172:175], v[180:183], v[220:223]
    ds_read_b64_tr_b16 v[128:129], v4 offset:3752
    v_mfma_f32_16x16x32_f16 v[224:227], v[176:179], v[180:183], v[224:227]
    ds_read_b64_tr_b16 v[130:131], v4 offset:3744
    s_waitcnt lgkmcnt(15)
    v_mfma_f32_16x16x32_f16 v[196:199], v[100:103], v[132:135], v[196:199]
    ds_read_b128 v[180:183], v5 offset:64
    v_mfma_f32_16x16x32_f16 v[200:203], v[104:107], v[132:135], v[200:203]
    ds_read_b64_tr_b16 v[148:149], v4 offset:712
    s_waitcnt lgkmcnt(15)
    v_mfma_f32_16x16x32_f16 v[204:207], v[100:103], v[136:139], v[204:207]
    ds_read_b64_tr_b16 v[150:151], v4 offset:704
    s_waitcnt vmcnt(36)
    s_add_u32 s69, s61, 28672
    buffer_load_dwordx4 v[252:255], v26, s[12:15], s69 offen
    v_mfma_f32_16x16x32_f16 v[208:211], v[104:107], v[136:139], v[208:211]
    ds_read_b64_tr_b16 v[152:153], v4 offset:744
    v_mfma_f32_16x16x32_f16 v[212:215], v[100:103], v[140:143], v[212:215]
    ds_read_b64_tr_b16 v[154:155], v4 offset:736
    v_mfma_f32_16x16x32_f16 v[216:219], v[104:107], v[140:143], v[216:219]
    ds_read_b128 v[184:187], v5 offset:320
    s_waitcnt lgkmcnt(15)
    v_mfma_f32_16x16x32_f16 v[220:223], v[100:103], v[144:147], v[220:223]
    ds_read_b128 v[188:191], v5 offset:576
    v_mfma_f32_16x16x32_f16 v[224:227], v[104:107], v[144:147], v[224:227]
    ds_read_b128 v[192:195], v5 offset:832
    v_mfma_f32_16x16x32_f16 v[204:207], v[108:111], v[132:135], v[204:207]
    ds_read_b64_tr_b16 v[156:157], v4 offset:1736
    s_waitcnt lgkmcnt(15)
    v_mfma_f32_16x16x32_f16 v[208:211], v[112:115], v[132:135], v[208:211]
    ds_read_b64_tr_b16 v[158:159], v4 offset:1728
    s_waitcnt vmcnt(36)
    s_add_u32 s69, s61, 29696
    buffer_load_dwordx4 v[252:255], v26, s[12:15], s69 offen
    v_mfma_f32_16x16x32_f16 v[212:215], v[108:111], v[136:139], v[212:215]
    ds_read_b64_tr_b16 v[160:161], v4 offset:1768
    v_mfma_f32_16x16x32_f16 v[216:219], v[112:115], v[136:139], v[216:219]
    ds_read_b64_tr_b16 v[162:163], v4 offset:1760
    v_mfma_f32_16x16x32_f16 v[220:223], v[108:111], v[140:143], v[220:223]
    ds_read_b64_tr_b16 v[164:165], v4 offset:2760
    v_mfma_f32_16x16x32_f16 v[224:227], v[112:115], v[140:143], v[224:227]
    ds_read_b64_tr_b16 v[166:167], v4 offset:2752
    v_mfma_f32_16x16x32_f16 v[212:215], v[116:119], v[132:135], v[212:215]
    ds_read_b64_tr_b16 v[168:169], v4 offset:2792
    s_waitcnt lgkmcnt(15)
    v_mfma_f32_16x16x32_f16 v[216:219], v[120:123], v[132:135], v[216:219]
    ds_read_b64_tr_b16 v[170:171], v4 offset:2784
    v_mfma_f32_16x16x32_f16 v[220:223], v[116:119], v[136:139], v[220:223]
    ds_read_b64_tr_b16 v[172:173], v4 offset:3784
    s_waitcnt vmcnt(36)
    s_add_u32 s69, s61, 30720
    buffer_load_dwordx4 v[252:255], v26, s[12:15], s69 offen
    v_mfma_f32_16x16x32_f16 v[224:227], v[120:123], v[136:139], v[224:227]
    ds_read_b64_tr_b16 v[174:175], v4 offset:3776
    v_mfma_f32_16x16x32_f16 v[220:223], v[124:127], v[132:135], v[220:223]
    ds_read_b64_tr_b16 v[176:177], v4 offset:3816
    v_mfma_f32_16x16x32_f16 v[224:227], v[128:131], v[132:135], v[224:227]
    ds_read_b64_tr_b16 v[178:179], v4 offset:3808
    s_waitcnt lgkmcnt(15)
    v_mfma_f32_16x16x32_f16 v[196:199], v[148:151], v[180:183], v[196:199]
    ds_read_b128 v[132:135], v5 offset:48
    v_mfma_f32_16x16x32_f16 v[200:203], v[152:155], v[180:183], v[200:203]
    ds_read_b64_tr_b16 v[100:101], v4 offset:776
    s_waitcnt lgkmcnt(15)
    v_mfma_f32_16x16x32_f16 v[204:207], v[148:151], v[184:187], v[204:207]
    ds_read_b64_tr_b16 v[102:103], v4 offset:768
    v_mfma_f32_16x16x32_f16 v[208:211], v[152:155], v[184:187], v[208:211]
    ds_read_b64_tr_b16 v[104:105], v4 offset:808
    s_waitcnt vmcnt(36)
    s_add_u32 s69, s61, 31744
    buffer_load_dwordx4 v[252:255], v26, s[12:15], s69 offen
    v_mfma_f32_16x16x32_f16 v[212:215], v[148:151], v[188:191], v[212:215]
    ds_read_b64_tr_b16 v[106:107], v4 offset:800
    v_mfma_f32_16x16x32_f16 v[216:219], v[152:155], v[188:191], v[216:219]
    ds_read_b128 v[136:139], v5 offset:304
    s_waitcnt lgkmcnt(15)
    v_mfma_f32_16x16x32_f16 v[220:223], v[148:151], v[192:195], v[220:223]
    ds_read_b128 v[140:143], v5 offset:560
    v_mfma_f32_16x16x32_f16 v[224:227], v[152:155], v[192:195], v[224:227]
    ds_read_b128 v[144:147], v5 offset:816
    v_mfma_f32_16x16x32_f16 v[204:207], v[156:159], v[180:183], v[204:207]
    ds_read_b64_tr_b16 v[108:109], v4 offset:1800
    s_waitcnt lgkmcnt(15)
    v_mfma_f32_16x16x32_f16 v[208:211], v[160:163], v[180:183], v[208:211]
    ds_read_b64_tr_b16 v[110:111], v4 offset:1792
    v_mfma_f32_16x16x32_f16 v[212:215], v[156:159], v[184:187], v[212:215]
    ds_read_b64_tr_b16 v[112:113], v4 offset:1832
    s_waitcnt vmcnt(36)
    s_add_u32 s69, s61, 32768
    buffer_load_dwordx4 v[252:255], v26, s[12:15], s69 offen
    v_mfma_f32_16x16x32_f16 v[216:219], v[160:163], v[184:187], v[216:219]
    ds_read_b64_tr_b16 v[114:115], v4 offset:1824
    v_mfma_f32_16x16x32_f16 v[220:223], v[156:159], v[188:191], v[220:223]
    ds_read_b64_tr_b16 v[116:117], v4 offset:2824
    v_mfma_f32_16x16x32_f16 v[224:227], v[160:163], v[188:191], v[224:227]
    ds_read_b64_tr_b16 v[118:119], v4 offset:2816
    v_mfma_f32_16x16x32_f16 v[212:215], v[164:167], v[180:183], v[212:215]
    ds_read_b64_tr_b16 v[120:121], v4 offset:2856
    s_waitcnt lgkmcnt(15)
    v_mfma_f32_16x16x32_f16 v[216:219], v[168:171], v[180:183], v[216:219]
    ds_read_b64_tr_b16 v[122:123], v4 offset:2848
    v_mfma_f32_16x16x32_f16 v[220:223], v[164:167], v[184:187], v[220:223]
    ds_read_b64_tr_b16 v[124:125], v4 offset:3848
    v_mfma_f32_16x16x32_f16 v[224:227], v[168:171], v[184:187], v[224:227]
    ds_read_b64_tr_b16 v[126:127], v4 offset:3840
    s_waitcnt vmcnt(36)
    s_add_u32 s69, s61, 33792
    buffer_load_dwordx4 v[252:255], v26, s[12:15], s69 offen
    v_mfma_f32_16x16x32_f16 v[220:223], v[172:175], v[180:183], v[220:223]
    ds_read_b64_tr_b16 v[128:129], v4 offset:3880
    v_mfma_f32_16x16x32_f16 v[224:227], v[176:179], v[180:183], v[224:227]
    ds_read_b64_tr_b16 v[130:131], v4 offset:3872
    s_waitcnt lgkmcnt(15)
    v_mfma_f32_16x16x32_f16 v[196:199], v[100:103], v[132:135], v[196:199]
    ds_read_b128 v[180:183], v5 offset:32
    v_mfma_f32_16x16x32_f16 v[200:203], v[104:107], v[132:135], v[200:203]
    ds_read_b64_tr_b16 v[148:149], v4 offset:840
    s_waitcnt lgkmcnt(15)
    v_mfma_f32_16x16x32_f16 v[204:207], v[100:103], v[136:139], v[204:207]
    ds_read_b64_tr_b16 v[150:151], v4 offset:832
    v_mfma_f32_16x16x32_f16 v[208:211], v[104:107], v[136:139], v[208:211]
    ds_read_b64_tr_b16 v[152:153], v4 offset:872
    v_mfma_f32_16x16x32_f16 v[212:215], v[100:103], v[140:143], v[212:215]
    ds_read_b64_tr_b16 v[154:155], v4 offset:864
    s_waitcnt vmcnt(36)
    s_add_u32 s69, s61, 34816
    buffer_load_dwordx4 v[252:255], v26, s[12:15], s69 offen
    v_mfma_f32_16x16x32_f16 v[216:219], v[104:107], v[140:143], v[216:219]
    ds_read_b128 v[184:187], v5 offset:288
    s_waitcnt lgkmcnt(15)
    v_mfma_f32_16x16x32_f16 v[220:223], v[100:103], v[144:147], v[220:223]
    ds_read_b128 v[188:191], v5 offset:544
    v_mfma_f32_16x16x32_f16 v[224:227], v[104:107], v[144:147], v[224:227]
    ds_read_b128 v[192:195], v5 offset:800
    v_mfma_f32_16x16x32_f16 v[204:207], v[108:111], v[132:135], v[204:207]
    ds_read_b64_tr_b16 v[156:157], v4 offset:1864
    s_waitcnt lgkmcnt(15)
    v_mfma_f32_16x16x32_f16 v[208:211], v[112:115], v[132:135], v[208:211]
    ds_read_b64_tr_b16 v[158:159], v4 offset:1856
    v_mfma_f32_16x16x32_f16 v[212:215], v[108:111], v[136:139], v[212:215]
    ds_read_b64_tr_b16 v[160:161], v4 offset:1896
    v_mfma_f32_16x16x32_f16 v[216:219], v[112:115], v[136:139], v[216:219]
    ds_read_b64_tr_b16 v[162:163], v4 offset:1888
    s_waitcnt vmcnt(36)
    s_add_u32 s69, s61, 35840
    buffer_load_dwordx4 v[252:255], v26, s[12:15], s69 offen
    v_mfma_f32_16x16x32_f16 v[220:223], v[108:111], v[140:143], v[220:223]
    ds_read_b64_tr_b16 v[164:165], v4 offset:2888
    v_mfma_f32_16x16x32_f16 v[224:227], v[112:115], v[140:143], v[224:227]
    ds_read_b64_tr_b16 v[166:167], v4 offset:2880
    v_mfma_f32_16x16x32_f16 v[212:215], v[116:119], v[132:135], v[212:215]
    ds_read_b64_tr_b16 v[168:169], v4 offset:2920
    s_waitcnt lgkmcnt(15)
    v_mfma_f32_16x16x32_f16 v[216:219], v[120:123], v[132:135], v[216:219]
    ds_read_b64_tr_b16 v[170:171], v4 offset:2912
    v_mfma_f32_16x16x32_f16 v[220:223], v[116:119], v[136:139], v[220:223]
    ds_read_b64_tr_b16 v[172:173], v4 offset:3912
    v_mfma_f32_16x16x32_f16 v[224:227], v[120:123], v[136:139], v[224:227]
    ds_read_b64_tr_b16 v[174:175], v4 offset:3904
    v_mfma_f32_16x16x32_f16 v[220:223], v[124:127], v[132:135], v[220:223]
    ds_read_b64_tr_b16 v[176:177], v4 offset:3944
    s_waitcnt vmcnt(36)
    s_add_u32 s69, s61, 36864
    buffer_load_dwordx4 v[252:255], v26, s[12:15], s69 offen
    v_mfma_f32_16x16x32_f16 v[224:227], v[128:131], v[132:135], v[224:227]
    ds_read_b64_tr_b16 v[178:179], v4 offset:3936
    s_waitcnt lgkmcnt(15)
    v_mfma_f32_16x16x32_f16 v[196:199], v[148:151], v[180:183], v[196:199]
    ds_read_b128 v[132:135], v5 offset:16
    v_mfma_f32_16x16x32_f16 v[200:203], v[152:155], v[180:183], v[200:203]
    ds_read_b64_tr_b16 v[100:101], v4 offset:904
    s_waitcnt lgkmcnt(15)
    v_mfma_f32_16x16x32_f16 v[204:207], v[148:151], v[184:187], v[204:207]
    ds_read_b64_tr_b16 v[102:103], v4 offset:896
    v_mfma_f32_16x16x32_f16 v[208:211], v[152:155], v[184:187], v[208:211]
    ds_read_b64_tr_b16 v[104:105], v4 offset:936
    v_mfma_f32_16x16x32_f16 v[212:215], v[148:151], v[188:191], v[212:215]
    ds_read_b64_tr_b16 v[106:107], v4 offset:928
    v_mfma_f32_16x16x32_f16 v[216:219], v[152:155], v[188:191], v[216:219]
    ds_read_b128 v[136:139], v5 offset:272
    s_waitcnt vmcnt(36)
    s_add_u32 s69, s61, 37888
    buffer_load_dwordx4 v[252:255], v26, s[12:15], s69 offen
    s_waitcnt lgkmcnt(15)
    v_mfma_f32_16x16x32_f16 v[220:223], v[148:151], v[192:195], v[220:223]
    ds_read_b128 v[140:143], v5 offset:528
    v_mfma_f32_16x16x32_f16 v[224:227], v[152:155], v[192:195], v[224:227]
    ds_read_b128 v[144:147], v5 offset:784
    v_mfma_f32_16x16x32_f16 v[204:207], v[156:159], v[180:183], v[204:207]
    ds_read_b64_tr_b16 v[108:109], v4 offset:1928
    s_waitcnt lgkmcnt(15)
    v_mfma_f32_16x16x32_f16 v[208:211], v[160:163], v[180:183], v[208:211]
    ds_read_b64_tr_b16 v[110:111], v4 offset:1920
    v_mfma_f32_16x16x32_f16 v[212:215], v[156:159], v[184:187], v[212:215]
    ds_read_b64_tr_b16 v[112:113], v4 offset:1960
    v_mfma_f32_16x16x32_f16 v[216:219], v[160:163], v[184:187], v[216:219]
    ds_read_b64_tr_b16 v[114:115], v4 offset:1952
    v_mfma_f32_16x16x32_f16 v[220:223], v[156:159], v[188:191], v[220:223]
    ds_read_b64_tr_b16 v[116:117], v4 offset:2952
    s_waitcnt vmcnt(36)
    s_add_u32 s69, s61, 38912
    buffer_load_dwordx4 v[252:255], v26, s[12:15], s69 offen
    v_mfma_f32_16x16x32_f16 v[224:227], v[160:163], v[188:191], v[224:227]
    ds_read_b64_tr_b16 v[118:119], v4 offset:2944
    v_mfma_f32_16x16x32_f16 v[212:215], v[164:167], v[180:183], v[212:215]
    ds_read_b64_tr_b16 v[120:121], v4 offset:2984
    s_waitcnt lgkmcnt(15)
    v_mfma_f32_16x16x32_f16 v[216:219], v[168:171], v[180:183], v[216:219]
    ds_read_b64_tr_b16 v[122:123], v4 offset:2976
    v_mfma_f32_16x16x32_f16 v[220:223], v[164:167], v[184:187], v[220:223]
    ds_read_b64_tr_b16 v[124:125], v4 offset:3976
    v_mfma_f32_16x16x32_f16 v[224:227], v[168:171], v[184:187], v[224:227]
    ds_read_b64_tr_b16 v[126:127], v4 offset:3968
    v_mfma_f32_16x16x32_f16 v[220:223], v[172:175], v[180:183], v[220:223]
    ds_read_b64_tr_b16 v[128:129], v4 offset:4008
    v_mfma_f32_16x16x32_f16 v[224:227], v[176:179], v[180:183], v[224:227]
    ds_read_b64_tr_b16 v[130:131], v4 offset:4000
    s_waitcnt vmcnt(36)
    s_add_u32 s69, s61, 39936
    buffer_load_dwordx4 v[252:255], v26, s[12:15], s69 offen
    s_waitcnt lgkmcnt(15)
    v_mfma_f32_16x16x32_f16 v[196:199], v[100:103], v[132:135], v[196:199]
    ds_read_b128 v[180:183], v5 offset:0
    v_mfma_f32_16x16x32_f16 v[200:203], v[104:107], v[132:135], v[200:203]
    ds_read_b64_tr_b16 v[148:149], v4 offset:968
    s_waitcnt lgkmcnt(15)
    v_mfma_f32_16x16x32_f16 v[204:207], v[100:103], v[136:139], v[204:207]
    ds_read_b64_tr_b16 v[150:151], v4 offset:960
    v_mfma_f32_16x16x32_f16 v[208:211], v[104:107], v[136:139], v[208:211]
    ds_read_b64_tr_b16 v[152:153], v4 offset:1000
    v_mfma_f32_16x16x32_f16 v[212:215], v[100:103], v[140:143], v[212:215]
    ds_read_b64_tr_b16 v[154:155], v4 offset:992
    v_mfma_f32_16x16x32_f16 v[216:219], v[104:107], v[140:143], v[216:219]
    ds_read_b128 v[184:187], v5 offset:256
    s_waitcnt lgkmcnt(15)
    v_mfma_f32_16x16x32_f16 v[220:223], v[100:103], v[144:147], v[220:223]
    ds_read_b128 v[188:191], v5 offset:512
    s_waitcnt vmcnt(36)
    s_add_u32 s69, s61, 40448
    buffer_load_dwordx4 v[252:255], v26, s[12:15], s69 offen
    v_mfma_f32_16x16x32_f16 v[224:227], v[104:107], v[144:147], v[224:227]
    ds_read_b128 v[192:195], v5 offset:768
    v_mfma_f32_16x16x32_f16 v[204:207], v[108:111], v[132:135], v[204:207]
    ds_read_b64_tr_b16 v[156:157], v4 offset:1992
    s_waitcnt lgkmcnt(15)
    v_mfma_f32_16x16x32_f16 v[208:211], v[112:115], v[132:135], v[208:211]
    ds_read_b64_tr_b16 v[158:159], v4 offset:1984
    v_mfma_f32_16x16x32_f16 v[212:215], v[108:111], v[136:139], v[212:215]
    ds_read_b64_tr_b16 v[160:161], v4 offset:2024
    v_mfma_f32_16x16x32_f16 v[216:219], v[112:115], v[136:139], v[216:219]
    ds_read_b64_tr_b16 v[162:163], v4 offset:2016
    v_mfma_f32_16x16x32_f16 v[220:223], v[108:111], v[140:143], v[220:223]
    ds_read_b64_tr_b16 v[164:165], v4 offset:3016
    v_mfma_f32_16x16x32_f16 v[224:227], v[112:115], v[140:143], v[224:227]
    ds_read_b64_tr_b16 v[166:167], v4 offset:3008
    v_mfma_f32_16x16x32_f16 v[212:215], v[116:119], v[132:135], v[212:215]
    ds_read_b64_tr_b16 v[168:169], v4 offset:3048
    s_waitcnt lgkmcnt(15)
    v_mfma_f32_16x16x32_f16 v[216:219], v[120:123], v[132:135], v[216:219]
    ds_read_b64_tr_b16 v[170:171], v4 offset:3040
    v_mfma_f32_16x16x32_f16 v[220:223], v[116:119], v[136:139], v[220:223]
    ds_read_b64_tr_b16 v[172:173], v4 offset:4040
    v_mfma_f32_16x16x32_f16 v[224:227], v[120:123], v[136:139], v[224:227]
    ds_read_b64_tr_b16 v[174:175], v4 offset:4032
    v_mfma_f32_16x16x32_f16 v[220:223], v[124:127], v[132:135], v[220:223]
    ds_read_b64_tr_b16 v[176:177], v4 offset:4072
    v_mfma_f32_16x16x32_f16 v[224:227], v[128:131], v[132:135], v[224:227]
    ds_read_b64_tr_b16 v[178:179], v4 offset:4064
    s_waitcnt lgkmcnt(15)
    v_mfma_f32_16x16x32_f16 v[196:199], v[148:151], v[180:183], v[196:199]
    v_mfma_f32_16x16x32_f16 v[200:203], v[152:155], v[180:183], v[200:203]
    s_waitcnt lgkmcnt(14)
    v_mfma_f32_16x16x32_f16 v[204:207], v[148:151], v[184:187], v[204:207]
    v_mfma_f32_16x16x32_f16 v[208:211], v[152:155], v[184:187], v[208:211]
    s_waitcnt lgkmcnt(13)
    v_mfma_f32_16x16x32_f16 v[212:215], v[148:151], v[188:191], v[212:215]
    v_mfma_f32_16x16x32_f16 v[216:219], v[152:155], v[188:191], v[216:219]
    s_waitcnt lgkmcnt(12)
    v_mfma_f32_16x16x32_f16 v[220:223], v[148:151], v[192:195], v[220:223]
    v_mfma_f32_16x16x32_f16 v[224:227], v[152:155], v[192:195], v[224:227]
    s_waitcnt lgkmcnt(10)
    v_mfma_f32_16x16x32_f16 v[204:207], v[156:159], v[180:183], v[204:207]
    s_waitcnt lgkmcnt(8)
    v_mfma_f32_16x16x32_f16 v[208:211], v[160:163], v[180:183], v[208:211]
    v_mfma_f32_16x16x32_f16 v[212:215], v[156:159], v[184:187], v[212:215]
    v_mfma_f32_16x16x32_f16 v[216:219], v[160:163], v[184:187], v[216:219]
    v_mfma_f32_16x16x32_f16 v[220:223], v[156:159], v[188:191], v[220:223]
    v_mfma_f32_16x16x32_f16 v[224:227], v[160:163], v[188:191], v[224:227]
    s_waitcnt lgkmcnt(6)
    v_mfma_f32_16x16x32_f16 v[212:215], v[164:167], v[180:183], v[212:215]
    s_waitcnt lgkmcnt(4)
    v_mfma_f32_16x16x32_f16 v[216:219], v[168:171], v[180:183], v[216:219]
    v_mfma_f32_16x16x32_f16 v[220:223], v[164:167], v[184:187], v[220:223]
    v_mfma_f32_16x16x32_f16 v[224:227], v[168:171], v[184:187], v[224:227]
    s_waitcnt lgkmcnt(2)
    v_mfma_f32_16x16x32_f16 v[220:223], v[172:175], v[180:183], v[220:223]
    s_waitcnt lgkmcnt(0)
    v_mfma_f32_16x16x32_f16 v[224:227], v[176:179], v[180:183], v[224:227]
    s_waitcnt lgkmcnt(0)
    s_lshl_b32 s59, s59, s60
    s_and_b32 s59, s59, 0xffff0000
    v_mov_b32 v116, s59

    v_mov_b32 v118, v61
    v_mov_b32 v119, v61
    s_nop 4
    ds_read_b64 v[100:101], v23 offset:0
    ds_read_b64 v[102:103], v23 offset:32
    ds_read_b64 v[104:105], v23 offset:1024
    ds_read_b64 v[106:107], v23 offset:1056
    ds_read_b64 v[108:109], v23 offset:2048
    ds_read_b64 v[110:111], v23 offset:2080
    ds_read_b64 v[112:113], v23 offset:3072
    ds_read_b64 v[114:115], v23 offset:3104
    s_waitcnt lgkmcnt(0)
    v_pk_mul_f32 v[196:197], v[196:197], v[118:119]
    v_pk_mul_f32 v[200:201], v[200:201], v[118:119]
    v_pk_mul_f32 v[204:205], v[204:205], v[118:119]
    v_pk_mul_f32 v[208:209], v[208:209], v[118:119]
    v_pk_mul_f32 v[198:199], v[198:199], v[118:119]
    v_pk_mul_f32 v[202:203], v[202:203], v[118:119]
    v_pk_mul_f32 v[206:207], v[206:207], v[118:119]
    v_pk_mul_f32 v[210:211], v[210:211], v[118:119]
    v_fma_mix_f32 v120, v100, v116, 0 op_sel_hi:[1,0,0]
    v_fma_mix_f32 v128, v102, v116, 0 op_sel_hi:[1,0,0]
    v_fma_mix_f32 v136, v104, v116, 0 op_sel_hi:[1,0,0]
    v_fma_mix_f32 v144, v106, v116, 0 op_sel_hi:[1,0,0]
    v_fma_mix_f32 v121, v100, v116, 0 op_sel:[1,0,0] op_sel_hi:[1,0,0]
    v_fma_mix_f32 v129, v102, v116, 0 op_sel:[1,0,0] op_sel_hi:[1,0,0]
    v_fma_mix_f32 v137, v104, v116, 0 op_sel:[1,0,0] op_sel_hi:[1,0,0]
    v_fma_mix_f32 v145, v106, v116, 0 op_sel:[1,0,0] op_sel_hi:[1,0,0]
    v_fma_mix_f32 v122, v101, v116, 0 op_sel_hi:[1,0,0]
    v_fma_mix_f32 v130, v103, v116, 0 op_sel_hi:[1,0,0]
    v_fma_mix_f32 v138, v105, v116, 0 op_sel_hi:[1,0,0]
    v_fma_mix_f32 v146, v107, v116, 0 op_sel_hi:[1,0,0]
    v_fma_mix_f32 v123, v101, v116, 0 op_sel:[1,0,0] op_sel_hi:[1,0,0]
    v_fma_mix_f32 v131, v103, v116, 0 op_sel:[1,0,0] op_sel_hi:[1,0,0]
    v_fma_mix_f32 v139, v105, v116, 0 op_sel:[1,0,0] op_sel_hi:[1,0,0]
    v_fma_mix_f32 v147, v107, v116, 0 op_sel:[1,0,0] op_sel_hi:[1,0,0]
    v_cvt_pk_bf16_f32 v124, v196, v197
    v_cvt_pk_bf16_f32 v132, v200, v201
    v_cvt_pk_bf16_f32 v140, v204, v205
    v_cvt_pk_bf16_f32 v148, v208, v209
    v_cvt_pk_bf16_f32 v125, v198, v199
    v_cvt_pk_bf16_f32 v133, v202, v203
    v_cvt_pk_bf16_f32 v141, v206, v207
    v_cvt_pk_bf16_f32 v149, v210, v211
    v_cvt_pk_bf16_f32 v126, v120, v121
    v_cvt_pk_bf16_f32 v134, v128, v129
    v_cvt_pk_bf16_f32 v142, v136, v137
    v_cvt_pk_bf16_f32 v150, v144, v145
    v_cvt_pk_bf16_f32 v127, v122, v123
    v_cvt_pk_bf16_f32 v135, v130, v131
    v_cvt_pk_bf16_f32 v143, v138, v139
    v_cvt_pk_bf16_f32 v151, v146, v147
    v_lshlrev_b32 v196, 16, v124
    v_lshlrev_b32 v200, 16, v132
    v_lshlrev_b32 v204, 16, v140
    v_lshlrev_b32 v208, 16, v148
    v_and_b32 v197, 0xffff0000, v124
    v_and_b32 v201, 0xffff0000, v132
    v_and_b32 v205, 0xffff0000, v140
    v_and_b32 v209, 0xffff0000, v148
    v_lshlrev_b32 v198, 16, v125
    v_lshlrev_b32 v202, 16, v133
    v_lshlrev_b32 v206, 16, v141
    v_lshlrev_b32 v210, 16, v149
    v_and_b32 v199, 0xffff0000, v125
    v_and_b32 v203, 0xffff0000, v133
    v_and_b32 v207, 0xffff0000, v141
    v_and_b32 v211, 0xffff0000, v149
    v_lshlrev_b32 v120, 16, v126
    v_lshlrev_b32 v128, 16, v134
    v_lshlrev_b32 v136, 16, v142
    v_lshlrev_b32 v144, 16, v150
    v_and_b32 v121, 0xffff0000, v126
    v_and_b32 v129, 0xffff0000, v134
    v_and_b32 v137, 0xffff0000, v142
    v_and_b32 v145, 0xffff0000, v150
    v_lshlrev_b32 v122, 16, v127
    v_lshlrev_b32 v130, 16, v135
    v_lshlrev_b32 v138, 16, v143
    v_lshlrev_b32 v146, 16, v151
    v_and_b32 v123, 0xffff0000, v127
    v_and_b32 v131, 0xffff0000, v135
    v_and_b32 v139, 0xffff0000, v143
    v_and_b32 v147, 0xffff0000, v151
    v_pk_add_f32 v[196:197], v[196:197], v[120:121]
    v_pk_add_f32 v[200:201], v[200:201], v[128:129]
    v_pk_add_f32 v[204:205], v[204:205], v[136:137]
    v_pk_add_f32 v[208:209], v[208:209], v[144:145]
    v_pk_add_f32 v[198:199], v[198:199], v[122:123]
    v_pk_add_f32 v[202:203], v[202:203], v[130:131]
    v_pk_add_f32 v[206:207], v[206:207], v[138:139]
    v_pk_add_f32 v[210:211], v[210:211], v[146:147]
    v_cvt_pk_bf16_f32 v124, v196, v197
    v_cvt_pk_bf16_f32 v132, v200, v201
    v_cvt_pk_bf16_f32 v140, v204, v205
    v_cvt_pk_bf16_f32 v148, v208, v209
    v_cvt_pk_bf16_f32 v125, v198, v199
    v_cvt_pk_bf16_f32 v133, v202, v203
    v_cvt_pk_bf16_f32 v141, v206, v207
    v_cvt_pk_bf16_f32 v149, v210, v211
    ds_write_b64 v24, v[124:125] offset:0
    ds_write_b64 v24, v[132:133] offset:32
    ds_write_b64 v24, v[140:141] offset:1024
    ds_write_b64 v24, v[148:149] offset:1056
    v_pk_mul_f32 v[212:213], v[212:213], v[118:119]
    v_pk_mul_f32 v[216:217], v[216:217], v[118:119]
    v_pk_mul_f32 v[220:221], v[220:221], v[118:119]
    v_pk_mul_f32 v[224:225], v[224:225], v[118:119]
    v_pk_mul_f32 v[214:215], v[214:215], v[118:119]
    v_pk_mul_f32 v[218:219], v[218:219], v[118:119]
    v_pk_mul_f32 v[222:223], v[222:223], v[118:119]
    v_pk_mul_f32 v[226:227], v[226:227], v[118:119]
    v_fma_mix_f32 v120, v108, v116, 0 op_sel_hi:[1,0,0]
    v_fma_mix_f32 v128, v110, v116, 0 op_sel_hi:[1,0,0]
    v_fma_mix_f32 v136, v112, v116, 0 op_sel_hi:[1,0,0]
    v_fma_mix_f32 v144, v114, v116, 0 op_sel_hi:[1,0,0]
    v_fma_mix_f32 v121, v108, v116, 0 op_sel:[1,0,0] op_sel_hi:[1,0,0]
    v_fma_mix_f32 v129, v110, v116, 0 op_sel:[1,0,0] op_sel_hi:[1,0,0]
    v_fma_mix_f32 v137, v112, v116, 0 op_sel:[1,0,0] op_sel_hi:[1,0,0]
    v_fma_mix_f32 v145, v114, v116, 0 op_sel:[1,0,0] op_sel_hi:[1,0,0]
    v_fma_mix_f32 v122, v109, v116, 0 op_sel_hi:[1,0,0]
    v_fma_mix_f32 v130, v111, v116, 0 op_sel_hi:[1,0,0]
    v_fma_mix_f32 v138, v113, v116, 0 op_sel_hi:[1,0,0]
    v_fma_mix_f32 v146, v115, v116, 0 op_sel_hi:[1,0,0]
    v_fma_mix_f32 v123, v109, v116, 0 op_sel:[1,0,0] op_sel_hi:[1,0,0]
    v_fma_mix_f32 v131, v111, v116, 0 op_sel:[1,0,0] op_sel_hi:[1,0,0]
    v_fma_mix_f32 v139, v113, v116, 0 op_sel:[1,0,0] op_sel_hi:[1,0,0]
    v_fma_mix_f32 v147, v115, v116, 0 op_sel:[1,0,0] op_sel_hi:[1,0,0]
    v_cvt_pk_bf16_f32 v124, v212, v213
    v_cvt_pk_bf16_f32 v132, v216, v217
    v_cvt_pk_bf16_f32 v140, v220, v221
    v_cvt_pk_bf16_f32 v148, v224, v225
    v_cvt_pk_bf16_f32 v125, v214, v215
    v_cvt_pk_bf16_f32 v133, v218, v219
    v_cvt_pk_bf16_f32 v141, v222, v223
    v_cvt_pk_bf16_f32 v149, v226, v227
    v_cvt_pk_bf16_f32 v126, v120, v121
    v_cvt_pk_bf16_f32 v134, v128, v129
    v_cvt_pk_bf16_f32 v142, v136, v137
    v_cvt_pk_bf16_f32 v150, v144, v145
    v_cvt_pk_bf16_f32 v127, v122, v123
    v_cvt_pk_bf16_f32 v135, v130, v131
    v_cvt_pk_bf16_f32 v143, v138, v139
    v_cvt_pk_bf16_f32 v151, v146, v147
    v_lshlrev_b32 v212, 16, v124
    v_lshlrev_b32 v216, 16, v132
    v_lshlrev_b32 v220, 16, v140
    v_lshlrev_b32 v224, 16, v148
    v_and_b32 v213, 0xffff0000, v124
    v_and_b32 v217, 0xffff0000, v132
    v_and_b32 v221, 0xffff0000, v140
    v_and_b32 v225, 0xffff0000, v148
    v_lshlrev_b32 v214, 16, v125
    v_lshlrev_b32 v218, 16, v133
    v_lshlrev_b32 v222, 16, v141
    v_lshlrev_b32 v226, 16, v149
    v_and_b32 v215, 0xffff0000, v125
    v_and_b32 v219, 0xffff0000, v133
    v_and_b32 v223, 0xffff0000, v141
    v_and_b32 v227, 0xffff0000, v149
    v_lshlrev_b32 v120, 16, v126
    v_lshlrev_b32 v128, 16, v134
    v_lshlrev_b32 v136, 16, v142
    v_lshlrev_b32 v144, 16, v150
    v_and_b32 v121, 0xffff0000, v126
    v_and_b32 v129, 0xffff0000, v134
    v_and_b32 v137, 0xffff0000, v142
    v_and_b32 v145, 0xffff0000, v150
    v_lshlrev_b32 v122, 16, v127
    v_lshlrev_b32 v130, 16, v135
    v_lshlrev_b32 v138, 16, v143
    v_lshlrev_b32 v146, 16, v151
    v_and_b32 v123, 0xffff0000, v127
    v_and_b32 v131, 0xffff0000, v135
    v_and_b32 v139, 0xffff0000, v143
    v_and_b32 v147, 0xffff0000, v151
    v_pk_add_f32 v[212:213], v[212:213], v[120:121]
    v_pk_add_f32 v[216:217], v[216:217], v[128:129]
    v_pk_add_f32 v[220:221], v[220:221], v[136:137]
    v_pk_add_f32 v[224:225], v[224:225], v[144:145]
    v_pk_add_f32 v[214:215], v[214:215], v[122:123]
    v_pk_add_f32 v[218:219], v[218:219], v[130:131]
    v_pk_add_f32 v[222:223], v[222:223], v[138:139]
    v_pk_add_f32 v[226:227], v[226:227], v[146:147]
    v_cvt_pk_bf16_f32 v124, v212, v213
    v_cvt_pk_bf16_f32 v132, v216, v217
    v_cvt_pk_bf16_f32 v140, v220, v221
    v_cvt_pk_bf16_f32 v148, v224, v225
    v_cvt_pk_bf16_f32 v125, v214, v215
    v_cvt_pk_bf16_f32 v133, v218, v219
    v_cvt_pk_bf16_f32 v141, v222, v223
    v_cvt_pk_bf16_f32 v149, v226, v227
    ds_write_b64 v24, v[124:125] offset:2048
    ds_write_b64 v24, v[132:133] offset:2080
    ds_write_b64 v24, v[140:141] offset:3072
    ds_write_b64 v24, v[148:149] offset:3104
    s_waitcnt lgkmcnt(0)
    ds_read_b128 v[152:155], v25 offset:0
    ds_read_b128 v[156:159], v25 offset:1024
    ds_read_b128 v[160:163], v25 offset:2048
    ds_read_b128 v[164:167], v25 offset:3072
    s_lshl_b32 s55, s54, 12
    s_add_u32 s55, s55, 4718592
    s_waitcnt lgkmcnt(0)
    buffer_store_dwordx4 v[152:155], v26, s[16:19], s55 offen offset:0 sc1
    buffer_store_dwordx4 v[156:159], v26, s[16:19], s55 offen offset:1024 sc1
    buffer_store_dwordx4 v[160:163], v26, s[16:19], s55 offen offset:2048 sc1
    buffer_store_dwordx4 v[164:167], v26, s[16:19], s55 offen offset:3072 sc1
    s_add_u32 s54, s40, s63
    s_lshl_b32 s56, s54, 1
    s_and_b32 s57, s56, 0xfffffffc
    s_load_dword s59, s[46:47], s57
    s_lshl_b32 s56, s54, 2
    s_add_u32 s56, s56, 7143424

    v_mov_b32 v61, s56
    buffer_load_dword v61, v61, s[16:19], 0 offen sc1
    s_bitcmp1_b32 s54, 0
    s_cselect_b32 s60, 0, 16
    s_lshl_b32 s55, s63, 4
    v_add_u32 v100, s55, v6
    v_subrev_u32 v101, 136, v100
    v_max_i32 v102, 0, v101

    ds_read_b64 v[104:105], v102 offset:0
    ds_read_b128 v[106:109], v100 offset:0
    ds_read_b64 v[110:111], v101 offset:9216
    ds_read_b128 v[112:115], v100 offset:9216
    ds_read_b64 v[116:117], v101 offset:18432
    ds_read_b128 v[118:121], v100 offset:18432
    ds_read_b64 v[122:123], v101 offset:27648
    ds_read_b128 v[124:127], v100 offset:27648
    s_waitcnt lgkmcnt(6)
    v_cmp_eq_u32 vcc, 0, v60
    v_mov_b32 v103, 0
    s_nop 0
    v_cndmask_b32 v104, v104, v103, vcc
    v_cndmask_b32 v105, v105, v103, vcc
    v_alignbit_b32 v128, v105, v104, 16
    v_alignbit_b32 v129, v106, v105, 16
    v_alignbit_b32 v130, v107, v106, 16
    v_alignbit_b32 v131, v108, v107, 16
    ds_write_b128 v7, v[106:109] offset:0
    v_alignbit_b32 v132, v106, v105, 16
    v_alignbit_b32 v133, v107, v106, 16
    v_alignbit_b32 v134, v108, v107, 16
    v_alignbit_b32 v135, v109, v108, 16
    ds_write_b128 v7, v[128:131] offset:12480
    v_mov_b32 v136, v105
    v_mov_b32 v137, v106
    v_mov_b32 v138, v107
    v_mov_b32 v139, v108
    ds_write_b128 v7, v[132:135] offset:4160
    ds_write_b128 v7, v[136:139] offset:8320

    s_waitcnt lgkmcnt(8)
    v_alignbit_b32 v140, v111, v110, 16
    v_alignbit_b32 v141, v112, v111, 16
    v_alignbit_b32 v142, v113, v112, 16
    v_alignbit_b32 v143, v114, v113, 16
    ds_write_b128 v7, v[112:115] offset:1024
    v_alignbit_b32 v144, v112, v111, 16
    v_alignbit_b32 v145, v113, v112, 16
    v_alignbit_b32 v146, v114, v113, 16
    v_alignbit_b32 v147, v115, v114, 16
    ds_write_b128 v7, v[140:143] offset:13504
    v_mov_b32 v148, v111
    v_mov_b32 v149, v112
    v_mov_b32 v150, v113
    v_mov_b32 v151, v114
    ds_write_b128 v7, v[144:147] offset:5184
    ds_write_b128 v7, v[148:151] offset:9344

    s_waitcnt lgkmcnt(10)
    v_alignbit_b32 v128, v117, v116, 16
    v_alignbit_b32 v129, v118, v117, 16
    v_alignbit_b32 v130, v119, v118, 16
    v_alignbit_b32 v131, v120, v119, 16
    ds_write_b128 v7, v[118:121] offset:2048
    v_alignbit_b32 v132, v118, v117, 16
    v_alignbit_b32 v133, v119, v118, 16
    v_alignbit_b32 v134, v120, v119, 16
    v_alignbit_b32 v135, v121, v120, 16
    ds_write_b128 v7, v[128:131] offset:14528
    v_mov_b32 v136, v117
    v_mov_b32 v137, v118
    v_mov_b32 v138, v119
    v_mov_b32 v139, v120
    ds_write_b128 v7, v[132:135] offset:6208
    ds_write_b128 v7, v[136:139] offset:10368

    s_waitcnt lgkmcnt(12)
    v_alignbit_b32 v140, v123, v122, 16
    v_alignbit_b32 v141, v124, v123, 16
    v_alignbit_b32 v142, v125, v124, 16
    v_alignbit_b32 v143, v126, v125, 16
    ds_write_b128 v7, v[124:127] offset:3072
    v_alignbit_b32 v144, v124, v123, 16
    v_alignbit_b32 v145, v125, v124, 16
    v_alignbit_b32 v146, v126, v125, 16
    v_alignbit_b32 v147, v127, v126, 16
    ds_write_b128 v7, v[140:143] offset:15552
    v_mov_b32 v148, v123
    v_mov_b32 v149, v124
    v_mov_b32 v150, v125
    v_mov_b32 v151, v126
    ds_write_b128 v7, v[144:147] offset:7232
    ds_write_b128 v7, v[148:151] offset:11392

    s_waitcnt vmcnt(0) lgkmcnt(0)
    s_cmp_lg_u32 s36, 0
    s_cbranch_scc1 L_nok_20
    s_add_u32 s55, s40, s64
    s_lshl_b32 s55, s55, 12
    s_add_u32 s55, s55, 38797312

    s_add_u32 m0, s41, 16896
    s_add_u32 s56, s55, 0
    buffer_load_dwordx4 v26, s[16:19], s56 offen sc1 lds
    s_add_u32 m0, s41, 18176
    s_add_u32 s56, s55, 1024
    buffer_load_dwordx4 v26, s[16:19], s56 offen sc1 lds
    s_add_u32 m0, s41, 19456
    s_add_u32 s56, s55, 2048
    buffer_load_dwordx4 v26, s[16:19], s56 offen sc1 lds
    s_add_u32 m0, s41, 20736
    s_add_u32 s56, s55, 3072
    buffer_load_dwordx4 v26, s[16:19], s56 offen sc1 lds
    L_nok_20:
    ds_read_b128 v[132:135], v5 offset:5360
    ds_read_b64_tr_b16 v[100:101], v4 offset:8
    ds_read_b64_tr_b16 v[102:103], v4 offset:0
    ds_read_b64_tr_b16 v[104:105], v4 offset:40
    ds_read_b64_tr_b16 v[106:107], v4 offset:32
    ds_read_b128 v[136:139], v5 offset:5616
    ds_read_b128 v[140:143], v5 offset:5872
    ds_read_b128 v[144:147], v5 offset:6128
    ds_read_b64_tr_b16 v[108:109], v4 offset:1032
    ds_read_b64_tr_b16 v[110:111], v4 offset:1024
    ds_read_b64_tr_b16 v[112:113], v4 offset:1064
    ds_read_b64_tr_b16 v[114:115], v4 offset:1056
    ds_read_b64_tr_b16 v[116:117], v4 offset:2056
    ds_read_b64_tr_b16 v[118:119], v4 offset:2048
    ds_read_b64_tr_b16 v[120:121], v4 offset:2088
    ds_read_b64_tr_b16 v[122:123], v4 offset:2080
    ds_read_b64_tr_b16 v[124:125], v4 offset:3080
    ds_read_b64_tr_b16 v[126:127], v4 offset:3072
    ds_read_b64_tr_b16 v[128:129], v4 offset:3112
    ds_read_b64_tr_b16 v[130:131], v4 offset:3104
    s_waitcnt lgkmcnt(15)
    v_mfma_f32_16x16x32_f16 v[196:199], v[100:103], v[132:135], 0
    ds_read_b128 v[180:183], v5 offset:5344
    v_mfma_f32_16x16x32_f16 v[200:203], v[104:107], v[132:135], 0
    ds_read_b64_tr_b16 v[148:149], v4 offset:72
    s_waitcnt lgkmcnt(15)
    v_mfma_f32_16x16x32_f16 v[204:207], v[100:103], v[136:139], 0
    ds_read_b64_tr_b16 v[150:151], v4 offset:64
    v_mfma_f32_16x16x32_f16 v[208:211], v[104:107], v[136:139], 0
    ds_read_b64_tr_b16 v[152:153], v4 offset:104
    v_mfma_f32_16x16x32_f16 v[212:215], v[100:103], v[140:143], 0
    ds_read_b64_tr_b16 v[154:155], v4 offset:96
    v_mfma_f32_16x16x32_f16 v[216:219], v[104:107], v[140:143], 0
    ds_read_b128 v[184:187], v5 offset:5600
    s_waitcnt lgkmcnt(15)
    v_mfma_f32_16x16x32_f16 v[220:223], v[100:103], v[144:147], 0
    ds_read_b128 v[188:191], v5 offset:5856
    v_mfma_f32_16x16x32_f16 v[224:227], v[104:107], v[144:147], 0
    ds_read_b128 v[192:195], v5 offset:6112
    v_mfma_f32_16x16x32_f16 v[204:207], v[108:111], v[132:135], v[204:207]
    ds_read_b64_tr_b16 v[156:157], v4 offset:1096
    s_waitcnt lgkmcnt(15)
    v_mfma_f32_16x16x32_f16 v[208:211], v[112:115], v[132:135], v[208:211]
    ds_read_b64_tr_b16 v[158:159], v4 offset:1088
    v_mfma_f32_16x16x32_f16 v[212:215], v[108:111], v[136:139], v[212:215]
    ds_read_b64_tr_b16 v[160:161], v4 offset:1128
    v_mfma_f32_16x16x32_f16 v[216:219], v[112:115], v[136:139], v[216:219]
    ds_read_b64_tr_b16 v[162:163], v4 offset:1120
    v_mfma_f32_16x16x32_f16 v[220:223], v[108:111], v[140:143], v[220:223]
    ds_read_b64_tr_b16 v[164:165], v4 offset:2120
    v_mfma_f32_16x16x32_f16 v[224:227], v[112:115], v[140:143], v[224:227]
    ds_read_b64_tr_b16 v[166:167], v4 offset:2112
    v_mfma_f32_16x16x32_f16 v[212:215], v[116:119], v[132:135], v[212:215]
    ds_read_b64_tr_b16 v[168:169], v4 offset:2152
    s_waitcnt lgkmcnt(15)
    v_mfma_f32_16x16x32_f16 v[216:219], v[120:123], v[132:135], v[216:219]
    ds_read_b64_tr_b16 v[170:171], v4 offset:2144
    v_mfma_f32_16x16x32_f16 v[220:223], v[116:119], v[136:139], v[220:223]
    ds_read_b64_tr_b16 v[172:173], v4 offset:3144
    v_mfma_f32_16x16x32_f16 v[224:227], v[120:123], v[136:139], v[224:227]
    ds_read_b64_tr_b16 v[174:175], v4 offset:3136
    v_mfma_f32_16x16x32_f16 v[220:223], v[124:127], v[132:135], v[220:223]
    ds_read_b64_tr_b16 v[176:177], v4 offset:3176
    v_mfma_f32_16x16x32_f16 v[224:227], v[128:131], v[132:135], v[224:227]
    ds_read_b64_tr_b16 v[178:179], v4 offset:3168
    s_waitcnt lgkmcnt(15)
    v_mfma_f32_16x16x32_f16 v[196:199], v[148:151], v[180:183], v[196:199]
    ds_read_b128 v[132:135], v5 offset:5328
    v_mfma_f32_16x16x32_f16 v[200:203], v[152:155], v[180:183], v[200:203]
    ds_read_b64_tr_b16 v[100:101], v4 offset:136
    s_waitcnt lgkmcnt(15)
    v_mfma_f32_16x16x32_f16 v[204:207], v[148:151], v[184:187], v[204:207]
    ds_read_b64_tr_b16 v[102:103], v4 offset:128
    v_mfma_f32_16x16x32_f16 v[208:211], v[152:155], v[184:187], v[208:211]
    ds_read_b64_tr_b16 v[104:105], v4 offset:168
    v_mfma_f32_16x16x32_f16 v[212:215], v[148:151], v[188:191], v[212:215]
    ds_read_b64_tr_b16 v[106:107], v4 offset:160
    v_mfma_f32_16x16x32_f16 v[216:219], v[152:155], v[188:191], v[216:219]
    ds_read_b128 v[136:139], v5 offset:5584
    s_waitcnt lgkmcnt(15)
    v_mfma_f32_16x16x32_f16 v[220:223], v[148:151], v[192:195], v[220:223]
    ds_read_b128 v[140:143], v5 offset:5840
    v_mfma_f32_16x16x32_f16 v[224:227], v[152:155], v[192:195], v[224:227]
    ds_read_b128 v[144:147], v5 offset:6096
    v_mfma_f32_16x16x32_f16 v[204:207], v[156:159], v[180:183], v[204:207]
    ds_read_b64_tr_b16 v[108:109], v4 offset:1160
    s_waitcnt lgkmcnt(15)
    v_mfma_f32_16x16x32_f16 v[208:211], v[160:163], v[180:183], v[208:211]
    ds_read_b64_tr_b16 v[110:111], v4 offset:1152
    v_mfma_f32_16x16x32_f16 v[212:215], v[156:159], v[184:187], v[212:215]
    ds_read_b64_tr_b16 v[112:113], v4 offset:1192
    v_mfma_f32_16x16x32_f16 v[216:219], v[160:163], v[184:187], v[216:219]
    ds_read_b64_tr_b16 v[114:115], v4 offset:1184
    v_mfma_f32_16x16x32_f16 v[220:223], v[156:159], v[188:191], v[220:223]
    ds_read_b64_tr_b16 v[116:117], v4 offset:2184
    v_mfma_f32_16x16x32_f16 v[224:227], v[160:163], v[188:191], v[224:227]
    ds_read_b64_tr_b16 v[118:119], v4 offset:2176
    v_mfma_f32_16x16x32_f16 v[212:215], v[164:167], v[180:183], v[212:215]
    ds_read_b64_tr_b16 v[120:121], v4 offset:2216
    s_waitcnt lgkmcnt(15)
    v_mfma_f32_16x16x32_f16 v[216:219], v[168:171], v[180:183], v[216:219]
    ds_read_b64_tr_b16 v[122:123], v4 offset:2208
    v_mfma_f32_16x16x32_f16 v[220:223], v[164:167], v[184:187], v[220:223]
    ds_read_b64_tr_b16 v[124:125], v4 offset:3208
    v_mfma_f32_16x16x32_f16 v[224:227], v[168:171], v[184:187], v[224:227]
    ds_read_b64_tr_b16 v[126:127], v4 offset:3200
    v_mfma_f32_16x16x32_f16 v[220:223], v[172:175], v[180:183], v[220:223]
    ds_read_b64_tr_b16 v[128:129], v4 offset:3240
    v_mfma_f32_16x16x32_f16 v[224:227], v[176:179], v[180:183], v[224:227]
    ds_read_b64_tr_b16 v[130:131], v4 offset:3232
    s_waitcnt lgkmcnt(15)
    v_mfma_f32_16x16x32_f16 v[196:199], v[100:103], v[132:135], v[196:199]
    ds_read_b128 v[180:183], v5 offset:5312
    v_mfma_f32_16x16x32_f16 v[200:203], v[104:107], v[132:135], v[200:203]
    ds_read_b64_tr_b16 v[148:149], v4 offset:200
    s_waitcnt lgkmcnt(15)
    v_mfma_f32_16x16x32_f16 v[204:207], v[100:103], v[136:139], v[204:207]
    ds_read_b64_tr_b16 v[150:151], v4 offset:192
    v_mfma_f32_16x16x32_f16 v[208:211], v[104:107], v[136:139], v[208:211]
    ds_read_b64_tr_b16 v[152:153], v4 offset:232
    v_mfma_f32_16x16x32_f16 v[212:215], v[100:103], v[140:143], v[212:215]
    ds_read_b64_tr_b16 v[154:155], v4 offset:224
    v_mfma_f32_16x16x32_f16 v[216:219], v[104:107], v[140:143], v[216:219]
    ds_read_b128 v[184:187], v5 offset:5568
    s_waitcnt lgkmcnt(15)
    v_mfma_f32_16x16x32_f16 v[220:223], v[100:103], v[144:147], v[220:223]
    ds_read_b128 v[188:191], v5 offset:5824
    v_mfma_f32_16x16x32_f16 v[224:227], v[104:107], v[144:147], v[224:227]
    ds_read_b128 v[192:195], v5 offset:6080
    v_mfma_f32_16x16x32_f16 v[204:207], v[108:111], v[132:135], v[204:207]
    ds_read_b64_tr_b16 v[156:157], v4 offset:1224
    s_waitcnt lgkmcnt(15)
    v_mfma_f32_16x16x32_f16 v[208:211], v[112:115], v[132:135], v[208:211]
    ds_read_b64_tr_b16 v[158:159], v4 offset:1216
    v_mfma_f32_16x16x32_f16 v[212:215], v[108:111], v[136:139], v[212:215]
    ds_read_b64_tr_b16 v[160:161], v4 offset:1256
    v_mfma_f32_16x16x32_f16 v[216:219], v[112:115], v[136:139], v[216:219]
    ds_read_b64_tr_b16 v[162:163], v4 offset:1248
    v_mfma_f32_16x16x32_f16 v[220:223], v[108:111], v[140:143], v[220:223]
    ds_read_b64_tr_b16 v[164:165], v4 offset:2248
    v_mfma_f32_16x16x32_f16 v[224:227], v[112:115], v[140:143], v[224:227]
    ds_read_b64_tr_b16 v[166:167], v4 offset:2240
    v_mfma_f32_16x16x32_f16 v[212:215], v[116:119], v[132:135], v[212:215]
    ds_read_b64_tr_b16 v[168:169], v4 offset:2280
    s_waitcnt lgkmcnt(15)
    v_mfma_f32_16x16x32_f16 v[216:219], v[120:123], v[132:135], v[216:219]
    ds_read_b64_tr_b16 v[170:171], v4 offset:2272
    v_mfma_f32_16x16x32_f16 v[220:223], v[116:119], v[136:139], v[220:223]
    ds_read_b64_tr_b16 v[172:173], v4 offset:3272
    v_mfma_f32_16x16x32_f16 v[224:227], v[120:123], v[136:139], v[224:227]
    ds_read_b64_tr_b16 v[174:175], v4 offset:3264
    v_mfma_f32_16x16x32_f16 v[220:223], v[124:127], v[132:135], v[220:223]
    ds_read_b64_tr_b16 v[176:177], v4 offset:3304
    v_mfma_f32_16x16x32_f16 v[224:227], v[128:131], v[132:135], v[224:227]
    ds_read_b64_tr_b16 v[178:179], v4 offset:3296
    s_waitcnt lgkmcnt(15)
    v_mfma_f32_16x16x32_f16 v[196:199], v[148:151], v[180:183], v[196:199]
    ds_read_b128 v[132:135], v5 offset:5296
    v_mfma_f32_16x16x32_f16 v[200:203], v[152:155], v[180:183], v[200:203]
    ds_read_b64_tr_b16 v[100:101], v4 offset:264
    s_waitcnt lgkmcnt(15)
    v_mfma_f32_16x16x32_f16 v[204:207], v[148:151], v[184:187], v[204:207]
    ds_read_b64_tr_b16 v[102:103], v4 offset:256
    v_mfma_f32_16x16x32_f16 v[208:211], v[152:155], v[184:187], v[208:211]
    ds_read_b64_tr_b16 v[104:105], v4 offset:296
    v_mfma_f32_16x16x32_f16 v[212:215], v[148:151], v[188:191], v[212:215]
    ds_read_b64_tr_b16 v[106:107], v4 offset:288
    v_mfma_f32_16x16x32_f16 v[216:219], v[152:155], v[188:191], v[216:219]
    ds_read_b128 v[136:139], v5 offset:5552
    s_waitcnt lgkmcnt(15)
    v_mfma_f32_16x16x32_f16 v[220:223], v[148:151], v[192:195], v[220:223]
    ds_read_b128 v[140:143], v5 offset:5808
    v_mfma_f32_16x16x32_f16 v[224:227], v[152:155], v[192:195], v[224:227]
    ds_read_b128 v[144:147], v5 offset:6064
    v_mfma_f32_16x16x32_f16 v[204:207], v[156:159], v[180:183], v[204:207]
    ds_read_b64_tr_b16 v[108:109], v4 offset:1288
    s_waitcnt lgkmcnt(15)
    v_mfma_f32_16x16x32_f16 v[208:211], v[160:163], v[180:183], v[208:211]
    ds_read_b64_tr_b16 v[110:111], v4 offset:1280
    v_mfma_f32_16x16x32_f16 v[212:215], v[156:159], v[184:187], v[212:215]
    ds_read_b64_tr_b16 v[112:113], v4 offset:1320
    v_mfma_f32_16x16x32_f16 v[216:219], v[160:163], v[184:187], v[216:219]
    ds_read_b64_tr_b16 v[114:115], v4 offset:1312
    v_mfma_f32_16x16x32_f16 v[220:223], v[156:159], v[188:191], v[220:223]
    ds_read_b64_tr_b16 v[116:117], v4 offset:2312
    v_mfma_f32_16x16x32_f16 v[224:227], v[160:163], v[188:191], v[224:227]
    ds_read_b64_tr_b16 v[118:119], v4 offset:2304
    v_mfma_f32_16x16x32_f16 v[212:215], v[164:167], v[180:183], v[212:215]
    ds_read_b64_tr_b16 v[120:121], v4 offset:2344
    s_waitcnt lgkmcnt(15)
    v_mfma_f32_16x16x32_f16 v[216:219], v[168:171], v[180:183], v[216:219]
    ds_read_b64_tr_b16 v[122:123], v4 offset:2336
    v_mfma_f32_16x16x32_f16 v[220:223], v[164:167], v[184:187], v[220:223]
    ds_read_b64_tr_b16 v[124:125], v4 offset:3336
    v_mfma_f32_16x16x32_f16 v[224:227], v[168:171], v[184:187], v[224:227]
    ds_read_b64_tr_b16 v[126:127], v4 offset:3328
    v_mfma_f32_16x16x32_f16 v[220:223], v[172:175], v[180:183], v[220:223]
    ds_read_b64_tr_b16 v[128:129], v4 offset:3368
    v_mfma_f32_16x16x32_f16 v[224:227], v[176:179], v[180:183], v[224:227]
    ds_read_b64_tr_b16 v[130:131], v4 offset:3360
    s_waitcnt lgkmcnt(15)
    v_mfma_f32_16x16x32_f16 v[196:199], v[100:103], v[132:135], v[196:199]
    ds_read_b128 v[180:183], v5 offset:5280
    v_mfma_f32_16x16x32_f16 v[200:203], v[104:107], v[132:135], v[200:203]
    ds_read_b64_tr_b16 v[148:149], v4 offset:328
    s_waitcnt lgkmcnt(15)
    v_mfma_f32_16x16x32_f16 v[204:207], v[100:103], v[136:139], v[204:207]
    ds_read_b64_tr_b16 v[150:151], v4 offset:320
    v_mfma_f32_16x16x32_f16 v[208:211], v[104:107], v[136:139], v[208:211]
    ds_read_b64_tr_b16 v[152:153], v4 offset:360
    v_mfma_f32_16x16x32_f16 v[212:215], v[100:103], v[140:143], v[212:215]
    ds_read_b64_tr_b16 v[154:155], v4 offset:352
    v_mfma_f32_16x16x32_f16 v[216:219], v[104:107], v[140:143], v[216:219]
    ds_read_b128 v[184:187], v5 offset:5536
    s_waitcnt lgkmcnt(15)
    v_mfma_f32_16x16x32_f16 v[220:223], v[100:103], v[144:147], v[220:223]
    ds_read_b128 v[188:191], v5 offset:5792
    v_mfma_f32_16x16x32_f16 v[224:227], v[104:107], v[144:147], v[224:227]
    ds_read_b128 v[192:195], v5 offset:6048
    v_mfma_f32_16x16x32_f16 v[204:207], v[108:111], v[132:135], v[204:207]
    ds_read_b64_tr_b16 v[156:157], v4 offset:1352
    s_waitcnt lgkmcnt(15)
    v_mfma_f32_16x16x32_f16 v[208:211], v[112:115], v[132:135], v[208:211]
    ds_read_b64_tr_b16 v[158:159], v4 offset:1344
    v_mfma_f32_16x16x32_f16 v[212:215], v[108:111], v[136:139], v[212:215]
    ds_read_b64_tr_b16 v[160:161], v4 offset:1384
    v_mfma_f32_16x16x32_f16 v[216:219], v[112:115], v[136:139], v[216:219]
    ds_read_b64_tr_b16 v[162:163], v4 offset:1376
    v_mfma_f32_16x16x32_f16 v[220:223], v[108:111], v[140:143], v[220:223]
    ds_read_b64_tr_b16 v[164:165], v4 offset:2376
    v_mfma_f32_16x16x32_f16 v[224:227], v[112:115], v[140:143], v[224:227]
    ds_read_b64_tr_b16 v[166:167], v4 offset:2368
    v_mfma_f32_16x16x32_f16 v[212:215], v[116:119], v[132:135], v[212:215]
    ds_read_b64_tr_b16 v[168:169], v4 offset:2408
    s_waitcnt lgkmcnt(15)
    v_mfma_f32_16x16x32_f16 v[216:219], v[120:123], v[132:135], v[216:219]
    ds_read_b64_tr_b16 v[170:171], v4 offset:2400
    v_mfma_f32_16x16x32_f16 v[220:223], v[116:119], v[136:139], v[220:223]
    ds_read_b64_tr_b16 v[172:173], v4 offset:3400
    v_mfma_f32_16x16x32_f16 v[224:227], v[120:123], v[136:139], v[224:227]
    ds_read_b64_tr_b16 v[174:175], v4 offset:3392
    v_mfma_f32_16x16x32_f16 v[220:223], v[124:127], v[132:135], v[220:223]
    ds_read_b64_tr_b16 v[176:177], v4 offset:3432
    v_mfma_f32_16x16x32_f16 v[224:227], v[128:131], v[132:135], v[224:227]
    ds_read_b64_tr_b16 v[178:179], v4 offset:3424
    s_waitcnt lgkmcnt(15)
    v_mfma_f32_16x16x32_f16 v[196:199], v[148:151], v[180:183], v[196:199]
    ds_read_b128 v[132:135], v5 offset:5264
    v_mfma_f32_16x16x32_f16 v[200:203], v[152:155], v[180:183], v[200:203]
    ds_read_b64_tr_b16 v[100:101], v4 offset:392
    s_waitcnt lgkmcnt(15)
    v_mfma_f32_16x16x32_f16 v[204:207], v[148:151], v[184:187], v[204:207]
    ds_read_b64_tr_b16 v[102:103], v4 offset:384
    v_mfma_f32_16x16x32_f16 v[208:211], v[152:155], v[184:187], v[208:211]
    ds_read_b64_tr_b16 v[104:105], v4 offset:424
    v_mfma_f32_16x16x32_f16 v[212:215], v[148:151], v[188:191], v[212:215]
    ds_read_b64_tr_b16 v[106:107], v4 offset:416
    v_mfma_f32_16x16x32_f16 v[216:219], v[152:155], v[188:191], v[216:219]
    ds_read_b128 v[136:139], v5 offset:5520
    s_waitcnt lgkmcnt(15)
    v_mfma_f32_16x16x32_f16 v[220:223], v[148:151], v[192:195], v[220:223]
    ds_read_b128 v[140:143], v5 offset:5776
    v_mfma_f32_16x16x32_f16 v[224:227], v[152:155], v[192:195], v[224:227]
    ds_read_b128 v[144:147], v5 offset:6032
    v_mfma_f32_16x16x32_f16 v[204:207], v[156:159], v[180:183], v[204:207]
    ds_read_b64_tr_b16 v[108:109], v4 offset:1416
    s_waitcnt lgkmcnt(15)
    v_mfma_f32_16x16x32_f16 v[208:211], v[160:163], v[180:183], v[208:211]
    ds_read_b64_tr_b16 v[110:111], v4 offset:1408
    v_mfma_f32_16x16x32_f16 v[212:215], v[156:159], v[184:187], v[212:215]
    ds_read_b64_tr_b16 v[112:113], v4 offset:1448
    v_mfma_f32_16x16x32_f16 v[216:219], v[160:163], v[184:187], v[216:219]
    ds_read_b64_tr_b16 v[114:115], v4 offset:1440
    v_mfma_f32_16x16x32_f16 v[220:223], v[156:159], v[188:191], v[220:223]
    ds_read_b64_tr_b16 v[116:117], v4 offset:2440
    v_mfma_f32_16x16x32_f16 v[224:227], v[160:163], v[188:191], v[224:227]
    ds_read_b64_tr_b16 v[118:119], v4 offset:2432
    v_mfma_f32_16x16x32_f16 v[212:215], v[164:167], v[180:183], v[212:215]
    ds_read_b64_tr_b16 v[120:121], v4 offset:2472
    s_waitcnt lgkmcnt(15)
    v_mfma_f32_16x16x32_f16 v[216:219], v[168:171], v[180:183], v[216:219]
    ds_read_b64_tr_b16 v[122:123], v4 offset:2464
    v_mfma_f32_16x16x32_f16 v[220:223], v[164:167], v[184:187], v[220:223]
    ds_read_b64_tr_b16 v[124:125], v4 offset:3464
    v_mfma_f32_16x16x32_f16 v[224:227], v[168:171], v[184:187], v[224:227]
    ds_read_b64_tr_b16 v[126:127], v4 offset:3456
    v_mfma_f32_16x16x32_f16 v[220:223], v[172:175], v[180:183], v[220:223]
    ds_read_b64_tr_b16 v[128:129], v4 offset:3496
    v_mfma_f32_16x16x32_f16 v[224:227], v[176:179], v[180:183], v[224:227]
    ds_read_b64_tr_b16 v[130:131], v4 offset:3488
    s_waitcnt lgkmcnt(15)
    v_mfma_f32_16x16x32_f16 v[196:199], v[100:103], v[132:135], v[196:199]
    ds_read_b128 v[180:183], v5 offset:5248
    v_mfma_f32_16x16x32_f16 v[200:203], v[104:107], v[132:135], v[200:203]
    ds_read_b64_tr_b16 v[148:149], v4 offset:456
    s_waitcnt lgkmcnt(15)
    v_mfma_f32_16x16x32_f16 v[204:207], v[100:103], v[136:139], v[204:207]
    ds_read_b64_tr_b16 v[150:151], v4 offset:448
    v_mfma_f32_16x16x32_f16 v[208:211], v[104:107], v[136:139], v[208:211]
    ds_read_b64_tr_b16 v[152:153], v4 offset:488
    v_mfma_f32_16x16x32_f16 v[212:215], v[100:103], v[140:143], v[212:215]
    ds_read_b64_tr_b16 v[154:155], v4 offset:480
    v_mfma_f32_16x16x32_f16 v[216:219], v[104:107], v[140:143], v[216:219]
    ds_read_b128 v[184:187], v5 offset:5504
    s_waitcnt lgkmcnt(15)
    v_mfma_f32_16x16x32_f16 v[220:223], v[100:103], v[144:147], v[220:223]
    ds_read_b128 v[188:191], v5 offset:5760
    v_mfma_f32_16x16x32_f16 v[224:227], v[104:107], v[144:147], v[224:227]
    ds_read_b128 v[192:195], v5 offset:6016
    v_mfma_f32_16x16x32_f16 v[204:207], v[108:111], v[132:135], v[204:207]
    ds_read_b64_tr_b16 v[156:157], v4 offset:1480
    s_waitcnt lgkmcnt(15)
    v_mfma_f32_16x16x32_f16 v[208:211], v[112:115], v[132:135], v[208:211]
    ds_read_b64_tr_b16 v[158:159], v4 offset:1472
    v_mfma_f32_16x16x32_f16 v[212:215], v[108:111], v[136:139], v[212:215]
    ds_read_b64_tr_b16 v[160:161], v4 offset:1512
    v_mfma_f32_16x16x32_f16 v[216:219], v[112:115], v[136:139], v[216:219]
    ds_read_b64_tr_b16 v[162:163], v4 offset:1504
    v_mfma_f32_16x16x32_f16 v[220:223], v[108:111], v[140:143], v[220:223]
    ds_read_b64_tr_b16 v[164:165], v4 offset:2504
    v_mfma_f32_16x16x32_f16 v[224:227], v[112:115], v[140:143], v[224:227]
    ds_read_b64_tr_b16 v[166:167], v4 offset:2496
    v_mfma_f32_16x16x32_f16 v[212:215], v[116:119], v[132:135], v[212:215]
    ds_read_b64_tr_b16 v[168:169], v4 offset:2536
    s_waitcnt lgkmcnt(15)
    v_mfma_f32_16x16x32_f16 v[216:219], v[120:123], v[132:135], v[216:219]
    ds_read_b64_tr_b16 v[170:171], v4 offset:2528
    v_mfma_f32_16x16x32_f16 v[220:223], v[116:119], v[136:139], v[220:223]
    ds_read_b64_tr_b16 v[172:173], v4 offset:3528
    v_mfma_f32_16x16x32_f16 v[224:227], v[120:123], v[136:139], v[224:227]
    ds_read_b64_tr_b16 v[174:175], v4 offset:3520
    v_mfma_f32_16x16x32_f16 v[220:223], v[124:127], v[132:135], v[220:223]
    ds_read_b64_tr_b16 v[176:177], v4 offset:3560
    v_mfma_f32_16x16x32_f16 v[224:227], v[128:131], v[132:135], v[224:227]
    ds_read_b64_tr_b16 v[178:179], v4 offset:3552
    s_waitcnt lgkmcnt(15)
    v_mfma_f32_16x16x32_f16 v[196:199], v[148:151], v[180:183], v[196:199]
    ds_read_b128 v[132:135], v5 offset:5232
    v_mfma_f32_16x16x32_f16 v[200:203], v[152:155], v[180:183], v[200:203]
    ds_read_b64_tr_b16 v[100:101], v4 offset:520
    s_waitcnt lgkmcnt(15)
    v_mfma_f32_16x16x32_f16 v[204:207], v[148:151], v[184:187], v[204:207]
    ds_read_b64_tr_b16 v[102:103], v4 offset:512
    v_mfma_f32_16x16x32_f16 v[208:211], v[152:155], v[184:187], v[208:211]
    ds_read_b64_tr_b16 v[104:105], v4 offset:552
    v_mfma_f32_16x16x32_f16 v[212:215], v[148:151], v[188:191], v[212:215]
    ds_read_b64_tr_b16 v[106:107], v4 offset:544
    v_mfma_f32_16x16x32_f16 v[216:219], v[152:155], v[188:191], v[216:219]
    ds_read_b128 v[136:139], v5 offset:5488
    s_waitcnt lgkmcnt(15)
    v_mfma_f32_16x16x32_f16 v[220:223], v[148:151], v[192:195], v[220:223]
    ds_read_b128 v[140:143], v5 offset:5744
    v_mfma_f32_16x16x32_f16 v[224:227], v[152:155], v[192:195], v[224:227]
    ds_read_b128 v[144:147], v5 offset:6000
    v_mfma_f32_16x16x32_f16 v[204:207], v[156:159], v[180:183], v[204:207]
    ds_read_b64_tr_b16 v[108:109], v4 offset:1544
    s_waitcnt lgkmcnt(15)
    v_mfma_f32_16x16x32_f16 v[208:211], v[160:163], v[180:183], v[208:211]
    ds_read_b64_tr_b16 v[110:111], v4 offset:1536
    v_mfma_f32_16x16x32_f16 v[212:215], v[156:159], v[184:187], v[212:215]
    ds_read_b64_tr_b16 v[112:113], v4 offset:1576
    v_mfma_f32_16x16x32_f16 v[216:219], v[160:163], v[184:187], v[216:219]
    ds_read_b64_tr_b16 v[114:115], v4 offset:1568
    v_mfma_f32_16x16x32_f16 v[220:223], v[156:159], v[188:191], v[220:223]
    ds_read_b64_tr_b16 v[116:117], v4 offset:2568
    v_mfma_f32_16x16x32_f16 v[224:227], v[160:163], v[188:191], v[224:227]
    ds_read_b64_tr_b16 v[118:119], v4 offset:2560
    v_mfma_f32_16x16x32_f16 v[212:215], v[164:167], v[180:183], v[212:215]
    ds_read_b64_tr_b16 v[120:121], v4 offset:2600
    s_waitcnt lgkmcnt(15)
    v_mfma_f32_16x16x32_f16 v[216:219], v[168:171], v[180:183], v[216:219]
    ds_read_b64_tr_b16 v[122:123], v4 offset:2592
    v_mfma_f32_16x16x32_f16 v[220:223], v[164:167], v[184:187], v[220:223]
    ds_read_b64_tr_b16 v[124:125], v4 offset:3592
    v_mfma_f32_16x16x32_f16 v[224:227], v[168:171], v[184:187], v[224:227]
    ds_read_b64_tr_b16 v[126:127], v4 offset:3584
    v_mfma_f32_16x16x32_f16 v[220:223], v[172:175], v[180:183], v[220:223]
    ds_read_b64_tr_b16 v[128:129], v4 offset:3624
    v_mfma_f32_16x16x32_f16 v[224:227], v[176:179], v[180:183], v[224:227]
    ds_read_b64_tr_b16 v[130:131], v4 offset:3616
    s_waitcnt lgkmcnt(15)
    v_mfma_f32_16x16x32_f16 v[196:199], v[100:103], v[132:135], v[196:199]
    ds_read_b128 v[180:183], v5 offset:5216
    v_mfma_f32_16x16x32_f16 v[200:203], v[104:107], v[132:135], v[200:203]
    ds_read_b64_tr_b16 v[148:149], v4 offset:584
    s_waitcnt lgkmcnt(15)
    v_mfma_f32_16x16x32_f16 v[204:207], v[100:103], v[136:139], v[204:207]
    ds_read_b64_tr_b16 v[150:151], v4 offset:576
    v_mfma_f32_16x16x32_f16 v[208:211], v[104:107], v[136:139], v[208:211]
    ds_read_b64_tr_b16 v[152:153], v4 offset:616
    v_mfma_f32_16x16x32_f16 v[212:215], v[100:103], v[140:143], v[212:215]
    ds_read_b64_tr_b16 v[154:155], v4 offset:608
    v_mfma_f32_16x16x32_f16 v[216:219], v[104:107], v[140:143], v[216:219]
    ds_read_b128 v[184:187], v5 offset:5472
    s_waitcnt lgkmcnt(15)
    v_mfma_f32_16x16x32_f16 v[220:223], v[100:103], v[144:147], v[220:223]
    ds_read_b128 v[188:191], v5 offset:5728
    v_mfma_f32_16x16x32_f16 v[224:227], v[104:107], v[144:147], v[224:227]
    ds_read_b128 v[192:195], v5 offset:5984
    v_mfma_f32_16x16x32_f16 v[204:207], v[108:111], v[132:135], v[204:207]
    ds_read_b64_tr_b16 v[156:157], v4 offset:1608
    s_waitcnt lgkmcnt(15)
    v_mfma_f32_16x16x32_f16 v[208:211], v[112:115], v[132:135], v[208:211]
    ds_read_b64_tr_b16 v[158:159], v4 offset:1600
    v_mfma_f32_16x16x32_f16 v[212:215], v[108:111], v[136:139], v[212:215]
    ds_read_b64_tr_b16 v[160:161], v4 offset:1640
    v_mfma_f32_16x16x32_f16 v[216:219], v[112:115], v[136:139], v[216:219]
    ds_read_b64_tr_b16 v[162:163], v4 offset:1632
    v_mfma_f32_16x16x32_f16 v[220:223], v[108:111], v[140:143], v[220:223]
    ds_read_b64_tr_b16 v[164:165], v4 offset:2632
    v_mfma_f32_16x16x32_f16 v[224:227], v[112:115], v[140:143], v[224:227]
    ds_read_b64_tr_b16 v[166:167], v4 offset:2624
    v_mfma_f32_16x16x32_f16 v[212:215], v[116:119], v[132:135], v[212:215]
    ds_read_b64_tr_b16 v[168:169], v4 offset:2664
    s_waitcnt lgkmcnt(15)
    v_mfma_f32_16x16x32_f16 v[216:219], v[120:123], v[132:135], v[216:219]
    ds_read_b64_tr_b16 v[170:171], v4 offset:2656
    v_mfma_f32_16x16x32_f16 v[220:223], v[116:119], v[136:139], v[220:223]
    ds_read_b64_tr_b16 v[172:173], v4 offset:3656
    v_mfma_f32_16x16x32_f16 v[224:227], v[120:123], v[136:139], v[224:227]
    ds_read_b64_tr_b16 v[174:175], v4 offset:3648
    v_mfma_f32_16x16x32_f16 v[220:223], v[124:127], v[132:135], v[220:223]
    ds_read_b64_tr_b16 v[176:177], v4 offset:3688
    v_mfma_f32_16x16x32_f16 v[224:227], v[128:131], v[132:135], v[224:227]
    ds_read_b64_tr_b16 v[178:179], v4 offset:3680
    s_waitcnt lgkmcnt(15)
    v_mfma_f32_16x16x32_f16 v[196:199], v[148:151], v[180:183], v[196:199]
    ds_read_b128 v[132:135], v5 offset:5200
    v_mfma_f32_16x16x32_f16 v[200:203], v[152:155], v[180:183], v[200:203]
    ds_read_b64_tr_b16 v[100:101], v4 offset:648
    s_waitcnt lgkmcnt(15)
    v_mfma_f32_16x16x32_f16 v[204:207], v[148:151], v[184:187], v[204:207]
    ds_read_b64_tr_b16 v[102:103], v4 offset:640
    v_mfma_f32_16x16x32_f16 v[208:211], v[152:155], v[184:187], v[208:211]
    ds_read_b64_tr_b16 v[104:105], v4 offset:680
    v_mfma_f32_16x16x32_f16 v[212:215], v[148:151], v[188:191], v[212:215]
    ds_read_b64_tr_b16 v[106:107], v4 offset:672
    v_mfma_f32_16x16x32_f16 v[216:219], v[152:155], v[188:191], v[216:219]
    ds_read_b128 v[136:139], v5 offset:5456
    s_waitcnt lgkmcnt(15)
    v_mfma_f32_16x16x32_f16 v[220:223], v[148:151], v[192:195], v[220:223]
    ds_read_b128 v[140:143], v5 offset:5712
    v_mfma_f32_16x16x32_f16 v[224:227], v[152:155], v[192:195], v[224:227]
    ds_read_b128 v[144:147], v5 offset:5968
    v_mfma_f32_16x16x32_f16 v[204:207], v[156:159], v[180:183], v[204:207]
    ds_read_b64_tr_b16 v[108:109], v4 offset:1672
    s_waitcnt lgkmcnt(15)
    v_mfma_f32_16x16x32_f16 v[208:211], v[160:163], v[180:183], v[208:211]
    ds_read_b64_tr_b16 v[110:111], v4 offset:1664
    v_mfma_f32_16x16x32_f16 v[212:215], v[156:159], v[184:187], v[212:215]
    ds_read_b64_tr_b16 v[112:113], v4 offset:1704
    v_mfma_f32_16x16x32_f16 v[216:219], v[160:163], v[184:187], v[216:219]
    ds_read_b64_tr_b16 v[114:115], v4 offset:1696
    v_mfma_f32_16x16x32_f16 v[220:223], v[156:159], v[188:191], v[220:223]
    ds_read_b64_tr_b16 v[116:117], v4 offset:2696
    v_mfma_f32_16x16x32_f16 v[224:227], v[160:163], v[188:191], v[224:227]
    ds_read_b64_tr_b16 v[118:119], v4 offset:2688
    v_mfma_f32_16x16x32_f16 v[212:215], v[164:167], v[180:183], v[212:215]
    ds_read_b64_tr_b16 v[120:121], v4 offset:2728
    s_waitcnt lgkmcnt(15)
    v_mfma_f32_16x16x32_f16 v[216:219], v[168:171], v[180:183], v[216:219]
    ds_read_b64_tr_b16 v[122:123], v4 offset:2720
    v_mfma_f32_16x16x32_f16 v[220:223], v[164:167], v[184:187], v[220:223]
    ds_read_b64_tr_b16 v[124:125], v4 offset:3720
    v_mfma_f32_16x16x32_f16 v[224:227], v[168:171], v[184:187], v[224:227]
    ds_read_b64_tr_b16 v[126:127], v4 offset:3712
    v_mfma_f32_16x16x32_f16 v[220:223], v[172:175], v[180:183], v[220:223]
    ds_read_b64_tr_b16 v[128:129], v4 offset:3752
    v_mfma_f32_16x16x32_f16 v[224:227], v[176:179], v[180:183], v[224:227]
    ds_read_b64_tr_b16 v[130:131], v4 offset:3744
    s_waitcnt lgkmcnt(15)
    v_mfma_f32_16x16x32_f16 v[196:199], v[100:103], v[132:135], v[196:199]
    ds_read_b128 v[180:183], v5 offset:5184
    v_mfma_f32_16x16x32_f16 v[200:203], v[104:107], v[132:135], v[200:203]
    ds_read_b64_tr_b16 v[148:149], v4 offset:712
    s_waitcnt lgkmcnt(15)
    v_mfma_f32_16x16x32_f16 v[204:207], v[100:103], v[136:139], v[204:207]
    ds_read_b64_tr_b16 v[150:151], v4 offset:704
    v_mfma_f32_16x16x32_f16 v[208:211], v[104:107], v[136:139], v[208:211]
    ds_read_b64_tr_b16 v[152:153], v4 offset:744
    v_mfma_f32_16x16x32_f16 v[212:215], v[100:103], v[140:143], v[212:215]
    ds_read_b64_tr_b16 v[154:155], v4 offset:736
    v_mfma_f32_16x16x32_f16 v[216:219], v[104:107], v[140:143], v[216:219]
    ds_read_b128 v[184:187], v5 offset:5440
    s_waitcnt lgkmcnt(15)
    v_mfma_f32_16x16x32_f16 v[220:223], v[100:103], v[144:147], v[220:223]
    ds_read_b128 v[188:191], v5 offset:5696
    v_mfma_f32_16x16x32_f16 v[224:227], v[104:107], v[144:147], v[224:227]
    ds_read_b128 v[192:195], v5 offset:5952
    v_mfma_f32_16x16x32_f16 v[204:207], v[108:111], v[132:135], v[204:207]
    ds_read_b64_tr_b16 v[156:157], v4 offset:1736
    s_waitcnt lgkmcnt(15)
    v_mfma_f32_16x16x32_f16 v[208:211], v[112:115], v[132:135], v[208:211]
    ds_read_b64_tr_b16 v[158:159], v4 offset:1728
    v_mfma_f32_16x16x32_f16 v[212:215], v[108:111], v[136:139], v[212:215]
    ds_read_b64_tr_b16 v[160:161], v4 offset:1768
    v_mfma_f32_16x16x32_f16 v[216:219], v[112:115], v[136:139], v[216:219]
    ds_read_b64_tr_b16 v[162:163], v4 offset:1760
    v_mfma_f32_16x16x32_f16 v[220:223], v[108:111], v[140:143], v[220:223]
    ds_read_b64_tr_b16 v[164:165], v4 offset:2760
    v_mfma_f32_16x16x32_f16 v[224:227], v[112:115], v[140:143], v[224:227]
    ds_read_b64_tr_b16 v[166:167], v4 offset:2752
    v_mfma_f32_16x16x32_f16 v[212:215], v[116:119], v[132:135], v[212:215]
    ds_read_b64_tr_b16 v[168:169], v4 offset:2792
    s_waitcnt lgkmcnt(15)
    v_mfma_f32_16x16x32_f16 v[216:219], v[120:123], v[132:135], v[216:219]
    ds_read_b64_tr_b16 v[170:171], v4 offset:2784
    v_mfma_f32_16x16x32_f16 v[220:223], v[116:119], v[136:139], v[220:223]
    ds_read_b64_tr_b16 v[172:173], v4 offset:3784
    v_mfma_f32_16x16x32_f16 v[224:227], v[120:123], v[136:139], v[224:227]
    ds_read_b64_tr_b16 v[174:175], v4 offset:3776
    v_mfma_f32_16x16x32_f16 v[220:223], v[124:127], v[132:135], v[220:223]
    ds_read_b64_tr_b16 v[176:177], v4 offset:3816
    v_mfma_f32_16x16x32_f16 v[224:227], v[128:131], v[132:135], v[224:227]
    ds_read_b64_tr_b16 v[178:179], v4 offset:3808
    s_waitcnt lgkmcnt(15)
    v_mfma_f32_16x16x32_f16 v[196:199], v[148:151], v[180:183], v[196:199]
    ds_read_b128 v[132:135], v5 offset:5168
    v_mfma_f32_16x16x32_f16 v[200:203], v[152:155], v[180:183], v[200:203]
    ds_read_b64_tr_b16 v[100:101], v4 offset:776
    s_waitcnt lgkmcnt(15)
    v_mfma_f32_16x16x32_f16 v[204:207], v[148:151], v[184:187], v[204:207]
    ds_read_b64_tr_b16 v[102:103], v4 offset:768
    v_mfma_f32_16x16x32_f16 v[208:211], v[152:155], v[184:187], v[208:211]
    ds_read_b64_tr_b16 v[104:105], v4 offset:808
    v_mfma_f32_16x16x32_f16 v[212:215], v[148:151], v[188:191], v[212:215]
    ds_read_b64_tr_b16 v[106:107], v4 offset:800
    v_mfma_f32_16x16x32_f16 v[216:219], v[152:155], v[188:191], v[216:219]
    ds_read_b128 v[136:139], v5 offset:5424
    s_waitcnt lgkmcnt(15)
    v_mfma_f32_16x16x32_f16 v[220:223], v[148:151], v[192:195], v[220:223]
    ds_read_b128 v[140:143], v5 offset:5680
    v_mfma_f32_16x16x32_f16 v[224:227], v[152:155], v[192:195], v[224:227]
    ds_read_b128 v[144:147], v5 offset:5936
    v_mfma_f32_16x16x32_f16 v[204:207], v[156:159], v[180:183], v[204:207]
    ds_read_b64_tr_b16 v[108:109], v4 offset:1800
    s_waitcnt lgkmcnt(15)
    v_mfma_f32_16x16x32_f16 v[208:211], v[160:163], v[180:183], v[208:211]
    ds_read_b64_tr_b16 v[110:111], v4 offset:1792
    v_mfma_f32_16x16x32_f16 v[212:215], v[156:159], v[184:187], v[212:215]
    ds_read_b64_tr_b16 v[112:113], v4 offset:1832
    v_mfma_f32_16x16x32_f16 v[216:219], v[160:163], v[184:187], v[216:219]
    ds_read_b64_tr_b16 v[114:115], v4 offset:1824
    v_mfma_f32_16x16x32_f16 v[220:223], v[156:159], v[188:191], v[220:223]
    ds_read_b64_tr_b16 v[116:117], v4 offset:2824
    v_mfma_f32_16x16x32_f16 v[224:227], v[160:163], v[188:191], v[224:227]
    ds_read_b64_tr_b16 v[118:119], v4 offset:2816
    v_mfma_f32_16x16x32_f16 v[212:215], v[164:167], v[180:183], v[212:215]
    ds_read_b64_tr_b16 v[120:121], v4 offset:2856
    s_waitcnt lgkmcnt(15)
    v_mfma_f32_16x16x32_f16 v[216:219], v[168:171], v[180:183], v[216:219]
    ds_read_b64_tr_b16 v[122:123], v4 offset:2848
    v_mfma_f32_16x16x32_f16 v[220:223], v[164:167], v[184:187], v[220:223]
    ds_read_b64_tr_b16 v[124:125], v4 offset:3848
    v_mfma_f32_16x16x32_f16 v[224:227], v[168:171], v[184:187], v[224:227]
    ds_read_b64_tr_b16 v[126:127], v4 offset:3840
    v_mfma_f32_16x16x32_f16 v[220:223], v[172:175], v[180:183], v[220:223]
    ds_read_b64_tr_b16 v[128:129], v4 offset:3880
    v_mfma_f32_16x16x32_f16 v[224:227], v[176:179], v[180:183], v[224:227]
    ds_read_b64_tr_b16 v[130:131], v4 offset:3872
    s_waitcnt lgkmcnt(15)
    v_mfma_f32_16x16x32_f16 v[196:199], v[100:103], v[132:135], v[196:199]
    ds_read_b128 v[180:183], v5 offset:5152
    v_mfma_f32_16x16x32_f16 v[200:203], v[104:107], v[132:135], v[200:203]
    ds_read_b64_tr_b16 v[148:149], v4 offset:840
    s_waitcnt lgkmcnt(15)
    v_mfma_f32_16x16x32_f16 v[204:207], v[100:103], v[136:139], v[204:207]
    ds_read_b64_tr_b16 v[150:151], v4 offset:832
    v_mfma_f32_16x16x32_f16 v[208:211], v[104:107], v[136:139], v[208:211]
    ds_read_b64_tr_b16 v[152:153], v4 offset:872
    v_mfma_f32_16x16x32_f16 v[212:215], v[100:103], v[140:143], v[212:215]
    ds_read_b64_tr_b16 v[154:155], v4 offset:864
    v_mfma_f32_16x16x32_f16 v[216:219], v[104:107], v[140:143], v[216:219]
    ds_read_b128 v[184:187], v5 offset:5408
    s_waitcnt lgkmcnt(15)
    v_mfma_f32_16x16x32_f16 v[220:223], v[100:103], v[144:147], v[220:223]
    ds_read_b128 v[188:191], v5 offset:5664
    v_mfma_f32_16x16x32_f16 v[224:227], v[104:107], v[144:147], v[224:227]
    ds_read_b128 v[192:195], v5 offset:5920
    v_mfma_f32_16x16x32_f16 v[204:207], v[108:111], v[132:135], v[204:207]
    ds_read_b64_tr_b16 v[156:157], v4 offset:1864
    s_waitcnt lgkmcnt(15)
    v_mfma_f32_16x16x32_f16 v[208:211], v[112:115], v[132:135], v[208:211]
    ds_read_b64_tr_b16 v[158:159], v4 offset:1856
    v_mfma_f32_16x16x32_f16 v[212:215], v[108:111], v[136:139], v[212:215]
    ds_read_b64_tr_b16 v[160:161], v4 offset:1896
    v_mfma_f32_16x16x32_f16 v[216:219], v[112:115], v[136:139], v[216:219]
    ds_read_b64_tr_b16 v[162:163], v4 offset:1888
    v_mfma_f32_16x16x32_f16 v[220:223], v[108:111], v[140:143], v[220:223]
    ds_read_b64_tr_b16 v[164:165], v4 offset:2888
    v_mfma_f32_16x16x32_f16 v[224:227], v[112:115], v[140:143], v[224:227]
    ds_read_b64_tr_b16 v[166:167], v4 offset:2880
    v_mfma_f32_16x16x32_f16 v[212:215], v[116:119], v[132:135], v[212:215]
    ds_read_b64_tr_b16 v[168:169], v4 offset:2920
    s_waitcnt lgkmcnt(15)
    v_mfma_f32_16x16x32_f16 v[216:219], v[120:123], v[132:135], v[216:219]
    ds_read_b64_tr_b16 v[170:171], v4 offset:2912
    v_mfma_f32_16x16x32_f16 v[220:223], v[116:119], v[136:139], v[220:223]
    ds_read_b64_tr_b16 v[172:173], v4 offset:3912
    v_mfma_f32_16x16x32_f16 v[224:227], v[120:123], v[136:139], v[224:227]
    ds_read_b64_tr_b16 v[174:175], v4 offset:3904
    v_mfma_f32_16x16x32_f16 v[220:223], v[124:127], v[132:135], v[220:223]
    ds_read_b64_tr_b16 v[176:177], v4 offset:3944
    v_mfma_f32_16x16x32_f16 v[224:227], v[128:131], v[132:135], v[224:227]
    ds_read_b64_tr_b16 v[178:179], v4 offset:3936
    s_waitcnt lgkmcnt(15)
    v_mfma_f32_16x16x32_f16 v[196:199], v[148:151], v[180:183], v[196:199]
    ds_read_b128 v[132:135], v5 offset:5136
    v_mfma_f32_16x16x32_f16 v[200:203], v[152:155], v[180:183], v[200:203]
    ds_read_b64_tr_b16 v[100:101], v4 offset:904
    s_waitcnt lgkmcnt(15)
    v_mfma_f32_16x16x32_f16 v[204:207], v[148:151], v[184:187], v[204:207]
    ds_read_b64_tr_b16 v[102:103], v4 offset:896
    v_mfma_f32_16x16x32_f16 v[208:211], v[152:155], v[184:187], v[208:211]
    ds_read_b64_tr_b16 v[104:105], v4 offset:936
    v_mfma_f32_16x16x32_f16 v[212:215], v[148:151], v[188:191], v[212:215]
    ds_read_b64_tr_b16 v[106:107], v4 offset:928
    v_mfma_f32_16x16x32_f16 v[216:219], v[152:155], v[188:191], v[216:219]
    ds_read_b128 v[136:139], v5 offset:5392
    s_waitcnt lgkmcnt(15)
    v_mfma_f32_16x16x32_f16 v[220:223], v[148:151], v[192:195], v[220:223]
    ds_read_b128 v[140:143], v5 offset:5648
    v_mfma_f32_16x16x32_f16 v[224:227], v[152:155], v[192:195], v[224:227]
    ds_read_b128 v[144:147], v5 offset:5904
    v_mfma_f32_16x16x32_f16 v[204:207], v[156:159], v[180:183], v[204:207]
    ds_read_b64_tr_b16 v[108:109], v4 offset:1928
    s_waitcnt lgkmcnt(15)
    v_mfma_f32_16x16x32_f16 v[208:211], v[160:163], v[180:183], v[208:211]
    ds_read_b64_tr_b16 v[110:111], v4 offset:1920
    v_mfma_f32_16x16x32_f16 v[212:215], v[156:159], v[184:187], v[212:215]
    ds_read_b64_tr_b16 v[112:113], v4 offset:1960
    v_mfma_f32_16x16x32_f16 v[216:219], v[160:163], v[184:187], v[216:219]
    ds_read_b64_tr_b16 v[114:115], v4 offset:1952
    v_mfma_f32_16x16x32_f16 v[220:223], v[156:159], v[188:191], v[220:223]
    ds_read_b64_tr_b16 v[116:117], v4 offset:2952
    v_mfma_f32_16x16x32_f16 v[224:227], v[160:163], v[188:191], v[224:227]
    ds_read_b64_tr_b16 v[118:119], v4 offset:2944
    v_mfma_f32_16x16x32_f16 v[212:215], v[164:167], v[180:183], v[212:215]
    ds_read_b64_tr_b16 v[120:121], v4 offset:2984
    s_waitcnt lgkmcnt(15)
    v_mfma_f32_16x16x32_f16 v[216:219], v[168:171], v[180:183], v[216:219]
    ds_read_b64_tr_b16 v[122:123], v4 offset:2976
    v_mfma_f32_16x16x32_f16 v[220:223], v[164:167], v[184:187], v[220:223]
    ds_read_b64_tr_b16 v[124:125], v4 offset:3976
    v_mfma_f32_16x16x32_f16 v[224:227], v[168:171], v[184:187], v[224:227]
    ds_read_b64_tr_b16 v[126:127], v4 offset:3968
    v_mfma_f32_16x16x32_f16 v[220:223], v[172:175], v[180:183], v[220:223]
    ds_read_b64_tr_b16 v[128:129], v4 offset:4008
    v_mfma_f32_16x16x32_f16 v[224:227], v[176:179], v[180:183], v[224:227]
    ds_read_b64_tr_b16 v[130:131], v4 offset:4000
    s_waitcnt lgkmcnt(15)
    v_mfma_f32_16x16x32_f16 v[196:199], v[100:103], v[132:135], v[196:199]
    ds_read_b128 v[180:183], v5 offset:5120
    v_mfma_f32_16x16x32_f16 v[200:203], v[104:107], v[132:135], v[200:203]
    ds_read_b64_tr_b16 v[148:149], v4 offset:968
    s_waitcnt lgkmcnt(15)
    v_mfma_f32_16x16x32_f16 v[204:207], v[100:103], v[136:139], v[204:207]
    ds_read_b64_tr_b16 v[150:151], v4 offset:960
    v_mfma_f32_16x16x32_f16 v[208:211], v[104:107], v[136:139], v[208:211]
    ds_read_b64_tr_b16 v[152:153], v4 offset:1000
    v_mfma_f32_16x16x32_f16 v[212:215], v[100:103], v[140:143], v[212:215]
    ds_read_b64_tr_b16 v[154:155], v4 offset:992
    v_mfma_f32_16x16x32_f16 v[216:219], v[104:107], v[140:143], v[216:219]
    ds_read_b128 v[184:187], v5 offset:5376
    s_waitcnt lgkmcnt(15)
    v_mfma_f32_16x16x32_f16 v[220:223], v[100:103], v[144:147], v[220:223]
    ds_read_b128 v[188:191], v5 offset:5632
    v_mfma_f32_16x16x32_f16 v[224:227], v[104:107], v[144:147], v[224:227]
    ds_read_b128 v[192:195], v5 offset:5888
    v_mfma_f32_16x16x32_f16 v[204:207], v[108:111], v[132:135], v[204:207]
    ds_read_b64_tr_b16 v[156:157], v4 offset:1992
    s_waitcnt lgkmcnt(15)
    v_mfma_f32_16x16x32_f16 v[208:211], v[112:115], v[132:135], v[208:211]
    ds_read_b64_tr_b16 v[158:159], v4 offset:1984
    v_mfma_f32_16x16x32_f16 v[212:215], v[108:111], v[136:139], v[212:215]
    ds_read_b64_tr_b16 v[160:161], v4 offset:2024
    v_mfma_f32_16x16x32_f16 v[216:219], v[112:115], v[136:139], v[216:219]
    ds_read_b64_tr_b16 v[162:163], v4 offset:2016
    v_mfma_f32_16x16x32_f16 v[220:223], v[108:111], v[140:143], v[220:223]
    ds_read_b64_tr_b16 v[164:165], v4 offset:3016
    v_mfma_f32_16x16x32_f16 v[224:227], v[112:115], v[140:143], v[224:227]
    ds_read_b64_tr_b16 v[166:167], v4 offset:3008
    v_mfma_f32_16x16x32_f16 v[212:215], v[116:119], v[132:135], v[212:215]
    ds_read_b64_tr_b16 v[168:169], v4 offset:3048
    s_waitcnt lgkmcnt(15)
    v_mfma_f32_16x16x32_f16 v[216:219], v[120:123], v[132:135], v[216:219]
    ds_read_b64_tr_b16 v[170:171], v4 offset:3040
    v_mfma_f32_16x16x32_f16 v[220:223], v[116:119], v[136:139], v[220:223]
    ds_read_b64_tr_b16 v[172:173], v4 offset:4040
    v_mfma_f32_16x16x32_f16 v[224:227], v[120:123], v[136:139], v[224:227]
    ds_read_b64_tr_b16 v[174:175], v4 offset:4032
    v_mfma_f32_16x16x32_f16 v[220:223], v[124:127], v[132:135], v[220:223]
    ds_read_b64_tr_b16 v[176:177], v4 offset:4072
    v_mfma_f32_16x16x32_f16 v[224:227], v[128:131], v[132:135], v[224:227]
    ds_read_b64_tr_b16 v[178:179], v4 offset:4064
    s_waitcnt lgkmcnt(15)
    v_mfma_f32_16x16x32_f16 v[196:199], v[148:151], v[180:183], v[196:199]
    v_mfma_f32_16x16x32_f16 v[200:203], v[152:155], v[180:183], v[200:203]
    s_waitcnt lgkmcnt(14)
    v_mfma_f32_16x16x32_f16 v[204:207], v[148:151], v[184:187], v[204:207]
    v_mfma_f32_16x16x32_f16 v[208:211], v[152:155], v[184:187], v[208:211]
    s_waitcnt lgkmcnt(13)
    v_mfma_f32_16x16x32_f16 v[212:215], v[148:151], v[188:191], v[212:215]
    v_mfma_f32_16x16x32_f16 v[216:219], v[152:155], v[188:191], v[216:219]
    s_waitcnt lgkmcnt(12)
    v_mfma_f32_16x16x32_f16 v[220:223], v[148:151], v[192:195], v[220:223]
    v_mfma_f32_16x16x32_f16 v[224:227], v[152:155], v[192:195], v[224:227]
    s_waitcnt lgkmcnt(10)
    v_mfma_f32_16x16x32_f16 v[204:207], v[156:159], v[180:183], v[204:207]
    s_waitcnt lgkmcnt(8)
    v_mfma_f32_16x16x32_f16 v[208:211], v[160:163], v[180:183], v[208:211]
    v_mfma_f32_16x16x32_f16 v[212:215], v[156:159], v[184:187], v[212:215]
    v_mfma_f32_16x16x32_f16 v[216:219], v[160:163], v[184:187], v[216:219]
    v_mfma_f32_16x16x32_f16 v[220:223], v[156:159], v[188:191], v[220:223]
    v_mfma_f32_16x16x32_f16 v[224:227], v[160:163], v[188:191], v[224:227]
    s_waitcnt lgkmcnt(6)
    v_mfma_f32_16x16x32_f16 v[212:215], v[164:167], v[180:183], v[212:215]
    s_waitcnt lgkmcnt(4)
    v_mfma_f32_16x16x32_f16 v[216:219], v[168:171], v[180:183], v[216:219]
    v_mfma_f32_16x16x32_f16 v[220:223], v[164:167], v[184:187], v[220:223]
    v_mfma_f32_16x16x32_f16 v[224:227], v[168:171], v[184:187], v[224:227]
    s_waitcnt lgkmcnt(2)
    v_mfma_f32_16x16x32_f16 v[220:223], v[172:175], v[180:183], v[220:223]
    s_waitcnt lgkmcnt(0)
    v_mfma_f32_16x16x32_f16 v[224:227], v[176:179], v[180:183], v[224:227]
    s_waitcnt lgkmcnt(0)
    s_lshl_b32 s59, s59, s60
    s_and_b32 s59, s59, 0xffff0000
    v_mov_b32 v116, s59

    v_mov_b32 v118, v61
    v_mov_b32 v119, v61
    s_nop 4
    ds_read_b64 v[100:101], v23 offset:0
    ds_read_b64 v[102:103], v23 offset:32
    ds_read_b64 v[104:105], v23 offset:1024
    ds_read_b64 v[106:107], v23 offset:1056
    ds_read_b64 v[108:109], v23 offset:2048
    ds_read_b64 v[110:111], v23 offset:2080
    ds_read_b64 v[112:113], v23 offset:3072
    ds_read_b64 v[114:115], v23 offset:3104
    s_waitcnt lgkmcnt(0)
    v_pk_mul_f32 v[196:197], v[196:197], v[118:119]
    v_pk_mul_f32 v[200:201], v[200:201], v[118:119]
    v_pk_mul_f32 v[204:205], v[204:205], v[118:119]
    v_pk_mul_f32 v[208:209], v[208:209], v[118:119]
    v_pk_mul_f32 v[198:199], v[198:199], v[118:119]
    v_pk_mul_f32 v[202:203], v[202:203], v[118:119]
    v_pk_mul_f32 v[206:207], v[206:207], v[118:119]
    v_pk_mul_f32 v[210:211], v[210:211], v[118:119]
    v_fma_mix_f32 v120, v100, v116, 0 op_sel_hi:[1,0,0]
    v_fma_mix_f32 v128, v102, v116, 0 op_sel_hi:[1,0,0]
    v_fma_mix_f32 v136, v104, v116, 0 op_sel_hi:[1,0,0]
    v_fma_mix_f32 v144, v106, v116, 0 op_sel_hi:[1,0,0]
    v_fma_mix_f32 v121, v100, v116, 0 op_sel:[1,0,0] op_sel_hi:[1,0,0]
    v_fma_mix_f32 v129, v102, v116, 0 op_sel:[1,0,0] op_sel_hi:[1,0,0]
    v_fma_mix_f32 v137, v104, v116, 0 op_sel:[1,0,0] op_sel_hi:[1,0,0]
    v_fma_mix_f32 v145, v106, v116, 0 op_sel:[1,0,0] op_sel_hi:[1,0,0]
    v_fma_mix_f32 v122, v101, v116, 0 op_sel_hi:[1,0,0]
    v_fma_mix_f32 v130, v103, v116, 0 op_sel_hi:[1,0,0]
    v_fma_mix_f32 v138, v105, v116, 0 op_sel_hi:[1,0,0]
    v_fma_mix_f32 v146, v107, v116, 0 op_sel_hi:[1,0,0]
    v_fma_mix_f32 v123, v101, v116, 0 op_sel:[1,0,0] op_sel_hi:[1,0,0]
    v_fma_mix_f32 v131, v103, v116, 0 op_sel:[1,0,0] op_sel_hi:[1,0,0]
    v_fma_mix_f32 v139, v105, v116, 0 op_sel:[1,0,0] op_sel_hi:[1,0,0]
    v_fma_mix_f32 v147, v107, v116, 0 op_sel:[1,0,0] op_sel_hi:[1,0,0]
    v_cvt_pk_bf16_f32 v124, v196, v197
    v_cvt_pk_bf16_f32 v132, v200, v201
    v_cvt_pk_bf16_f32 v140, v204, v205
    v_cvt_pk_bf16_f32 v148, v208, v209
    v_cvt_pk_bf16_f32 v125, v198, v199
    v_cvt_pk_bf16_f32 v133, v202, v203
    v_cvt_pk_bf16_f32 v141, v206, v207
    v_cvt_pk_bf16_f32 v149, v210, v211
    v_cvt_pk_bf16_f32 v126, v120, v121
    v_cvt_pk_bf16_f32 v134, v128, v129
    v_cvt_pk_bf16_f32 v142, v136, v137
    v_cvt_pk_bf16_f32 v150, v144, v145
    v_cvt_pk_bf16_f32 v127, v122, v123
    v_cvt_pk_bf16_f32 v135, v130, v131
    v_cvt_pk_bf16_f32 v143, v138, v139
    v_cvt_pk_bf16_f32 v151, v146, v147
    v_lshlrev_b32 v196, 16, v124
    v_lshlrev_b32 v200, 16, v132
    v_lshlrev_b32 v204, 16, v140
    v_lshlrev_b32 v208, 16, v148
    v_and_b32 v197, 0xffff0000, v124
    v_and_b32 v201, 0xffff0000, v132
    v_and_b32 v205, 0xffff0000, v140
    v_and_b32 v209, 0xffff0000, v148
    v_lshlrev_b32 v198, 16, v125
    v_lshlrev_b32 v202, 16, v133
    v_lshlrev_b32 v206, 16, v141
    v_lshlrev_b32 v210, 16, v149
    v_and_b32 v199, 0xffff0000, v125
    v_and_b32 v203, 0xffff0000, v133
    v_and_b32 v207, 0xffff0000, v141
    v_and_b32 v211, 0xffff0000, v149
    v_lshlrev_b32 v120, 16, v126
    v_lshlrev_b32 v128, 16, v134
    v_lshlrev_b32 v136, 16, v142
    v_lshlrev_b32 v144, 16, v150
    v_and_b32 v121, 0xffff0000, v126
    v_and_b32 v129, 0xffff0000, v134
    v_and_b32 v137, 0xffff0000, v142
    v_and_b32 v145, 0xffff0000, v150
    v_lshlrev_b32 v122, 16, v127
    v_lshlrev_b32 v130, 16, v135
    v_lshlrev_b32 v138, 16, v143
    v_lshlrev_b32 v146, 16, v151
    v_and_b32 v123, 0xffff0000, v127
    v_and_b32 v131, 0xffff0000, v135
    v_and_b32 v139, 0xffff0000, v143
    v_and_b32 v147, 0xffff0000, v151
    v_pk_add_f32 v[196:197], v[196:197], v[120:121]
    v_pk_add_f32 v[200:201], v[200:201], v[128:129]
    v_pk_add_f32 v[204:205], v[204:205], v[136:137]
    v_pk_add_f32 v[208:209], v[208:209], v[144:145]
    v_pk_add_f32 v[198:199], v[198:199], v[122:123]
    v_pk_add_f32 v[202:203], v[202:203], v[130:131]
    v_pk_add_f32 v[206:207], v[206:207], v[138:139]
    v_pk_add_f32 v[210:211], v[210:211], v[146:147]
    v_cvt_pk_bf16_f32 v124, v196, v197
    v_cvt_pk_bf16_f32 v132, v200, v201
    v_cvt_pk_bf16_f32 v140, v204, v205
    v_cvt_pk_bf16_f32 v148, v208, v209
    v_cvt_pk_bf16_f32 v125, v198, v199
    v_cvt_pk_bf16_f32 v133, v202, v203
    v_cvt_pk_bf16_f32 v141, v206, v207
    v_cvt_pk_bf16_f32 v149, v210, v211
    ds_write_b64 v24, v[124:125] offset:0
    ds_write_b64 v24, v[132:133] offset:32
    ds_write_b64 v24, v[140:141] offset:1024
    ds_write_b64 v24, v[148:149] offset:1056
    v_pk_mul_f32 v[212:213], v[212:213], v[118:119]
    v_pk_mul_f32 v[216:217], v[216:217], v[118:119]
    v_pk_mul_f32 v[220:221], v[220:221], v[118:119]
    v_pk_mul_f32 v[224:225], v[224:225], v[118:119]
    v_pk_mul_f32 v[214:215], v[214:215], v[118:119]
    v_pk_mul_f32 v[218:219], v[218:219], v[118:119]
    v_pk_mul_f32 v[222:223], v[222:223], v[118:119]
    v_pk_mul_f32 v[226:227], v[226:227], v[118:119]
    v_fma_mix_f32 v120, v108, v116, 0 op_sel_hi:[1,0,0]
    v_fma_mix_f32 v128, v110, v116, 0 op_sel_hi:[1,0,0]
    v_fma_mix_f32 v136, v112, v116, 0 op_sel_hi:[1,0,0]
    v_fma_mix_f32 v144, v114, v116, 0 op_sel_hi:[1,0,0]
    v_fma_mix_f32 v121, v108, v116, 0 op_sel:[1,0,0] op_sel_hi:[1,0,0]
    v_fma_mix_f32 v129, v110, v116, 0 op_sel:[1,0,0] op_sel_hi:[1,0,0]
    v_fma_mix_f32 v137, v112, v116, 0 op_sel:[1,0,0] op_sel_hi:[1,0,0]
    v_fma_mix_f32 v145, v114, v116, 0 op_sel:[1,0,0] op_sel_hi:[1,0,0]
    v_fma_mix_f32 v122, v109, v116, 0 op_sel_hi:[1,0,0]
    v_fma_mix_f32 v130, v111, v116, 0 op_sel_hi:[1,0,0]
    v_fma_mix_f32 v138, v113, v116, 0 op_sel_hi:[1,0,0]
    v_fma_mix_f32 v146, v115, v116, 0 op_sel_hi:[1,0,0]
    v_fma_mix_f32 v123, v109, v116, 0 op_sel:[1,0,0] op_sel_hi:[1,0,0]
    v_fma_mix_f32 v131, v111, v116, 0 op_sel:[1,0,0] op_sel_hi:[1,0,0]
    v_fma_mix_f32 v139, v113, v116, 0 op_sel:[1,0,0] op_sel_hi:[1,0,0]
    v_fma_mix_f32 v147, v115, v116, 0 op_sel:[1,0,0] op_sel_hi:[1,0,0]
    v_cvt_pk_bf16_f32 v124, v212, v213
    v_cvt_pk_bf16_f32 v132, v216, v217
    v_cvt_pk_bf16_f32 v140, v220, v221
    v_cvt_pk_bf16_f32 v148, v224, v225
    v_cvt_pk_bf16_f32 v125, v214, v215
    v_cvt_pk_bf16_f32 v133, v218, v219
    v_cvt_pk_bf16_f32 v141, v222, v223
    v_cvt_pk_bf16_f32 v149, v226, v227
    v_cvt_pk_bf16_f32 v126, v120, v121
    v_cvt_pk_bf16_f32 v134, v128, v129
    v_cvt_pk_bf16_f32 v142, v136, v137
    v_cvt_pk_bf16_f32 v150, v144, v145
    v_cvt_pk_bf16_f32 v127, v122, v123
    v_cvt_pk_bf16_f32 v135, v130, v131
    v_cvt_pk_bf16_f32 v143, v138, v139
    v_cvt_pk_bf16_f32 v151, v146, v147
    v_lshlrev_b32 v212, 16, v124
    v_lshlrev_b32 v216, 16, v132
    v_lshlrev_b32 v220, 16, v140
    v_lshlrev_b32 v224, 16, v148
    v_and_b32 v213, 0xffff0000, v124
    v_and_b32 v217, 0xffff0000, v132
    v_and_b32 v221, 0xffff0000, v140
    v_and_b32 v225, 0xffff0000, v148
    v_lshlrev_b32 v214, 16, v125
    v_lshlrev_b32 v218, 16, v133
    v_lshlrev_b32 v222, 16, v141
    v_lshlrev_b32 v226, 16, v149
    v_and_b32 v215, 0xffff0000, v125
    v_and_b32 v219, 0xffff0000, v133
    v_and_b32 v223, 0xffff0000, v141
    v_and_b32 v227, 0xffff0000, v149
    v_lshlrev_b32 v120, 16, v126
    v_lshlrev_b32 v128, 16, v134
    v_lshlrev_b32 v136, 16, v142
    v_lshlrev_b32 v144, 16, v150
    v_and_b32 v121, 0xffff0000, v126
    v_and_b32 v129, 0xffff0000, v134
    v_and_b32 v137, 0xffff0000, v142
    v_and_b32 v145, 0xffff0000, v150
    v_lshlrev_b32 v122, 16, v127
    v_lshlrev_b32 v130, 16, v135
    v_lshlrev_b32 v138, 16, v143
    v_lshlrev_b32 v146, 16, v151
    v_and_b32 v123, 0xffff0000, v127
    v_and_b32 v131, 0xffff0000, v135
    v_and_b32 v139, 0xffff0000, v143
    v_and_b32 v147, 0xffff0000, v151
    v_pk_add_f32 v[212:213], v[212:213], v[120:121]
    v_pk_add_f32 v[216:217], v[216:217], v[128:129]
    v_pk_add_f32 v[220:221], v[220:221], v[136:137]
    v_pk_add_f32 v[224:225], v[224:225], v[144:145]
    v_pk_add_f32 v[214:215], v[214:215], v[122:123]
    v_pk_add_f32 v[218:219], v[218:219], v[130:131]
    v_pk_add_f32 v[222:223], v[222:223], v[138:139]
    v_pk_add_f32 v[226:227], v[226:227], v[146:147]
    v_cvt_pk_bf16_f32 v124, v212, v213
    v_cvt_pk_bf16_f32 v132, v216, v217
    v_cvt_pk_bf16_f32 v140, v220, v221
    v_cvt_pk_bf16_f32 v148, v224, v225
    v_cvt_pk_bf16_f32 v125, v214, v215
    v_cvt_pk_bf16_f32 v133, v218, v219
    v_cvt_pk_bf16_f32 v141, v222, v223
    v_cvt_pk_bf16_f32 v149, v226, v227
    ds_write_b64 v24, v[124:125] offset:2048
    ds_write_b64 v24, v[132:133] offset:2080
    ds_write_b64 v24, v[140:141] offset:3072
    ds_write_b64 v24, v[148:149] offset:3104
    s_waitcnt lgkmcnt(0)
    ds_read_b128 v[152:155], v25 offset:0
    ds_read_b128 v[156:159], v25 offset:1024
    ds_read_b128 v[160:163], v25 offset:2048
    ds_read_b128 v[164:167], v25 offset:3072
    s_lshl_b32 s55, s54, 12
    s_add_u32 s55, s55, 4718592
    s_waitcnt lgkmcnt(0)
    buffer_store_dwordx4 v[152:155], v26, s[16:19], s55 offen offset:0 sc1
    buffer_store_dwordx4 v[156:159], v26, s[16:19], s55 offen offset:1024 sc1
    buffer_store_dwordx4 v[160:163], v26, s[16:19], s55 offen offset:2048 sc1
    buffer_store_dwordx4 v[164:167], v26, s[16:19], s55 offen offset:3072 sc1
    s_add_u32 s54, s40, 8
    s_mov_b32 s64, 8
    s_sub_u32 s65, s41, 36864
    v_subrev_u32 v28, s65, v7
    s_lshl_b32 s66, s36, 10
    v_add_u32 v28, s66, v28
    s_and_b32 s67, s36, 1
    s_lshl_b32 s68, s67, 5
    v_subrev_u32 v29, s65, v4
    v_add_u32 v29, s68, v29
    v_subrev_u32 v30, s65, v5
    v_subrev_u32 v31, s65, v23
    v_add_u32 v31, s68, v31
    v_subrev_u32 v32, s65, v24
    v_add_u32 v32, s68, v32
    v_subrev_u32 v33, s65, v25
    v_add_u32 v33, s66, v33

    s_lshl_b32 s56, s54, 1
    s_and_b32 s57, s56, 0xfffffffc
    s_load_dword s59, s[46:47], s57
    s_lshl_b32 s56, s54, 2
    s_add_u32 s56, s56, 7143424

    v_mov_b32 v61, s56
    buffer_load_dword v61, v61, s[16:19], 0 offen sc1
    s_bitcmp1_b32 s54, 0
    s_cselect_b32 s60, 0, 16
    s_mul_i32 s55, s36, 9216
    s_add_u32 s55, s55, 128
    v_add_u32 v100, s55, v6
    v_subrev_u32 v101, 136, v100
    v_max_i32 v101, 0, v101
    s_waitcnt vmcnt(0)
    s_barrier
    ds_read_b64 v[104:105], v101
    ds_read_b128 v[106:109], v100
    v_cmp_eq_u32 vcc, 0, v0
    v_mov_b32 v103, 0
    s_waitcnt lgkmcnt(0)
    v_cndmask_b32 v104, v104, v103, vcc
    v_cndmask_b32 v105, v105, v103, vcc
    v_alignbit_b32 v128, v105, v104, 16
    v_alignbit_b32 v129, v106, v105, 16
    v_alignbit_b32 v130, v107, v106, 16
    v_alignbit_b32 v131, v108, v107, 16
    ds_write_b128 v28, v[106:109]
    v_alignbit_b32 v132, v106, v105, 16
    v_alignbit_b32 v133, v107, v106, 16
    v_alignbit_b32 v134, v108, v107, 16
    v_alignbit_b32 v135, v109, v108, 16
    ds_write_b128 v28, v[128:131] offset:12480
    v_mov_b32 v136, v105
    v_mov_b32 v137, v106
    v_mov_b32 v138, v107
    v_mov_b32 v139, v108
    ds_write_b128 v28, v[132:135] offset:4160
    ds_write_b128 v28, v[136:139] offset:8320
    s_waitcnt lgkmcnt(0)
    s_barrier
    s_cmp_ge_u32 s36, 2
    s_cbranch_scc1 L_ninth_b

    ds_read_b128 v[132:135], v30 offset:240
    ds_read_b64_tr_b16 v[100:101], v29 offset:8
    ds_read_b64_tr_b16 v[102:103], v29 offset:0
    ds_read_b128 v[144:147], v30 offset:1008
    ds_read_b128 v[140:143], v30 offset:752
    ds_read_b64_tr_b16 v[108:109], v29 offset:1032
    ds_read_b64_tr_b16 v[110:111], v29 offset:1024
    ds_read_b128 v[136:139], v30 offset:496
    ds_read_b64_tr_b16 v[116:117], v29 offset:2056
    ds_read_b64_tr_b16 v[118:119], v29 offset:2048
    ds_read_b64_tr_b16 v[124:125], v29 offset:3080
    ds_read_b64_tr_b16 v[126:127], v29 offset:3072
    s_waitcnt lgkmcnt(9)
    v_mfma_f32_16x16x32_f16 v[196:199], v[100:103], v[132:135], 0
    ds_read_b128 v[180:183], v30 offset:224
    ds_read_b64_tr_b16 v[148:149], v29 offset:72
    ds_read_b64_tr_b16 v[150:151], v29 offset:64
    s_waitcnt lgkmcnt(11)
    v_mfma_f32_16x16x32_f16 v[220:223], v[100:103], v[144:147], 0
    ds_read_b128 v[192:195], v30 offset:992
    ds_read_b128 v[188:191], v30 offset:736
    ds_read_b64_tr_b16 v[156:157], v29 offset:1096
    s_waitcnt lgkmcnt(11)
    v_mfma_f32_16x16x32_f16 v[220:223], v[108:111], v[140:143], v[220:223]
    ds_read_b64_tr_b16 v[158:159], v29 offset:1088
    ds_read_b128 v[184:187], v30 offset:480
    ds_read_b64_tr_b16 v[164:165], v29 offset:2120
    s_waitcnt lgkmcnt(11)
    v_mfma_f32_16x16x32_f16 v[220:223], v[116:119], v[136:139], v[220:223]
    ds_read_b64_tr_b16 v[166:167], v29 offset:2112
    ds_read_b64_tr_b16 v[172:173], v29 offset:3144
    ds_read_b64_tr_b16 v[174:175], v29 offset:3136
    s_waitcnt lgkmcnt(12)
    v_mfma_f32_16x16x32_f16 v[220:223], v[124:127], v[132:135], v[220:223]
    s_waitcnt lgkmcnt(9)
    v_mfma_f32_16x16x32_f16 v[196:199], v[148:151], v[180:183], v[196:199]
    ds_read_b128 v[132:135], v30 offset:208
    ds_read_b64_tr_b16 v[100:101], v29 offset:136
    ds_read_b64_tr_b16 v[102:103], v29 offset:128
    s_waitcnt lgkmcnt(11)
    v_mfma_f32_16x16x32_f16 v[220:223], v[148:151], v[192:195], v[220:223]
    ds_read_b128 v[144:147], v30 offset:976
    ds_read_b128 v[140:143], v30 offset:720
    ds_read_b64_tr_b16 v[108:109], v29 offset:1160
    s_waitcnt lgkmcnt(11)
    v_mfma_f32_16x16x32_f16 v[220:223], v[156:159], v[188:191], v[220:223]
    ds_read_b64_tr_b16 v[110:111], v29 offset:1152
    ds_read_b128 v[136:139], v30 offset:464
    ds_read_b64_tr_b16 v[116:117], v29 offset:2184
    s_waitcnt lgkmcnt(11)
    v_mfma_f32_16x16x32_f16 v[220:223], v[164:167], v[184:187], v[220:223]
    ds_read_b64_tr_b16 v[118:119], v29 offset:2176
    ds_read_b64_tr_b16 v[124:125], v29 offset:3208
    ds_read_b64_tr_b16 v[126:127], v29 offset:3200
    s_waitcnt lgkmcnt(12)
    v_mfma_f32_16x16x32_f16 v[220:223], v[172:175], v[180:183], v[220:223]
    s_waitcnt lgkmcnt(9)
    v_mfma_f32_16x16x32_f16 v[196:199], v[100:103], v[132:135], v[196:199]
    ds_read_b128 v[180:183], v30 offset:192
    ds_read_b64_tr_b16 v[148:149], v29 offset:200
    ds_read_b64_tr_b16 v[150:151], v29 offset:192
    s_waitcnt lgkmcnt(11)
    v_mfma_f32_16x16x32_f16 v[220:223], v[100:103], v[144:147], v[220:223]
    ds_read_b128 v[192:195], v30 offset:960
    ds_read_b128 v[188:191], v30 offset:704
    ds_read_b64_tr_b16 v[156:157], v29 offset:1224
    s_waitcnt lgkmcnt(11)
    v_mfma_f32_16x16x32_f16 v[220:223], v[108:111], v[140:143], v[220:223]
    ds_read_b64_tr_b16 v[158:159], v29 offset:1216
    ds_read_b128 v[184:187], v30 offset:448
    ds_read_b64_tr_b16 v[164:165], v29 offset:2248
    s_waitcnt lgkmcnt(11)
    v_mfma_f32_16x16x32_f16 v[220:223], v[116:119], v[136:139], v[220:223]
    ds_read_b64_tr_b16 v[166:167], v29 offset:2240
    ds_read_b64_tr_b16 v[172:173], v29 offset:3272
    ds_read_b64_tr_b16 v[174:175], v29 offset:3264
    s_waitcnt lgkmcnt(12)
    v_mfma_f32_16x16x32_f16 v[220:223], v[124:127], v[132:135], v[220:223]
    s_waitcnt lgkmcnt(9)
    v_mfma_f32_16x16x32_f16 v[196:199], v[148:151], v[180:183], v[196:199]
    ds_read_b128 v[132:135], v30 offset:176
    ds_read_b64_tr_b16 v[100:101], v29 offset:264
    ds_read_b64_tr_b16 v[102:103], v29 offset:256
    s_waitcnt lgkmcnt(11)
    v_mfma_f32_16x16x32_f16 v[220:223], v[148:151], v[192:195], v[220:223]
    ds_read_b128 v[144:147], v30 offset:944
    ds_read_b128 v[140:143], v30 offset:688
    ds_read_b64_tr_b16 v[108:109], v29 offset:1288
    s_waitcnt lgkmcnt(11)
    v_mfma_f32_16x16x32_f16 v[220:223], v[156:159], v[188:191], v[220:223]
    ds_read_b64_tr_b16 v[110:111], v29 offset:1280
    ds_read_b128 v[136:139], v30 offset:432
    ds_read_b64_tr_b16 v[116:117], v29 offset:2312
    s_waitcnt lgkmcnt(11)
    v_mfma_f32_16x16x32_f16 v[220:223], v[164:167], v[184:187], v[220:223]
    ds_read_b64_tr_b16 v[118:119], v29 offset:2304
    ds_read_b64_tr_b16 v[124:125], v29 offset:3336
    ds_read_b64_tr_b16 v[126:127], v29 offset:3328
    s_waitcnt lgkmcnt(12)
    v_mfma_f32_16x16x32_f16 v[220:223], v[172:175], v[180:183], v[220:223]
    s_waitcnt lgkmcnt(9)
    v_mfma_f32_16x16x32_f16 v[196:199], v[100:103], v[132:135], v[196:199]
    ds_read_b128 v[180:183], v30 offset:160
    ds_read_b64_tr_b16 v[148:149], v29 offset:328
    ds_read_b64_tr_b16 v[150:151], v29 offset:320
    s_waitcnt lgkmcnt(11)
    v_mfma_f32_16x16x32_f16 v[220:223], v[100:103], v[144:147], v[220:223]
    ds_read_b128 v[192:195], v30 offset:928
    ds_read_b128 v[188:191], v30 offset:672
    ds_read_b64_tr_b16 v[156:157], v29 offset:1352
    s_waitcnt lgkmcnt(11)
    v_mfma_f32_16x16x32_f16 v[220:223], v[108:111], v[140:143], v[220:223]
    ds_read_b64_tr_b16 v[158:159], v29 offset:1344
    ds_read_b128 v[184:187], v30 offset:416
    ds_read_b64_tr_b16 v[164:165], v29 offset:2376
    s_waitcnt lgkmcnt(11)
    v_mfma_f32_16x16x32_f16 v[220:223], v[116:119], v[136:139], v[220:223]
    ds_read_b64_tr_b16 v[166:167], v29 offset:2368
    ds_read_b64_tr_b16 v[172:173], v29 offset:3400
    ds_read_b64_tr_b16 v[174:175], v29 offset:3392
    s_waitcnt lgkmcnt(12)
    v_mfma_f32_16x16x32_f16 v[220:223], v[124:127], v[132:135], v[220:223]
    s_waitcnt lgkmcnt(9)
    v_mfma_f32_16x16x32_f16 v[196:199], v[148:151], v[180:183], v[196:199]
    ds_read_b128 v[132:135], v30 offset:144
    ds_read_b64_tr_b16 v[100:101], v29 offset:392
    ds_read_b64_tr_b16 v[102:103], v29 offset:384
    s_waitcnt lgkmcnt(11)
    v_mfma_f32_16x16x32_f16 v[220:223], v[148:151], v[192:195], v[220:223]
    ds_read_b128 v[144:147], v30 offset:912
    ds_read_b128 v[140:143], v30 offset:656
    ds_read_b64_tr_b16 v[108:109], v29 offset:1416
    s_waitcnt lgkmcnt(11)
    v_mfma_f32_16x16x32_f16 v[220:223], v[156:159], v[188:191], v[220:223]
    ds_read_b64_tr_b16 v[110:111], v29 offset:1408
    ds_read_b128 v[136:139], v30 offset:400
    ds_read_b64_tr_b16 v[116:117], v29 offset:2440
    s_waitcnt lgkmcnt(11)
    v_mfma_f32_16x16x32_f16 v[220:223], v[164:167], v[184:187], v[220:223]
    ds_read_b64_tr_b16 v[118:119], v29 offset:2432
    ds_read_b64_tr_b16 v[124:125], v29 offset:3464
    ds_read_b64_tr_b16 v[126:127], v29 offset:3456
    s_waitcnt lgkmcnt(12)
    v_mfma_f32_16x16x32_f16 v[220:223], v[172:175], v[180:183], v[220:223]
    s_waitcnt lgkmcnt(9)
    v_mfma_f32_16x16x32_f16 v[196:199], v[100:103], v[132:135], v[196:199]
    ds_read_b128 v[180:183], v30 offset:128
    ds_read_b64_tr_b16 v[148:149], v29 offset:456
    ds_read_b64_tr_b16 v[150:151], v29 offset:448
    s_waitcnt lgkmcnt(11)
    v_mfma_f32_16x16x32_f16 v[220:223], v[100:103], v[144:147], v[220:223]
    ds_read_b128 v[192:195], v30 offset:896
    ds_read_b128 v[188:191], v30 offset:640
    ds_read_b64_tr_b16 v[156:157], v29 offset:1480
    s_waitcnt lgkmcnt(11)
    v_mfma_f32_16x16x32_f16 v[220:223], v[108:111], v[140:143], v[220:223]
    ds_read_b64_tr_b16 v[158:159], v29 offset:1472
    ds_read_b128 v[184:187], v30 offset:384
    ds_read_b64_tr_b16 v[164:165], v29 offset:2504
    s_waitcnt lgkmcnt(11)
    v_mfma_f32_16x16x32_f16 v[220:223], v[116:119], v[136:139], v[220:223]
    ds_read_b64_tr_b16 v[166:167], v29 offset:2496
    ds_read_b64_tr_b16 v[172:173], v29 offset:3528
    ds_read_b64_tr_b16 v[174:175], v29 offset:3520
    s_waitcnt lgkmcnt(12)
    v_mfma_f32_16x16x32_f16 v[220:223], v[124:127], v[132:135], v[220:223]
    s_waitcnt lgkmcnt(9)
    v_mfma_f32_16x16x32_f16 v[196:199], v[148:151], v[180:183], v[196:199]
    ds_read_b128 v[132:135], v30 offset:112
    ds_read_b64_tr_b16 v[100:101], v29 offset:520
    ds_read_b64_tr_b16 v[102:103], v29 offset:512
    s_waitcnt lgkmcnt(11)
    v_mfma_f32_16x16x32_f16 v[220:223], v[148:151], v[192:195], v[220:223]
    ds_read_b128 v[144:147], v30 offset:880
    ds_read_b128 v[140:143], v30 offset:624
    ds_read_b64_tr_b16 v[108:109], v29 offset:1544
    s_waitcnt lgkmcnt(11)
    v_mfma_f32_16x16x32_f16 v[220:223], v[156:159], v[188:191], v[220:223]
    ds_read_b64_tr_b16 v[110:111], v29 offset:1536
    ds_read_b128 v[136:139], v30 offset:368
    ds_read_b64_tr_b16 v[116:117], v29 offset:2568
    s_waitcnt lgkmcnt(11)
    v_mfma_f32_16x16x32_f16 v[220:223], v[164:167], v[184:187], v[220:223]
    ds_read_b64_tr_b16 v[118:119], v29 offset:2560
    ds_read_b64_tr_b16 v[124:125], v29 offset:3592
    ds_read_b64_tr_b16 v[126:127], v29 offset:3584
    s_waitcnt lgkmcnt(12)
    v_mfma_f32_16x16x32_f16 v[220:223], v[172:175], v[180:183], v[220:223]
    s_waitcnt lgkmcnt(9)
    v_mfma_f32_16x16x32_f16 v[196:199], v[100:103], v[132:135], v[196:199]
    ds_read_b128 v[180:183], v30 offset:96
    ds_read_b64_tr_b16 v[148:149], v29 offset:584
    ds_read_b64_tr_b16 v[150:151], v29 offset:576
    s_waitcnt lgkmcnt(11)
    v_mfma_f32_16x16x32_f16 v[220:223], v[100:103], v[144:147], v[220:223]
    ds_read_b128 v[192:195], v30 offset:864
    ds_read_b128 v[188:191], v30 offset:608
    ds_read_b64_tr_b16 v[156:157], v29 offset:1608
    s_waitcnt lgkmcnt(11)
    v_mfma_f32_16x16x32_f16 v[220:223], v[108:111], v[140:143], v[220:223]
    ds_read_b64_tr_b16 v[158:159], v29 offset:1600
    ds_read_b128 v[184:187], v30 offset:352
    ds_read_b64_tr_b16 v[164:165], v29 offset:2632
    s_waitcnt lgkmcnt(11)
    v_mfma_f32_16x16x32_f16 v[220:223], v[116:119], v[136:139], v[220:223]
    ds_read_b64_tr_b16 v[166:167], v29 offset:2624
    ds_read_b64_tr_b16 v[172:173], v29 offset:3656
    ds_read_b64_tr_b16 v[174:175], v29 offset:3648
    s_waitcnt lgkmcnt(12)
    v_mfma_f32_16x16x32_f16 v[220:223], v[124:127], v[132:135], v[220:223]
    s_waitcnt lgkmcnt(9)
    v_mfma_f32_16x16x32_f16 v[196:199], v[148:151], v[180:183], v[196:199]
    ds_read_b128 v[132:135], v30 offset:80
    ds_read_b64_tr_b16 v[100:101], v29 offset:648
    ds_read_b64_tr_b16 v[102:103], v29 offset:640
    s_waitcnt lgkmcnt(11)
    v_mfma_f32_16x16x32_f16 v[220:223], v[148:151], v[192:195], v[220:223]
    ds_read_b128 v[144:147], v30 offset:848
    ds_read_b128 v[140:143], v30 offset:592
    ds_read_b64_tr_b16 v[108:109], v29 offset:1672
    s_waitcnt lgkmcnt(11)
    v_mfma_f32_16x16x32_f16 v[220:223], v[156:159], v[188:191], v[220:223]
    ds_read_b64_tr_b16 v[110:111], v29 offset:1664
    ds_read_b128 v[136:139], v30 offset:336
    ds_read_b64_tr_b16 v[116:117], v29 offset:2696
    s_waitcnt lgkmcnt(11)
    v_mfma_f32_16x16x32_f16 v[220:223], v[164:167], v[184:187], v[220:223]
    ds_read_b64_tr_b16 v[118:119], v29 offset:2688
    ds_read_b64_tr_b16 v[124:125], v29 offset:3720
    ds_read_b64_tr_b16 v[126:127], v29 offset:3712
    s_waitcnt lgkmcnt(12)
    v_mfma_f32_16x16x32_f16 v[220:223], v[172:175], v[180:183], v[220:223]
    s_waitcnt lgkmcnt(9)
    v_mfma_f32_16x16x32_f16 v[196:199], v[100:103], v[132:135], v[196:199]
    ds_read_b128 v[180:183], v30 offset:64
    ds_read_b64_tr_b16 v[148:149], v29 offset:712
    ds_read_b64_tr_b16 v[150:151], v29 offset:704
    s_waitcnt lgkmcnt(11)
    v_mfma_f32_16x16x32_f16 v[220:223], v[100:103], v[144:147], v[220:223]
    ds_read_b128 v[192:195], v30 offset:832
    ds_read_b128 v[188:191], v30 offset:576
    ds_read_b64_tr_b16 v[156:157], v29 offset:1736
    s_waitcnt lgkmcnt(11)
    v_mfma_f32_16x16x32_f16 v[220:223], v[108:111], v[140:143], v[220:223]
    ds_read_b64_tr_b16 v[158:159], v29 offset:1728
    ds_read_b128 v[184:187], v30 offset:320
    ds_read_b64_tr_b16 v[164:165], v29 offset:2760
    s_waitcnt lgkmcnt(11)
    v_mfma_f32_16x16x32_f16 v[220:223], v[116:119], v[136:139], v[220:223]
    ds_read_b64_tr_b16 v[166:167], v29 offset:2752
    ds_read_b64_tr_b16 v[172:173], v29 offset:3784
    ds_read_b64_tr_b16 v[174:175], v29 offset:3776
    s_waitcnt lgkmcnt(12)
    v_mfma_f32_16x16x32_f16 v[220:223], v[124:127], v[132:135], v[220:223]
    s_waitcnt lgkmcnt(9)
    v_mfma_f32_16x16x32_f16 v[196:199], v[148:151], v[180:183], v[196:199]
    ds_read_b128 v[132:135], v30 offset:48
    ds_read_b64_tr_b16 v[100:101], v29 offset:776
    ds_read_b64_tr_b16 v[102:103], v29 offset:768
    s_waitcnt lgkmcnt(11)
    v_mfma_f32_16x16x32_f16 v[220:223], v[148:151], v[192:195], v[220:223]
    ds_read_b128 v[144:147], v30 offset:816
    ds_read_b128 v[140:143], v30 offset:560
    ds_read_b64_tr_b16 v[108:109], v29 offset:1800
    s_waitcnt lgkmcnt(11)
    v_mfma_f32_16x16x32_f16 v[220:223], v[156:159], v[188:191], v[220:223]
    ds_read_b64_tr_b16 v[110:111], v29 offset:1792
    ds_read_b128 v[136:139], v30 offset:304
    ds_read_b64_tr_b16 v[116:117], v29 offset:2824
    s_waitcnt lgkmcnt(11)
    v_mfma_f32_16x16x32_f16 v[220:223], v[164:167], v[184:187], v[220:223]
    ds_read_b64_tr_b16 v[118:119], v29 offset:2816
    ds_read_b64_tr_b16 v[124:125], v29 offset:3848
    ds_read_b64_tr_b16 v[126:127], v29 offset:3840
    s_waitcnt lgkmcnt(12)
    v_mfma_f32_16x16x32_f16 v[220:223], v[172:175], v[180:183], v[220:223]
    s_waitcnt lgkmcnt(9)
    v_mfma_f32_16x16x32_f16 v[196:199], v[100:103], v[132:135], v[196:199]
    ds_read_b128 v[180:183], v30 offset:32
    ds_read_b64_tr_b16 v[148:149], v29 offset:840
    ds_read_b64_tr_b16 v[150:151], v29 offset:832
    s_waitcnt lgkmcnt(11)
    v_mfma_f32_16x16x32_f16 v[220:223], v[100:103], v[144:147], v[220:223]
    ds_read_b128 v[192:195], v30 offset:800
    ds_read_b128 v[188:191], v30 offset:544
    ds_read_b64_tr_b16 v[156:157], v29 offset:1864
    s_waitcnt lgkmcnt(11)
    v_mfma_f32_16x16x32_f16 v[220:223], v[108:111], v[140:143], v[220:223]
    ds_read_b64_tr_b16 v[158:159], v29 offset:1856
    ds_read_b128 v[184:187], v30 offset:288
    ds_read_b64_tr_b16 v[164:165], v29 offset:2888
    s_waitcnt lgkmcnt(11)
    v_mfma_f32_16x16x32_f16 v[220:223], v[116:119], v[136:139], v[220:223]
    ds_read_b64_tr_b16 v[166:167], v29 offset:2880
    ds_read_b64_tr_b16 v[172:173], v29 offset:3912
    ds_read_b64_tr_b16 v[174:175], v29 offset:3904
    s_waitcnt lgkmcnt(12)
    v_mfma_f32_16x16x32_f16 v[220:223], v[124:127], v[132:135], v[220:223]
    s_waitcnt lgkmcnt(9)
    v_mfma_f32_16x16x32_f16 v[196:199], v[148:151], v[180:183], v[196:199]
    ds_read_b128 v[132:135], v30 offset:16
    ds_read_b64_tr_b16 v[100:101], v29 offset:904
    ds_read_b64_tr_b16 v[102:103], v29 offset:896
    s_waitcnt lgkmcnt(11)
    v_mfma_f32_16x16x32_f16 v[220:223], v[148:151], v[192:195], v[220:223]
    ds_read_b128 v[144:147], v30 offset:784
    ds_read_b128 v[140:143], v30 offset:528
    ds_read_b64_tr_b16 v[108:109], v29 offset:1928
    s_waitcnt lgkmcnt(11)
    v_mfma_f32_16x16x32_f16 v[220:223], v[156:159], v[188:191], v[220:223]
    ds_read_b64_tr_b16 v[110:111], v29 offset:1920
    ds_read_b128 v[136:139], v30 offset:272
    ds_read_b64_tr_b16 v[116:117], v29 offset:2952
    s_waitcnt lgkmcnt(11)
    v_mfma_f32_16x16x32_f16 v[220:223], v[164:167], v[184:187], v[220:223]
    ds_read_b64_tr_b16 v[118:119], v29 offset:2944
    ds_read_b64_tr_b16 v[124:125], v29 offset:3976
    ds_read_b64_tr_b16 v[126:127], v29 offset:3968
    s_waitcnt lgkmcnt(12)
    v_mfma_f32_16x16x32_f16 v[220:223], v[172:175], v[180:183], v[220:223]
    s_waitcnt lgkmcnt(9)
    v_mfma_f32_16x16x32_f16 v[196:199], v[100:103], v[132:135], v[196:199]
    ds_read_b128 v[180:183], v30 offset:0
    ds_read_b64_tr_b16 v[148:149], v29 offset:968
    ds_read_b64_tr_b16 v[150:151], v29 offset:960
    s_waitcnt lgkmcnt(11)
    v_mfma_f32_16x16x32_f16 v[220:223], v[100:103], v[144:147], v[220:223]
    ds_read_b128 v[192:195], v30 offset:768
    ds_read_b128 v[188:191], v30 offset:512
    ds_read_b64_tr_b16 v[156:157], v29 offset:1992
    s_waitcnt lgkmcnt(11)
    v_mfma_f32_16x16x32_f16 v[220:223], v[108:111], v[140:143], v[220:223]
    ds_read_b64_tr_b16 v[158:159], v29 offset:1984
    ds_read_b128 v[184:187], v30 offset:256
    ds_read_b64_tr_b16 v[164:165], v29 offset:3016
    s_waitcnt lgkmcnt(11)
    v_mfma_f32_16x16x32_f16 v[220:223], v[116:119], v[136:139], v[220:223]
    ds_read_b64_tr_b16 v[166:167], v29 offset:3008
    ds_read_b64_tr_b16 v[172:173], v29 offset:4040
    ds_read_b64_tr_b16 v[174:175], v29 offset:4032
    s_waitcnt lgkmcnt(12)
    v_mfma_f32_16x16x32_f16 v[220:223], v[124:127], v[132:135], v[220:223]
    s_waitcnt lgkmcnt(9)
    v_mfma_f32_16x16x32_f16 v[196:199], v[148:151], v[180:183], v[196:199]
    s_waitcnt lgkmcnt(8)
    v_mfma_f32_16x16x32_f16 v[220:223], v[148:151], v[192:195], v[220:223]
    s_waitcnt lgkmcnt(5)
    v_mfma_f32_16x16x32_f16 v[220:223], v[156:159], v[188:191], v[220:223]
    s_waitcnt lgkmcnt(2)
    v_mfma_f32_16x16x32_f16 v[220:223], v[164:167], v[184:187], v[220:223]
    s_waitcnt lgkmcnt(0)
    v_mfma_f32_16x16x32_f16 v[220:223], v[172:175], v[180:183], v[220:223]
    s_waitcnt lgkmcnt(0)
    s_lshl_b32 s59, s59, s60
    s_and_b32 s59, s59, 0xffff0000
    v_mov_b32 v116, s59

    v_mov_b32 v118, v61
    v_mov_b32 v119, v61
    s_nop 4
    ds_read_b64 v[100:101], v31 offset:0
    ds_read_b64 v[102:103], v31 offset:3072
    s_waitcnt lgkmcnt(0)
    v_pk_mul_f32 v[196:197], v[196:197], v[118:119]
    v_pk_mul_f32 v[220:221], v[220:221], v[118:119]
    v_pk_mul_f32 v[198:199], v[198:199], v[118:119]
    v_pk_mul_f32 v[222:223], v[222:223], v[118:119]
    v_fma_mix_f32 v120, v100, v116, 0 op_sel_hi:[1,0,0]
    v_fma_mix_f32 v128, v102, v116, 0 op_sel_hi:[1,0,0]
    v_fma_mix_f32 v121, v100, v116, 0 op_sel:[1,0,0] op_sel_hi:[1,0,0]
    v_fma_mix_f32 v129, v102, v116, 0 op_sel:[1,0,0] op_sel_hi:[1,0,0]
    v_fma_mix_f32 v122, v101, v116, 0 op_sel_hi:[1,0,0]
    v_fma_mix_f32 v130, v103, v116, 0 op_sel_hi:[1,0,0]
    v_fma_mix_f32 v123, v101, v116, 0 op_sel:[1,0,0] op_sel_hi:[1,0,0]
    v_fma_mix_f32 v131, v103, v116, 0 op_sel:[1,0,0] op_sel_hi:[1,0,0]
    v_cvt_pk_bf16_f32 v124, v196, v197
    v_cvt_pk_bf16_f32 v132, v220, v221
    v_cvt_pk_bf16_f32 v125, v198, v199
    v_cvt_pk_bf16_f32 v133, v222, v223
    v_cvt_pk_bf16_f32 v126, v120, v121
    v_cvt_pk_bf16_f32 v134, v128, v129
    v_cvt_pk_bf16_f32 v127, v122, v123
    v_cvt_pk_bf16_f32 v135, v130, v131
    v_lshlrev_b32 v196, 16, v124
    v_lshlrev_b32 v220, 16, v132
    v_and_b32 v197, 0xffff0000, v124
    v_and_b32 v221, 0xffff0000, v132
    v_lshlrev_b32 v198, 16, v125
    v_lshlrev_b32 v222, 16, v133
    v_and_b32 v199, 0xffff0000, v125
    v_and_b32 v223, 0xffff0000, v133
    v_lshlrev_b32 v120, 16, v126
    v_lshlrev_b32 v128, 16, v134
    v_and_b32 v121, 0xffff0000, v126
    v_and_b32 v129, 0xffff0000, v134
    v_lshlrev_b32 v122, 16, v127
    v_lshlrev_b32 v130, 16, v135
    v_and_b32 v123, 0xffff0000, v127
    v_and_b32 v131, 0xffff0000, v135
    v_pk_add_f32 v[196:197], v[196:197], v[120:121]
    v_pk_add_f32 v[220:221], v[220:221], v[128:129]
    v_pk_add_f32 v[198:199], v[198:199], v[122:123]
    v_pk_add_f32 v[222:223], v[222:223], v[130:131]
    v_cvt_pk_bf16_f32 v124, v196, v197
    v_cvt_pk_bf16_f32 v132, v220, v221
    v_cvt_pk_bf16_f32 v125, v198, v199
    v_cvt_pk_bf16_f32 v133, v222, v223
    ds_write_b64 v32, v[124:125] offset:0
    ds_write_b64 v32, v[132:133] offset:3072
    s_branch L_ninth_join
    L_ninth_b:
    ds_read_b128 v[136:139], v30 offset:496
    ds_read_b64_tr_b16 v[100:101], v29 offset:8
    ds_read_b64_tr_b16 v[102:103], v29 offset:0
    ds_read_b128 v[140:143], v30 offset:752
    ds_read_b128 v[132:135], v30 offset:240
    ds_read_b64_tr_b16 v[108:109], v29 offset:1032
    ds_read_b64_tr_b16 v[110:111], v29 offset:1024
    ds_read_b64_tr_b16 v[116:117], v29 offset:2056
    ds_read_b64_tr_b16 v[118:119], v29 offset:2048
    s_waitcnt lgkmcnt(6)
    v_mfma_f32_16x16x32_f16 v[204:207], v[100:103], v[136:139], 0
    ds_read_b128 v[184:187], v30 offset:480
    ds_read_b64_tr_b16 v[148:149], v29 offset:72
    s_waitcnt lgkmcnt(7)
    v_mfma_f32_16x16x32_f16 v[212:215], v[100:103], v[140:143], 0
    ds_read_b64_tr_b16 v[150:151], v29 offset:64
    ds_read_b128 v[188:191], v30 offset:736
    s_waitcnt lgkmcnt(6)
    v_mfma_f32_16x16x32_f16 v[204:207], v[108:111], v[132:135], v[204:207]
    ds_read_b128 v[180:183], v30 offset:224
    ds_read_b64_tr_b16 v[156:157], v29 offset:1096
    v_mfma_f32_16x16x32_f16 v[212:215], v[108:111], v[136:139], v[212:215]
    ds_read_b64_tr_b16 v[158:159], v29 offset:1088
    ds_read_b64_tr_b16 v[164:165], v29 offset:2120
    s_waitcnt lgkmcnt(8)
    v_mfma_f32_16x16x32_f16 v[212:215], v[116:119], v[132:135], v[212:215]
    ds_read_b64_tr_b16 v[166:167], v29 offset:2112
    s_waitcnt lgkmcnt(6)
    v_mfma_f32_16x16x32_f16 v[204:207], v[148:151], v[184:187], v[204:207]
    ds_read_b128 v[136:139], v30 offset:464
    ds_read_b64_tr_b16 v[100:101], v29 offset:136
    s_waitcnt lgkmcnt(7)
    v_mfma_f32_16x16x32_f16 v[212:215], v[148:151], v[188:191], v[212:215]
    ds_read_b64_tr_b16 v[102:103], v29 offset:128
    ds_read_b128 v[140:143], v30 offset:720
    s_waitcnt lgkmcnt(6)
    v_mfma_f32_16x16x32_f16 v[204:207], v[156:159], v[180:183], v[204:207]
    ds_read_b128 v[132:135], v30 offset:208
    ds_read_b64_tr_b16 v[108:109], v29 offset:1160
    v_mfma_f32_16x16x32_f16 v[212:215], v[156:159], v[184:187], v[212:215]
    ds_read_b64_tr_b16 v[110:111], v29 offset:1152
    ds_read_b64_tr_b16 v[116:117], v29 offset:2184
    s_waitcnt lgkmcnt(8)
    v_mfma_f32_16x16x32_f16 v[212:215], v[164:167], v[180:183], v[212:215]
    ds_read_b64_tr_b16 v[118:119], v29 offset:2176
    s_waitcnt lgkmcnt(6)
    v_mfma_f32_16x16x32_f16 v[204:207], v[100:103], v[136:139], v[204:207]
    ds_read_b128 v[184:187], v30 offset:448
    ds_read_b64_tr_b16 v[148:149], v29 offset:200
    s_waitcnt lgkmcnt(7)
    v_mfma_f32_16x16x32_f16 v[212:215], v[100:103], v[140:143], v[212:215]
    ds_read_b64_tr_b16 v[150:151], v29 offset:192
    ds_read_b128 v[188:191], v30 offset:704
    s_waitcnt lgkmcnt(6)
    v_mfma_f32_16x16x32_f16 v[204:207], v[108:111], v[132:135], v[204:207]
    ds_read_b128 v[180:183], v30 offset:192
    ds_read_b64_tr_b16 v[156:157], v29 offset:1224
    v_mfma_f32_16x16x32_f16 v[212:215], v[108:111], v[136:139], v[212:215]
    ds_read_b64_tr_b16 v[158:159], v29 offset:1216
    ds_read_b64_tr_b16 v[164:165], v29 offset:2248
    s_waitcnt lgkmcnt(8)
    v_mfma_f32_16x16x32_f16 v[212:215], v[116:119], v[132:135], v[212:215]
    ds_read_b64_tr_b16 v[166:167], v29 offset:2240
    s_waitcnt lgkmcnt(6)
    v_mfma_f32_16x16x32_f16 v[204:207], v[148:151], v[184:187], v[204:207]
    ds_read_b128 v[136:139], v30 offset:432
    ds_read_b64_tr_b16 v[100:101], v29 offset:264
    s_waitcnt lgkmcnt(7)
    v_mfma_f32_16x16x32_f16 v[212:215], v[148:151], v[188:191], v[212:215]
    ds_read_b64_tr_b16 v[102:103], v29 offset:256
    ds_read_b128 v[140:143], v30 offset:688
    s_waitcnt lgkmcnt(6)
    v_mfma_f32_16x16x32_f16 v[204:207], v[156:159], v[180:183], v[204:207]
    ds_read_b128 v[132:135], v30 offset:176
    ds_read_b64_tr_b16 v[108:109], v29 offset:1288
    v_mfma_f32_16x16x32_f16 v[212:215], v[156:159], v[184:187], v[212:215]
    ds_read_b64_tr_b16 v[110:111], v29 offset:1280
    ds_read_b64_tr_b16 v[116:117], v29 offset:2312
    s_waitcnt lgkmcnt(8)
    v_mfma_f32_16x16x32_f16 v[212:215], v[164:167], v[180:183], v[212:215]
    ds_read_b64_tr_b16 v[118:119], v29 offset:2304
    s_waitcnt lgkmcnt(6)
    v_mfma_f32_16x16x32_f16 v[204:207], v[100:103], v[136:139], v[204:207]
    ds_read_b128 v[184:187], v30 offset:416
    ds_read_b64_tr_b16 v[148:149], v29 offset:328
    s_waitcnt lgkmcnt(7)
    v_mfma_f32_16x16x32_f16 v[212:215], v[100:103], v[140:143], v[212:215]
    ds_read_b64_tr_b16 v[150:151], v29 offset:320
    ds_read_b128 v[188:191], v30 offset:672
    s_waitcnt lgkmcnt(6)
    v_mfma_f32_16x16x32_f16 v[204:207], v[108:111], v[132:135], v[204:207]
    ds_read_b128 v[180:183], v30 offset:160
    ds_read_b64_tr_b16 v[156:157], v29 offset:1352
    v_mfma_f32_16x16x32_f16 v[212:215], v[108:111], v[136:139], v[212:215]
    ds_read_b64_tr_b16 v[158:159], v29 offset:1344
    ds_read_b64_tr_b16 v[164:165], v29 offset:2376
    s_waitcnt lgkmcnt(8)
    v_mfma_f32_16x16x32_f16 v[212:215], v[116:119], v[132:135], v[212:215]
    ds_read_b64_tr_b16 v[166:167], v29 offset:2368
    s_waitcnt lgkmcnt(6)
    v_mfma_f32_16x16x32_f16 v[204:207], v[148:151], v[184:187], v[204:207]
    ds_read_b128 v[136:139], v30 offset:400
    ds_read_b64_tr_b16 v[100:101], v29 offset:392
    s_waitcnt lgkmcnt(7)
    v_mfma_f32_16x16x32_f16 v[212:215], v[148:151], v[188:191], v[212:215]
    ds_read_b64_tr_b16 v[102:103], v29 offset:384
    ds_read_b128 v[140:143], v30 offset:656
    s_waitcnt lgkmcnt(6)
    v_mfma_f32_16x16x32_f16 v[204:207], v[156:159], v[180:183], v[204:207]
    ds_read_b128 v[132:135], v30 offset:144
    ds_read_b64_tr_b16 v[108:109], v29 offset:1416
    v_mfma_f32_16x16x32_f16 v[212:215], v[156:159], v[184:187], v[212:215]
    ds_read_b64_tr_b16 v[110:111], v29 offset:1408
    ds_read_b64_tr_b16 v[116:117], v29 offset:2440
    s_waitcnt lgkmcnt(8)
    v_mfma_f32_16x16x32_f16 v[212:215], v[164:167], v[180:183], v[212:215]
    ds_read_b64_tr_b16 v[118:119], v29 offset:2432
    s_waitcnt lgkmcnt(6)
    v_mfma_f32_16x16x32_f16 v[204:207], v[100:103], v[136:139], v[204:207]
    ds_read_b128 v[184:187], v30 offset:384
    ds_read_b64_tr_b16 v[148:149], v29 offset:456
    s_waitcnt lgkmcnt(7)
    v_mfma_f32_16x16x32_f16 v[212:215], v[100:103], v[140:143], v[212:215]
    ds_read_b64_tr_b16 v[150:151], v29 offset:448
    ds_read_b128 v[188:191], v30 offset:640
    s_waitcnt lgkmcnt(6)
    v_mfma_f32_16x16x32_f16 v[204:207], v[108:111], v[132:135], v[204:207]
    ds_read_b128 v[180:183], v30 offset:128
    ds_read_b64_tr_b16 v[156:157], v29 offset:1480
    v_mfma_f32_16x16x32_f16 v[212:215], v[108:111], v[136:139], v[212:215]
    ds_read_b64_tr_b16 v[158:159], v29 offset:1472
    ds_read_b64_tr_b16 v[164:165], v29 offset:2504
    s_waitcnt lgkmcnt(8)
    v_mfma_f32_16x16x32_f16 v[212:215], v[116:119], v[132:135], v[212:215]
    ds_read_b64_tr_b16 v[166:167], v29 offset:2496
    s_waitcnt lgkmcnt(6)
    v_mfma_f32_16x16x32_f16 v[204:207], v[148:151], v[184:187], v[204:207]
    ds_read_b128 v[136:139], v30 offset:368
    ds_read_b64_tr_b16 v[100:101], v29 offset:520
    s_waitcnt lgkmcnt(7)
    v_mfma_f32_16x16x32_f16 v[212:215], v[148:151], v[188:191], v[212:215]
    ds_read_b64_tr_b16 v[102:103], v29 offset:512
    ds_read_b128 v[140:143], v30 offset:624
    s_waitcnt lgkmcnt(6)
    v_mfma_f32_16x16x32_f16 v[204:207], v[156:159], v[180:183], v[204:207]
    ds_read_b128 v[132:135], v30 offset:112
    ds_read_b64_tr_b16 v[108:109], v29 offset:1544
    v_mfma_f32_16x16x32_f16 v[212:215], v[156:159], v[184:187], v[212:215]
    ds_read_b64_tr_b16 v[110:111], v29 offset:1536
    ds_read_b64_tr_b16 v[116:117], v29 offset:2568
    s_waitcnt lgkmcnt(8)
    v_mfma_f32_16x16x32_f16 v[212:215], v[164:167], v[180:183], v[212:215]
    ds_read_b64_tr_b16 v[118:119], v29 offset:2560
    s_waitcnt lgkmcnt(6)
    v_mfma_f32_16x16x32_f16 v[204:207], v[100:103], v[136:139], v[204:207]
    ds_read_b128 v[184:187], v30 offset:352
    ds_read_b64_tr_b16 v[148:149], v29 offset:584
    s_waitcnt lgkmcnt(7)
    v_mfma_f32_16x16x32_f16 v[212:215], v[100:103], v[140:143], v[212:215]
    ds_read_b64_tr_b16 v[150:151], v29 offset:576
    ds_read_b128 v[188:191], v30 offset:608
    s_waitcnt lgkmcnt(6)
    v_mfma_f32_16x16x32_f16 v[204:207], v[108:111], v[132:135], v[204:207]
    ds_read_b128 v[180:183], v30 offset:96
    ds_read_b64_tr_b16 v[156:157], v29 offset:1608
    v_mfma_f32_16x16x32_f16 v[212:215], v[108:111], v[136:139], v[212:215]
    ds_read_b64_tr_b16 v[158:159], v29 offset:1600
    ds_read_b64_tr_b16 v[164:165], v29 offset:2632
    s_waitcnt lgkmcnt(8)
    v_mfma_f32_16x16x32_f16 v[212:215], v[116:119], v[132:135], v[212:215]
    ds_read_b64_tr_b16 v[166:167], v29 offset:2624
    s_waitcnt lgkmcnt(6)
    v_mfma_f32_16x16x32_f16 v[204:207], v[148:151], v[184:187], v[204:207]
    ds_read_b128 v[136:139], v30 offset:336
    ds_read_b64_tr_b16 v[100:101], v29 offset:648
    s_waitcnt lgkmcnt(7)
    v_mfma_f32_16x16x32_f16 v[212:215], v[148:151], v[188:191], v[212:215]
    ds_read_b64_tr_b16 v[102:103], v29 offset:640
    ds_read_b128 v[140:143], v30 offset:592
    s_waitcnt lgkmcnt(6)
    v_mfma_f32_16x16x32_f16 v[204:207], v[156:159], v[180:183], v[204:207]
    ds_read_b128 v[132:135], v30 offset:80
    ds_read_b64_tr_b16 v[108:109], v29 offset:1672
    v_mfma_f32_16x16x32_f16 v[212:215], v[156:159], v[184:187], v[212:215]
    ds_read_b64_tr_b16 v[110:111], v29 offset:1664
    ds_read_b64_tr_b16 v[116:117], v29 offset:2696
    s_waitcnt lgkmcnt(8)
    v_mfma_f32_16x16x32_f16 v[212:215], v[164:167], v[180:183], v[212:215]
    ds_read_b64_tr_b16 v[118:119], v29 offset:2688
    s_waitcnt lgkmcnt(6)
    v_mfma_f32_16x16x32_f16 v[204:207], v[100:103], v[136:139], v[204:207]
    ds_read_b128 v[184:187], v30 offset:320
    ds_read_b64_tr_b16 v[148:149], v29 offset:712
    s_waitcnt lgkmcnt(7)
    v_mfma_f32_16x16x32_f16 v[212:215], v[100:103], v[140:143], v[212:215]
    ds_read_b64_tr_b16 v[150:151], v29 offset:704
    ds_read_b128 v[188:191], v30 offset:576
    s_waitcnt lgkmcnt(6)
    v_mfma_f32_16x16x32_f16 v[204:207], v[108:111], v[132:135], v[204:207]
    ds_read_b128 v[180:183], v30 offset:64
    ds_read_b64_tr_b16 v[156:157], v29 offset:1736
    v_mfma_f32_16x16x32_f16 v[212:215], v[108:111], v[136:139], v[212:215]
    ds_read_b64_tr_b16 v[158:159], v29 offset:1728
    ds_read_b64_tr_b16 v[164:165], v29 offset:2760
    s_waitcnt lgkmcnt(8)
    v_mfma_f32_16x16x32_f16 v[212:215], v[116:119], v[132:135], v[212:215]
    ds_read_b64_tr_b16 v[166:167], v29 offset:2752
    s_waitcnt lgkmcnt(6)
    v_mfma_f32_16x16x32_f16 v[204:207], v[148:151], v[184:187], v[204:207]
    ds_read_b128 v[136:139], v30 offset:304
    ds_read_b64_tr_b16 v[100:101], v29 offset:776
    s_waitcnt lgkmcnt(7)
    v_mfma_f32_16x16x32_f16 v[212:215], v[148:151], v[188:191], v[212:215]
    ds_read_b64_tr_b16 v[102:103], v29 offset:768
    ds_read_b128 v[140:143], v30 offset:560
    s_waitcnt lgkmcnt(6)
    v_mfma_f32_16x16x32_f16 v[204:207], v[156:159], v[180:183], v[204:207]
    ds_read_b128 v[132:135], v30 offset:48
    ds_read_b64_tr_b16 v[108:109], v29 offset:1800
    v_mfma_f32_16x16x32_f16 v[212:215], v[156:159], v[184:187], v[212:215]
    ds_read_b64_tr_b16 v[110:111], v29 offset:1792
    ds_read_b64_tr_b16 v[116:117], v29 offset:2824
    s_waitcnt lgkmcnt(8)
    v_mfma_f32_16x16x32_f16 v[212:215], v[164:167], v[180:183], v[212:215]
    ds_read_b64_tr_b16 v[118:119], v29 offset:2816
    s_waitcnt lgkmcnt(6)
    v_mfma_f32_16x16x32_f16 v[204:207], v[100:103], v[136:139], v[204:207]
    ds_read_b128 v[184:187], v30 offset:288
    ds_read_b64_tr_b16 v[148:149], v29 offset:840
    s_waitcnt lgkmcnt(7)
    v_mfma_f32_16x16x32_f16 v[212:215], v[100:103], v[140:143], v[212:215]
    ds_read_b64_tr_b16 v[150:151], v29 offset:832
    ds_read_b128 v[188:191], v30 offset:544
    s_waitcnt lgkmcnt(6)
    v_mfma_f32_16x16x32_f16 v[204:207], v[108:111], v[132:135], v[204:207]
    ds_read_b128 v[180:183], v30 offset:32
    ds_read_b64_tr_b16 v[156:157], v29 offset:1864
    v_mfma_f32_16x16x32_f16 v[212:215], v[108:111], v[136:139], v[212:215]
    ds_read_b64_tr_b16 v[158:159], v29 offset:1856
    ds_read_b64_tr_b16 v[164:165], v29 offset:2888
    s_waitcnt lgkmcnt(8)
    v_mfma_f32_16x16x32_f16 v[212:215], v[116:119], v[132:135], v[212:215]
    ds_read_b64_tr_b16 v[166:167], v29 offset:2880
    s_waitcnt lgkmcnt(6)
    v_mfma_f32_16x16x32_f16 v[204:207], v[148:151], v[184:187], v[204:207]
    ds_read_b128 v[136:139], v30 offset:272
    ds_read_b64_tr_b16 v[100:101], v29 offset:904
    s_waitcnt lgkmcnt(7)
    v_mfma_f32_16x16x32_f16 v[212:215], v[148:151], v[188:191], v[212:215]
    ds_read_b64_tr_b16 v[102:103], v29 offset:896
    ds_read_b128 v[140:143], v30 offset:528
    s_waitcnt lgkmcnt(6)
    v_mfma_f32_16x16x32_f16 v[204:207], v[156:159], v[180:183], v[204:207]
    ds_read_b128 v[132:135], v30 offset:16
    ds_read_b64_tr_b16 v[108:109], v29 offset:1928
    v_mfma_f32_16x16x32_f16 v[212:215], v[156:159], v[184:187], v[212:215]
    ds_read_b64_tr_b16 v[110:111], v29 offset:1920
    ds_read_b64_tr_b16 v[116:117], v29 offset:2952
    s_waitcnt lgkmcnt(8)
    v_mfma_f32_16x16x32_f16 v[212:215], v[164:167], v[180:183], v[212:215]
    ds_read_b64_tr_b16 v[118:119], v29 offset:2944
    s_waitcnt lgkmcnt(6)
    v_mfma_f32_16x16x32_f16 v[204:207], v[100:103], v[136:139], v[204:207]
    ds_read_b128 v[184:187], v30 offset:256
    ds_read_b64_tr_b16 v[148:149], v29 offset:968
    s_waitcnt lgkmcnt(7)
    v_mfma_f32_16x16x32_f16 v[212:215], v[100:103], v[140:143], v[212:215]
    ds_read_b64_tr_b16 v[150:151], v29 offset:960
    ds_read_b128 v[188:191], v30 offset:512
    s_waitcnt lgkmcnt(6)
    v_mfma_f32_16x16x32_f16 v[204:207], v[108:111], v[132:135], v[204:207]
    ds_read_b128 v[180:183], v30 offset:0
    ds_read_b64_tr_b16 v[156:157], v29 offset:1992
    v_mfma_f32_16x16x32_f16 v[212:215], v[108:111], v[136:139], v[212:215]
    ds_read_b64_tr_b16 v[158:159], v29 offset:1984
    ds_read_b64_tr_b16 v[164:165], v29 offset:3016
    s_waitcnt lgkmcnt(8)
    v_mfma_f32_16x16x32_f16 v[212:215], v[116:119], v[132:135], v[212:215]
    ds_read_b64_tr_b16 v[166:167], v29 offset:3008
    s_waitcnt lgkmcnt(6)
    v_mfma_f32_16x16x32_f16 v[204:207], v[148:151], v[184:187], v[204:207]
    s_waitcnt lgkmcnt(5)
    v_mfma_f32_16x16x32_f16 v[212:215], v[148:151], v[188:191], v[212:215]
    s_waitcnt lgkmcnt(2)
    v_mfma_f32_16x16x32_f16 v[204:207], v[156:159], v[180:183], v[204:207]
    v_mfma_f32_16x16x32_f16 v[212:215], v[156:159], v[184:187], v[212:215]
    s_waitcnt lgkmcnt(0)
    v_mfma_f32_16x16x32_f16 v[212:215], v[164:167], v[180:183], v[212:215]
    s_waitcnt lgkmcnt(0)
    s_lshl_b32 s59, s59, s60
    s_and_b32 s59, s59, 0xffff0000
    v_mov_b32 v116, s59

    v_mov_b32 v118, v61
    v_mov_b32 v119, v61
    s_nop 4
    ds_read_b64 v[100:101], v31 offset:1024
    ds_read_b64 v[102:103], v31 offset:2048
    s_waitcnt lgkmcnt(0)
    v_pk_mul_f32 v[204:205], v[204:205], v[118:119]
    v_pk_mul_f32 v[212:213], v[212:213], v[118:119]
    v_pk_mul_f32 v[206:207], v[206:207], v[118:119]
    v_pk_mul_f32 v[214:215], v[214:215], v[118:119]
    v_fma_mix_f32 v120, v100, v116, 0 op_sel_hi:[1,0,0]
    v_fma_mix_f32 v128, v102, v116, 0 op_sel_hi:[1,0,0]
    v_fma_mix_f32 v121, v100, v116, 0 op_sel:[1,0,0] op_sel_hi:[1,0,0]
    v_fma_mix_f32 v129, v102, v116, 0 op_sel:[1,0,0] op_sel_hi:[1,0,0]
    v_fma_mix_f32 v122, v101, v116, 0 op_sel_hi:[1,0,0]
    v_fma_mix_f32 v130, v103, v116, 0 op_sel_hi:[1,0,0]
    v_fma_mix_f32 v123, v101, v116, 0 op_sel:[1,0,0] op_sel_hi:[1,0,0]
    v_fma_mix_f32 v131, v103, v116, 0 op_sel:[1,0,0] op_sel_hi:[1,0,0]
    v_cvt_pk_bf16_f32 v124, v204, v205
    v_cvt_pk_bf16_f32 v132, v212, v213
    v_cvt_pk_bf16_f32 v125, v206, v207
    v_cvt_pk_bf16_f32 v133, v214, v215
    v_cvt_pk_bf16_f32 v126, v120, v121
    v_cvt_pk_bf16_f32 v134, v128, v129
    v_cvt_pk_bf16_f32 v127, v122, v123
    v_cvt_pk_bf16_f32 v135, v130, v131
    v_lshlrev_b32 v204, 16, v124
    v_lshlrev_b32 v212, 16, v132
    v_and_b32 v205, 0xffff0000, v124
    v_and_b32 v213, 0xffff0000, v132
    v_lshlrev_b32 v206, 16, v125
    v_lshlrev_b32 v214, 16, v133
    v_and_b32 v207, 0xffff0000, v125
    v_and_b32 v215, 0xffff0000, v133
    v_lshlrev_b32 v120, 16, v126
    v_lshlrev_b32 v128, 16, v134
    v_and_b32 v121, 0xffff0000, v126
    v_and_b32 v129, 0xffff0000, v134
    v_lshlrev_b32 v122, 16, v127
    v_lshlrev_b32 v130, 16, v135
    v_and_b32 v123, 0xffff0000, v127
    v_and_b32 v131, 0xffff0000, v135
    v_pk_add_f32 v[204:205], v[204:205], v[120:121]
    v_pk_add_f32 v[212:213], v[212:213], v[128:129]
    v_pk_add_f32 v[206:207], v[206:207], v[122:123]
    v_pk_add_f32 v[214:215], v[214:215], v[130:131]
    v_cvt_pk_bf16_f32 v124, v204, v205
    v_cvt_pk_bf16_f32 v132, v212, v213
    v_cvt_pk_bf16_f32 v125, v206, v207
    v_cvt_pk_bf16_f32 v133, v214, v215
    ds_write_b64 v32, v[124:125] offset:1024
    ds_write_b64 v32, v[132:133] offset:2048
    L_ninth_join:
    s_waitcnt lgkmcnt(0)
    s_barrier
    ds_read_b128 v[152:155], v33
    s_lshl_b32 s55, s54, 12
    s_add_u32 s55, s55, 4718592
    s_add_u32 s55, s55, s66
    s_waitcnt lgkmcnt(0)
    buffer_store_dwordx4 v[152:155], v26, s[16:19], s55 offen sc1

    s_waitcnt vmcnt(0)
    s_barrier
    s_sub_u32 s3, s2, 192
    s_lshl_b32 s4, s3, 6
    s_add_u32 s4, s4, 42057728
    v_mov_b32 v2, s4
    v_mov_b32 v3, 0x7ffffff0
    v_cmp_eq_u32 vcc, 0, v0
    s_nop 1
    v_cndmask_b32 v3, v3, v2, vcc

    s_add_u32 s4, s90, 1
    v_mov_b32 v4, s4
    buffer_store_dword v4, v3, s[16:19], 0 offen sc1
    v_min_u32 v8, 11, v60
    s_mul_i32 s3, s91, 12
    v_add_u32 v8, s3, v8
    v_lshlrev_b32 v8, 2, v8
    s_lshr_b32 s3, s92, 1
    s_lshl_b32 s3, s3, 1
    s_add_u32 s3, s3, s93
    v_add_u32 v8, s3, v8
    v_lshlrev_b32 v8, 6, v8
    v_add_u32 v37, 42008576, v8

    s_mov_b32 s69, 20000
    L_poll_21:
    buffer_load_dword v40, v37, s[16:19], 0 offen sc1
    s_waitcnt vmcnt(0)
    s_add_u32 s4, s90, 1
    v_subrev_u32 v7, s4, v40
    v_cmp_le_u32 vcc, 15, v7
    s_sub_u32 s69, s69, 1
    s_cbranch_scc1 L_ok_22
    s_nop 1
    s_cmp_eq_u64 vcc, 0
    s_cbranch_scc1 L_ok_22
    s_sleep 8
    s_branch L_poll_21
    L_ok_22:
    s_add_u32 s50, s97, 0
    buffer_load_dwordx4 a[0:3], v38, s[16:19], s50 offen sc1
    s_add_u32 s50, s50, 16384
    buffer_load_dwordx4 a[4:7], v38, s[16:19], s50 offen sc1
    s_add_u32 s50, s50, 16384
    buffer_load_dwordx4 a[8:11], v38, s[16:19], s50 offen sc1
    s_add_u32 s50, s50, 16384
    buffer_load_dwordx4 a[12:15], v38, s[16:19], s50 offen sc1
    s_add_u32 s50, s50, 16384
    buffer_load_dwordx4 a[16:19], v38, s[16:19], s50 offen sc1
    s_add_u32 s50, s50, 16384
    buffer_load_dwordx4 a[20:23], v38, s[16:19], s50 offen sc1
    s_add_u32 s50, s50, 16384
    buffer_load_dwordx4 a[24:27], v38, s[16:19], s50 offen sc1
    s_add_u32 s50, s50, 16384
    buffer_load_dwordx4 a[28:31], v38, s[16:19], s50 offen sc1
    s_add_u32 s50, s50, 16384
    buffer_load_dwordx4 a[32:35], v38, s[16:19], s50 offen sc1
    s_add_u32 s50, s50, 16384
    buffer_load_dwordx4 a[36:39], v38, s[16:19], s50 offen sc1
    s_add_u32 s50, s50, 16384
    buffer_load_dwordx4 a[40:43], v38, s[16:19], s50 offen sc1
    s_add_u32 s50, s50, 16384
    buffer_load_dwordx4 a[44:47], v38, s[16:19], s50 offen sc1
    v_lshlrev_b32 v37, 6, v60
    v_add_u32 v37, 42057728, v37
    s_mov_b32 s69, 20000
    L_poll_23:
    buffer_load_dword v43, v37, s[16:19], 0 offen sc1
    s_waitcnt vmcnt(0)
    s_add_u32 s4, s90, 1
    v_subrev_u32 v7, s4, v43
    v_cmp_le_u32 vcc, 15, v7
    s_sub_u32 s69, s69, 1
    s_cbranch_scc1 L_ok_24
    s_nop 1
    s_cmp_eq_u64 vcc, 0
    s_cbranch_scc1 L_ok_24
    s_sleep 8
    s_branch L_poll_23
    L_ok_24:
    s_add_u32 m0, s99, 0
    s_add_u32 s50, s98, 0
    buffer_load_dwordx4 v42, s[16:19], s50 offen sc1 lds
    s_add_u32 m0, s99, 1024
    s_add_u32 s50, s98, 262144
    buffer_load_dwordx4 v42, s[16:19], s50 offen sc1 lds
    s_add_u32 m0, s99, 2048
    s_add_u32 s50, s98, 524288
    buffer_load_dwordx4 v42, s[16:19], s50 offen sc1 lds
    s_add_u32 m0, s99, 3072
    s_add_u32 s50, s98, 786432
    buffer_load_dwordx4 v42, s[16:19], s50 offen sc1 lds
    s_add_u32 m0, s99, 4096
    s_add_u32 s50, s98, 1048576
    buffer_load_dwordx4 v42, s[16:19], s50 offen sc1 lds
    s_add_u32 m0, s99, 5120
    s_add_u32 s50, s98, 1310720
    buffer_load_dwordx4 v42, s[16:19], s50 offen sc1 lds
    v_min_u32 v8, 11, v60
    s_mul_i32 s3, s91, 12
    v_add_u32 v8, s3, v8
    v_lshlrev_b32 v8, 2, v8
    s_lshr_b32 s3, s92, 1
    s_lshl_b32 s3, s3, 1
    s_add_u32 s3, s3, s93
    v_add_u32 v8, s3, v8
    v_lshlrev_b32 v8, 6, v8
    v_add_u32 v37, 42008576, v8

    s_add_u32 s4, s90, 2
    v_subrev_u32 v7, s4, v40
    v_cmp_le_u32 vcc, 14, v7
    s_nop 3
    s_cmp_eq_u64 vcc, 0
    s_cbranch_scc1 L_ok_26
    s_mov_b32 s69, 20000
    L_poll_25:
    buffer_load_dword v40, v37, s[16:19], 0 offen sc1
    s_waitcnt vmcnt(0)
    s_add_u32 s4, s90, 2
    v_subrev_u32 v7, s4, v40
    v_cmp_le_u32 vcc, 14, v7
    s_sub_u32 s69, s69, 1
    s_cbranch_scc1 L_ok_26
    s_nop 1
    s_cmp_eq_u64 vcc, 0
    s_cbranch_scc1 L_ok_26
    s_sleep 8
    s_branch L_poll_25
    L_ok_26:
    s_add_u32 s50, s97, 196608
    buffer_load_dwordx4 a[48:51], v38, s[16:19], s50 offen sc1
    s_add_u32 s50, s50, 16384
    buffer_load_dwordx4 a[52:55], v38, s[16:19], s50 offen sc1
    s_add_u32 s50, s50, 16384
    buffer_load_dwordx4 a[56:59], v38, s[16:19], s50 offen sc1
    s_add_u32 s50, s50, 16384
    buffer_load_dwordx4 a[60:63], v38, s[16:19], s50 offen sc1
    s_add_u32 s50, s50, 16384
    buffer_load_dwordx4 a[64:67], v38, s[16:19], s50 offen sc1
    s_add_u32 s50, s50, 16384
    buffer_load_dwordx4 a[68:71], v38, s[16:19], s50 offen sc1
    s_add_u32 s50, s50, 16384
    buffer_load_dwordx4 a[72:75], v38, s[16:19], s50 offen sc1
    s_add_u32 s50, s50, 16384
    buffer_load_dwordx4 a[76:79], v38, s[16:19], s50 offen sc1
    s_add_u32 s50, s50, 16384
    buffer_load_dwordx4 a[80:83], v38, s[16:19], s50 offen sc1
    s_add_u32 s50, s50, 16384
    buffer_load_dwordx4 a[84:87], v38, s[16:19], s50 offen sc1
    s_add_u32 s50, s50, 16384
    buffer_load_dwordx4 a[88:91], v38, s[16:19], s50 offen sc1
    s_add_u32 s50, s50, 16384
    buffer_load_dwordx4 a[92:95], v38, s[16:19], s50 offen sc1
    s_add_u32 s4, s90, 3
    v_subrev_u32 v7, s4, v40
    v_cmp_le_u32 vcc, 13, v7
    s_nop 3
    s_cmp_eq_u64 vcc, 0
    s_cbranch_scc1 L_ok_28
    s_mov_b32 s69, 20000
    L_poll_27:
    buffer_load_dword v40, v37, s[16:19], 0 offen sc1
    s_waitcnt vmcnt(0)
    s_add_u32 s4, s90, 3
    v_subrev_u32 v7, s4, v40
    v_cmp_le_u32 vcc, 13, v7
    s_sub_u32 s69, s69, 1
    s_cbranch_scc1 L_ok_28
    s_nop 1
    s_cmp_eq_u64 vcc, 0
    s_cbranch_scc1 L_ok_28
    s_sleep 8
    s_branch L_poll_27
    L_ok_28:
    s_add_u32 s50, s97, 393216
    buffer_load_dwordx4 a[96:99], v38, s[16:19], s50 offen sc1
    s_add_u32 s50, s50, 16384
    buffer_load_dwordx4 a[100:103], v38, s[16:19], s50 offen sc1
    s_add_u32 s50, s50, 16384
    buffer_load_dwordx4 a[104:107], v38, s[16:19], s50 offen sc1
    s_add_u32 s50, s50, 16384
    buffer_load_dwordx4 a[108:111], v38, s[16:19], s50 offen sc1
    s_add_u32 s50, s50, 16384
    buffer_load_dwordx4 a[112:115], v38, s[16:19], s50 offen sc1
    s_add_u32 s50, s50, 16384
    buffer_load_dwordx4 a[116:119], v38, s[16:19], s50 offen sc1
    s_add_u32 s50, s50, 16384
    buffer_load_dwordx4 a[120:123], v38, s[16:19], s50 offen sc1
    s_add_u32 s50, s50, 16384
    buffer_load_dwordx4 a[124:127], v38, s[16:19], s50 offen sc1
    s_add_u32 s50, s50, 16384
    buffer_load_dwordx4 a[128:131], v38, s[16:19], s50 offen sc1
    s_add_u32 s50, s50, 16384
    buffer_load_dwordx4 a[132:135], v38, s[16:19], s50 offen sc1
    s_add_u32 s50, s50, 16384
    buffer_load_dwordx4 a[136:139], v38, s[16:19], s50 offen sc1
    s_add_u32 s50, s50, 16384
    buffer_load_dwordx4 a[140:143], v38, s[16:19], s50 offen sc1
    s_waitcnt vmcnt(24)
    ds_read_b64_tr_b16 v[20:21], v39 offset:0
    ds_read_b64_tr_b16 v[22:23], v39 offset:256
    v_mfma_f32_16x16x32_bf16 v[8:11], v[88:91], a[0:3], 0
    v_mfma_f32_16x16x32_bf16 v[12:15], v[92:95], a[0:3], 0
    v_mfma_f32_16x16x32_bf16 v[8:11], v[88:91], a[4:7], v[8:11]
    v_mfma_f32_16x16x32_bf16 v[12:15], v[92:95], a[4:7], v[12:15]
    v_mfma_f32_16x16x32_bf16 v[8:11], v[88:91], a[8:11], v[8:11]
    v_mfma_f32_16x16x32_bf16 v[12:15], v[92:95], a[8:11], v[12:15]
    v_mfma_f32_16x16x32_bf16 v[8:11], v[88:91], a[12:15], v[8:11]
    v_mfma_f32_16x16x32_bf16 v[12:15], v[92:95], a[12:15], v[12:15]
    v_mfma_f32_16x16x32_bf16 v[8:11], v[88:91], a[16:19], v[8:11]
    v_mfma_f32_16x16x32_bf16 v[12:15], v[92:95], a[16:19], v[12:15]
    v_mfma_f32_16x16x32_bf16 v[8:11], v[88:91], a[20:23], v[8:11]
    v_mfma_f32_16x16x32_bf16 v[12:15], v[92:95], a[20:23], v[12:15]
    v_mfma_f32_16x16x32_bf16 v[8:11], v[88:91], a[24:27], v[8:11]
    v_mfma_f32_16x16x32_bf16 v[12:15], v[92:95], a[24:27], v[12:15]
    v_mfma_f32_16x16x32_bf16 v[8:11], v[88:91], a[28:31], v[8:11]
    v_mfma_f32_16x16x32_bf16 v[12:15], v[92:95], a[28:31], v[12:15]
    v_mfma_f32_16x16x32_bf16 v[8:11], v[88:91], a[32:35], v[8:11]
    v_mfma_f32_16x16x32_bf16 v[12:15], v[92:95], a[32:35], v[12:15]
    v_mfma_f32_16x16x32_bf16 v[8:11], v[88:91], a[36:39], v[8:11]
    v_mfma_f32_16x16x32_bf16 v[12:15], v[92:95], a[36:39], v[12:15]
    v_mfma_f32_16x16x32_bf16 v[8:11], v[88:91], a[40:43], v[8:11]
    v_mfma_f32_16x16x32_bf16 v[12:15], v[92:95], a[40:43], v[12:15]
    v_mfma_f32_16x16x32_bf16 v[8:11], v[88:91], a[44:47], v[8:11]
    v_mfma_f32_16x16x32_bf16 v[12:15], v[92:95], a[44:47], v[12:15]
    s_nop 7
    v_cvt_pk_bf16_f32 v16, v8, v9
    v_cvt_pk_bf16_f32 v17, v10, v11
    v_cvt_pk_bf16_f32 v18, v12, v13
    v_cvt_pk_bf16_f32 v19, v14, v15
    s_waitcnt lgkmcnt(0)
    v_lshlrev_b32 v44, 16, v16
    v_and_b32 v45, 0xffff0000, v16
    v_lshlrev_b32 v46, 16, v17
    v_and_b32 v47, 0xffff0000, v17
    v_lshlrev_b32 v48, 16, v18
    v_and_b32 v49, 0xffff0000, v18
    v_lshlrev_b32 v50, 16, v19
    v_and_b32 v51, 0xffff0000, v19
    v_lshlrev_b32 v52, 16, v228
    v_and_b32 v53, 0xffff0000, v228
    v_lshlrev_b32 v54, 16, v229
    v_and_b32 v55, 0xffff0000, v229
    v_lshlrev_b32 v56, 16, v230
    v_and_b32 v57, 0xffff0000, v230
    v_lshlrev_b32 v58, 16, v231
    v_and_b32 v59, 0xffff0000, v231
    v_pk_add_f32 v[44:45], v[44:45], v[52:53]
    v_pk_add_f32 v[46:47], v[46:47], v[54:55]
    v_pk_add_f32 v[48:49], v[48:49], v[56:57]
    v_pk_add_f32 v[50:51], v[50:51], v[58:59]
    v_cvt_pk_bf16_f32 v16, v44, v45
    v_cvt_pk_bf16_f32 v17, v46, v47
    v_cvt_pk_bf16_f32 v18, v48, v49
    v_cvt_pk_bf16_f32 v19, v50, v51
    v_lshlrev_b32 v44, 16, v16
    v_and_b32 v45, 0xffff0000, v16
    v_lshlrev_b32 v46, 16, v17
    v_and_b32 v47, 0xffff0000, v17
    v_lshlrev_b32 v48, 16, v18
    v_and_b32 v49, 0xffff0000, v18
    v_lshlrev_b32 v50, 16, v19
    v_and_b32 v51, 0xffff0000, v19
    v_mul_f32 v52, 0xbfb8aa3b, v44
    v_mul_f32 v53, 0xbfb8aa3b, v45
    v_mul_f32 v54, 0xbfb8aa3b, v46
    v_mul_f32 v55, 0xbfb8aa3b, v47
    v_mul_f32 v56, 0xbfb8aa3b, v48
    v_mul_f32 v57, 0xbfb8aa3b, v49
    v_mul_f32 v58, 0xbfb8aa3b, v50
    v_mul_f32 v59, 0xbfb8aa3b, v51
    v_exp_f32 v52, v52
    v_exp_f32 v53, v53
    v_exp_f32 v54, v54
    v_exp_f32 v55, v55
    v_exp_f32 v56, v56
    v_exp_f32 v57, v57
    v_exp_f32 v58, v58
    v_exp_f32 v59, v59
    v_add_f32 v52, 1.0, v52
    v_add_f32 v53, 1.0, v53
    v_add_f32 v54, 1.0, v54
    v_add_f32 v55, 1.0, v55
    v_add_f32 v56, 1.0, v56
    v_add_f32 v57, 1.0, v57
    v_add_f32 v58, 1.0, v58
    v_add_f32 v59, 1.0, v59
    v_rcp_f32 v52, v52
    v_rcp_f32 v53, v53
    v_rcp_f32 v54, v54
    v_rcp_f32 v55, v55
    v_rcp_f32 v56, v56
    v_rcp_f32 v57, v57
    v_rcp_f32 v58, v58
    v_rcp_f32 v59, v59
    s_nop 0
    v_pk_mul_f32 v[44:45], v[44:45], v[52:53]
    v_pk_mul_f32 v[46:47], v[46:47], v[54:55]
    v_pk_mul_f32 v[48:49], v[48:49], v[56:57]
    v_pk_mul_f32 v[50:51], v[50:51], v[58:59]
    v_cvt_pk_bf16_f32 v16, v44, v45
    v_cvt_pk_bf16_f32 v17, v46, v47
    v_cvt_pk_bf16_f32 v18, v48, v49
    v_cvt_pk_bf16_f32 v19, v50, v51
    v_lshlrev_b32 v44, 16, v16
    v_and_b32 v45, 0xffff0000, v16
    v_lshlrev_b32 v46, 16, v17
    v_and_b32 v47, 0xffff0000, v17
    v_lshlrev_b32 v48, 16, v18
    v_and_b32 v49, 0xffff0000, v18
    v_lshlrev_b32 v50, 16, v19
    v_and_b32 v51, 0xffff0000, v19
    v_lshlrev_b32 v52, 16, v20
    v_and_b32 v53, 0xffff0000, v20
    v_lshlrev_b32 v54, 16, v21
    v_and_b32 v55, 0xffff0000, v21
    v_lshlrev_b32 v56, 16, v22
    v_and_b32 v57, 0xffff0000, v22
    v_lshlrev_b32 v58, 16, v23
    v_and_b32 v59, 0xffff0000, v23
    v_pk_mul_f32 v[44:45], v[44:45], v[52:53]
    v_pk_mul_f32 v[46:47], v[46:47], v[54:55]
    v_pk_mul_f32 v[48:49], v[48:49], v[56:57]
    v_pk_mul_f32 v[50:51], v[50:51], v[58:59]
    v_cvt_pk_bf16_f32 v16, v44, v45
    v_cvt_pk_bf16_f32 v17, v46, v47
    v_cvt_pk_bf16_f32 v18, v48, v49
    v_cvt_pk_bf16_f32 v19, v50, v51
    v_lshlrev_b32 v44, 16, v16
    v_and_b32 v45, 0xffff0000, v16
    v_lshlrev_b32 v46, 16, v17
    v_and_b32 v47, 0xffff0000, v17
    v_lshlrev_b32 v48, 16, v18
    v_and_b32 v49, 0xffff0000, v18
    v_lshlrev_b32 v50, 16, v19
    v_and_b32 v51, 0xffff0000, v19
    v_lshlrev_b32 v52, 16, v64
    v_and_b32 v53, 0xffff0000, v64
    v_lshlrev_b32 v54, 16, v65
    v_and_b32 v55, 0xffff0000, v65
    v_lshlrev_b32 v56, 16, v66
    v_and_b32 v57, 0xffff0000, v66
    v_lshlrev_b32 v58, 16, v67
    v_and_b32 v59, 0xffff0000, v67
    v_pk_add_f32 v[44:45], v[44:45], v[52:53]
    v_pk_add_f32 v[46:47], v[46:47], v[54:55]
    v_pk_add_f32 v[48:49], v[48:49], v[56:57]
    v_pk_add_f32 v[50:51], v[50:51], v[58:59]
    v_cvt_pk_bf16_f32 v24, v44, v45
    v_cvt_pk_bf16_f32 v25, v46, v47
    v_cvt_pk_bf16_f32 v26, v48, v49
    v_cvt_pk_bf16_f32 v27, v50, v51
    buffer_store_dwordx4 v[24:27], v36, s[28:31], 0 offen offset:0
    s_add_u32 s4, s90, 4
    v_subrev_u32 v7, s4, v40
    v_cmp_le_u32 vcc, 12, v7
    s_nop 3
    s_cmp_eq_u64 vcc, 0
    s_cbranch_scc1 L_ok_30
    s_mov_b32 s69, 20000
    L_poll_29:
    buffer_load_dword v40, v37, s[16:19], 0 offen sc1
    s_waitcnt vmcnt(0)
    s_add_u32 s4, s90, 4
    v_subrev_u32 v7, s4, v40
    v_cmp_le_u32 vcc, 12, v7
    s_sub_u32 s69, s69, 1
    s_cbranch_scc1 L_ok_30
    s_nop 1
    s_cmp_eq_u64 vcc, 0
    s_cbranch_scc1 L_ok_30
    s_sleep 8
    s_branch L_poll_29
    L_ok_30:
    s_add_u32 s50, s97, 589824
    buffer_load_dwordx4 a[0:3], v38, s[16:19], s50 offen sc1
    s_add_u32 s50, s50, 16384
    buffer_load_dwordx4 a[4:7], v38, s[16:19], s50 offen sc1
    s_add_u32 s50, s50, 16384
    buffer_load_dwordx4 a[8:11], v38, s[16:19], s50 offen sc1
    s_add_u32 s50, s50, 16384
    buffer_load_dwordx4 a[12:15], v38, s[16:19], s50 offen sc1
    s_add_u32 s50, s50, 16384
    buffer_load_dwordx4 a[16:19], v38, s[16:19], s50 offen sc1
    s_add_u32 s50, s50, 16384
    buffer_load_dwordx4 a[20:23], v38, s[16:19], s50 offen sc1
    s_add_u32 s50, s50, 16384
    buffer_load_dwordx4 a[24:27], v38, s[16:19], s50 offen sc1
    s_add_u32 s50, s50, 16384
    buffer_load_dwordx4 a[28:31], v38, s[16:19], s50 offen sc1
    s_add_u32 s50, s50, 16384
    buffer_load_dwordx4 a[32:35], v38, s[16:19], s50 offen sc1
    s_add_u32 s50, s50, 16384
    buffer_load_dwordx4 a[36:39], v38, s[16:19], s50 offen sc1
    s_add_u32 s50, s50, 16384
    buffer_load_dwordx4 a[40:43], v38, s[16:19], s50 offen sc1
    s_add_u32 s50, s50, 16384
    buffer_load_dwordx4 a[44:47], v38, s[16:19], s50 offen sc1
    s_waitcnt vmcnt(24)
    ds_read_b64_tr_b16 v[20:21], v39 offset:1024
    ds_read_b64_tr_b16 v[22:23], v39 offset:1280
    v_mfma_f32_16x16x32_bf16 v[8:11], v[88:91], a[48:51], 0
    v_mfma_f32_16x16x32_bf16 v[12:15], v[92:95], a[48:51], 0
    v_mfma_f32_16x16x32_bf16 v[8:11], v[88:91], a[52:55], v[8:11]
    v_mfma_f32_16x16x32_bf16 v[12:15], v[92:95], a[52:55], v[12:15]
    v_mfma_f32_16x16x32_bf16 v[8:11], v[88:91], a[56:59], v[8:11]
    v_mfma_f32_16x16x32_bf16 v[12:15], v[92:95], a[56:59], v[12:15]
    v_mfma_f32_16x16x32_bf16 v[8:11], v[88:91], a[60:63], v[8:11]
    v_mfma_f32_16x16x32_bf16 v[12:15], v[92:95], a[60:63], v[12:15]
    v_mfma_f32_16x16x32_bf16 v[8:11], v[88:91], a[64:67], v[8:11]
    v_mfma_f32_16x16x32_bf16 v[12:15], v[92:95], a[64:67], v[12:15]
    v_mfma_f32_16x16x32_bf16 v[8:11], v[88:91], a[68:71], v[8:11]
    v_mfma_f32_16x16x32_bf16 v[12:15], v[92:95], a[68:71], v[12:15]
    v_mfma_f32_16x16x32_bf16 v[8:11], v[88:91], a[72:75], v[8:11]
    v_mfma_f32_16x16x32_bf16 v[12:15], v[92:95], a[72:75], v[12:15]
    v_mfma_f32_16x16x32_bf16 v[8:11], v[88:91], a[76:79], v[8:11]
    v_mfma_f32_16x16x32_bf16 v[12:15], v[92:95], a[76:79], v[12:15]
    v_mfma_f32_16x16x32_bf16 v[8:11], v[88:91], a[80:83], v[8:11]
    v_mfma_f32_16x16x32_bf16 v[12:15], v[92:95], a[80:83], v[12:15]
    v_mfma_f32_16x16x32_bf16 v[8:11], v[88:91], a[84:87], v[8:11]
    v_mfma_f32_16x16x32_bf16 v[12:15], v[92:95], a[84:87], v[12:15]
    v_mfma_f32_16x16x32_bf16 v[8:11], v[88:91], a[88:91], v[8:11]
    v_mfma_f32_16x16x32_bf16 v[12:15], v[92:95], a[88:91], v[12:15]
    v_mfma_f32_16x16x32_bf16 v[8:11], v[88:91], a[92:95], v[8:11]
    v_mfma_f32_16x16x32_bf16 v[12:15], v[92:95], a[92:95], v[12:15]
    s_nop 7
    v_cvt_pk_bf16_f32 v16, v8, v9
    v_cvt_pk_bf16_f32 v17, v10, v11
    v_cvt_pk_bf16_f32 v18, v12, v13
    v_cvt_pk_bf16_f32 v19, v14, v15
    s_waitcnt lgkmcnt(0)
    v_lshlrev_b32 v44, 16, v16
    v_and_b32 v45, 0xffff0000, v16
    v_lshlrev_b32 v46, 16, v17
    v_and_b32 v47, 0xffff0000, v17
    v_lshlrev_b32 v48, 16, v18
    v_and_b32 v49, 0xffff0000, v18
    v_lshlrev_b32 v50, 16, v19
    v_and_b32 v51, 0xffff0000, v19
    v_lshlrev_b32 v52, 16, v232
    v_and_b32 v53, 0xffff0000, v232
    v_lshlrev_b32 v54, 16, v233
    v_and_b32 v55, 0xffff0000, v233
    v_lshlrev_b32 v56, 16, v234
    v_and_b32 v57, 0xffff0000, v234
    v_lshlrev_b32 v58, 16, v235
    v_and_b32 v59, 0xffff0000, v235
    v_pk_add_f32 v[44:45], v[44:45], v[52:53]
    v_pk_add_f32 v[46:47], v[46:47], v[54:55]
    v_pk_add_f32 v[48:49], v[48:49], v[56:57]
    v_pk_add_f32 v[50:51], v[50:51], v[58:59]
    v_cvt_pk_bf16_f32 v16, v44, v45
    v_cvt_pk_bf16_f32 v17, v46, v47
    v_cvt_pk_bf16_f32 v18, v48, v49
    v_cvt_pk_bf16_f32 v19, v50, v51
    v_lshlrev_b32 v44, 16, v16
    v_and_b32 v45, 0xffff0000, v16
    v_lshlrev_b32 v46, 16, v17
    v_and_b32 v47, 0xffff0000, v17
    v_lshlrev_b32 v48, 16, v18
    v_and_b32 v49, 0xffff0000, v18
    v_lshlrev_b32 v50, 16, v19
    v_and_b32 v51, 0xffff0000, v19
    v_mul_f32 v52, 0xbfb8aa3b, v44
    v_mul_f32 v53, 0xbfb8aa3b, v45
    v_mul_f32 v54, 0xbfb8aa3b, v46
    v_mul_f32 v55, 0xbfb8aa3b, v47
    v_mul_f32 v56, 0xbfb8aa3b, v48
    v_mul_f32 v57, 0xbfb8aa3b, v49
    v_mul_f32 v58, 0xbfb8aa3b, v50
    v_mul_f32 v59, 0xbfb8aa3b, v51
    v_exp_f32 v52, v52
    v_exp_f32 v53, v53
    v_exp_f32 v54, v54
    v_exp_f32 v55, v55
    v_exp_f32 v56, v56
    v_exp_f32 v57, v57
    v_exp_f32 v58, v58
    v_exp_f32 v59, v59
    v_add_f32 v52, 1.0, v52
    v_add_f32 v53, 1.0, v53
    v_add_f32 v54, 1.0, v54
    v_add_f32 v55, 1.0, v55
    v_add_f32 v56, 1.0, v56
    v_add_f32 v57, 1.0, v57
    v_add_f32 v58, 1.0, v58
    v_add_f32 v59, 1.0, v59
    v_rcp_f32 v52, v52
    v_rcp_f32 v53, v53
    v_rcp_f32 v54, v54
    v_rcp_f32 v55, v55
    v_rcp_f32 v56, v56
    v_rcp_f32 v57, v57
    v_rcp_f32 v58, v58
    v_rcp_f32 v59, v59
    s_nop 0
    v_pk_mul_f32 v[44:45], v[44:45], v[52:53]
    v_pk_mul_f32 v[46:47], v[46:47], v[54:55]
    v_pk_mul_f32 v[48:49], v[48:49], v[56:57]
    v_pk_mul_f32 v[50:51], v[50:51], v[58:59]
    v_cvt_pk_bf16_f32 v16, v44, v45
    v_cvt_pk_bf16_f32 v17, v46, v47
    v_cvt_pk_bf16_f32 v18, v48, v49
    v_cvt_pk_bf16_f32 v19, v50, v51
    v_lshlrev_b32 v44, 16, v16
    v_and_b32 v45, 0xffff0000, v16
    v_lshlrev_b32 v46, 16, v17
    v_and_b32 v47, 0xffff0000, v17
    v_lshlrev_b32 v48, 16, v18
    v_and_b32 v49, 0xffff0000, v18
    v_lshlrev_b32 v50, 16, v19
    v_and_b32 v51, 0xffff0000, v19
    v_lshlrev_b32 v52, 16, v20
    v_and_b32 v53, 0xffff0000, v20
    v_lshlrev_b32 v54, 16, v21
    v_and_b32 v55, 0xffff0000, v21
    v_lshlrev_b32 v56, 16, v22
    v_and_b32 v57, 0xffff0000, v22
    v_lshlrev_b32 v58, 16, v23
    v_and_b32 v59, 0xffff0000, v23
    v_pk_mul_f32 v[44:45], v[44:45], v[52:53]
    v_pk_mul_f32 v[46:47], v[46:47], v[54:55]
    v_pk_mul_f32 v[48:49], v[48:49], v[56:57]
    v_pk_mul_f32 v[50:51], v[50:51], v[58:59]
    v_cvt_pk_bf16_f32 v16, v44, v45
    v_cvt_pk_bf16_f32 v17, v46, v47
    v_cvt_pk_bf16_f32 v18, v48, v49
    v_cvt_pk_bf16_f32 v19, v50, v51
    v_lshlrev_b32 v44, 16, v16
    v_and_b32 v45, 0xffff0000, v16
    v_lshlrev_b32 v46, 16, v17
    v_and_b32 v47, 0xffff0000, v17
    v_lshlrev_b32 v48, 16, v18
    v_and_b32 v49, 0xffff0000, v18
    v_lshlrev_b32 v50, 16, v19
    v_and_b32 v51, 0xffff0000, v19
    v_lshlrev_b32 v52, 16, v68
    v_and_b32 v53, 0xffff0000, v68
    v_lshlrev_b32 v54, 16, v69
    v_and_b32 v55, 0xffff0000, v69
    v_lshlrev_b32 v56, 16, v70
    v_and_b32 v57, 0xffff0000, v70
    v_lshlrev_b32 v58, 16, v71
    v_and_b32 v59, 0xffff0000, v71
    v_pk_add_f32 v[44:45], v[44:45], v[52:53]
    v_pk_add_f32 v[46:47], v[46:47], v[54:55]
    v_pk_add_f32 v[48:49], v[48:49], v[56:57]
    v_pk_add_f32 v[50:51], v[50:51], v[58:59]
    v_cvt_pk_bf16_f32 v24, v44, v45
    v_cvt_pk_bf16_f32 v25, v46, v47
    v_cvt_pk_bf16_f32 v26, v48, v49
    v_cvt_pk_bf16_f32 v27, v50, v51
    buffer_store_dwordx4 v[24:27], v36, s[28:31], 0 offen offset:128
    s_add_u32 s4, s90, 5
    v_subrev_u32 v7, s4, v40
    v_cmp_le_u32 vcc, 11, v7
    s_nop 3
    s_cmp_eq_u64 vcc, 0
    s_cbranch_scc1 L_ok_32
    s_mov_b32 s69, 20000
    L_poll_31:
    buffer_load_dword v40, v37, s[16:19], 0 offen sc1
    s_waitcnt vmcnt(0)
    s_add_u32 s4, s90, 5
    v_subrev_u32 v7, s4, v40
    v_cmp_le_u32 vcc, 11, v7
    s_sub_u32 s69, s69, 1
    s_cbranch_scc1 L_ok_32
    s_nop 1
    s_cmp_eq_u64 vcc, 0
    s_cbranch_scc1 L_ok_32
    s_sleep 8
    s_branch L_poll_31
    L_ok_32:
    s_add_u32 s50, s97, 786432
    buffer_load_dwordx4 a[48:51], v38, s[16:19], s50 offen sc1
    s_add_u32 s50, s50, 16384
    buffer_load_dwordx4 a[52:55], v38, s[16:19], s50 offen sc1
    s_add_u32 s50, s50, 16384
    buffer_load_dwordx4 a[56:59], v38, s[16:19], s50 offen sc1
    s_add_u32 s50, s50, 16384
    buffer_load_dwordx4 a[60:63], v38, s[16:19], s50 offen sc1
    s_add_u32 s50, s50, 16384
    buffer_load_dwordx4 a[64:67], v38, s[16:19], s50 offen sc1
    s_add_u32 s50, s50, 16384
    buffer_load_dwordx4 a[68:71], v38, s[16:19], s50 offen sc1
    s_add_u32 s50, s50, 16384
    buffer_load_dwordx4 a[72:75], v38, s[16:19], s50 offen sc1
    s_add_u32 s50, s50, 16384
    buffer_load_dwordx4 a[76:79], v38, s[16:19], s50 offen sc1
    s_add_u32 s50, s50, 16384
    buffer_load_dwordx4 a[80:83], v38, s[16:19], s50 offen sc1
    s_add_u32 s50, s50, 16384
    buffer_load_dwordx4 a[84:87], v38, s[16:19], s50 offen sc1
    s_add_u32 s50, s50, 16384
    buffer_load_dwordx4 a[88:91], v38, s[16:19], s50 offen sc1
    s_add_u32 s50, s50, 16384
    buffer_load_dwordx4 a[92:95], v38, s[16:19], s50 offen sc1
    s_waitcnt vmcnt(24)
    ds_read_b64_tr_b16 v[20:21], v39 offset:2048
    ds_read_b64_tr_b16 v[22:23], v39 offset:2304
    v_mfma_f32_16x16x32_bf16 v[8:11], v[88:91], a[96:99], 0
    v_mfma_f32_16x16x32_bf16 v[12:15], v[92:95], a[96:99], 0
    v_mfma_f32_16x16x32_bf16 v[8:11], v[88:91], a[100:103], v[8:11]
    v_mfma_f32_16x16x32_bf16 v[12:15], v[92:95], a[100:103], v[12:15]
    v_mfma_f32_16x16x32_bf16 v[8:11], v[88:91], a[104:107], v[8:11]
    v_mfma_f32_16x16x32_bf16 v[12:15], v[92:95], a[104:107], v[12:15]
    v_mfma_f32_16x16x32_bf16 v[8:11], v[88:91], a[108:111], v[8:11]
    v_mfma_f32_16x16x32_bf16 v[12:15], v[92:95], a[108:111], v[12:15]
    v_mfma_f32_16x16x32_bf16 v[8:11], v[88:91], a[112:115], v[8:11]
    v_mfma_f32_16x16x32_bf16 v[12:15], v[92:95], a[112:115], v[12:15]
    v_mfma_f32_16x16x32_bf16 v[8:11], v[88:91], a[116:119], v[8:11]
    v_mfma_f32_16x16x32_bf16 v[12:15], v[92:95], a[116:119], v[12:15]
    v_mfma_f32_16x16x32_bf16 v[8:11], v[88:91], a[120:123], v[8:11]
    v_mfma_f32_16x16x32_bf16 v[12:15], v[92:95], a[120:123], v[12:15]
    v_mfma_f32_16x16x32_bf16 v[8:11], v[88:91], a[124:127], v[8:11]
    v_mfma_f32_16x16x32_bf16 v[12:15], v[92:95], a[124:127], v[12:15]
    v_mfma_f32_16x16x32_bf16 v[8:11], v[88:91], a[128:131], v[8:11]
    v_mfma_f32_16x16x32_bf16 v[12:15], v[92:95], a[128:131], v[12:15]
    v_mfma_f32_16x16x32_bf16 v[8:11], v[88:91], a[132:135], v[8:11]
    v_mfma_f32_16x16x32_bf16 v[12:15], v[92:95], a[132:135], v[12:15]
    v_mfma_f32_16x16x32_bf16 v[8:11], v[88:91], a[136:139], v[8:11]
    v_mfma_f32_16x16x32_bf16 v[12:15], v[92:95], a[136:139], v[12:15]
    v_mfma_f32_16x16x32_bf16 v[8:11], v[88:91], a[140:143], v[8:11]
    v_mfma_f32_16x16x32_bf16 v[12:15], v[92:95], a[140:143], v[12:15]
    s_nop 7
    v_cvt_pk_bf16_f32 v16, v8, v9
    v_cvt_pk_bf16_f32 v17, v10, v11
    v_cvt_pk_bf16_f32 v18, v12, v13
    v_cvt_pk_bf16_f32 v19, v14, v15
    s_waitcnt lgkmcnt(0)
    v_lshlrev_b32 v44, 16, v16
    v_and_b32 v45, 0xffff0000, v16
    v_lshlrev_b32 v46, 16, v17
    v_and_b32 v47, 0xffff0000, v17
    v_lshlrev_b32 v48, 16, v18
    v_and_b32 v49, 0xffff0000, v18
    v_lshlrev_b32 v50, 16, v19
    v_and_b32 v51, 0xffff0000, v19
    v_lshlrev_b32 v52, 16, v236
    v_and_b32 v53, 0xffff0000, v236
    v_lshlrev_b32 v54, 16, v237
    v_and_b32 v55, 0xffff0000, v237
    v_lshlrev_b32 v56, 16, v238
    v_and_b32 v57, 0xffff0000, v238
    v_lshlrev_b32 v58, 16, v239
    v_and_b32 v59, 0xffff0000, v239
    v_pk_add_f32 v[44:45], v[44:45], v[52:53]
    v_pk_add_f32 v[46:47], v[46:47], v[54:55]
    v_pk_add_f32 v[48:49], v[48:49], v[56:57]
    v_pk_add_f32 v[50:51], v[50:51], v[58:59]
    v_cvt_pk_bf16_f32 v16, v44, v45
    v_cvt_pk_bf16_f32 v17, v46, v47
    v_cvt_pk_bf16_f32 v18, v48, v49
    v_cvt_pk_bf16_f32 v19, v50, v51
    v_lshlrev_b32 v44, 16, v16
    v_and_b32 v45, 0xffff0000, v16
    v_lshlrev_b32 v46, 16, v17
    v_and_b32 v47, 0xffff0000, v17
    v_lshlrev_b32 v48, 16, v18
    v_and_b32 v49, 0xffff0000, v18
    v_lshlrev_b32 v50, 16, v19
    v_and_b32 v51, 0xffff0000, v19
    v_mul_f32 v52, 0xbfb8aa3b, v44
    v_mul_f32 v53, 0xbfb8aa3b, v45
    v_mul_f32 v54, 0xbfb8aa3b, v46
    v_mul_f32 v55, 0xbfb8aa3b, v47
    v_mul_f32 v56, 0xbfb8aa3b, v48
    v_mul_f32 v57, 0xbfb8aa3b, v49
    v_mul_f32 v58, 0xbfb8aa3b, v50
    v_mul_f32 v59, 0xbfb8aa3b, v51
    v_exp_f32 v52, v52
    v_exp_f32 v53, v53
    v_exp_f32 v54, v54
    v_exp_f32 v55, v55
    v_exp_f32 v56, v56
    v_exp_f32 v57, v57
    v_exp_f32 v58, v58
    v_exp_f32 v59, v59
    v_add_f32 v52, 1.0, v52
    v_add_f32 v53, 1.0, v53
    v_add_f32 v54, 1.0, v54
    v_add_f32 v55, 1.0, v55
    v_add_f32 v56, 1.0, v56
    v_add_f32 v57, 1.0, v57
    v_add_f32 v58, 1.0, v58
    v_add_f32 v59, 1.0, v59
    v_rcp_f32 v52, v52
    v_rcp_f32 v53, v53
    v_rcp_f32 v54, v54
    v_rcp_f32 v55, v55
    v_rcp_f32 v56, v56
    v_rcp_f32 v57, v57
    v_rcp_f32 v58, v58
    v_rcp_f32 v59, v59
    s_nop 0
    v_pk_mul_f32 v[44:45], v[44:45], v[52:53]
    v_pk_mul_f32 v[46:47], v[46:47], v[54:55]
    v_pk_mul_f32 v[48:49], v[48:49], v[56:57]
    v_pk_mul_f32 v[50:51], v[50:51], v[58:59]
    v_cvt_pk_bf16_f32 v16, v44, v45
    v_cvt_pk_bf16_f32 v17, v46, v47
    v_cvt_pk_bf16_f32 v18, v48, v49
    v_cvt_pk_bf16_f32 v19, v50, v51
    v_lshlrev_b32 v44, 16, v16
    v_and_b32 v45, 0xffff0000, v16
    v_lshlrev_b32 v46, 16, v17
    v_and_b32 v47, 0xffff0000, v17
    v_lshlrev_b32 v48, 16, v18
    v_and_b32 v49, 0xffff0000, v18
    v_lshlrev_b32 v50, 16, v19
    v_and_b32 v51, 0xffff0000, v19
    v_lshlrev_b32 v52, 16, v20
    v_and_b32 v53, 0xffff0000, v20
    v_lshlrev_b32 v54, 16, v21
    v_and_b32 v55, 0xffff0000, v21
    v_lshlrev_b32 v56, 16, v22
    v_and_b32 v57, 0xffff0000, v22
    v_lshlrev_b32 v58, 16, v23
    v_and_b32 v59, 0xffff0000, v23
    v_pk_mul_f32 v[44:45], v[44:45], v[52:53]
    v_pk_mul_f32 v[46:47], v[46:47], v[54:55]
    v_pk_mul_f32 v[48:49], v[48:49], v[56:57]
    v_pk_mul_f32 v[50:51], v[50:51], v[58:59]
    v_cvt_pk_bf16_f32 v16, v44, v45
    v_cvt_pk_bf16_f32 v17, v46, v47
    v_cvt_pk_bf16_f32 v18, v48, v49
    v_cvt_pk_bf16_f32 v19, v50, v51
    v_lshlrev_b32 v44, 16, v16
    v_and_b32 v45, 0xffff0000, v16
    v_lshlrev_b32 v46, 16, v17
    v_and_b32 v47, 0xffff0000, v17
    v_lshlrev_b32 v48, 16, v18
    v_and_b32 v49, 0xffff0000, v18
    v_lshlrev_b32 v50, 16, v19
    v_and_b32 v51, 0xffff0000, v19
    v_lshlrev_b32 v52, 16, v72
    v_and_b32 v53, 0xffff0000, v72
    v_lshlrev_b32 v54, 16, v73
    v_and_b32 v55, 0xffff0000, v73
    v_lshlrev_b32 v56, 16, v74
    v_and_b32 v57, 0xffff0000, v74
    v_lshlrev_b32 v58, 16, v75
    v_and_b32 v59, 0xffff0000, v75
    v_pk_add_f32 v[44:45], v[44:45], v[52:53]
    v_pk_add_f32 v[46:47], v[46:47], v[54:55]
    v_pk_add_f32 v[48:49], v[48:49], v[56:57]
    v_pk_add_f32 v[50:51], v[50:51], v[58:59]
    v_cvt_pk_bf16_f32 v24, v44, v45
    v_cvt_pk_bf16_f32 v25, v46, v47
    v_cvt_pk_bf16_f32 v26, v48, v49
    v_cvt_pk_bf16_f32 v27, v50, v51
    buffer_store_dwordx4 v[24:27], v36, s[28:31], 0 offen offset:256
    s_add_u32 s4, s90, 6
    v_subrev_u32 v7, s4, v40
    v_cmp_le_u32 vcc, 10, v7
    s_nop 3
    s_cmp_eq_u64 vcc, 0
    s_cbranch_scc1 L_ok_34
    s_mov_b32 s69, 20000
    L_poll_33:
    buffer_load_dword v40, v37, s[16:19], 0 offen sc1
    s_waitcnt vmcnt(0)
    s_add_u32 s4, s90, 6
    v_subrev_u32 v7, s4, v40
    v_cmp_le_u32 vcc, 10, v7
    s_sub_u32 s69, s69, 1
    s_cbranch_scc1 L_ok_34
    s_nop 1
    s_cmp_eq_u64 vcc, 0
    s_cbranch_scc1 L_ok_34
    s_sleep 8
    s_branch L_poll_33
    L_ok_34:
    s_add_u32 s50, s97, 983040
    buffer_load_dwordx4 a[96:99], v38, s[16:19], s50 offen sc1
    s_add_u32 s50, s50, 16384
    buffer_load_dwordx4 a[100:103], v38, s[16:19], s50 offen sc1
    s_add_u32 s50, s50, 16384
    buffer_load_dwordx4 a[104:107], v38, s[16:19], s50 offen sc1
    s_add_u32 s50, s50, 16384
    buffer_load_dwordx4 a[108:111], v38, s[16:19], s50 offen sc1
    s_add_u32 s50, s50, 16384
    buffer_load_dwordx4 a[112:115], v38, s[16:19], s50 offen sc1
    s_add_u32 s50, s50, 16384
    buffer_load_dwordx4 a[116:119], v38, s[16:19], s50 offen sc1
    s_add_u32 s50, s50, 16384
    buffer_load_dwordx4 a[120:123], v38, s[16:19], s50 offen sc1
    s_add_u32 s50, s50, 16384
    buffer_load_dwordx4 a[124:127], v38, s[16:19], s50 offen sc1
    s_add_u32 s50, s50, 16384
    buffer_load_dwordx4 a[128:131], v38, s[16:19], s50 offen sc1
    s_add_u32 s50, s50, 16384
    buffer_load_dwordx4 a[132:135], v38, s[16:19], s50 offen sc1
    s_add_u32 s50, s50, 16384
    buffer_load_dwordx4 a[136:139], v38, s[16:19], s50 offen sc1
    s_add_u32 s50, s50, 16384
    buffer_load_dwordx4 a[140:143], v38, s[16:19], s50 offen sc1
    s_waitcnt vmcnt(24)
    ds_read_b64_tr_b16 v[20:21], v39 offset:3072
    ds_read_b64_tr_b16 v[22:23], v39 offset:3328
    v_mfma_f32_16x16x32_bf16 v[8:11], v[88:91], a[0:3], 0
    v_mfma_f32_16x16x32_bf16 v[12:15], v[92:95], a[0:3], 0
    v_mfma_f32_16x16x32_bf16 v[8:11], v[88:91], a[4:7], v[8:11]
    v_mfma_f32_16x16x32_bf16 v[12:15], v[92:95], a[4:7], v[12:15]
    v_mfma_f32_16x16x32_bf16 v[8:11], v[88:91], a[8:11], v[8:11]
    v_mfma_f32_16x16x32_bf16 v[12:15], v[92:95], a[8:11], v[12:15]
    v_mfma_f32_16x16x32_bf16 v[8:11], v[88:91], a[12:15], v[8:11]
    v_mfma_f32_16x16x32_bf16 v[12:15], v[92:95], a[12:15], v[12:15]
    v_mfma_f32_16x16x32_bf16 v[8:11], v[88:91], a[16:19], v[8:11]
    v_mfma_f32_16x16x32_bf16 v[12:15], v[92:95], a[16:19], v[12:15]
    v_mfma_f32_16x16x32_bf16 v[8:11], v[88:91], a[20:23], v[8:11]
    v_mfma_f32_16x16x32_bf16 v[12:15], v[92:95], a[20:23], v[12:15]
    v_mfma_f32_16x16x32_bf16 v[8:11], v[88:91], a[24:27], v[8:11]
    v_mfma_f32_16x16x32_bf16 v[12:15], v[92:95], a[24:27], v[12:15]
    v_mfma_f32_16x16x32_bf16 v[8:11], v[88:91], a[28:31], v[8:11]
    v_mfma_f32_16x16x32_bf16 v[12:15], v[92:95], a[28:31], v[12:15]
    v_mfma_f32_16x16x32_bf16 v[8:11], v[88:91], a[32:35], v[8:11]
    v_mfma_f32_16x16x32_bf16 v[12:15], v[92:95], a[32:35], v[12:15]
    v_mfma_f32_16x16x32_bf16 v[8:11], v[88:91], a[36:39], v[8:11]
    v_mfma_f32_16x16x32_bf16 v[12:15], v[92:95], a[36:39], v[12:15]
    v_mfma_f32_16x16x32_bf16 v[8:11], v[88:91], a[40:43], v[8:11]
    v_mfma_f32_16x16x32_bf16 v[12:15], v[92:95], a[40:43], v[12:15]
    v_mfma_f32_16x16x32_bf16 v[8:11], v[88:91], a[44:47], v[8:11]
    v_mfma_f32_16x16x32_bf16 v[12:15], v[92:95], a[44:47], v[12:15]
    s_nop 7
    v_cvt_pk_bf16_f32 v16, v8, v9
    v_cvt_pk_bf16_f32 v17, v10, v11
    v_cvt_pk_bf16_f32 v18, v12, v13
    v_cvt_pk_bf16_f32 v19, v14, v15
    s_waitcnt lgkmcnt(0)
    v_lshlrev_b32 v44, 16, v16
    v_and_b32 v45, 0xffff0000, v16
    v_lshlrev_b32 v46, 16, v17
    v_and_b32 v47, 0xffff0000, v17
    v_lshlrev_b32 v48, 16, v18
    v_and_b32 v49, 0xffff0000, v18
    v_lshlrev_b32 v50, 16, v19
    v_and_b32 v51, 0xffff0000, v19
    v_lshlrev_b32 v52, 16, v240
    v_and_b32 v53, 0xffff0000, v240
    v_lshlrev_b32 v54, 16, v241
    v_and_b32 v55, 0xffff0000, v241
    v_lshlrev_b32 v56, 16, v242
    v_and_b32 v57, 0xffff0000, v242
    v_lshlrev_b32 v58, 16, v243
    v_and_b32 v59, 0xffff0000, v243
    v_pk_add_f32 v[44:45], v[44:45], v[52:53]
    v_pk_add_f32 v[46:47], v[46:47], v[54:55]
    v_pk_add_f32 v[48:49], v[48:49], v[56:57]
    v_pk_add_f32 v[50:51], v[50:51], v[58:59]
    v_cvt_pk_bf16_f32 v16, v44, v45
    v_cvt_pk_bf16_f32 v17, v46, v47
    v_cvt_pk_bf16_f32 v18, v48, v49
    v_cvt_pk_bf16_f32 v19, v50, v51
    v_lshlrev_b32 v44, 16, v16
    v_and_b32 v45, 0xffff0000, v16
    v_lshlrev_b32 v46, 16, v17
    v_and_b32 v47, 0xffff0000, v17
    v_lshlrev_b32 v48, 16, v18
    v_and_b32 v49, 0xffff0000, v18
    v_lshlrev_b32 v50, 16, v19
    v_and_b32 v51, 0xffff0000, v19
    v_mul_f32 v52, 0xbfb8aa3b, v44
    v_mul_f32 v53, 0xbfb8aa3b, v45
    v_mul_f32 v54, 0xbfb8aa3b, v46
    v_mul_f32 v55, 0xbfb8aa3b, v47
    v_mul_f32 v56, 0xbfb8aa3b, v48
    v_mul_f32 v57, 0xbfb8aa3b, v49
    v_mul_f32 v58, 0xbfb8aa3b, v50
    v_mul_f32 v59, 0xbfb8aa3b, v51
    v_exp_f32 v52, v52
    v_exp_f32 v53, v53
    v_exp_f32 v54, v54
    v_exp_f32 v55, v55
    v_exp_f32 v56, v56
    v_exp_f32 v57, v57
    v_exp_f32 v58, v58
    v_exp_f32 v59, v59
    v_add_f32 v52, 1.0, v52
    v_add_f32 v53, 1.0, v53
    v_add_f32 v54, 1.0, v54
    v_add_f32 v55, 1.0, v55
    v_add_f32 v56, 1.0, v56
    v_add_f32 v57, 1.0, v57
    v_add_f32 v58, 1.0, v58
    v_add_f32 v59, 1.0, v59
    v_rcp_f32 v52, v52
    v_rcp_f32 v53, v53
    v_rcp_f32 v54, v54
    v_rcp_f32 v55, v55
    v_rcp_f32 v56, v56
    v_rcp_f32 v57, v57
    v_rcp_f32 v58, v58
    v_rcp_f32 v59, v59
    s_nop 0
    v_pk_mul_f32 v[44:45], v[44:45], v[52:53]
    v_pk_mul_f32 v[46:47], v[46:47], v[54:55]
    v_pk_mul_f32 v[48:49], v[48:49], v[56:57]
    v_pk_mul_f32 v[50:51], v[50:51], v[58:59]
    v_cvt_pk_bf16_f32 v16, v44, v45
    v_cvt_pk_bf16_f32 v17, v46, v47
    v_cvt_pk_bf16_f32 v18, v48, v49
    v_cvt_pk_bf16_f32 v19, v50, v51
    v_lshlrev_b32 v44, 16, v16
    v_and_b32 v45, 0xffff0000, v16
    v_lshlrev_b32 v46, 16, v17
    v_and_b32 v47, 0xffff0000, v17
    v_lshlrev_b32 v48, 16, v18
    v_and_b32 v49, 0xffff0000, v18
    v_lshlrev_b32 v50, 16, v19
    v_and_b32 v51, 0xffff0000, v19
    v_lshlrev_b32 v52, 16, v20
    v_and_b32 v53, 0xffff0000, v20
    v_lshlrev_b32 v54, 16, v21
    v_and_b32 v55, 0xffff0000, v21
    v_lshlrev_b32 v56, 16, v22
    v_and_b32 v57, 0xffff0000, v22
    v_lshlrev_b32 v58, 16, v23
    v_and_b32 v59, 0xffff0000, v23
    v_pk_mul_f32 v[44:45], v[44:45], v[52:53]
    v_pk_mul_f32 v[46:47], v[46:47], v[54:55]
    v_pk_mul_f32 v[48:49], v[48:49], v[56:57]
    v_pk_mul_f32 v[50:51], v[50:51], v[58:59]
    v_cvt_pk_bf16_f32 v16, v44, v45
    v_cvt_pk_bf16_f32 v17, v46, v47
    v_cvt_pk_bf16_f32 v18, v48, v49
    v_cvt_pk_bf16_f32 v19, v50, v51
    v_lshlrev_b32 v44, 16, v16
    v_and_b32 v45, 0xffff0000, v16
    v_lshlrev_b32 v46, 16, v17
    v_and_b32 v47, 0xffff0000, v17
    v_lshlrev_b32 v48, 16, v18
    v_and_b32 v49, 0xffff0000, v18
    v_lshlrev_b32 v50, 16, v19
    v_and_b32 v51, 0xffff0000, v19
    v_lshlrev_b32 v52, 16, v76
    v_and_b32 v53, 0xffff0000, v76
    v_lshlrev_b32 v54, 16, v77
    v_and_b32 v55, 0xffff0000, v77
    v_lshlrev_b32 v56, 16, v78
    v_and_b32 v57, 0xffff0000, v78
    v_lshlrev_b32 v58, 16, v79
    v_and_b32 v59, 0xffff0000, v79
    v_pk_add_f32 v[44:45], v[44:45], v[52:53]
    v_pk_add_f32 v[46:47], v[46:47], v[54:55]
    v_pk_add_f32 v[48:49], v[48:49], v[56:57]
    v_pk_add_f32 v[50:51], v[50:51], v[58:59]
    v_cvt_pk_bf16_f32 v24, v44, v45
    v_cvt_pk_bf16_f32 v25, v46, v47
    v_cvt_pk_bf16_f32 v26, v48, v49
    v_cvt_pk_bf16_f32 v27, v50, v51
    buffer_store_dwordx4 v[24:27], v36, s[28:31], 0 offen offset:384
    s_waitcnt vmcnt(12)
    ds_read_b64_tr_b16 v[20:21], v39 offset:4096
    ds_read_b64_tr_b16 v[22:23], v39 offset:4352
    v_mfma_f32_16x16x32_bf16 v[8:11], v[88:91], a[48:51], 0
    v_mfma_f32_16x16x32_bf16 v[12:15], v[92:95], a[48:51], 0
    v_mfma_f32_16x16x32_bf16 v[8:11], v[88:91], a[52:55], v[8:11]
    v_mfma_f32_16x16x32_bf16 v[12:15], v[92:95], a[52:55], v[12:15]
    v_mfma_f32_16x16x32_bf16 v[8:11], v[88:91], a[56:59], v[8:11]
    v_mfma_f32_16x16x32_bf16 v[12:15], v[92:95], a[56:59], v[12:15]
    v_mfma_f32_16x16x32_bf16 v[8:11], v[88:91], a[60:63], v[8:11]
    v_mfma_f32_16x16x32_bf16 v[12:15], v[92:95], a[60:63], v[12:15]
    v_mfma_f32_16x16x32_bf16 v[8:11], v[88:91], a[64:67], v[8:11]
    v_mfma_f32_16x16x32_bf16 v[12:15], v[92:95], a[64:67], v[12:15]
    v_mfma_f32_16x16x32_bf16 v[8:11], v[88:91], a[68:71], v[8:11]
    v_mfma_f32_16x16x32_bf16 v[12:15], v[92:95], a[68:71], v[12:15]
    v_mfma_f32_16x16x32_bf16 v[8:11], v[88:91], a[72:75], v[8:11]
    v_mfma_f32_16x16x32_bf16 v[12:15], v[92:95], a[72:75], v[12:15]
    v_mfma_f32_16x16x32_bf16 v[8:11], v[88:91], a[76:79], v[8:11]
    v_mfma_f32_16x16x32_bf16 v[12:15], v[92:95], a[76:79], v[12:15]
    v_mfma_f32_16x16x32_bf16 v[8:11], v[88:91], a[80:83], v[8:11]
    v_mfma_f32_16x16x32_bf16 v[12:15], v[92:95], a[80:83], v[12:15]
    v_mfma_f32_16x16x32_bf16 v[8:11], v[88:91], a[84:87], v[8:11]
    v_mfma_f32_16x16x32_bf16 v[12:15], v[92:95], a[84:87], v[12:15]
    v_mfma_f32_16x16x32_bf16 v[8:11], v[88:91], a[88:91], v[8:11]
    v_mfma_f32_16x16x32_bf16 v[12:15], v[92:95], a[88:91], v[12:15]
    v_mfma_f32_16x16x32_bf16 v[8:11], v[88:91], a[92:95], v[8:11]
    v_mfma_f32_16x16x32_bf16 v[12:15], v[92:95], a[92:95], v[12:15]
    s_nop 7
    v_cvt_pk_bf16_f32 v16, v8, v9
    v_cvt_pk_bf16_f32 v17, v10, v11
    v_cvt_pk_bf16_f32 v18, v12, v13
    v_cvt_pk_bf16_f32 v19, v14, v15
    s_waitcnt lgkmcnt(0)
    v_lshlrev_b32 v44, 16, v16
    v_and_b32 v45, 0xffff0000, v16
    v_lshlrev_b32 v46, 16, v17
    v_and_b32 v47, 0xffff0000, v17
    v_lshlrev_b32 v48, 16, v18
    v_and_b32 v49, 0xffff0000, v18
    v_lshlrev_b32 v50, 16, v19
    v_and_b32 v51, 0xffff0000, v19
    v_lshlrev_b32 v52, 16, v244
    v_and_b32 v53, 0xffff0000, v244
    v_lshlrev_b32 v54, 16, v245
    v_and_b32 v55, 0xffff0000, v245
    v_lshlrev_b32 v56, 16, v246
    v_and_b32 v57, 0xffff0000, v246
    v_lshlrev_b32 v58, 16, v247
    v_and_b32 v59, 0xffff0000, v247
    v_pk_add_f32 v[44:45], v[44:45], v[52:53]
    v_pk_add_f32 v[46:47], v[46:47], v[54:55]
    v_pk_add_f32 v[48:49], v[48:49], v[56:57]
    v_pk_add_f32 v[50:51], v[50:51], v[58:59]
    v_cvt_pk_bf16_f32 v16, v44, v45
    v_cvt_pk_bf16_f32 v17, v46, v47
    v_cvt_pk_bf16_f32 v18, v48, v49
    v_cvt_pk_bf16_f32 v19, v50, v51
    v_lshlrev_b32 v44, 16, v16
    v_and_b32 v45, 0xffff0000, v16
    v_lshlrev_b32 v46, 16, v17
    v_and_b32 v47, 0xffff0000, v17
    v_lshlrev_b32 v48, 16, v18
    v_and_b32 v49, 0xffff0000, v18
    v_lshlrev_b32 v50, 16, v19
    v_and_b32 v51, 0xffff0000, v19
    v_mul_f32 v52, 0xbfb8aa3b, v44
    v_mul_f32 v53, 0xbfb8aa3b, v45
    v_mul_f32 v54, 0xbfb8aa3b, v46
    v_mul_f32 v55, 0xbfb8aa3b, v47
    v_mul_f32 v56, 0xbfb8aa3b, v48
    v_mul_f32 v57, 0xbfb8aa3b, v49
    v_mul_f32 v58, 0xbfb8aa3b, v50
    v_mul_f32 v59, 0xbfb8aa3b, v51
    v_exp_f32 v52, v52
    v_exp_f32 v53, v53
    v_exp_f32 v54, v54
    v_exp_f32 v55, v55
    v_exp_f32 v56, v56
    v_exp_f32 v57, v57
    v_exp_f32 v58, v58
    v_exp_f32 v59, v59
    v_add_f32 v52, 1.0, v52
    v_add_f32 v53, 1.0, v53
    v_add_f32 v54, 1.0, v54
    v_add_f32 v55, 1.0, v55
    v_add_f32 v56, 1.0, v56
    v_add_f32 v57, 1.0, v57
    v_add_f32 v58, 1.0, v58
    v_add_f32 v59, 1.0, v59
    v_rcp_f32 v52, v52
    v_rcp_f32 v53, v53
    v_rcp_f32 v54, v54
    v_rcp_f32 v55, v55
    v_rcp_f32 v56, v56
    v_rcp_f32 v57, v57
    v_rcp_f32 v58, v58
    v_rcp_f32 v59, v59
    s_nop 0
    v_pk_mul_f32 v[44:45], v[44:45], v[52:53]
    v_pk_mul_f32 v[46:47], v[46:47], v[54:55]
    v_pk_mul_f32 v[48:49], v[48:49], v[56:57]
    v_pk_mul_f32 v[50:51], v[50:51], v[58:59]
    v_cvt_pk_bf16_f32 v16, v44, v45
    v_cvt_pk_bf16_f32 v17, v46, v47
    v_cvt_pk_bf16_f32 v18, v48, v49
    v_cvt_pk_bf16_f32 v19, v50, v51
    v_lshlrev_b32 v44, 16, v16
    v_and_b32 v45, 0xffff0000, v16
    v_lshlrev_b32 v46, 16, v17
    v_and_b32 v47, 0xffff0000, v17
    v_lshlrev_b32 v48, 16, v18
    v_and_b32 v49, 0xffff0000, v18
    v_lshlrev_b32 v50, 16, v19
    v_and_b32 v51, 0xffff0000, v19
    v_lshlrev_b32 v52, 16, v20
    v_and_b32 v53, 0xffff0000, v20
    v_lshlrev_b32 v54, 16, v21
    v_and_b32 v55, 0xffff0000, v21
    v_lshlrev_b32 v56, 16, v22
    v_and_b32 v57, 0xffff0000, v22
    v_lshlrev_b32 v58, 16, v23
    v_and_b32 v59, 0xffff0000, v23
    v_pk_mul_f32 v[44:45], v[44:45], v[52:53]
    v_pk_mul_f32 v[46:47], v[46:47], v[54:55]
    v_pk_mul_f32 v[48:49], v[48:49], v[56:57]
    v_pk_mul_f32 v[50:51], v[50:51], v[58:59]
    v_cvt_pk_bf16_f32 v16, v44, v45
    v_cvt_pk_bf16_f32 v17, v46, v47
    v_cvt_pk_bf16_f32 v18, v48, v49
    v_cvt_pk_bf16_f32 v19, v50, v51
    v_lshlrev_b32 v44, 16, v16
    v_and_b32 v45, 0xffff0000, v16
    v_lshlrev_b32 v46, 16, v17
    v_and_b32 v47, 0xffff0000, v17
    v_lshlrev_b32 v48, 16, v18
    v_and_b32 v49, 0xffff0000, v18
    v_lshlrev_b32 v50, 16, v19
    v_and_b32 v51, 0xffff0000, v19
    v_lshlrev_b32 v52, 16, v80
    v_and_b32 v53, 0xffff0000, v80
    v_lshlrev_b32 v54, 16, v81
    v_and_b32 v55, 0xffff0000, v81
    v_lshlrev_b32 v56, 16, v82
    v_and_b32 v57, 0xffff0000, v82
    v_lshlrev_b32 v58, 16, v83
    v_and_b32 v59, 0xffff0000, v83
    v_pk_add_f32 v[44:45], v[44:45], v[52:53]
    v_pk_add_f32 v[46:47], v[46:47], v[54:55]
    v_pk_add_f32 v[48:49], v[48:49], v[56:57]
    v_pk_add_f32 v[50:51], v[50:51], v[58:59]
    v_cvt_pk_bf16_f32 v24, v44, v45
    v_cvt_pk_bf16_f32 v25, v46, v47
    v_cvt_pk_bf16_f32 v26, v48, v49
    v_cvt_pk_bf16_f32 v27, v50, v51
    buffer_store_dwordx4 v[24:27], v36, s[28:31], 0 offen offset:512
    s_waitcnt vmcnt(0)
    ds_read_b64_tr_b16 v[20:21], v39 offset:5120
    ds_read_b64_tr_b16 v[22:23], v39 offset:5376
    v_mfma_f32_16x16x32_bf16 v[8:11], v[88:91], a[96:99], 0
    v_mfma_f32_16x16x32_bf16 v[12:15], v[92:95], a[96:99], 0
    v_mfma_f32_16x16x32_bf16 v[8:11], v[88:91], a[100:103], v[8:11]
    v_mfma_f32_16x16x32_bf16 v[12:15], v[92:95], a[100:103], v[12:15]
    v_mfma_f32_16x16x32_bf16 v[8:11], v[88:91], a[104:107], v[8:11]
    v_mfma_f32_16x16x32_bf16 v[12:15], v[92:95], a[104:107], v[12:15]
    v_mfma_f32_16x16x32_bf16 v[8:11], v[88:91], a[108:111], v[8:11]
    v_mfma_f32_16x16x32_bf16 v[12:15], v[92:95], a[108:111], v[12:15]
    v_mfma_f32_16x16x32_bf16 v[8:11], v[88:91], a[112:115], v[8:11]
    v_mfma_f32_16x16x32_bf16 v[12:15], v[92:95], a[112:115], v[12:15]
    v_mfma_f32_16x16x32_bf16 v[8:11], v[88:91], a[116:119], v[8:11]
    v_mfma_f32_16x16x32_bf16 v[12:15], v[92:95], a[116:119], v[12:15]
    v_mfma_f32_16x16x32_bf16 v[8:11], v[88:91], a[120:123], v[8:11]
    v_mfma_f32_16x16x32_bf16 v[12:15], v[92:95], a[120:123], v[12:15]
    v_mfma_f32_16x16x32_bf16 v[8:11], v[88:91], a[124:127], v[8:11]
    v_mfma_f32_16x16x32_bf16 v[12:15], v[92:95], a[124:127], v[12:15]
    v_mfma_f32_16x16x32_bf16 v[8:11], v[88:91], a[128:131], v[8:11]
    v_mfma_f32_16x16x32_bf16 v[12:15], v[92:95], a[128:131], v[12:15]
    v_mfma_f32_16x16x32_bf16 v[8:11], v[88:91], a[132:135], v[8:11]
    v_mfma_f32_16x16x32_bf16 v[12:15], v[92:95], a[132:135], v[12:15]
    v_mfma_f32_16x16x32_bf16 v[8:11], v[88:91], a[136:139], v[8:11]
    v_mfma_f32_16x16x32_bf16 v[12:15], v[92:95], a[136:139], v[12:15]
    v_mfma_f32_16x16x32_bf16 v[8:11], v[88:91], a[140:143], v[8:11]
    v_mfma_f32_16x16x32_bf16 v[12:15], v[92:95], a[140:143], v[12:15]
    s_nop 7
    v_cvt_pk_bf16_f32 v16, v8, v9
    v_cvt_pk_bf16_f32 v17, v10, v11
    v_cvt_pk_bf16_f32 v18, v12, v13
    v_cvt_pk_bf16_f32 v19, v14, v15
    s_waitcnt lgkmcnt(0)
    v_lshlrev_b32 v44, 16, v16
    v_and_b32 v45, 0xffff0000, v16
    v_lshlrev_b32 v46, 16, v17
    v_and_b32 v47, 0xffff0000, v17
    v_lshlrev_b32 v48, 16, v18
    v_and_b32 v49, 0xffff0000, v18
    v_lshlrev_b32 v50, 16, v19
    v_and_b32 v51, 0xffff0000, v19
    v_lshlrev_b32 v52, 16, v248
    v_and_b32 v53, 0xffff0000, v248
    v_lshlrev_b32 v54, 16, v249
    v_and_b32 v55, 0xffff0000, v249
    v_lshlrev_b32 v56, 16, v250
    v_and_b32 v57, 0xffff0000, v250
    v_lshlrev_b32 v58, 16, v251
    v_and_b32 v59, 0xffff0000, v251
    v_pk_add_f32 v[44:45], v[44:45], v[52:53]
    v_pk_add_f32 v[46:47], v[46:47], v[54:55]
    v_pk_add_f32 v[48:49], v[48:49], v[56:57]
    v_pk_add_f32 v[50:51], v[50:51], v[58:59]
    v_cvt_pk_bf16_f32 v16, v44, v45
    v_cvt_pk_bf16_f32 v17, v46, v47
    v_cvt_pk_bf16_f32 v18, v48, v49
    v_cvt_pk_bf16_f32 v19, v50, v51
    v_lshlrev_b32 v44, 16, v16
    v_and_b32 v45, 0xffff0000, v16
    v_lshlrev_b32 v46, 16, v17
    v_and_b32 v47, 0xffff0000, v17
    v_lshlrev_b32 v48, 16, v18
    v_and_b32 v49, 0xffff0000, v18
    v_lshlrev_b32 v50, 16, v19
    v_and_b32 v51, 0xffff0000, v19
    v_mul_f32 v52, 0xbfb8aa3b, v44
    v_mul_f32 v53, 0xbfb8aa3b, v45
    v_mul_f32 v54, 0xbfb8aa3b, v46
    v_mul_f32 v55, 0xbfb8aa3b, v47
    v_mul_f32 v56, 0xbfb8aa3b, v48
    v_mul_f32 v57, 0xbfb8aa3b, v49
    v_mul_f32 v58, 0xbfb8aa3b, v50
    v_mul_f32 v59, 0xbfb8aa3b, v51
    v_exp_f32 v52, v52
    v_exp_f32 v53, v53
    v_exp_f32 v54, v54
    v_exp_f32 v55, v55
    v_exp_f32 v56, v56
    v_exp_f32 v57, v57
    v_exp_f32 v58, v58
    v_exp_f32 v59, v59
    v_add_f32 v52, 1.0, v52
    v_add_f32 v53, 1.0, v53
    v_add_f32 v54, 1.0, v54
    v_add_f32 v55, 1.0, v55
    v_add_f32 v56, 1.0, v56
    v_add_f32 v57, 1.0, v57
    v_add_f32 v58, 1.0, v58
    v_add_f32 v59, 1.0, v59
    v_rcp_f32 v52, v52
    v_rcp_f32 v53, v53
    v_rcp_f32 v54, v54
    v_rcp_f32 v55, v55
    v_rcp_f32 v56, v56
    v_rcp_f32 v57, v57
    v_rcp_f32 v58, v58
    v_rcp_f32 v59, v59
    s_nop 0
    v_pk_mul_f32 v[44:45], v[44:45], v[52:53]
    v_pk_mul_f32 v[46:47], v[46:47], v[54:55]
    v_pk_mul_f32 v[48:49], v[48:49], v[56:57]
    v_pk_mul_f32 v[50:51], v[50:51], v[58:59]
    v_cvt_pk_bf16_f32 v16, v44, v45
    v_cvt_pk_bf16_f32 v17, v46, v47
    v_cvt_pk_bf16_f32 v18, v48, v49
    v_cvt_pk_bf16_f32 v19, v50, v51
    v_lshlrev_b32 v44, 16, v16
    v_and_b32 v45, 0xffff0000, v16
    v_lshlrev_b32 v46, 16, v17
    v_and_b32 v47, 0xffff0000, v17
    v_lshlrev_b32 v48, 16, v18
    v_and_b32 v49, 0xffff0000, v18
    v_lshlrev_b32 v50, 16, v19
    v_and_b32 v51, 0xffff0000, v19
    v_lshlrev_b32 v52, 16, v20
    v_and_b32 v53, 0xffff0000, v20
    v_lshlrev_b32 v54, 16, v21
    v_and_b32 v55, 0xffff0000, v21
    v_lshlrev_b32 v56, 16, v22
    v_and_b32 v57, 0xffff0000, v22
    v_lshlrev_b32 v58, 16, v23
    v_and_b32 v59, 0xffff0000, v23
    v_pk_mul_f32 v[44:45], v[44:45], v[52:53]
    v_pk_mul_f32 v[46:47], v[46:47], v[54:55]
    v_pk_mul_f32 v[48:49], v[48:49], v[56:57]
    v_pk_mul_f32 v[50:51], v[50:51], v[58:59]
    v_cvt_pk_bf16_f32 v16, v44, v45
    v_cvt_pk_bf16_f32 v17, v46, v47
    v_cvt_pk_bf16_f32 v18, v48, v49
    v_cvt_pk_bf16_f32 v19, v50, v51
    v_lshlrev_b32 v44, 16, v16
    v_and_b32 v45, 0xffff0000, v16
    v_lshlrev_b32 v46, 16, v17
    v_and_b32 v47, 0xffff0000, v17
    v_lshlrev_b32 v48, 16, v18
    v_and_b32 v49, 0xffff0000, v18
    v_lshlrev_b32 v50, 16, v19
    v_and_b32 v51, 0xffff0000, v19
    v_lshlrev_b32 v52, 16, v84
    v_and_b32 v53, 0xffff0000, v84
    v_lshlrev_b32 v54, 16, v85
    v_and_b32 v55, 0xffff0000, v85
    v_lshlrev_b32 v56, 16, v86
    v_and_b32 v57, 0xffff0000, v86
    v_lshlrev_b32 v58, 16, v87
    v_and_b32 v59, 0xffff0000, v87
    v_pk_add_f32 v[44:45], v[44:45], v[52:53]
    v_pk_add_f32 v[46:47], v[46:47], v[54:55]
    v_pk_add_f32 v[48:49], v[48:49], v[56:57]
    v_pk_add_f32 v[50:51], v[50:51], v[58:59]
    v_cvt_pk_bf16_f32 v24, v44, v45
    v_cvt_pk_bf16_f32 v25, v46, v47
    v_cvt_pk_bf16_f32 v26, v48, v49
    v_cvt_pk_bf16_f32 v27, v50, v51
    buffer_store_dwordx4 v[24:27], v36, s[28:31], 0 offen offset:640
    s_waitcnt vmcnt(0)
    L_main_done:
    s_endpgm

L_code_end:
.section .rodata,"a"
.p2align 6
.amdhsa_kernel recurrent_scan__ssm_conv_s4d__mixer_channel_mlp__prompt_kernel
  .amdhsa_next_free_vgpr 512
  .amdhsa_next_free_sgpr 102
  .amdhsa_accum_offset 256
  .amdhsa_group_segment_fixed_size 0
  .amdhsa_kernarg_size 120
  .amdhsa_user_sgpr_count 2
  .amdhsa_user_sgpr_kernarg_segment_ptr 1
  .amdhsa_system_sgpr_workgroup_id_x 1
  .amdhsa_float_denorm_mode_32 3
.end_amdhsa_kernel
```
